```python
import torch

def _softmax(x, axis=-1):
    return torch.softmax(x, dim=axis)
def _gelu(x):
    return torch.nn.functional.gelu(x, approximate="tanh")
def _silu(x):
    return torch.nn.functional.silu(x)
def _sigmoid(x):
    return torch.sigmoid(x)
def _layernorm(x, axis=-1, eps=1e-5):
    m = x.mean(dim=axis, keepdim=True)
    v = x.var(dim=axis, keepdim=True, unbiased=False)
    return (x - m) / torch.sqrt(v + eps)
def _scatter_add(tgt, idx, src, axis=0):
    return tgt.clone().index_add_(axis, idx, src)
def _segment_sum(src, seg, n):
    out = torch.zeros((n,) + src.shape[1:], dtype=src.dtype)
    return out.index_add_(0, seg, src)
def _pad(x, pw):
    flat = tuple(v for pair in reversed(pw) for v in pair)
    return torch.nn.functional.pad(x, flat)

kernel_name = 'recurrent_scan__mha_block_cached__glu_gated_swiglu__prompt'

def setup_inputs():

    _w = (lambda a: (lambda t: t.to(torch.bfloat16) if t.is_floating_point() else t)(torch.as_tensor(a)))
    def _A_setup():
        B, Sq, D = 1, 2048, 512
        H, Sk, Dh = 32, 2048, 128
        return {
            "x": _w((lambda *s: torch.randn(*s, dtype=torch.bfloat16) * 0.05)(B, Sq, D)),
            "k_cache": _w((lambda *s: torch.randn(*s, dtype=torch.bfloat16) * 1.6)(B, H, Sk, Dh)),
            "v_cache": _w((lambda *s: torch.randn(*s, dtype=torch.bfloat16) * 1.6)(B, H, Sk, Dh)),
            "wq": _w((lambda *s: torch.randn(*s, dtype=torch.bfloat16) * 1.6)(D, H * Dh) * (D ** -0.5)),
            "wo": _w((lambda *s: torch.randn(*s, dtype=torch.bfloat16) * 1.6)(H * Dh, D) * ((H * Dh) ** -0.5)),
        }
    _A_in = _A_setup()

    def _B_setup():
        B, S, D, F = 1, 2048, 512, 1792
        return {
            "x": _w((lambda *s: torch.randn(*s, dtype=torch.bfloat16) * 0.05)(B, S, D)),
            "w1": _w((lambda *s: torch.randn(*s, dtype=torch.bfloat16) * 0.2)(D, F) * (2.0 / D) ** 0.5),
            "w3": _w((lambda *s: torch.randn(*s, dtype=torch.bfloat16) * 0.2)(D, F) * (2.0 / D) ** 0.5),
            "w2": _w((lambda *s: torch.randn(*s, dtype=torch.bfloat16) * 0.2)(F, D) * (2.0 / F) ** 0.5),
        }
    _B_in = _B_setup()

    return {
        "A_x": _A_in["x"],
        "A_k_cache": _A_in["k_cache"],
        "A_v_cache": _A_in["v_cache"],
        "A_wq": _A_in["wq"],
        "A_wo": _A_in["wo"],
        "B_x": _B_in["x"],
        "B_w1": _B_in["w1"],
        "B_w3": _B_in["w3"],
        "B_w2": _B_in["w2"],
    }

def reference(A_x, A_k_cache, A_v_cache, A_wq, A_wo, B_x, B_w1, B_w3, B_w2):
    def _A_ref(x, k_cache, v_cache, wq, wo):
        B, Sq, D = x.shape
        H, Dh = 32, 128
        q = (lambda x, *d: x.permute(*d))((x @ wq).reshape(B, Sq, H, Dh), 0, 2, 1, 3)
        scores = torch.einsum("bhqd,bhkd->bhqk", q, k_cache) * (Dh ** -0.5)
        p = _softmax(scores, axis=-1)
        o = torch.einsum("bhqk,bhkd->bhqd", p, v_cache)
        return (lambda x, *d: x.permute(*d))(o, 0, 2, 1, 3).reshape(B, Sq, H * Dh) @ wo

    def _B_ref(x, w1, w3, w2):
        gate = torch.einsum("bsd,df->bsf", x, w1)
        up = torch.einsum("bsd,df->bsf", x, w3)
        h = _silu(gate) * up
        out = torch.einsum("bsf,fd->bsd", h, w2)
        return out

    x = A_x
    xn = _layernorm(x, axis=-1)
    s = _A_ref(xn, A_k_cache, A_v_cache, A_wq, A_wo)
    g = _silu(_B_ref(xn, B_w1, B_w3, B_w2))
    return x + s * g
```

```asm
; @launch grid=(256,1,1) block=(256,1,1) lds=163840
.amdgcn_target "amdgcn-amd-amdhsa--gfx950"
.text
.globl recurrent_scan__mha_block_cached__glu_gated_swiglu__prompt_kernel
.p2align 8
.type recurrent_scan__mha_block_cached__glu_gated_swiglu__prompt_kernel,@function
recurrent_scan__mha_block_cached__glu_gated_swiglu__prompt_kernel:
    s_cmp_ge_u32 s2, 256
    s_cbranch_scc1 L_end
    s_mov_b32 s70, 0
L_restart:
    s_load_dwordx2 s[4:5], s[0:1], 0
    s_load_dwordx2 s[12:13], s[0:1], 48
    s_load_dwordx2 s[16:17], s[0:1], 56
    s_load_dwordx2 s[8:9], s[0:1], 24
    s_getpc_b64 s[100:101]
L_pc:
    s_lshr_b32 s65, s2, 3
    s_mul_i32 s66, s65, 2560
    v_mul_u32_u24 v108, 10, v0
    v_add_u32 v108, s66, v108
    v_and_b32 v108, 0xffffff80, v108
    v_min_u32 v108, L_code_end-L_pc, v108
    v_mov_b32 v109, s101
    v_add_co_u32 v108, vcc, s100, v108
    v_lshrrev_b32 v56, 6, v0
    v_and_b32 v62, 15, v0
    v_addc_co_u32 v109, vcc, 0, v109, vcc
    global_load_dword v107, v[108:109], off
    v_readfirstlane_b32 s58, v56
    v_bfe_u32 v63, v0, 4, 2
    s_and_b32 s65, s65, 3
    s_lshr_b32 s57, s2, 5
    s_lshl_b32 s71, s58, 14
    s_lshl_b32 s61, s57, 18
    s_lshl_b32 s66, s58, 16
    s_add_u32 s61, s61, s66
    s_lshl_b32 s100, s65, 12
    s_add_u32 s100, s100, s71
    s_lshl_b32 s101, s65, 14
    s_add_u32 s101, s101, s61
    s_and_b32 s56, s2, 7
    s_lshl_b32 s56, s56, 2
    s_add_u32 s56, s56, s65
    v_xor_b32 v56, v63, v62
    v_lshlrev_b32 v56, 4, v56
    v_lshl_add_u32 v44, v63, 10, v56
    v_xor_b32 v58, 64, v44
    v_add_u32 v45, 3072, v58
    v_xor_b32 v58, 128, v44
    v_add_u32 v46, 6144, v58
    v_xor_b32 v58, 192, v44
    v_add_u32 v47, 9216, v58
    s_mov_b32 s6, 0x200000
    s_mov_b32 s7, 0x20000
    s_waitcnt lgkmcnt(0)
    s_and_b32 s5, s5, 0xffff
    s_xor_b32 m0, s100, 0
    s_xor_b32 s65, s101, 0
    buffer_load_dwordx4 v44, s[4:7], s65 offen offset:0 lds
    buffer_load_dwordx4 v45, s[4:7], s65 offen offset:1024 lds
    buffer_load_dwordx4 v46, s[4:7], s65 offen offset:2048 lds
    buffer_load_dwordx4 v47, s[4:7], s65 offen offset:3072 lds
    s_load_dwordx2 s[20:21], s[0:1], 8
    s_load_dwordx2 s[24:25], s[0:1], 16
    s_load_dwordx2 s[28:29], s[0:1], 88
    s_load_dwordx2 s[32:33], s[0:1], 88
    s_load_dwordx2 s[36:37], s[0:1], 88
    s_load_dwordx2 s[40:41], s[0:1], 80
    s_load_dwordx2 s[44:45], s[0:1], 32
    s_load_dwordx2 s[48:49], s[0:1], 64
    s_load_dwordx2 s[52:53], s[0:1], 72
    s_and_b32 s66, s56, 3
    s_lshr_b32 s3, s66, 1
    s_add_u32 s65, s3, 8
    s_mul_i32 s3, s3, 3
    s_add_u32 s3, s3, 8
    s_lshl_b32 s92, s66, 1
    s_bitcmp1_b32 s2, 0
    s_cselect_b32 s65, s65, s66
    s_cselect_b32 s92, s3, s92
    s_add_u32 s65, s65, s66
    s_lshr_b32 s3, s56, 3
    s_mul_i32 s3, s3, 14
    s_add_u32 s65, s65, s3
    s_lshl_b32 s65, s65, 6
    s_add_u32 s12, s12, s65
    s_addc_u32 s13, s13, 0
    s_add_u32 s16, s16, s65
    s_addc_u32 s17, s17, 0
    s_sub_u32 s66, 1835008, s65
    s_add_u32 s92, s92, s3
    s_add_u32 s92, s92, 128
    s_lshl_b32 s92, s92, 10
    s_and_b32 s13, s13, 0xffff
    s_mov_b32 s14, s66
    s_mov_b32 s15, 0x20000
    s_and_b32 s17, s17, 0xffff
    s_mov_b32 s18, s66
    s_mov_b32 s19, 0x20000
    s_lshr_b32 s69, s61, 14
    v_and_b32 v61, 63, v0
    v_lshrrev_b32 v56, 2, v61
    v_and_b32 v57, 3, v0
    v_lshl_add_u32 v57, v56, 7, v57
    v_add_u32 v57, s69, v57
    v_mul_u32_u24 v101, 3584, v57
    v_lshl_add_u32 v103, v56, 26, v101
    buffer_load_dword v105, v103, s[12:15], 0 offen
    buffer_load_dword v106, v103, s[16:19], 0 offen
    s_lshl_b32 s64, s57, 7
    s_lshl_b32 s66, s56, 2
    s_add_u32 s64, s64, s66
    s_add_u32 s64, s64, s58
    v_lshlrev_b32 v1, 4, v61
    s_xor_b32 m0, s100, 4096
    s_xor_b32 s65, s101, 16384
    buffer_load_dwordx4 v44, s[4:7], s65 offen offset:0 lds
    buffer_load_dwordx4 v45, s[4:7], s65 offen offset:1024 lds
    buffer_load_dwordx4 v46, s[4:7], s65 offen offset:2048 lds
    buffer_load_dwordx4 v47, s[4:7], s65 offen offset:3072 lds
    s_lshl_b32 s65, s56, 8
    s_add_u32 s8, s8, s65
    s_addc_u32 s9, s9, 0
    s_sub_u32 s66, 0x400000, s65
    s_and_b32 s9, s9, 0xffff
    s_mov_b32 s10, s66
    s_mov_b32 s11, 0x20000
    v_lshrrev_b32 v56, 3, v61
    v_bfe_u32 v57, v0, 1, 2
    v_lshl_add_u32 v57, v56, 7, v57
    v_add_u32 v57, s69, v57
    v_and_b32 v58, 1, v0
    v_lshlrev_b32 v58, 7, v58
    v_lshl_add_u32 v100, v57, 13, v58
    v_lshl_add_u32 v102, v56, 26, v100
    s_bfe_u32 s95, s2, 0x20001
    s_lshr_b32 s94, s2, 6
    s_bfe_u32 s93, s2, 0x30003
    s_and_b32 s65, s2, 1
    s_lshl_b32 s65, s65, 3
    s_add_u32 s93, s93, s65
    s_lshl_b32 s59, s58, 13
    s_lshl_b32 s60, s58, 12
    s_mul_i32 s69, s69, 188416
    s_lshl_b32 s67, s58, 18
    s_mul_i32 s68, s58, 114688
    s_mov_b32 s62, s59
    s_mov_b32 s63, s59
    v_mul_u32_u24 v56, 3584, v56
    v_and_b32 v57, 7, v0
    v_and_b32 v58, 1, v63
    v_lshlrev_b32 v58, 1, v58
    v_xor_b32 v57, v57, v58
    v_xor_b32 v58, 0, v57
    v_lshl_add_u32 v58, v58, 4, v56
    v_add_u32 v36, 0, v58
    v_xor_b32 v58, 4, v57
    v_lshl_add_u32 v58, v58, 4, v56
    v_add_u32 v37, 27648, v58
    v_xor_b32 v58, 0, v57
    v_lshl_add_u32 v58, v58, 4, v56
    v_add_u32 v38, 55296, v58
    v_xor_b32 v58, 4, v57
    v_lshl_add_u32 v58, v58, 4, v56
    v_add_u32 v39, 82944, v58
    v_lshlrev_b32 v56, 2, v63
    v_xor_b32 v56, v62, v56
    v_lshlrev_b32 v56, 4, v56
    v_lshl_add_u32 v32, v63, 13, v56
    v_add_u32 v33, 31744, v32
    v_add_u32 v34, 63488, v32
    v_add_u32 v35, 95232, v32
    s_waitcnt lgkmcnt(0)
    s_lshl_b32 s65, s56, 19
    s_add_u32 s20, s20, s65
    s_addc_u32 s21, s21, 0
    s_add_u32 s24, s24, s65
    s_addc_u32 s25, s25, 0
    s_and_b32 s21, s21, 0xffff
    s_mov_b32 s22, 524288
    s_mov_b32 s23, 0x20000
    s_and_b32 s25, s25, 0xffff
    s_mov_b32 s26, 524288
    s_mov_b32 s27, 0x20000
    s_add_u32 s28, s28, 2097152
    s_addc_u32 s29, s29, 0
    s_add_u32 s32, s32, 2097152
    s_addc_u32 s33, s33, 0
    s_and_b32 s29, s29, 0xffff
    s_mov_b32 s30, 24117248
    s_mov_b32 s31, 0x20000
    s_and_b32 s33, s33, 0xffff
    s_mov_b32 s34, 0
    s_mov_b32 s35, 0x20000
    s_and_b32 s37, s37, 0xffff
    s_mov_b32 s38, 163840
    s_mov_b32 s39, 0x20000
    s_and_b32 s41, s41, 0xffff
    s_mov_b32 s42, 256
    s_mov_b32 s43, 0x20000
    s_and_b32 s53, s53, 0xffff
    s_mov_b32 s55, 0x20000
    s_and_b32 s45, s45, 0xffff
    s_mov_b32 s46, 4194304
    s_mov_b32 s47, 0x20000
    s_and_b32 s49, s49, 0xffff
    s_mov_b32 s50, 1835008
    s_mov_b32 s51, 0x20000
    v_bfe_u32 v22, v0, 2, 2
    v_and_b32 v23, 3, v0
    v_lshl_add_u32 v56, v63, 3, v22
    v_lshlrev_b32 v57, 8, v56
    v_lshl_add_u32 v57, v23, 4, v57
    s_xor_b32 m0, s100, 8192
    s_xor_b32 s54, s101, 32768
    buffer_load_dwordx4 v44, s[4:7], s54 offen offset:0 lds
    v_add_u32 v57, 65536, v57
    v_xor_b32 v59, s58, v22
    v_xor_b32 v58, 0, v59
    v_lshl_add_u32 v24, v58, 6, v57
    v_xor_b32 v58, 1, v59
    v_lshl_add_u32 v25, v58, 6, v57
    v_xor_b32 v58, 2, v59
    v_lshl_add_u32 v26, v58, 6, v57
    v_xor_b32 v58, 3, v59
    v_lshl_add_u32 v27, v58, 6, v57
    v_lshlrev_b32 v57, 7, v56
    buffer_load_dwordx4 v45, s[4:7], s54 offen offset:1024 lds
    v_lshl_add_u32 v57, v23, 3, v57
    v_add_u32 v57, 98304, v57
    v_and_b32 v59, 1, v63
    v_lshlrev_b32 v59, 1, v59
    v_lshrrev_b32 v60, 1, v22
    v_or_b32 v59, v59, v60
    s_and_b32 s3, s56, 1
    s_sub_u32 s66, 2, s3
    s_lshl_b32 s3, s3, 1
    s_and_b32 s65, s58, 1
    s_or_b32 s65, s65, s3
    buffer_load_dwordx4 v46, s[4:7], s54 offen offset:2048 lds
    s_xor_b32 s3, s58, 2
    s_bitcmp1_b32 s2, 0
    s_cselect_b32 s65, s65, s58
    s_cselect_b32 s66, s66, s3
    v_xor_b32 v58, s65, v59
    v_lshl_add_u32 v28, v58, 5, v57
    v_xor_b32 v29, 32, v28
    v_xor_b32 v58, s66, v59
    v_lshl_add_u32 v30, v58, 5, v57
    v_xor_b32 v31, 32, v30
    v_mov_b32 v176, 0
    buffer_load_dwordx4 v47, s[4:7], s54 offen offset:3072 lds
    v_mov_b32 v177, 0
    v_mov_b32 v178, 0
    v_mov_b32 v179, 0
    v_mov_b32 v180, 0
    v_mov_b32 v181, 0
    v_mov_b32 v182, 0
    v_mov_b32 v183, 0
    v_accvgpr_write_b32 a244, -1
    v_accvgpr_write_b32 a245, -1
    v_accvgpr_write_b32 a246, -1
    v_accvgpr_write_b32 a247, -1
    s_xor_b32 m0, s100, 12288
    s_xor_b32 s54, s101, 49152
    buffer_load_dwordx4 v44, s[4:7], s54 offen offset:0 lds
    v_xor_b32 v56, v63, v62
    v_lshlrev_b32 v57, 8, v62
    v_add_u32 v59, s71, v57
    s_lshl_b32 s65, s58, 2
    v_xor_b32 v58, 0, v56
    v_lshl_add_u32 v40, v58, 4, v59
    v_xor_b32 v58, s65, v58
    v_lshl_add_u32 v2, v58, 4, v57
    v_xor_b32 v58, 4, v56
    v_lshl_add_u32 v41, v58, 4, v59
    v_xor_b32 v58, s65, v58
    buffer_load_dwordx4 v45, s[4:7], s54 offen offset:1024 lds
    v_lshl_add_u32 v3, v58, 4, v57
    v_xor_b32 v58, 8, v56
    v_lshl_add_u32 v42, v58, 4, v59
    v_xor_b32 v58, s65, v58
    v_lshl_add_u32 v4, v58, 4, v57
    v_xor_b32 v58, 12, v56
    v_lshl_add_u32 v43, v58, 4, v59
    v_xor_b32 v58, s65, v58
    v_lshl_add_u32 v5, v58, 4, v57
    v_lshl_add_u32 v56, v63, 2, v22
    v_lshlrev_b32 v57, 8, v56
    buffer_load_dwordx4 v46, s[4:7], s54 offen offset:2048 lds
    v_lshl_add_u32 v57, v23, 3, v57
    v_add_u32 v57, 98304, v57
    v_and_b32 v56, 7, v56
    v_xor_b32 v58, 0, v56
    v_lshl_add_u32 v6, v58, 5, v57
    v_xor_b32 v58, 1, v56
    v_lshl_add_u32 v7, v58, 5, v57
    v_xor_b32 v58, 2, v56
    v_lshl_add_u32 v8, v58, 5, v57
    v_xor_b32 v58, 3, v56
    v_lshl_add_u32 v9, v58, 5, v57
    buffer_load_dwordx4 v47, s[4:7], s54 offen offset:3072 lds
    v_xor_b32 v58, 4, v56
    v_lshl_add_u32 v10, v58, 5, v57
    v_xor_b32 v58, 5, v56
    v_lshl_add_u32 v11, v58, 5, v57
    v_xor_b32 v58, 6, v56
    v_lshl_add_u32 v12, v58, 5, v57
    v_xor_b32 v58, 7, v56
    v_lshl_add_u32 v13, v58, 5, v57
    v_lshlrev_b32 v57, 8, v63
    v_xor_b32 v56, v63, v62
    v_xor_b32 v58, 0, v56
    s_add_u32 m0, s60, 131072
    s_add_u32 s54, s68, 0
    buffer_load_dwordx4 v36, s[12:15], s54 offen offset:0 lds
    v_lshl_add_u32 v14, v58, 4, v57
    v_xor_b32 v58, 4, v56
    v_lshl_add_u32 v15, v58, 4, v57
    v_xor_b32 v58, 8, v56
    v_lshl_add_u32 v16, v58, 4, v57
    v_xor_b32 v58, 12, v56
    v_lshl_add_u32 v17, v58, 4, v57
    v_lshlrev_b32 v56, 1, v63
    v_xor_b32 v56, v56, v62
    v_xor_b32 v58, 0, v56
    v_lshl_add_u32 v18, v58, 4, v57
    buffer_load_dwordx4 v37, s[12:15], s54 offen offset:1024 lds
    v_xor_b32 v58, 8, v56
    v_lshl_add_u32 v19, v58, 4, v57
    v_mov_b32 v56, 0x3f803f80
    v_accvgpr_write_b32 a208, v56
    v_accvgpr_write_b32 a209, v56
    v_accvgpr_write_b32 a210, v56
    v_accvgpr_write_b32 a211, v56
    s_lshl_b32 s65, s57, 5
    v_and_b32 v51, 7, v0
    v_lshlrev_b32 v51, 5, v51
    s_cmp_eq_u32 s70, 0
    buffer_load_dwordx4 v38, s[12:15], s54 offen offset:2048 lds
    s_cselect_b32 s65, s65, 2147483632
    v_mov_b32 v56, 2147483632
    v_mov_b32 v57, s65
    v_cmp_eq_u32 vcc, 0, v0
    v_mov_b32 v49, 1
    s_nop 0
    v_cndmask_b32 v48, v56, v57, vcc
    s_lshl_b32 s65, s57, 5
    s_add_u32 s65, s65, s56
    s_lshl_b32 s65, s65, 7
    s_add_u32 s65, s65, 32768
    s_cmp_eq_u32 s70, 0
    buffer_load_dwordx4 v39, s[12:15], s54 offen offset:3072 lds
    s_cselect_b32 s65, s65, 1073741816
    s_and_b32 s66, s56, 7
    s_mul_i32 s66, s66, 124
    s_sub_u32 s66, 32768, s66
    v_mov_b32 v58, s65
    v_mad_u32_u24 v57, v0, s66, v58
    v_cmp_gt_u32 vcc, 2, v0
    v_mov_b32 v55, 0
    s_nop 0
    v_cndmask_b32 v53, v56, v57, vcc
    s_lshr_b32 s65, s61, 7
    v_lshlrev_b32 v52, 3, v62
    s_add_u32 m0, s60, 147456
    s_add_u32 s54, s68, 0
    buffer_load_dwordx4 v36, s[16:19], s54 offen offset:0 lds
    v_add_u32 v52, s65, v52
    s_lshl_b32 s65, s58, 7
    v_lshlrev_b32 v54, 4, v63
    v_add_u32 v54, s65, v54
    v_add_u32 v54, 32768, v54
    s_add_u32 s65, s65, 32768
    v_lshl_add_u32 v21, v62, 2, s65
    v_accvgpr_write_b32 a248, 0
    v_accvgpr_write_b32 a249, 0
    v_accvgpr_write_b32 a250, 0
    v_accvgpr_write_b32 a251, 0
    buffer_load_dwordx4 v37, s[16:19], s54 offen offset:1024 lds
    v_and_b32 v20, 1, v0
    v_mul_u32_u24 v20, 0xaaaa, v20
    v_add_u32 v20, 0x4444, v20
    v_mfma_f32_32x32x16_bf16 a[192:207], a[248:251], a[248:251], 0
    s_lshl_b32 s66, s64, 4
    v_lshrrev_b32 v58, 5, v61
    v_lshl_add_u32 v57, v58, 3, s66
    v_lshl_add_u32 v58, v58, 9, v1
    v_and_b32 v59, 31, v0
    v_cmp_eq_u32 vcc, 0, v59
    s_nop 1
    v_cndmask_b32 v57, v56, v57, vcc
    buffer_load_dwordx4 v38, s[16:19], s54 offen offset:2048 lds
    v_mov_b32 v22, v102
    v_mov_b32 v23, v103
    v_accvgpr_write_b32 a254, v108
    v_accvgpr_write_b32 a255, v109
    v_mov_b32 v60, v108
    v_mov_b32 v61, v109
    buffer_load_dwordx4 v39, s[16:19], s54 offen offset:3072 lds
    s_mov_b32 s54, 2097152
    s_bitcmp1_b32 s2, 0
    s_cbranch_scc0 L_proj_join
    s_waitcnt vmcnt(8)
    ds_read_b128 a[0:3], v40 offset:0
    ds_read_b128 a[4:7], v41 offset:0
    ds_read_b128 a[8:11], v42 offset:0
    ds_read_b128 a[12:15], v43 offset:0
    ds_read_b128 a[16:19], v40 offset:4096
    ds_read_b128 a[20:23], v41 offset:4096
    ds_read_b128 a[24:27], v42 offset:4096
    ds_read_b128 a[28:31], v43 offset:4096
    ds_read_b128 a[32:35], v40 offset:8192
    ds_read_b128 a[36:39], v41 offset:8192
    ds_read_b128 a[40:43], v42 offset:8192
    ds_read_b128 a[44:47], v43 offset:8192
    ds_read_b128 a[48:51], v40 offset:12288
    ds_read_b128 a[52:55], v41 offset:12288
    ds_read_b128 a[56:59], v42 offset:12288
    ds_read_b128 a[60:63], v43 offset:12288
    buffer_load_dword a252, v22, s[8:11], 0 offen
    s_lshl_b32 s65, s64, 11
    buffer_load_dwordx4 v[72:75], v58, s[4:7], s65 offen offset:0
    buffer_load_dwordx4 v[76:79], v58, s[4:7], s65 offen offset:512
    buffer_store_dword v55, v53, s[36:39], 0 offen sc1
    s_waitcnt vmcnt(4)
    s_barrier
    ds_read_b64_tr_b16 a[212:213], v28 offset:32768
    ds_read_b64_tr_b16 a[214:215], v28 offset:33280
    ds_read_b64_tr_b16 a[216:217], v28 offset:36864
    ds_read_b64_tr_b16 a[218:219], v28 offset:37376
    ds_read_b64_tr_b16 a[220:221], v28 offset:40960
    ds_read_b64_tr_b16 a[222:223], v28 offset:41472
    ds_read_b64_tr_b16 a[224:225], v28 offset:45056
    ds_read_b64_tr_b16 a[226:227], v28 offset:45568
    s_waitcnt lgkmcnt(0)
    v_mfma_f32_16x16x32_bf16 v[128:131], a[212:215], a[0:3], 0
    ds_read_b64_tr_b16 a[228:229], v28 offset:49152
    v_mfma_f32_16x16x32_bf16 v[128:131], a[216:219], a[4:7], v[128:131]
    ds_read_b64_tr_b16 a[230:231], v28 offset:49664
    v_mfma_f32_16x16x32_bf16 v[128:131], a[220:223], a[8:11], v[128:131]
    ds_read_b64_tr_b16 a[232:233], v28 offset:53248
    v_mfma_f32_16x16x32_bf16 v[128:131], a[224:227], a[12:15], v[128:131]
    v_mfma_f32_16x16x32_bf16 v[132:135], a[224:227], a[28:31], 0
    ds_read_b64_tr_b16 a[234:235], v28 offset:53760
    v_mfma_f32_16x16x32_bf16 v[132:135], a[220:223], a[24:27], v[132:135]
    ds_read_b64_tr_b16 a[236:237], v28 offset:57344
    v_mfma_f32_16x16x32_bf16 v[132:135], a[216:219], a[20:23], v[132:135]
    ds_read_b64_tr_b16 a[238:239], v28 offset:57856
    v_mfma_f32_16x16x32_bf16 v[132:135], a[212:215], a[16:19], v[132:135]
    v_mfma_f32_16x16x32_bf16 v[136:139], a[212:215], a[32:35], 0
    s_add_u32 m0, s59, 65536
    ds_read_b64_tr_b16 a[240:241], v28 offset:61440
    v_mfma_f32_16x16x32_bf16 v[136:139], a[216:219], a[36:39], v[136:139]
    s_add_u32 s65, s67, 0
    ds_read_b64_tr_b16 a[242:243], v28 offset:61952
    v_mfma_f32_16x16x32_bf16 v[136:139], a[220:223], a[40:43], v[136:139]
    buffer_load_dwordx4 v32, s[8:11], s65 offen offset:0 lds
    v_mfma_f32_16x16x32_bf16 v[136:139], a[224:227], a[44:47], v[136:139]
    v_mfma_f32_16x16x32_bf16 v[140:143], a[224:227], a[60:63], 0
    v_mfma_f32_16x16x32_bf16 v[140:143], a[220:223], a[56:59], v[140:143]
    v_mfma_f32_16x16x32_bf16 v[140:143], a[216:219], a[52:55], v[140:143]
    buffer_load_dwordx4 v33, s[8:11], s65 offen offset:1024 lds
    v_mfma_f32_16x16x32_bf16 v[140:143], a[212:215], a[48:51], v[140:143]
    v_smfmac_f32_16x16x64_bf16 a[192:195], a[208:211], a[212:219], v20
    v_smfmac_f32_16x16x64_bf16 a[192:195], a[208:211], a[220:227], v20
    s_waitcnt lgkmcnt(0)
    v_mfma_f32_16x16x32_bf16 v[192:195], a[228:231], a[0:3], 0
    ds_read_b64_tr_b16 a[212:213], v30 offset:32768
    buffer_load_dwordx4 v34, s[8:11], s65 offen offset:2048 lds
    v_mfma_f32_16x16x32_bf16 v[192:195], a[232:235], a[4:7], v[192:195]
    ds_read_b64_tr_b16 a[214:215], v30 offset:33280
    v_mfma_f32_16x16x32_bf16 v[192:195], a[236:239], a[8:11], v[192:195]
    ds_read_b64_tr_b16 a[216:217], v30 offset:36864
    v_mfma_f32_16x16x32_bf16 v[192:195], a[240:243], a[12:15], v[192:195]
    v_mfma_f32_16x16x32_bf16 v[196:199], a[240:243], a[28:31], 0
    ds_read_b64_tr_b16 a[218:219], v30 offset:37376
    v_mfma_f32_16x16x32_bf16 v[196:199], a[236:239], a[24:27], v[196:199]
    ds_read_b64_tr_b16 a[220:221], v30 offset:40960
    v_mfma_f32_16x16x32_bf16 v[196:199], a[232:235], a[20:23], v[196:199]
    ds_read_b64_tr_b16 a[222:223], v30 offset:41472
    v_mfma_f32_16x16x32_bf16 v[196:199], a[228:231], a[16:19], v[196:199]
    buffer_load_dwordx4 v35, s[8:11], s65 offen offset:3072 lds
    v_mfma_f32_16x16x32_bf16 v[200:203], a[228:231], a[32:35], 0
    s_add_u32 m0, s59, 69632
    ds_read_b64_tr_b16 a[224:225], v30 offset:45056
    v_mfma_f32_16x16x32_bf16 v[200:203], a[232:235], a[36:39], v[200:203]
    s_add_u32 s65, s67, 131072
    ds_read_b64_tr_b16 a[226:227], v30 offset:45568
    v_mfma_f32_16x16x32_bf16 v[200:203], a[236:239], a[40:43], v[200:203]
    buffer_load_dwordx4 v32, s[8:11], s65 offen offset:0 lds
    v_mfma_f32_16x16x32_bf16 v[200:203], a[240:243], a[44:47], v[200:203]
    v_mfma_f32_16x16x32_bf16 v[204:207], a[240:243], a[60:63], 0
    v_mfma_f32_16x16x32_bf16 v[204:207], a[236:239], a[56:59], v[204:207]
    buffer_load_dwordx4 v33, s[8:11], s65 offen offset:1024 lds
    v_mfma_f32_16x16x32_bf16 v[204:207], a[232:235], a[52:55], v[204:207]
    v_mfma_f32_16x16x32_bf16 v[204:207], a[228:231], a[48:51], v[204:207]
    v_smfmac_f32_16x16x64_bf16 a[196:199], a[208:211], a[228:235], v20
    v_smfmac_f32_16x16x64_bf16 a[196:199], a[208:211], a[236:243], v20
    s_waitcnt lgkmcnt(0)
    v_mfma_f32_16x16x32_bf16 v[160:163], a[212:215], a[0:3], 0
    ds_read_b64_tr_b16 a[228:229], v30 offset:49152
    buffer_load_dwordx4 v34, s[8:11], s65 offen offset:2048 lds
    v_mfma_f32_16x16x32_bf16 v[160:163], a[216:219], a[4:7], v[160:163]
    ds_read_b64_tr_b16 a[230:231], v30 offset:49664
    v_mfma_f32_16x16x32_bf16 v[160:163], a[220:223], a[8:11], v[160:163]
    ds_read_b64_tr_b16 a[232:233], v30 offset:53248
    v_mfma_f32_16x16x32_bf16 v[160:163], a[224:227], a[12:15], v[160:163]
    buffer_load_dwordx4 v35, s[8:11], s65 offen offset:3072 lds
    v_mfma_f32_16x16x32_bf16 v[164:167], a[224:227], a[28:31], 0
    ds_read_b64_tr_b16 a[234:235], v30 offset:53760
    v_mfma_f32_16x16x32_bf16 v[164:167], a[220:223], a[24:27], v[164:167]
    ds_read_b64_tr_b16 a[236:237], v30 offset:57344
    v_mfma_f32_16x16x32_bf16 v[164:167], a[216:219], a[20:23], v[164:167]
    s_xor_b32 m0, s100, 0
    ds_read_b64_tr_b16 a[238:239], v30 offset:57856
    v_mfma_f32_16x16x32_bf16 v[164:167], a[212:215], a[16:19], v[164:167]
    s_xor_b32 s65, s101, 256
    v_mfma_f32_16x16x32_bf16 v[168:171], a[212:215], a[32:35], 0
    ds_read_b64_tr_b16 a[240:241], v30 offset:61440
    v_mfma_f32_16x16x32_bf16 v[168:171], a[216:219], a[36:39], v[168:171]
    ds_read_b64_tr_b16 a[242:243], v30 offset:61952
    v_mfma_f32_16x16x32_bf16 v[168:171], a[220:223], a[40:43], v[168:171]
    buffer_load_dwordx4 v44, s[4:7], s65 offen offset:0 lds
    v_mfma_f32_16x16x32_bf16 v[168:171], a[224:227], a[44:47], v[168:171]
    v_mfma_f32_16x16x32_bf16 v[172:175], a[224:227], a[60:63], 0
    v_mfma_f32_16x16x32_bf16 v[172:175], a[220:223], a[56:59], v[172:175]
    buffer_load_dwordx4 v45, s[4:7], s65 offen offset:1024 lds
    v_mfma_f32_16x16x32_bf16 v[172:175], a[216:219], a[52:55], v[172:175]
    v_mfma_f32_16x16x32_bf16 v[172:175], a[212:215], a[48:51], v[172:175]
    v_smfmac_f32_16x16x64_bf16 v[176:179], a[208:211], a[212:219], v20
    v_smfmac_f32_16x16x64_bf16 v[176:179], a[208:211], a[220:227], v20
    s_waitcnt lgkmcnt(0)
    buffer_load_dwordx4 v46, s[4:7], s65 offen offset:2048 lds
    v_mfma_f32_16x16x32_bf16 v[224:227], a[228:231], a[0:3], 0
    s_waitcnt vmcnt(12)
    ds_read_b64_tr_b16 a[212:213], v29 offset:32768
    v_lshlrev_b32 v88, 16, v72
    v_mfma_f32_16x16x32_bf16 v[224:227], a[232:235], a[4:7], v[224:227]
    ds_read_b64_tr_b16 a[214:215], v29 offset:33280
    v_and_b32 v89, 0xffff0000, v72
    v_mfma_f32_16x16x32_bf16 v[224:227], a[236:239], a[8:11], v[224:227]
    ds_read_b64_tr_b16 a[216:217], v29 offset:36864
    v_lshlrev_b32 v90, 16, v73
    v_mfma_f32_16x16x32_bf16 v[224:227], a[240:243], a[12:15], v[224:227]
    buffer_load_dwordx4 v47, s[4:7], s65 offen offset:3072 lds
    v_mfma_f32_16x16x32_bf16 v[228:231], a[240:243], a[28:31], 0
    ds_read_b64_tr_b16 a[218:219], v29 offset:37376
    v_and_b32 v91, 0xffff0000, v73
    v_mfma_f32_16x16x32_bf16 v[228:231], a[236:239], a[24:27], v[228:231]
    ds_read_b64_tr_b16 a[220:221], v29 offset:40960
    v_lshlrev_b32 v92, 16, v74
    v_mfma_f32_16x16x32_bf16 v[228:231], a[232:235], a[20:23], v[228:231]
    s_mov_b32 s65, 458752
    ds_read_b64_tr_b16 a[222:223], v29 offset:41472
    v_and_b32 v93, 0xffff0000, v74
    v_mfma_f32_16x16x32_bf16 v[228:231], a[228:231], a[16:19], v[228:231]
    buffer_load_dword a252, v23, s[12:15], s65 offen
    v_mfma_f32_16x16x32_bf16 v[232:235], a[228:231], a[32:35], 0
    ds_read_b64_tr_b16 a[224:225], v29 offset:45056
    v_lshlrev_b32 v94, 16, v75
    v_mfma_f32_16x16x32_bf16 v[232:235], a[232:235], a[36:39], v[232:235]
    ds_read_b64_tr_b16 a[226:227], v29 offset:45568
    v_and_b32 v95, 0xffff0000, v75
    v_mfma_f32_16x16x32_bf16 v[232:235], a[236:239], a[40:43], v[232:235]
    v_lshlrev_b32 v104, 16, v76
    v_and_b32 v105, 0xffff0000, v76
    v_mfma_f32_16x16x32_bf16 v[232:235], a[240:243], a[44:47], v[232:235]
    v_lshlrev_b32 v106, 16, v77
    v_and_b32 v107, 0xffff0000, v77
    v_mfma_f32_16x16x32_bf16 v[236:239], a[240:243], a[60:63], 0
    v_lshlrev_b32 v108, 16, v78
    v_and_b32 v109, 0xffff0000, v78
    v_mfma_f32_16x16x32_bf16 v[236:239], a[236:239], a[56:59], v[236:239]
    buffer_load_dword a252, v23, s[16:19], s65 offen
    v_mfma_f32_16x16x32_bf16 v[236:239], a[232:235], a[52:55], v[236:239]
    v_lshlrev_b32 v110, 16, v79
    v_and_b32 v111, 0xffff0000, v79
    v_mfma_f32_16x16x32_bf16 v[236:239], a[228:231], a[48:51], v[236:239]
    v_add_f32 v120, v89, v88
    v_add_f32 v121, v105, v104
    v_smfmac_f32_16x16x64_bf16 v[180:183], a[208:211], a[228:235], v20
    v_add_f32 v120, v90, v120
    v_smfmac_f32_16x16x64_bf16 v[180:183], a[208:211], a[236:243], v20
    s_waitcnt lgkmcnt(0)
    v_add_f32 v121, v106, v121
    v_mfma_f32_16x16x32_bf16 v[144:147], a[212:215], a[0:3], 0
    ds_read_b64_tr_b16 a[228:229], v29 offset:49152
    v_add_f32 v120, v91, v120
    v_mfma_f32_16x16x32_bf16 v[144:147], a[216:219], a[4:7], v[144:147]
    ds_read_b64_tr_b16 a[230:231], v29 offset:49664
    v_add_f32 v121, v107, v121
    v_mfma_f32_16x16x32_bf16 v[144:147], a[220:223], a[8:11], v[144:147]
    ds_read_b64_tr_b16 a[232:233], v29 offset:53248
    v_add_f32 v120, v92, v120
    v_mfma_f32_16x16x32_bf16 v[144:147], a[224:227], a[12:15], v[144:147]
    v_add_f32 v121, v108, v121
    v_add_f32 v120, v93, v120
    v_mfma_f32_16x16x32_bf16 v[148:151], a[224:227], a[28:31], 0
    s_xor_b32 m0, s100, 4096
    ds_read_b64_tr_b16 a[234:235], v29 offset:53760
    v_add_f32 v121, v109, v121
    v_mfma_f32_16x16x32_bf16 v[148:151], a[220:223], a[24:27], v[148:151]
    s_xor_b32 s65, s101, 16640
    ds_read_b64_tr_b16 a[236:237], v29 offset:57344
    v_add_f32 v120, v94, v120
    v_mfma_f32_16x16x32_bf16 v[148:151], a[216:219], a[20:23], v[148:151]
    ds_read_b64_tr_b16 a[238:239], v29 offset:57856
    v_add_f32 v121, v110, v121
    v_mfma_f32_16x16x32_bf16 v[148:151], a[212:215], a[16:19], v[148:151]
    buffer_load_dwordx4 v44, s[4:7], s65 offen offset:0 lds
    v_mfma_f32_16x16x32_bf16 v[152:155], a[212:215], a[32:35], 0
    ds_read_b64_tr_b16 a[240:241], v29 offset:61440
    v_add_f32 v120, v95, v120
    v_mfma_f32_16x16x32_bf16 v[152:155], a[216:219], a[36:39], v[152:155]
    ds_read_b64_tr_b16 a[242:243], v29 offset:61952
    v_add_f32 v121, v111, v121
    v_mfma_f32_16x16x32_bf16 v[152:155], a[220:223], a[40:43], v[152:155]
    buffer_load_dwordx4 v45, s[4:7], s65 offen offset:1024 lds
    v_mfma_f32_16x16x32_bf16 v[152:155], a[224:227], a[44:47], v[152:155]
    v_add_f32 v120, v120, v121
    v_mfma_f32_16x16x32_bf16 v[156:159], a[224:227], a[60:63], 0
    v_mfma_f32_16x16x32_bf16 v[156:159], a[220:223], a[56:59], v[156:159]
    v_add_f32_dpp v120, v120, v120 row_ror:8 row_mask:0xf bank_mask:0xf
    v_mfma_f32_16x16x32_bf16 v[156:159], a[216:219], a[52:55], v[156:159]
    buffer_load_dwordx4 v46, s[4:7], s65 offen offset:2048 lds
    v_mfma_f32_16x16x32_bf16 v[156:159], a[212:215], a[48:51], v[156:159]
    s_waitcnt lgkmcnt(0)
    v_add_f32_dpp v120, v120, v120 row_ror:4 row_mask:0xf bank_mask:0xf
    v_mfma_f32_16x16x32_bf16 v[208:211], a[228:231], a[0:3], 0
    s_waitcnt vmcnt(9)
    v_mfma_f32_16x16x32_bf16 v[208:211], a[232:235], a[4:7], v[208:211]
    s_barrier
    v_add_f32_dpp v120, v120, v120 row_ror:2 row_mask:0xf bank_mask:0xf
    v_mfma_f32_16x16x32_bf16 v[208:211], a[236:239], a[8:11], v[208:211]
    ds_read_b64_tr_b16 a[212:213], v24 offset:0
    v_mfma_f32_16x16x32_bf16 v[208:211], a[240:243], a[12:15], v[208:211]
    ds_read_b64_tr_b16 a[214:215], v24 offset:1024
    buffer_load_dwordx4 v47, s[4:7], s65 offen offset:3072 lds
    v_mfma_f32_16x16x32_bf16 v[212:215], a[240:243], a[28:31], 0
    s_xor_b32 m0, s100, 8192
    ds_read_b64_tr_b16 a[216:217], v24 offset:8192
    v_add_f32_dpp v120, v120, v120 row_ror:1 row_mask:0xf bank_mask:0xf
    v_mfma_f32_16x16x32_bf16 v[212:215], a[236:239], a[24:27], v[212:215]
    s_xor_b32 s65, s101, 33024
    ds_read_b64_tr_b16 a[218:219], v24 offset:9216
    v_mov_b32 v121, v120
    v_mfma_f32_16x16x32_bf16 v[212:215], a[232:235], a[20:23], v[212:215]
    ds_read_b64_tr_b16 a[220:221], v24 offset:16384
    v_mfma_f32_16x16x32_bf16 v[212:215], a[228:231], a[16:19], v[212:215]
    ds_read_b64_tr_b16 a[222:223], v24 offset:17408
    buffer_load_dwordx4 v44, s[4:7], s65 offen offset:0 lds
    v_mfma_f32_16x16x32_bf16 v[216:219], a[228:231], a[32:35], 0
    ds_read_b64_tr_b16 a[224:225], v24 offset:24576
    v_permlane16_swap_b32 v121, v120
    v_mfma_f32_16x16x32_bf16 v[216:219], a[232:235], a[36:39], v[216:219]
    ds_read_b64_tr_b16 a[226:227], v24 offset:25600
    v_add_f32 v120, v120, v121
    v_mfma_f32_16x16x32_bf16 v[216:219], a[236:239], a[40:43], v[216:219]
    v_mul_f32 v122, 0x3b000000, v120
    v_sub_f32 v88, v88, v122
    v_mfma_f32_16x16x32_bf16 v[216:219], a[240:243], a[44:47], v[216:219]
    v_sub_f32 v89, v89, v122
    v_sub_f32 v90, v90, v122
    v_mfma_f32_16x16x32_bf16 v[220:223], a[240:243], a[60:63], 0
    buffer_load_dwordx4 v45, s[4:7], s65 offen offset:1024 lds
    v_mfma_f32_16x16x32_bf16 v[220:223], a[236:239], a[56:59], v[220:223]
    v_sub_f32 v91, v91, v122
    v_sub_f32 v92, v92, v122
    v_mfma_f32_16x16x32_bf16 v[220:223], a[232:235], a[52:55], v[220:223]
    v_sub_f32 v93, v93, v122
    v_sub_f32 v94, v94, v122
    v_mfma_f32_16x16x32_bf16 v[220:223], a[228:231], a[48:51], v[220:223]
    s_waitcnt lgkmcnt(0)
    buffer_load_dwordx4 v46, s[4:7], s65 offen offset:2048 lds
    v_mfma_f32_16x16x32_bf16 v[64:67], a[212:215], a[0:3], 0
    ds_read_b64_tr_b16 a[228:229], v24 offset:8
    v_sub_f32 v95, v95, v122
    v_mfma_f32_16x16x32_bf16 v[64:67], a[216:219], a[4:7], v[64:67]
    ds_read_b64_tr_b16 a[230:231], v24 offset:1032
    v_sub_f32 v104, v104, v122
    v_mfma_f32_16x16x32_bf16 v[64:67], a[220:223], a[8:11], v[64:67]
    ds_read_b64_tr_b16 a[232:233], v24 offset:8200
    v_sub_f32 v105, v105, v122
    v_mfma_f32_16x16x32_bf16 v[64:67], a[224:227], a[12:15], v[64:67]
    buffer_load_dwordx4 v47, s[4:7], s65 offen offset:3072 lds
    v_mfma_f32_16x16x32_bf16 v[80:83], a[224:227], a[28:31], 0
    ds_read_b64_tr_b16 a[234:235], v24 offset:9224
    v_sub_f32 v106, v106, v122
    v_mfma_f32_16x16x32_bf16 v[80:83], a[220:223], a[24:27], v[80:83]
    ds_read_b64_tr_b16 a[236:237], v24 offset:16392
    v_sub_f32 v107, v107, v122
    v_mfma_f32_16x16x32_bf16 v[80:83], a[216:219], a[20:23], v[80:83]
    s_xor_b32 m0, s100, 12288
    ds_read_b64_tr_b16 a[238:239], v24 offset:17416
    v_sub_f32 v108, v108, v122
    v_mfma_f32_16x16x32_bf16 v[80:83], a[212:215], a[16:19], v[80:83]
    s_xor_b32 s65, s101, 49408
    v_sub_f32 v109, v109, v122
    v_sub_f32 v110, v110, v122
    v_mfma_f32_16x16x32_bf16 v[96:99], a[212:215], a[32:35], 0
    ds_read_b64_tr_b16 a[240:241], v24 offset:24584
    v_sub_f32 v111, v111, v122
    v_mfma_f32_16x16x32_bf16 v[96:99], a[216:219], a[36:39], v[96:99]
    ds_read_b64_tr_b16 a[242:243], v24 offset:25608
    v_mul_f32 v120, v88, v88
    v_mfma_f32_16x16x32_bf16 v[96:99], a[220:223], a[40:43], v[96:99]
    buffer_load_dwordx4 v44, s[4:7], s65 offen offset:0 lds
    v_mfma_f32_16x16x32_bf16 v[96:99], a[224:227], a[44:47], v[96:99]
    v_mul_f32 v121, v104, v104
    v_fmac_f32 v120, v89, v89
    v_mfma_f32_16x16x32_bf16 v[112:115], a[224:227], a[60:63], 0
    v_fmac_f32 v121, v105, v105
    v_fmac_f32 v120, v90, v90
    v_mfma_f32_16x16x32_bf16 v[112:115], a[220:223], a[56:59], v[112:115]
    buffer_load_dwordx4 v45, s[4:7], s65 offen offset:1024 lds
    v_mfma_f32_16x16x32_bf16 v[112:115], a[216:219], a[52:55], v[112:115]
    v_fmac_f32 v121, v106, v106
    v_fmac_f32 v120, v91, v91
    v_mfma_f32_16x16x32_bf16 v[112:115], a[212:215], a[48:51], v[112:115]
    v_fmac_f32 v121, v107, v107
    v_fmac_f32 v120, v92, v92
    v_smfmac_f32_16x16x64_bf16 a[200:203], a[208:211], a[212:219], v20
    v_fmac_f32 v121, v108, v108
    v_smfmac_f32_16x16x64_bf16 a[200:203], a[208:211], a[220:227], v20
    s_waitcnt lgkmcnt(0)
    v_fmac_f32 v120, v93, v93
    v_mfma_f32_16x16x32_bf16 a[128:131], a[228:231], a[0:3], 0
    ds_read_b64_tr_b16 a[212:213], v25 offset:0
    buffer_load_dwordx4 v46, s[4:7], s65 offen offset:2048 lds
    v_mfma_f32_16x16x32_bf16 a[128:131], a[232:235], a[4:7], a[128:131]
    ds_read_b64_tr_b16 a[214:215], v25 offset:1024
    v_fmac_f32 v121, v109, v109
    v_mfma_f32_16x16x32_bf16 a[128:131], a[236:239], a[8:11], a[128:131]
    ds_read_b64_tr_b16 a[216:217], v25 offset:8192
    v_fmac_f32 v120, v94, v94
    v_mfma_f32_16x16x32_bf16 a[128:131], a[240:243], a[12:15], a[128:131]
    buffer_load_dwordx4 v47, s[4:7], s65 offen offset:3072 lds
    v_mfma_f32_16x16x32_bf16 a[144:147], a[240:243], a[28:31], 0
    ds_read_b64_tr_b16 a[218:219], v25 offset:9216
    v_fmac_f32 v121, v110, v110
    v_mfma_f32_16x16x32_bf16 a[144:147], a[236:239], a[24:27], a[144:147]
    s_add_u32 m0, s60, 98304
    ds_read_b64_tr_b16 a[220:221], v25 offset:16384
    v_fmac_f32 v120, v95, v95
    v_mfma_f32_16x16x32_bf16 a[144:147], a[232:235], a[20:23], a[144:147]
    s_add_u32 s65, s68, 458752
    ds_read_b64_tr_b16 a[222:223], v25 offset:17408
    v_fmac_f32 v121, v111, v111
    v_mfma_f32_16x16x32_bf16 a[144:147], a[228:231], a[16:19], a[144:147]
    buffer_load_dwordx4 v36, s[12:15], s65 offen offset:0 lds
    v_mfma_f32_16x16x32_bf16 a[160:163], a[228:231], a[32:35], 0
    ds_read_b64_tr_b16 a[224:225], v25 offset:24576
    v_add_f32 v120, v120, v121
    v_mfma_f32_16x16x32_bf16 a[160:163], a[232:235], a[36:39], a[160:163]
    ds_read_b64_tr_b16 a[226:227], v25 offset:25600
    v_cvt_pk_bf16_f32 v122, v122, v122
    v_mfma_f32_16x16x32_bf16 a[160:163], a[236:239], a[40:43], a[160:163]
    v_add_f32_dpp v120, v120, v120 row_ror:8 row_mask:0xf bank_mask:0xf
    v_and_b32 v122, 0xffff0000, v122
    v_mfma_f32_16x16x32_bf16 a[160:163], a[240:243], a[44:47], a[160:163]
    v_mfma_f32_16x16x32_bf16 a[176:179], a[240:243], a[60:63], 0
    v_add_f32_dpp v120, v120, v120 row_ror:4 row_mask:0xf bank_mask:0xf
    v_mfma_f32_16x16x32_bf16 a[176:179], a[236:239], a[56:59], a[176:179]
    buffer_load_dwordx4 v37, s[12:15], s65 offen offset:1024 lds
    v_mfma_f32_16x16x32_bf16 a[176:179], a[232:235], a[52:55], a[176:179]
    v_add_f32_dpp v120, v120, v120 row_ror:2 row_mask:0xf bank_mask:0xf
    v_mfma_f32_16x16x32_bf16 a[176:179], a[228:231], a[48:51], a[176:179]
    v_smfmac_f32_16x16x64_bf16 a[204:207], a[208:211], a[228:235], v20
    v_add_f32_dpp v120, v120, v120 row_ror:1 row_mask:0xf bank_mask:0xf
    v_smfmac_f32_16x16x64_bf16 a[204:207], a[208:211], a[236:243], v20
    s_waitcnt lgkmcnt(0)
    buffer_load_dwordx4 v38, s[12:15], s65 offen offset:2048 lds
    v_mfma_f32_16x16x32_bf16 v[68:71], a[212:215], a[0:3], 0
    ds_read_b64_tr_b16 a[228:229], v25 offset:8
    v_mov_b32 v121, v120
    v_mfma_f32_16x16x32_bf16 v[68:71], a[216:219], a[4:7], v[68:71]
    ds_read_b64_tr_b16 a[230:231], v25 offset:1032
    v_mfma_f32_16x16x32_bf16 v[68:71], a[220:223], a[8:11], v[68:71]
    ds_read_b64_tr_b16 a[232:233], v25 offset:8200
    v_permlane16_swap_b32 v121, v120
    v_mfma_f32_16x16x32_bf16 v[68:71], a[224:227], a[12:15], v[68:71]
    buffer_load_dwordx4 v39, s[12:15], s65 offen offset:3072 lds
    v_mfma_f32_16x16x32_bf16 v[84:87], a[224:227], a[28:31], 0
    ds_read_b64_tr_b16 a[234:235], v25 offset:9224
    v_add_f32 v120, v120, v121
    v_mfma_f32_16x16x32_bf16 v[84:87], a[220:223], a[24:27], v[84:87]
    s_add_u32 m0, s60, 114688
    ds_read_b64_tr_b16 a[236:237], v25 offset:16392
    v_mul_f32 v123, 0x3b000000, v120
    v_mfma_f32_16x16x32_bf16 v[84:87], a[216:219], a[20:23], v[84:87]
    s_add_u32 s65, s68, 458752
    ds_read_b64_tr_b16 a[238:239], v25 offset:17416
    v_cvt_pk_bf16_f32 v123, v123, v123
    v_mfma_f32_16x16x32_bf16 v[84:87], a[212:215], a[16:19], v[84:87]
    buffer_load_dwordx4 v36, s[16:19], s65 offen offset:0 lds
    v_mfma_f32_16x16x32_bf16 v[100:103], a[212:215], a[32:35], 0
    ds_read_b64_tr_b16 a[240:241], v25 offset:24584
    v_and_b32 v123, 0xffff0000, v123
    v_mfma_f32_16x16x32_bf16 v[100:103], a[216:219], a[36:39], v[100:103]
    ds_read_b64_tr_b16 a[242:243], v25 offset:25608
    v_add_f32 v123, 0x3727c5ac, v123
    v_mfma_f32_16x16x32_bf16 v[100:103], a[220:223], a[40:43], v[100:103]
    v_cvt_pk_bf16_f32 v123, v123, v123
    v_and_b32 v123, 0xffff0000, v123
    v_mfma_f32_16x16x32_bf16 v[100:103], a[224:227], a[44:47], v[100:103]
    v_sqrt_f32 v123, v123
    v_mfma_f32_16x16x32_bf16 v[116:119], a[224:227], a[60:63], 0
    buffer_load_dwordx4 v37, s[16:19], s65 offen offset:1024 lds
    v_mfma_f32_16x16x32_bf16 v[116:119], a[220:223], a[56:59], v[116:119]
    v_cvt_pk_bf16_f32 v123, v123, v123
    v_and_b32 v123, 0xffff0000, v123
    v_mfma_f32_16x16x32_bf16 v[116:119], a[216:219], a[52:55], v[116:119]
    v_mul_f32 v123, v123, v123
    v_mfma_f32_16x16x32_bf16 v[116:119], a[212:215], a[48:51], v[116:119]
    s_waitcnt lgkmcnt(0)
    buffer_store_dwordx2 v[122:123], v57, s[36:39], 0 offen sc1
    v_mfma_f32_16x16x32_bf16 a[132:135], a[228:231], a[0:3], 0
    ds_read_b64_tr_b16 a[212:213], v26 offset:0
    v_mfma_f32_16x16x32_bf16 a[132:135], a[232:235], a[4:7], a[132:135]
    ds_read_b64_tr_b16 a[214:215], v26 offset:1024
    v_mfma_f32_16x16x32_bf16 a[132:135], a[236:239], a[8:11], a[132:135]
    ds_read_b64_tr_b16 a[216:217], v26 offset:8192
    v_mfma_f32_16x16x32_bf16 a[132:135], a[240:243], a[12:15], a[132:135]
    buffer_load_dwordx4 v38, s[16:19], s65 offen offset:2048 lds
    v_mfma_f32_16x16x32_bf16 a[148:151], a[240:243], a[28:31], 0
    ds_read_b64_tr_b16 a[218:219], v26 offset:9216
    v_mfma_f32_16x16x32_bf16 a[148:151], a[236:239], a[24:27], a[148:151]
    ds_read_b64_tr_b16 a[220:221], v26 offset:16384
    v_mfma_f32_16x16x32_bf16 a[148:151], a[232:235], a[20:23], a[148:151]
    ds_read_b64_tr_b16 a[222:223], v26 offset:17408
    v_mfma_f32_16x16x32_bf16 a[148:151], a[228:231], a[16:19], a[148:151]
    s_waitcnt vmcnt(8)
    buffer_load_dwordx4 v39, s[16:19], s65 offen offset:3072 lds
    v_mfma_f32_16x16x32_bf16 a[164:167], a[228:231], a[32:35], 0
    s_mov_b32 s65, 1048576
    ds_read_b64_tr_b16 a[224:225], v26 offset:24576
    ds_read_b128 a[64:67], v40 offset:0
    v_mfma_f32_16x16x32_bf16 a[164:167], a[232:235], a[36:39], a[164:167]
    ds_read_b64_tr_b16 a[226:227], v26 offset:25600
    ds_read_b128 a[68:71], v41 offset:0
    v_mfma_f32_16x16x32_bf16 a[164:167], a[236:239], a[40:43], a[164:167]
    buffer_load_dword a252, v22, s[8:11], s65 offen
    v_mfma_f32_16x16x32_bf16 a[164:167], a[240:243], a[44:47], a[164:167]
    ds_read_b128 a[72:75], v42 offset:0
    ds_read_b128 a[76:79], v43 offset:0
    v_mfma_f32_16x16x32_bf16 a[180:183], a[240:243], a[60:63], 0
    ds_read_b128 a[80:83], v40 offset:4096
    v_mfma_f32_16x16x32_bf16 a[180:183], a[236:239], a[56:59], a[180:183]
    ds_read_b128 a[84:87], v41 offset:4096
    v_mfma_f32_16x16x32_bf16 a[180:183], a[232:235], a[52:55], a[180:183]
    ds_read_b128 a[88:91], v42 offset:4096
    v_mfma_f32_16x16x32_bf16 a[180:183], a[228:231], a[48:51], a[180:183]
    s_waitcnt lgkmcnt(6)
    ds_read_b128 a[92:95], v43 offset:4096
    v_mfma_f32_16x16x32_bf16 v[72:75], a[212:215], a[0:3], 0
    ds_read_b64_tr_b16 a[228:229], v26 offset:8
    v_mfma_f32_16x16x32_bf16 v[72:75], a[216:219], a[4:7], v[72:75]
    ds_read_b64_tr_b16 a[230:231], v26 offset:1032
    v_mfma_f32_16x16x32_bf16 v[72:75], a[220:223], a[8:11], v[72:75]
    ds_read_b64_tr_b16 a[232:233], v26 offset:8200
    v_mfma_f32_16x16x32_bf16 v[72:75], a[224:227], a[12:15], v[72:75]
    ds_read_b128 a[96:99], v40 offset:8192
    v_mfma_f32_16x16x32_bf16 v[88:91], a[224:227], a[28:31], 0
    ds_read_b64_tr_b16 a[234:235], v26 offset:9224
    v_mfma_f32_16x16x32_bf16 v[88:91], a[220:223], a[24:27], v[88:91]
    ds_read_b64_tr_b16 a[236:237], v26 offset:16392
    v_mfma_f32_16x16x32_bf16 v[88:91], a[216:219], a[20:23], v[88:91]
    ds_read_b64_tr_b16 a[238:239], v26 offset:17416
    v_mfma_f32_16x16x32_bf16 v[88:91], a[212:215], a[16:19], v[88:91]
    ds_read_b128 a[100:103], v41 offset:8192
    v_mfma_f32_16x16x32_bf16 v[104:107], a[212:215], a[32:35], 0
    ds_read_b64_tr_b16 a[240:241], v26 offset:24584
    v_mfma_f32_16x16x32_bf16 v[104:107], a[216:219], a[36:39], v[104:107]
    ds_read_b64_tr_b16 a[242:243], v26 offset:25608
    v_mfma_f32_16x16x32_bf16 v[104:107], a[220:223], a[40:43], v[104:107]
    ds_read_b128 a[104:107], v42 offset:8192
    v_mfma_f32_16x16x32_bf16 v[104:107], a[224:227], a[44:47], v[104:107]
    ds_read_b128 a[108:111], v43 offset:8192
    v_mfma_f32_16x16x32_bf16 v[120:123], a[224:227], a[60:63], 0
    ds_read_b128 a[112:115], v40 offset:12288
    v_mfma_f32_16x16x32_bf16 v[120:123], a[220:223], a[56:59], v[120:123]
    ds_read_b128 a[116:119], v41 offset:12288
    v_mfma_f32_16x16x32_bf16 v[120:123], a[216:219], a[52:55], v[120:123]
    ds_read_b128 a[120:123], v42 offset:12288
    v_mfma_f32_16x16x32_bf16 v[120:123], a[212:215], a[48:51], v[120:123]
    s_waitcnt lgkmcnt(5)
    ds_read_b128 a[124:127], v43 offset:12288
    v_mfma_f32_16x16x32_bf16 a[136:139], a[228:231], a[0:3], 0
    ds_read_b64_tr_b16 a[212:213], v27 offset:0
    v_mfma_f32_16x16x32_bf16 a[136:139], a[232:235], a[4:7], a[136:139]
    ds_read_b64_tr_b16 a[214:215], v27 offset:1024
    v_mfma_f32_16x16x32_bf16 a[136:139], a[236:239], a[8:11], a[136:139]
    ds_read_b64_tr_b16 a[216:217], v27 offset:8192
    v_mfma_f32_16x16x32_bf16 a[136:139], a[240:243], a[12:15], a[136:139]
    v_mfma_f32_16x16x32_bf16 a[152:155], a[240:243], a[28:31], 0
    s_waitcnt lgkmcnt(3)
    ds_read_b64_tr_b16 a[218:219], v27 offset:9216
    v_mfma_f32_16x16x32_bf16 a[152:155], a[236:239], a[24:27], a[152:155]
    ds_read_b64_tr_b16 a[220:221], v27 offset:16384
    v_mfma_f32_16x16x32_bf16 a[152:155], a[232:235], a[20:23], a[152:155]
    s_xor_b32 m0, s100, 0
    ds_read_b64_tr_b16 a[222:223], v27 offset:17408
    v_mfma_f32_16x16x32_bf16 a[152:155], a[228:231], a[16:19], a[152:155]
    s_xor_b32 s65, s101, 512
    v_mfma_f32_16x16x32_bf16 a[168:171], a[228:231], a[32:35], 0
    ds_read_b64_tr_b16 a[224:225], v27 offset:24576
    v_mfma_f32_16x16x32_bf16 a[168:171], a[232:235], a[36:39], a[168:171]
    ds_read_b64_tr_b16 a[226:227], v27 offset:25600
    v_mfma_f32_16x16x32_bf16 a[168:171], a[236:239], a[40:43], a[168:171]
    buffer_load_dwordx4 v44, s[4:7], s65 offen offset:0 lds
    v_mfma_f32_16x16x32_bf16 a[168:171], a[240:243], a[44:47], a[168:171]
    v_mfma_f32_16x16x32_bf16 a[184:187], a[240:243], a[60:63], 0
    buffer_load_dwordx4 v45, s[4:7], s65 offen offset:1024 lds
    v_mfma_f32_16x16x32_bf16 a[184:187], a[236:239], a[56:59], a[184:187]
    v_mfma_f32_16x16x32_bf16 a[184:187], a[232:235], a[52:55], a[184:187]
    v_mfma_f32_16x16x32_bf16 a[184:187], a[228:231], a[48:51], a[184:187]
    s_waitcnt lgkmcnt(0)
    buffer_load_dwordx4 v46, s[4:7], s65 offen offset:2048 lds
    v_mfma_f32_16x16x32_bf16 v[76:79], a[212:215], a[0:3], 0
    ds_read_b64_tr_b16 a[228:229], v27 offset:8
    v_mfma_f32_16x16x32_bf16 v[76:79], a[216:219], a[4:7], v[76:79]
    ds_read_b64_tr_b16 a[230:231], v27 offset:1032
    v_mfma_f32_16x16x32_bf16 v[76:79], a[220:223], a[8:11], v[76:79]
    ds_read_b64_tr_b16 a[232:233], v27 offset:8200
    v_mfma_f32_16x16x32_bf16 v[76:79], a[224:227], a[12:15], v[76:79]
    v_mfma_f32_16x16x32_bf16 v[92:95], a[224:227], a[28:31], 0
    ds_read_b64_tr_b16 a[234:235], v27 offset:9224
    v_mfma_f32_16x16x32_bf16 v[92:95], a[220:223], a[24:27], v[92:95]
    ds_read_b64_tr_b16 a[236:237], v27 offset:16392
    v_mfma_f32_16x16x32_bf16 v[92:95], a[216:219], a[20:23], v[92:95]
    ds_read_b64_tr_b16 a[238:239], v27 offset:17416
    v_mfma_f32_16x16x32_bf16 v[92:95], a[212:215], a[16:19], v[92:95]
    buffer_load_dwordx4 v47, s[4:7], s65 offen offset:3072 lds
    v_mfma_f32_16x16x32_bf16 v[108:111], a[212:215], a[32:35], 0
    s_mov_b32 s65, 917504
    ds_read_b64_tr_b16 a[240:241], v27 offset:24584
    v_mfma_f32_16x16x32_bf16 v[108:111], a[216:219], a[36:39], v[108:111]
    ds_read_b64_tr_b16 a[242:243], v27 offset:25608
    v_mfma_f32_16x16x32_bf16 v[108:111], a[220:223], a[40:43], v[108:111]
    buffer_load_dword a252, v23, s[12:15], s65 offen
    v_mfma_f32_16x16x32_bf16 v[108:111], a[224:227], a[44:47], v[108:111]
    v_mfma_f32_16x16x32_bf16 v[124:127], a[224:227], a[60:63], 0
    v_mfma_f32_16x16x32_bf16 v[124:127], a[220:223], a[56:59], v[124:127]
    v_mfma_f32_16x16x32_bf16 v[124:127], a[216:219], a[52:55], v[124:127]
    buffer_load_dword a252, v23, s[16:19], s65 offen
    v_mfma_f32_16x16x32_bf16 v[124:127], a[212:215], a[48:51], v[124:127]
    s_waitcnt lgkmcnt(0)
    v_mfma_f32_16x16x32_bf16 a[140:143], a[228:231], a[0:3], 0
    s_waitcnt vmcnt(7)
    v_mfma_f32_16x16x32_bf16 a[140:143], a[232:235], a[4:7], a[140:143]
    s_barrier
    v_mfma_f32_16x16x32_bf16 a[140:143], a[236:239], a[8:11], a[140:143]
    ds_read_b64_tr_b16 a[212:213], v28 offset:0
    v_mfma_f32_16x16x32_bf16 a[140:143], a[240:243], a[12:15], a[140:143]
    ds_read_b64_tr_b16 a[214:215], v28 offset:512
    v_mfma_f32_16x16x32_bf16 a[156:159], a[240:243], a[28:31], 0
    ds_read_b64_tr_b16 a[216:217], v28 offset:4096
    v_mfma_f32_16x16x32_bf16 a[156:159], a[236:239], a[24:27], a[156:159]
    ds_read_b64_tr_b16 a[218:219], v28 offset:4608
    v_mfma_f32_16x16x32_bf16 a[156:159], a[232:235], a[20:23], a[156:159]
    ds_read_b64_tr_b16 a[220:221], v28 offset:8192
    buffer_atomic_add v49, v48, s[40:43], 0 offen
    v_mfma_f32_16x16x32_bf16 a[156:159], a[228:231], a[16:19], a[156:159]
    s_add_u32 m0, s59, 131072
    ds_read_b64_tr_b16 a[222:223], v28 offset:8704
    v_mfma_f32_16x16x32_bf16 a[172:175], a[228:231], a[32:35], 0
    s_add_u32 s65, s67, 1048576
    ds_read_b64_tr_b16 a[224:225], v28 offset:12288
    v_mfma_f32_16x16x32_bf16 a[172:175], a[232:235], a[36:39], a[172:175]
    ds_read_b64_tr_b16 a[226:227], v28 offset:12800
    v_mfma_f32_16x16x32_bf16 a[172:175], a[236:239], a[40:43], a[172:175]
    buffer_load_dwordx4 v32, s[8:11], s65 offen offset:0 lds
    v_mfma_f32_16x16x32_bf16 a[172:175], a[240:243], a[44:47], a[172:175]
    v_mfma_f32_16x16x32_bf16 a[188:191], a[240:243], a[60:63], 0
    v_mfma_f32_16x16x32_bf16 a[188:191], a[236:239], a[56:59], a[188:191]
    v_mfma_f32_16x16x32_bf16 a[188:191], a[232:235], a[52:55], a[188:191]
    buffer_load_dwordx4 v33, s[8:11], s65 offen offset:1024 lds
    v_mfma_f32_16x16x32_bf16 a[188:191], a[228:231], a[48:51], a[188:191]
    s_waitcnt lgkmcnt(0)
    v_mfma_f32_16x16x32_bf16 v[128:131], a[212:215], a[64:67], v[128:131]
    ds_read_b64_tr_b16 a[228:229], v28 offset:16384
    v_mfma_f32_16x16x32_bf16 v[128:131], a[216:219], a[68:71], v[128:131]
    ds_read_b64_tr_b16 a[230:231], v28 offset:16896
    v_mfma_f32_16x16x32_bf16 v[128:131], a[220:223], a[72:75], v[128:131]
    ds_read_b64_tr_b16 a[232:233], v28 offset:20480
    v_mfma_f32_16x16x32_bf16 v[128:131], a[224:227], a[76:79], v[128:131]
    buffer_load_dwordx4 v34, s[8:11], s65 offen offset:2048 lds
    v_mfma_f32_16x16x32_bf16 v[132:135], a[224:227], a[92:95], v[132:135]
    ds_read_b64_tr_b16 a[234:235], v28 offset:20992
    v_mfma_f32_16x16x32_bf16 v[132:135], a[220:223], a[88:91], v[132:135]
    ds_read_b64_tr_b16 a[236:237], v28 offset:24576
    v_mfma_f32_16x16x32_bf16 v[132:135], a[216:219], a[84:87], v[132:135]
    ds_read_b64_tr_b16 a[238:239], v28 offset:25088
    v_mfma_f32_16x16x32_bf16 v[132:135], a[212:215], a[80:83], v[132:135]
    buffer_load_dwordx4 v35, s[8:11], s65 offen offset:3072 lds
    v_mfma_f32_16x16x32_bf16 v[136:139], a[212:215], a[96:99], v[136:139]
    s_add_u32 m0, s59, 135168
    ds_read_b64_tr_b16 a[240:241], v28 offset:28672
    v_mfma_f32_16x16x32_bf16 v[136:139], a[216:219], a[100:103], v[136:139]
    s_add_u32 s65, s67, 1179648
    ds_read_b64_tr_b16 a[242:243], v28 offset:29184
    v_mfma_f32_16x16x32_bf16 v[136:139], a[220:223], a[104:107], v[136:139]
    v_mfma_f32_16x16x32_bf16 v[136:139], a[224:227], a[108:111], v[136:139]
    buffer_load_dwordx4 v32, s[8:11], s65 offen offset:0 lds
    v_mfma_f32_16x16x32_bf16 v[140:143], a[224:227], a[124:127], v[140:143]
    v_mfma_f32_16x16x32_bf16 v[140:143], a[220:223], a[120:123], v[140:143]
    v_mfma_f32_16x16x32_bf16 v[140:143], a[216:219], a[116:119], v[140:143]
    v_mfma_f32_16x16x32_bf16 v[140:143], a[212:215], a[112:115], v[140:143]
    buffer_load_dwordx4 v33, s[8:11], s65 offen offset:1024 lds
    v_smfmac_f32_16x16x64_bf16 a[192:195], a[208:211], a[212:219], v20
    v_smfmac_f32_16x16x64_bf16 a[192:195], a[208:211], a[220:227], v20
    s_waitcnt lgkmcnt(0)
    v_mfma_f32_16x16x32_bf16 v[192:195], a[228:231], a[64:67], v[192:195]
    ds_read_b64_tr_b16 a[212:213], v30 offset:0
    v_mfma_f32_16x16x32_bf16 v[192:195], a[232:235], a[68:71], v[192:195]
    ds_read_b64_tr_b16 a[214:215], v30 offset:512
    v_mfma_f32_16x16x32_bf16 v[192:195], a[236:239], a[72:75], v[192:195]
    ds_read_b64_tr_b16 a[216:217], v30 offset:4096
    v_mfma_f32_16x16x32_bf16 v[192:195], a[240:243], a[76:79], v[192:195]
    buffer_load_dwordx4 v34, s[8:11], s65 offen offset:2048 lds
    v_mfma_f32_16x16x32_bf16 v[196:199], a[240:243], a[92:95], v[196:199]
    ds_read_b64_tr_b16 a[218:219], v30 offset:4608
    v_mfma_f32_16x16x32_bf16 v[196:199], a[236:239], a[88:91], v[196:199]
    ds_read_b64_tr_b16 a[220:221], v30 offset:8192
    v_mfma_f32_16x16x32_bf16 v[196:199], a[232:235], a[84:87], v[196:199]
    ds_read_b64_tr_b16 a[222:223], v30 offset:8704
    v_mfma_f32_16x16x32_bf16 v[196:199], a[228:231], a[80:83], v[196:199]
    buffer_load_dwordx4 v35, s[8:11], s65 offen offset:3072 lds
    v_mfma_f32_16x16x32_bf16 v[200:203], a[228:231], a[96:99], v[200:203]
    ds_read_b64_tr_b16 a[224:225], v30 offset:12288
    v_mfma_f32_16x16x32_bf16 v[200:203], a[232:235], a[100:103], v[200:203]
    s_xor_b32 m0, s100, 4096
    ds_read_b64_tr_b16 a[226:227], v30 offset:12800
    v_mfma_f32_16x16x32_bf16 v[200:203], a[236:239], a[104:107], v[200:203]
    s_xor_b32 s65, s101, 16896
    v_mfma_f32_16x16x32_bf16 v[200:203], a[240:243], a[108:111], v[200:203]
    buffer_load_dwordx4 v44, s[4:7], s65 offen offset:0 lds
    v_mfma_f32_16x16x32_bf16 v[204:207], a[240:243], a[124:127], v[204:207]
    v_mfma_f32_16x16x32_bf16 v[204:207], a[236:239], a[120:123], v[204:207]
    v_mfma_f32_16x16x32_bf16 v[204:207], a[232:235], a[116:119], v[204:207]
    v_mfma_f32_16x16x32_bf16 v[204:207], a[228:231], a[112:115], v[204:207]
    buffer_load_dwordx4 v45, s[4:7], s65 offen offset:1024 lds
    v_smfmac_f32_16x16x64_bf16 a[196:199], a[208:211], a[228:235], v20
    v_smfmac_f32_16x16x64_bf16 a[196:199], a[208:211], a[236:243], v20
    s_waitcnt lgkmcnt(0)
    v_mfma_f32_16x16x32_bf16 v[160:163], a[212:215], a[64:67], v[160:163]
    ds_read_b64_tr_b16 a[228:229], v30 offset:16384
    v_mfma_f32_16x16x32_bf16 v[160:163], a[216:219], a[68:71], v[160:163]
    ds_read_b64_tr_b16 a[230:231], v30 offset:16896
    v_mfma_f32_16x16x32_bf16 v[160:163], a[220:223], a[72:75], v[160:163]
    ds_read_b64_tr_b16 a[232:233], v30 offset:20480
    v_mfma_f32_16x16x32_bf16 v[160:163], a[224:227], a[76:79], v[160:163]
    buffer_load_dwordx4 v46, s[4:7], s65 offen offset:2048 lds
    v_mfma_f32_16x16x32_bf16 v[164:167], a[224:227], a[92:95], v[164:167]
    ds_read_b64_tr_b16 a[234:235], v30 offset:20992
    v_mfma_f32_16x16x32_bf16 v[164:167], a[220:223], a[88:91], v[164:167]
    ds_read_b64_tr_b16 a[236:237], v30 offset:24576
    v_mfma_f32_16x16x32_bf16 v[164:167], a[216:219], a[84:87], v[164:167]
    ds_read_b64_tr_b16 a[238:239], v30 offset:25088
    v_mfma_f32_16x16x32_bf16 v[164:167], a[212:215], a[80:83], v[164:167]
    buffer_load_dwordx4 v47, s[4:7], s65 offen offset:3072 lds
    v_mfma_f32_16x16x32_bf16 v[168:171], a[212:215], a[96:99], v[168:171]
    s_xor_b32 m0, s100, 8192
    ds_read_b64_tr_b16 a[240:241], v30 offset:28672
    v_mfma_f32_16x16x32_bf16 v[168:171], a[216:219], a[100:103], v[168:171]
    s_xor_b32 s65, s101, 33280
    ds_read_b64_tr_b16 a[242:243], v30 offset:29184
    v_mfma_f32_16x16x32_bf16 v[168:171], a[220:223], a[104:107], v[168:171]
    buffer_load_dwordx4 v44, s[4:7], s65 offen offset:0 lds
    v_mfma_f32_16x16x32_bf16 v[168:171], a[224:227], a[108:111], v[168:171]
    v_mfma_f32_16x16x32_bf16 v[172:175], a[224:227], a[124:127], v[172:175]
    v_mfma_f32_16x16x32_bf16 v[172:175], a[220:223], a[120:123], v[172:175]
    v_mfma_f32_16x16x32_bf16 v[172:175], a[216:219], a[116:119], v[172:175]
    buffer_load_dwordx4 v45, s[4:7], s65 offen offset:1024 lds
    v_mfma_f32_16x16x32_bf16 v[172:175], a[212:215], a[112:115], v[172:175]
    v_smfmac_f32_16x16x64_bf16 v[176:179], a[208:211], a[212:219], v20
    v_smfmac_f32_16x16x64_bf16 v[176:179], a[208:211], a[220:227], v20
    s_waitcnt lgkmcnt(0)
    v_mfma_f32_16x16x32_bf16 v[224:227], a[228:231], a[64:67], v[224:227]
    ds_read_b64_tr_b16 a[212:213], v29 offset:0
    v_mfma_f32_16x16x32_bf16 v[224:227], a[232:235], a[68:71], v[224:227]
    ds_read_b64_tr_b16 a[214:215], v29 offset:512
    v_mfma_f32_16x16x32_bf16 v[224:227], a[236:239], a[72:75], v[224:227]
    ds_read_b64_tr_b16 a[216:217], v29 offset:4096
    v_mfma_f32_16x16x32_bf16 v[224:227], a[240:243], a[76:79], v[224:227]
    buffer_load_dwordx4 v46, s[4:7], s65 offen offset:2048 lds
    v_mfma_f32_16x16x32_bf16 v[228:231], a[240:243], a[92:95], v[228:231]
    ds_read_b64_tr_b16 a[218:219], v29 offset:4608
    v_mfma_f32_16x16x32_bf16 v[228:231], a[236:239], a[88:91], v[228:231]
    ds_read_b64_tr_b16 a[220:221], v29 offset:8192
    v_mfma_f32_16x16x32_bf16 v[228:231], a[232:235], a[84:87], v[228:231]
    ds_read_b64_tr_b16 a[222:223], v29 offset:8704
    v_mfma_f32_16x16x32_bf16 v[228:231], a[228:231], a[80:83], v[228:231]
    buffer_load_dwordx4 v47, s[4:7], s65 offen offset:3072 lds
    v_mfma_f32_16x16x32_bf16 v[232:235], a[228:231], a[96:99], v[232:235]
    s_xor_b32 m0, s100, 12288
    ds_read_b64_tr_b16 a[224:225], v29 offset:12288
    v_mfma_f32_16x16x32_bf16 v[232:235], a[232:235], a[100:103], v[232:235]
    s_xor_b32 s65, s101, 49664
    ds_read_b64_tr_b16 a[226:227], v29 offset:12800
    v_mfma_f32_16x16x32_bf16 v[232:235], a[236:239], a[104:107], v[232:235]
    buffer_load_dwordx4 v44, s[4:7], s65 offen offset:0 lds
    v_mfma_f32_16x16x32_bf16 v[232:235], a[240:243], a[108:111], v[232:235]
    v_mfma_f32_16x16x32_bf16 v[236:239], a[240:243], a[124:127], v[236:239]
    v_mfma_f32_16x16x32_bf16 v[236:239], a[236:239], a[120:123], v[236:239]
    v_mfma_f32_16x16x32_bf16 v[236:239], a[232:235], a[116:119], v[236:239]
    buffer_load_dwordx4 v45, s[4:7], s65 offen offset:1024 lds
    v_mfma_f32_16x16x32_bf16 v[236:239], a[228:231], a[112:115], v[236:239]
    v_smfmac_f32_16x16x64_bf16 v[180:183], a[208:211], a[228:235], v20
    v_smfmac_f32_16x16x64_bf16 v[180:183], a[208:211], a[236:243], v20
    s_waitcnt lgkmcnt(0)
    v_mfma_f32_16x16x32_bf16 v[144:147], a[212:215], a[64:67], v[144:147]
    ds_read_b64_tr_b16 a[228:229], v29 offset:16384
    buffer_load_dwordx4 v46, s[4:7], s65 offen offset:2048 lds
    v_mfma_f32_16x16x32_bf16 v[144:147], a[216:219], a[68:71], v[144:147]
    ds_read_b64_tr_b16 a[230:231], v29 offset:16896
    v_mfma_f32_16x16x32_bf16 v[144:147], a[220:223], a[72:75], v[144:147]
    ds_read_b64_tr_b16 a[232:233], v29 offset:20480
    v_mfma_f32_16x16x32_bf16 v[144:147], a[224:227], a[76:79], v[144:147]
    v_mfma_f32_16x16x32_bf16 v[148:151], a[224:227], a[92:95], v[148:151]
    ds_read_b64_tr_b16 a[234:235], v29 offset:20992
    v_mfma_f32_16x16x32_bf16 v[148:151], a[220:223], a[88:91], v[148:151]
    ds_read_b64_tr_b16 a[236:237], v29 offset:24576
    v_mfma_f32_16x16x32_bf16 v[148:151], a[216:219], a[84:87], v[148:151]
    ds_read_b64_tr_b16 a[238:239], v29 offset:25088
    v_mfma_f32_16x16x32_bf16 v[148:151], a[212:215], a[80:83], v[148:151]
    buffer_load_dwordx4 v47, s[4:7], s65 offen offset:3072 lds
    v_mfma_f32_16x16x32_bf16 v[152:155], a[212:215], a[96:99], v[152:155]
    s_add_u32 m0, s60, 65536
    ds_read_b64_tr_b16 a[240:241], v29 offset:28672
    v_mfma_f32_16x16x32_bf16 v[152:155], a[216:219], a[100:103], v[152:155]
    s_add_u32 s65, s68, 917504
    ds_read_b64_tr_b16 a[242:243], v29 offset:29184
    v_mfma_f32_16x16x32_bf16 v[152:155], a[220:223], a[104:107], v[152:155]
    buffer_load_dwordx4 v36, s[12:15], s65 offen offset:0 lds
    v_mfma_f32_16x16x32_bf16 v[152:155], a[224:227], a[108:111], v[152:155]
    v_mfma_f32_16x16x32_bf16 v[156:159], a[224:227], a[124:127], v[156:159]
    v_mfma_f32_16x16x32_bf16 v[156:159], a[220:223], a[120:123], v[156:159]
    buffer_load_dwordx4 v37, s[12:15], s65 offen offset:1024 lds
    v_mfma_f32_16x16x32_bf16 v[156:159], a[216:219], a[116:119], v[156:159]
    v_mfma_f32_16x16x32_bf16 v[156:159], a[212:215], a[112:115], v[156:159]
    s_waitcnt lgkmcnt(0)
    v_mfma_f32_16x16x32_bf16 v[208:211], a[228:231], a[64:67], v[208:211]
    s_waitcnt vmcnt(14)
    v_add_u32 v24, 65536, v24
    v_add_u32 v25, 65536, v25
    v_mfma_f32_16x16x32_bf16 v[208:211], a[232:235], a[68:71], v[208:211]
    s_barrier
    v_add_u32 v26, 65536, v26
    v_add_u32 v27, 65536, v27
    v_mfma_f32_16x16x32_bf16 v[208:211], a[236:239], a[72:75], v[208:211]
    ds_read_b64_tr_b16 a[212:213], v24 offset:0
    buffer_load_dwordx4 v38, s[12:15], s65 offen offset:2048 lds
    v_mfma_f32_16x16x32_bf16 v[208:211], a[240:243], a[76:79], v[208:211]
    ds_read_b64_tr_b16 a[214:215], v24 offset:1024
    v_mfma_f32_16x16x32_bf16 v[212:215], a[240:243], a[92:95], v[212:215]
    ds_read_b64_tr_b16 a[216:217], v24 offset:8192
    v_mfma_f32_16x16x32_bf16 v[212:215], a[236:239], a[88:91], v[212:215]
    ds_read_b64_tr_b16 a[218:219], v24 offset:9216
    v_mfma_f32_16x16x32_bf16 v[212:215], a[232:235], a[84:87], v[212:215]
    ds_read_b64_tr_b16 a[220:221], v24 offset:16384
    buffer_load_dwordx4 v39, s[12:15], s65 offen offset:3072 lds
    v_mfma_f32_16x16x32_bf16 v[212:215], a[228:231], a[80:83], v[212:215]
    s_add_u32 m0, s60, 81920
    ds_read_b64_tr_b16 a[222:223], v24 offset:17408
    v_mfma_f32_16x16x32_bf16 v[216:219], a[228:231], a[96:99], v[216:219]
    s_add_u32 s65, s68, 917504
    ds_read_b64_tr_b16 a[224:225], v24 offset:24576
    v_mfma_f32_16x16x32_bf16 v[216:219], a[232:235], a[100:103], v[216:219]
    ds_read_b64_tr_b16 a[226:227], v24 offset:25600
    v_mfma_f32_16x16x32_bf16 v[216:219], a[236:239], a[104:107], v[216:219]
    buffer_load_dwordx4 v36, s[16:19], s65 offen offset:0 lds
    v_mfma_f32_16x16x32_bf16 v[216:219], a[240:243], a[108:111], v[216:219]
    v_mfma_f32_16x16x32_bf16 v[220:223], a[240:243], a[124:127], v[220:223]
    v_mfma_f32_16x16x32_bf16 v[220:223], a[236:239], a[120:123], v[220:223]
    v_mfma_f32_16x16x32_bf16 v[220:223], a[232:235], a[116:119], v[220:223]
    v_mfma_f32_16x16x32_bf16 v[220:223], a[228:231], a[112:115], v[220:223]
    s_waitcnt lgkmcnt(0)
    buffer_load_dwordx4 v37, s[16:19], s65 offen offset:1024 lds
    v_mfma_f32_16x16x32_bf16 v[64:67], a[212:215], a[64:67], v[64:67]
    ds_read_b64_tr_b16 a[228:229], v24 offset:8
    v_mfma_f32_16x16x32_bf16 v[64:67], a[216:219], a[68:71], v[64:67]
    ds_read_b64_tr_b16 a[230:231], v24 offset:1032
    v_mfma_f32_16x16x32_bf16 v[64:67], a[220:223], a[72:75], v[64:67]
    ds_read_b64_tr_b16 a[232:233], v24 offset:8200
    v_mfma_f32_16x16x32_bf16 v[64:67], a[224:227], a[76:79], v[64:67]
    buffer_load_dwordx4 v38, s[16:19], s65 offen offset:2048 lds
    v_mfma_f32_16x16x32_bf16 v[80:83], a[224:227], a[92:95], v[80:83]
    ds_read_b64_tr_b16 a[234:235], v24 offset:9224
    v_mfma_f32_16x16x32_bf16 v[80:83], a[220:223], a[88:91], v[80:83]
    ds_read_b64_tr_b16 a[236:237], v24 offset:16392
    v_mfma_f32_16x16x32_bf16 v[80:83], a[216:219], a[84:87], v[80:83]
    s_waitcnt vmcnt(7)
    ds_read_b64_tr_b16 a[238:239], v24 offset:17416
    ds_read_b128 a[0:3], v40 offset:0
    v_mfma_f32_16x16x32_bf16 v[80:83], a[212:215], a[80:83], v[80:83]
    buffer_load_dwordx4 v39, s[16:19], s65 offen offset:3072 lds
    v_mfma_f32_16x16x32_bf16 v[96:99], a[212:215], a[96:99], v[96:99]
    ds_read_b64_tr_b16 a[240:241], v24 offset:24584
    ds_read_b128 a[4:7], v41 offset:0
    v_mfma_f32_16x16x32_bf16 v[96:99], a[216:219], a[100:103], v[96:99]
    ds_read_b64_tr_b16 a[242:243], v24 offset:25608
    ds_read_b128 a[8:11], v42 offset:0
    v_mfma_f32_16x16x32_bf16 v[96:99], a[220:223], a[104:107], v[96:99]
    s_mov_b32 s65, 1376256
    ds_read_b128 a[12:15], v43 offset:0
    v_mfma_f32_16x16x32_bf16 v[96:99], a[224:227], a[108:111], v[96:99]
    ds_read_b128 a[16:19], v40 offset:4096
    v_mfma_f32_16x16x32_bf16 v[112:115], a[224:227], a[124:127], v[112:115]
    buffer_load_dword a252, v23, s[12:15], s65 offen
    v_mfma_f32_16x16x32_bf16 v[112:115], a[220:223], a[120:123], v[112:115]
    ds_read_b128 a[20:23], v41 offset:4096
    v_mfma_f32_16x16x32_bf16 v[112:115], a[216:219], a[116:119], v[112:115]
    ds_read_b128 a[24:27], v42 offset:4096
    v_mfma_f32_16x16x32_bf16 v[112:115], a[212:215], a[112:115], v[112:115]
    buffer_load_dword a252, v23, s[16:19], s65 offen
    v_smfmac_f32_16x16x64_bf16 a[200:203], a[208:211], a[212:219], v20
    ds_read_b128 a[28:31], v43 offset:4096
    v_smfmac_f32_16x16x64_bf16 a[200:203], a[208:211], a[220:227], v20
    s_waitcnt lgkmcnt(6)
    ds_read_b128 a[32:35], v40 offset:8192
    v_mfma_f32_16x16x32_bf16 a[128:131], a[228:231], a[64:67], a[128:131]
    ds_read_b64_tr_b16 a[212:213], v25 offset:0
    v_mfma_f32_16x16x32_bf16 a[128:131], a[232:235], a[68:71], a[128:131]
    s_mov_b32 s65, 2097152
    ds_read_b64_tr_b16 a[214:215], v25 offset:1024
    v_mfma_f32_16x16x32_bf16 a[128:131], a[236:239], a[72:75], a[128:131]
    ds_read_b64_tr_b16 a[216:217], v25 offset:8192
    v_mfma_f32_16x16x32_bf16 a[128:131], a[240:243], a[76:79], a[128:131]
    buffer_load_dword a252, v22, s[8:11], s65 offen
    v_mfma_f32_16x16x32_bf16 a[144:147], a[240:243], a[92:95], a[144:147]
    ds_read_b64_tr_b16 a[218:219], v25 offset:9216
    v_mfma_f32_16x16x32_bf16 a[144:147], a[236:239], a[88:91], a[144:147]
    ds_read_b64_tr_b16 a[220:221], v25 offset:16384
    v_mfma_f32_16x16x32_bf16 a[144:147], a[232:235], a[84:87], a[144:147]
    ds_read_b64_tr_b16 a[222:223], v25 offset:17408
    v_mfma_f32_16x16x32_bf16 a[144:147], a[228:231], a[80:83], a[144:147]
    ds_read_b128 a[36:39], v41 offset:8192
    v_mfma_f32_16x16x32_bf16 a[160:163], a[228:231], a[96:99], a[160:163]
    ds_read_b64_tr_b16 a[224:225], v25 offset:24576
    v_mfma_f32_16x16x32_bf16 a[160:163], a[232:235], a[100:103], a[160:163]
    ds_read_b64_tr_b16 a[226:227], v25 offset:25600
    v_mfma_f32_16x16x32_bf16 a[160:163], a[236:239], a[104:107], a[160:163]
    ds_read_b128 a[40:43], v42 offset:8192
    v_mfma_f32_16x16x32_bf16 a[160:163], a[240:243], a[108:111], a[160:163]
    ds_read_b128 a[44:47], v43 offset:8192
    v_mfma_f32_16x16x32_bf16 a[176:179], a[240:243], a[124:127], a[176:179]
    ds_read_b128 a[48:51], v40 offset:12288
    v_mfma_f32_16x16x32_bf16 a[176:179], a[236:239], a[120:123], a[176:179]
    ds_read_b128 a[52:55], v41 offset:12288
    v_mfma_f32_16x16x32_bf16 a[176:179], a[232:235], a[116:119], a[176:179]
    ds_read_b128 a[56:59], v42 offset:12288
    v_mfma_f32_16x16x32_bf16 a[176:179], a[228:231], a[112:115], a[176:179]
    ds_read_b128 a[60:63], v43 offset:12288
    v_smfmac_f32_16x16x64_bf16 a[204:207], a[208:211], a[228:235], v20
    v_smfmac_f32_16x16x64_bf16 a[204:207], a[208:211], a[236:243], v20
    s_waitcnt lgkmcnt(6)
    v_mfma_f32_16x16x32_bf16 v[68:71], a[212:215], a[64:67], v[68:71]
    ds_read_b64_tr_b16 a[228:229], v25 offset:8
    v_mfma_f32_16x16x32_bf16 v[68:71], a[216:219], a[68:71], v[68:71]
    ds_read_b64_tr_b16 a[230:231], v25 offset:1032
    v_mfma_f32_16x16x32_bf16 v[68:71], a[220:223], a[72:75], v[68:71]
    s_waitcnt lgkmcnt(2)
    ds_read_b64_tr_b16 a[232:233], v25 offset:8200
    v_mfma_f32_16x16x32_bf16 v[68:71], a[224:227], a[76:79], v[68:71]
    v_mfma_f32_16x16x32_bf16 v[84:87], a[224:227], a[92:95], v[84:87]
    s_xor_b32 m0, s100, 0
    ds_read_b64_tr_b16 a[234:235], v25 offset:9224
    v_mfma_f32_16x16x32_bf16 v[84:87], a[220:223], a[88:91], v[84:87]
    s_xor_b32 s65, s101, 768
    ds_read_b64_tr_b16 a[236:237], v25 offset:16392
    v_mfma_f32_16x16x32_bf16 v[84:87], a[216:219], a[84:87], v[84:87]
    ds_read_b64_tr_b16 a[238:239], v25 offset:17416
    v_mfma_f32_16x16x32_bf16 v[84:87], a[212:215], a[80:83], v[84:87]
    buffer_load_dwordx4 v44, s[4:7], s65 offen offset:0 lds
    v_mfma_f32_16x16x32_bf16 v[100:103], a[212:215], a[96:99], v[100:103]
    ds_read_b64_tr_b16 a[240:241], v25 offset:24584
    v_mfma_f32_16x16x32_bf16 v[100:103], a[216:219], a[100:103], v[100:103]
    ds_read_b64_tr_b16 a[242:243], v25 offset:25608
    v_mfma_f32_16x16x32_bf16 v[100:103], a[220:223], a[104:107], v[100:103]
    buffer_load_dwordx4 v45, s[4:7], s65 offen offset:1024 lds
    v_mfma_f32_16x16x32_bf16 v[100:103], a[224:227], a[108:111], v[100:103]
    v_mfma_f32_16x16x32_bf16 v[116:119], a[224:227], a[124:127], v[116:119]
    v_mfma_f32_16x16x32_bf16 v[116:119], a[220:223], a[120:123], v[116:119]
    v_mfma_f32_16x16x32_bf16 v[116:119], a[216:219], a[116:119], v[116:119]
    buffer_load_dwordx4 v46, s[4:7], s65 offen offset:2048 lds
    v_mfma_f32_16x16x32_bf16 v[116:119], a[212:215], a[112:115], v[116:119]
    s_waitcnt lgkmcnt(0)
    v_mfma_f32_16x16x32_bf16 a[132:135], a[228:231], a[64:67], a[132:135]
    ds_read_b64_tr_b16 a[212:213], v26 offset:0
    v_mfma_f32_16x16x32_bf16 a[132:135], a[232:235], a[68:71], a[132:135]
    ds_read_b64_tr_b16 a[214:215], v26 offset:1024
    v_mfma_f32_16x16x32_bf16 a[132:135], a[236:239], a[72:75], a[132:135]
    ds_read_b64_tr_b16 a[216:217], v26 offset:8192
    v_mfma_f32_16x16x32_bf16 a[132:135], a[240:243], a[76:79], a[132:135]
    buffer_load_dwordx4 v47, s[4:7], s65 offen offset:3072 lds
    v_mfma_f32_16x16x32_bf16 a[148:151], a[240:243], a[92:95], a[148:151]
    ds_read_b64_tr_b16 a[218:219], v26 offset:9216
    v_mfma_f32_16x16x32_bf16 a[148:151], a[236:239], a[88:91], a[148:151]
    s_mov_b32 s65, 3145728
    ds_read_b64_tr_b16 a[220:221], v26 offset:16384
    v_mfma_f32_16x16x32_bf16 a[148:151], a[232:235], a[84:87], a[148:151]
    ds_read_b64_tr_b16 a[222:223], v26 offset:17408
    v_mfma_f32_16x16x32_bf16 a[148:151], a[228:231], a[80:83], a[148:151]
    buffer_load_dword a252, v22, s[8:11], s65 offen
    v_mfma_f32_16x16x32_bf16 a[164:167], a[228:231], a[96:99], a[164:167]
    ds_read_b64_tr_b16 a[224:225], v26 offset:24576
    v_mfma_f32_16x16x32_bf16 a[164:167], a[232:235], a[100:103], a[164:167]
    ds_read_b64_tr_b16 a[226:227], v26 offset:25600
    v_mfma_f32_16x16x32_bf16 a[164:167], a[236:239], a[104:107], a[164:167]
    v_mfma_f32_16x16x32_bf16 a[164:167], a[240:243], a[108:111], a[164:167]
    v_mfma_f32_16x16x32_bf16 a[180:183], a[240:243], a[124:127], a[180:183]
    global_load_dword a252, v[60:61], off
    v_mfma_f32_16x16x32_bf16 a[180:183], a[236:239], a[120:123], a[180:183]
    v_mfma_f32_16x16x32_bf16 a[180:183], a[232:235], a[116:119], a[180:183]
    v_mfma_f32_16x16x32_bf16 a[180:183], a[228:231], a[112:115], a[180:183]
    s_waitcnt lgkmcnt(0)
    v_mfma_f32_16x16x32_bf16 v[72:75], a[212:215], a[64:67], v[72:75]
    ds_read_b64_tr_b16 a[228:229], v26 offset:8
    v_mfma_f32_16x16x32_bf16 v[72:75], a[216:219], a[68:71], v[72:75]
    ds_read_b64_tr_b16 a[230:231], v26 offset:1032
    v_mfma_f32_16x16x32_bf16 v[72:75], a[220:223], a[72:75], v[72:75]
    ds_read_b64_tr_b16 a[232:233], v26 offset:8200
    v_mfma_f32_16x16x32_bf16 v[72:75], a[224:227], a[76:79], v[72:75]
    v_mfma_f32_16x16x32_bf16 v[88:91], a[224:227], a[92:95], v[88:91]
    ds_read_b64_tr_b16 a[234:235], v26 offset:9224
    v_mfma_f32_16x16x32_bf16 v[88:91], a[220:223], a[88:91], v[88:91]
    ds_read_b64_tr_b16 a[236:237], v26 offset:16392
    v_mfma_f32_16x16x32_bf16 v[88:91], a[216:219], a[84:87], v[88:91]
    ds_read_b64_tr_b16 a[238:239], v26 offset:17416
    v_mfma_f32_16x16x32_bf16 v[88:91], a[212:215], a[80:83], v[88:91]
    v_mfma_f32_16x16x32_bf16 v[104:107], a[212:215], a[96:99], v[104:107]
    ds_read_b64_tr_b16 a[240:241], v26 offset:24584
    v_mfma_f32_16x16x32_bf16 v[104:107], a[216:219], a[100:103], v[104:107]
    ds_read_b64_tr_b16 a[242:243], v26 offset:25608
    v_mfma_f32_16x16x32_bf16 v[104:107], a[220:223], a[104:107], v[104:107]
    v_mfma_f32_16x16x32_bf16 v[104:107], a[224:227], a[108:111], v[104:107]
    v_mfma_f32_16x16x32_bf16 v[120:123], a[224:227], a[124:127], v[120:123]
    v_mfma_f32_16x16x32_bf16 v[120:123], a[220:223], a[120:123], v[120:123]
    v_mfma_f32_16x16x32_bf16 v[120:123], a[216:219], a[116:119], v[120:123]
    v_mfma_f32_16x16x32_bf16 v[120:123], a[212:215], a[112:115], v[120:123]
    s_waitcnt lgkmcnt(0)
    v_mfma_f32_16x16x32_bf16 a[136:139], a[228:231], a[64:67], a[136:139]
    ds_read_b64_tr_b16 a[212:213], v27 offset:0
    v_mfma_f32_16x16x32_bf16 a[136:139], a[232:235], a[68:71], a[136:139]
    ds_read_b64_tr_b16 a[214:215], v27 offset:1024
    v_mfma_f32_16x16x32_bf16 a[136:139], a[236:239], a[72:75], a[136:139]
    ds_read_b64_tr_b16 a[216:217], v27 offset:8192
    v_mfma_f32_16x16x32_bf16 a[136:139], a[240:243], a[76:79], a[136:139]
    v_mfma_f32_16x16x32_bf16 a[152:155], a[240:243], a[92:95], a[152:155]
    ds_read_b64_tr_b16 a[218:219], v27 offset:9216
    v_mfma_f32_16x16x32_bf16 a[152:155], a[236:239], a[88:91], a[152:155]
    ds_read_b64_tr_b16 a[220:221], v27 offset:16384
    v_mfma_f32_16x16x32_bf16 a[152:155], a[232:235], a[84:87], a[152:155]
    s_xor_b32 m0, s100, 4096
    ds_read_b64_tr_b16 a[222:223], v27 offset:17408
    v_mfma_f32_16x16x32_bf16 a[152:155], a[228:231], a[80:83], a[152:155]
    s_xor_b32 s65, s101, 17152
    v_mfma_f32_16x16x32_bf16 a[168:171], a[228:231], a[96:99], a[168:171]
    ds_read_b64_tr_b16 a[224:225], v27 offset:24576
    v_mfma_f32_16x16x32_bf16 a[168:171], a[232:235], a[100:103], a[168:171]
    ds_read_b64_tr_b16 a[226:227], v27 offset:25600
    v_mfma_f32_16x16x32_bf16 a[168:171], a[236:239], a[104:107], a[168:171]
    buffer_load_dwordx4 v44, s[4:7], s65 offen offset:0 lds
    v_mfma_f32_16x16x32_bf16 a[168:171], a[240:243], a[108:111], a[168:171]
    v_mfma_f32_16x16x32_bf16 a[184:187], a[240:243], a[124:127], a[184:187]
    buffer_load_dwordx4 v45, s[4:7], s65 offen offset:1024 lds
    v_mfma_f32_16x16x32_bf16 a[184:187], a[236:239], a[120:123], a[184:187]
    v_mfma_f32_16x16x32_bf16 a[184:187], a[232:235], a[116:119], a[184:187]
    v_mfma_f32_16x16x32_bf16 a[184:187], a[228:231], a[112:115], a[184:187]
    s_waitcnt lgkmcnt(0)
    buffer_load_dwordx4 v46, s[4:7], s65 offen offset:2048 lds
    v_mfma_f32_16x16x32_bf16 v[76:79], a[212:215], a[64:67], v[76:79]
    ds_read_b64_tr_b16 a[228:229], v27 offset:8
    v_mfma_f32_16x16x32_bf16 v[76:79], a[216:219], a[68:71], v[76:79]
    ds_read_b64_tr_b16 a[230:231], v27 offset:1032
    v_mfma_f32_16x16x32_bf16 v[76:79], a[220:223], a[72:75], v[76:79]
    ds_read_b64_tr_b16 a[232:233], v27 offset:8200
    v_mfma_f32_16x16x32_bf16 v[76:79], a[224:227], a[76:79], v[76:79]
    v_mfma_f32_16x16x32_bf16 v[92:95], a[224:227], a[92:95], v[92:95]
    ds_read_b64_tr_b16 a[234:235], v27 offset:9224
    v_mfma_f32_16x16x32_bf16 v[92:95], a[220:223], a[88:91], v[92:95]
    ds_read_b64_tr_b16 a[236:237], v27 offset:16392
    v_mfma_f32_16x16x32_bf16 v[92:95], a[216:219], a[84:87], v[92:95]
    ds_read_b64_tr_b16 a[238:239], v27 offset:17416
    v_mfma_f32_16x16x32_bf16 v[92:95], a[212:215], a[80:83], v[92:95]
    buffer_load_dwordx4 v47, s[4:7], s65 offen offset:3072 lds
    v_mfma_f32_16x16x32_bf16 v[108:111], a[212:215], a[96:99], v[108:111]
    s_xor_b32 m0, s100, 8192
    ds_read_b64_tr_b16 a[240:241], v27 offset:24584
    v_mfma_f32_16x16x32_bf16 v[108:111], a[216:219], a[100:103], v[108:111]
    s_xor_b32 s65, s101, 33536
    ds_read_b64_tr_b16 a[242:243], v27 offset:25608
    v_mfma_f32_16x16x32_bf16 v[108:111], a[220:223], a[104:107], v[108:111]
    buffer_load_dwordx4 v44, s[4:7], s65 offen offset:0 lds
    v_mfma_f32_16x16x32_bf16 v[108:111], a[224:227], a[108:111], v[108:111]
    v_mfma_f32_16x16x32_bf16 v[124:127], a[224:227], a[124:127], v[124:127]
    v_mfma_f32_16x16x32_bf16 v[124:127], a[220:223], a[120:123], v[124:127]
    buffer_load_dwordx4 v45, s[4:7], s65 offen offset:1024 lds
    v_mfma_f32_16x16x32_bf16 v[124:127], a[216:219], a[116:119], v[124:127]
    v_mfma_f32_16x16x32_bf16 v[124:127], a[212:215], a[112:115], v[124:127]
    s_waitcnt lgkmcnt(0)
    v_mfma_f32_16x16x32_bf16 a[140:143], a[228:231], a[64:67], a[140:143]
    s_waitcnt vmcnt(15)
    v_add_u32 v28, 4294934528, v28
    v_add_u32 v29, 4294934528, v29
    v_mfma_f32_16x16x32_bf16 a[140:143], a[232:235], a[68:71], a[140:143]
    s_barrier
    v_add_u32 v30, 4294934528, v30
    v_add_u32 v31, 4294934528, v31
    v_mfma_f32_16x16x32_bf16 a[140:143], a[236:239], a[72:75], a[140:143]
    ds_read_b64_tr_b16 a[212:213], v28 offset:0
    buffer_load_dwordx4 v46, s[4:7], s65 offen offset:2048 lds
    v_mfma_f32_16x16x32_bf16 a[140:143], a[240:243], a[76:79], a[140:143]
    ds_read_b64_tr_b16 a[214:215], v28 offset:512
    v_mfma_f32_16x16x32_bf16 a[156:159], a[240:243], a[92:95], a[156:159]
    ds_read_b64_tr_b16 a[216:217], v28 offset:4096
    v_mfma_f32_16x16x32_bf16 a[156:159], a[236:239], a[88:91], a[156:159]
    ds_read_b64_tr_b16 a[218:219], v28 offset:4608
    v_mfma_f32_16x16x32_bf16 a[156:159], a[232:235], a[84:87], a[156:159]
    ds_read_b64_tr_b16 a[220:221], v28 offset:8192
    buffer_load_dwordx4 v47, s[4:7], s65 offen offset:3072 lds
    v_mfma_f32_16x16x32_bf16 a[156:159], a[228:231], a[80:83], a[156:159]
    s_xor_b32 m0, s100, 12288
    ds_read_b64_tr_b16 a[222:223], v28 offset:8704
    v_mfma_f32_16x16x32_bf16 a[172:175], a[228:231], a[96:99], a[172:175]
    s_xor_b32 s65, s101, 49920
    ds_read_b64_tr_b16 a[224:225], v28 offset:12288
    v_mfma_f32_16x16x32_bf16 a[172:175], a[232:235], a[100:103], a[172:175]
    ds_read_b64_tr_b16 a[226:227], v28 offset:12800
    v_mfma_f32_16x16x32_bf16 a[172:175], a[236:239], a[104:107], a[172:175]
    buffer_load_dwordx4 v44, s[4:7], s65 offen offset:0 lds
    v_mfma_f32_16x16x32_bf16 a[172:175], a[240:243], a[108:111], a[172:175]
    v_mfma_f32_16x16x32_bf16 a[188:191], a[240:243], a[124:127], a[188:191]
    v_mfma_f32_16x16x32_bf16 a[188:191], a[236:239], a[120:123], a[188:191]
    v_mfma_f32_16x16x32_bf16 a[188:191], a[232:235], a[116:119], a[188:191]
    v_mfma_f32_16x16x32_bf16 a[188:191], a[228:231], a[112:115], a[188:191]
    s_waitcnt lgkmcnt(0)
    buffer_load_dwordx4 v45, s[4:7], s65 offen offset:1024 lds
    v_mfma_f32_16x16x32_bf16 v[128:131], a[212:215], a[0:3], v[128:131]
    ds_read_b64_tr_b16 a[228:229], v28 offset:16384
    v_mfma_f32_16x16x32_bf16 v[128:131], a[216:219], a[4:7], v[128:131]
    ds_read_b64_tr_b16 a[230:231], v28 offset:16896
    v_mfma_f32_16x16x32_bf16 v[128:131], a[220:223], a[8:11], v[128:131]
    ds_read_b64_tr_b16 a[232:233], v28 offset:20480
    v_mfma_f32_16x16x32_bf16 v[128:131], a[224:227], a[12:15], v[128:131]
    buffer_load_dwordx4 v46, s[4:7], s65 offen offset:2048 lds
    v_mfma_f32_16x16x32_bf16 v[132:135], a[224:227], a[28:31], v[132:135]
    ds_read_b64_tr_b16 a[234:235], v28 offset:20992
    v_mfma_f32_16x16x32_bf16 v[132:135], a[220:223], a[24:27], v[132:135]
    ds_read_b64_tr_b16 a[236:237], v28 offset:24576
    v_mfma_f32_16x16x32_bf16 v[132:135], a[216:219], a[20:23], v[132:135]
    ds_read_b64_tr_b16 a[238:239], v28 offset:25088
    v_mfma_f32_16x16x32_bf16 v[132:135], a[212:215], a[16:19], v[132:135]
    buffer_load_dwordx4 v47, s[4:7], s65 offen offset:3072 lds
    v_mfma_f32_16x16x32_bf16 v[136:139], a[212:215], a[32:35], v[136:139]
    ds_read_b64_tr_b16 a[240:241], v28 offset:28672
    v_mfma_f32_16x16x32_bf16 v[136:139], a[216:219], a[36:39], v[136:139]
    s_add_u32 m0, s60, 98304
    ds_read_b64_tr_b16 a[242:243], v28 offset:29184
    v_mfma_f32_16x16x32_bf16 v[136:139], a[220:223], a[40:43], v[136:139]
    s_add_u32 s65, s68, 1376256
    v_mfma_f32_16x16x32_bf16 v[136:139], a[224:227], a[44:47], v[136:139]
    v_mfma_f32_16x16x32_bf16 v[140:143], a[224:227], a[60:63], v[140:143]
    buffer_load_dwordx4 v36, s[12:15], s65 offen offset:0 lds
    v_mfma_f32_16x16x32_bf16 v[140:143], a[220:223], a[56:59], v[140:143]
    v_mfma_f32_16x16x32_bf16 v[140:143], a[216:219], a[52:55], v[140:143]
    v_mfma_f32_16x16x32_bf16 v[140:143], a[212:215], a[48:51], v[140:143]
    buffer_load_dwordx4 v37, s[12:15], s65 offen offset:1024 lds
    v_smfmac_f32_16x16x64_bf16 a[192:195], a[208:211], a[212:219], v20
    v_smfmac_f32_16x16x64_bf16 a[192:195], a[208:211], a[220:227], v20
    s_waitcnt lgkmcnt(0)
    v_mfma_f32_16x16x32_bf16 v[192:195], a[228:231], a[0:3], v[192:195]
    ds_read_b64_tr_b16 a[212:213], v30 offset:0
    v_mfma_f32_16x16x32_bf16 v[192:195], a[232:235], a[4:7], v[192:195]
    ds_read_b64_tr_b16 a[214:215], v30 offset:512
    v_mfma_f32_16x16x32_bf16 v[192:195], a[236:239], a[8:11], v[192:195]
    ds_read_b64_tr_b16 a[216:217], v30 offset:4096
    v_mfma_f32_16x16x32_bf16 v[192:195], a[240:243], a[12:15], v[192:195]
    buffer_load_dwordx4 v38, s[12:15], s65 offen offset:2048 lds
    v_mfma_f32_16x16x32_bf16 v[196:199], a[240:243], a[28:31], v[196:199]
    ds_read_b64_tr_b16 a[218:219], v30 offset:4608
    v_mfma_f32_16x16x32_bf16 v[196:199], a[236:239], a[24:27], v[196:199]
    ds_read_b64_tr_b16 a[220:221], v30 offset:8192
    v_mfma_f32_16x16x32_bf16 v[196:199], a[232:235], a[20:23], v[196:199]
    ds_read_b64_tr_b16 a[222:223], v30 offset:8704
    v_mfma_f32_16x16x32_bf16 v[196:199], a[228:231], a[16:19], v[196:199]
    buffer_load_dwordx4 v39, s[12:15], s65 offen offset:3072 lds
    v_mfma_f32_16x16x32_bf16 v[200:203], a[228:231], a[32:35], v[200:203]
    s_add_u32 m0, s60, 114688
    ds_read_b64_tr_b16 a[224:225], v30 offset:12288
    v_mfma_f32_16x16x32_bf16 v[200:203], a[232:235], a[36:39], v[200:203]
    s_add_u32 s65, s68, 1376256
    ds_read_b64_tr_b16 a[226:227], v30 offset:12800
    v_mfma_f32_16x16x32_bf16 v[200:203], a[236:239], a[40:43], v[200:203]
    v_mfma_f32_16x16x32_bf16 v[200:203], a[240:243], a[44:47], v[200:203]
    buffer_load_dwordx4 v36, s[16:19], s65 offen offset:0 lds
    v_mfma_f32_16x16x32_bf16 v[204:207], a[240:243], a[60:63], v[204:207]
    v_mfma_f32_16x16x32_bf16 v[204:207], a[236:239], a[56:59], v[204:207]
    v_mfma_f32_16x16x32_bf16 v[204:207], a[232:235], a[52:55], v[204:207]
    v_mfma_f32_16x16x32_bf16 v[204:207], a[228:231], a[48:51], v[204:207]
    buffer_load_dwordx4 v37, s[16:19], s65 offen offset:1024 lds
    v_smfmac_f32_16x16x64_bf16 a[196:199], a[208:211], a[228:235], v20
    v_smfmac_f32_16x16x64_bf16 a[196:199], a[208:211], a[236:243], v20
    s_waitcnt lgkmcnt(0)
    v_mfma_f32_16x16x32_bf16 v[160:163], a[212:215], a[0:3], v[160:163]
    ds_read_b64_tr_b16 a[228:229], v30 offset:16384
    v_mfma_f32_16x16x32_bf16 v[160:163], a[216:219], a[4:7], v[160:163]
    ds_read_b64_tr_b16 a[230:231], v30 offset:16896
    v_mfma_f32_16x16x32_bf16 v[160:163], a[220:223], a[8:11], v[160:163]
    ds_read_b64_tr_b16 a[232:233], v30 offset:20480
    v_mfma_f32_16x16x32_bf16 v[160:163], a[224:227], a[12:15], v[160:163]
    buffer_load_dwordx4 v38, s[16:19], s65 offen offset:2048 lds
    v_mfma_f32_16x16x32_bf16 v[164:167], a[224:227], a[28:31], v[164:167]
    ds_read_b64_tr_b16 a[234:235], v30 offset:20992
    v_mfma_f32_16x16x32_bf16 v[164:167], a[220:223], a[24:27], v[164:167]
    ds_read_b64_tr_b16 a[236:237], v30 offset:24576
    v_mfma_f32_16x16x32_bf16 v[164:167], a[216:219], a[20:23], v[164:167]
    ds_read_b64_tr_b16 a[238:239], v30 offset:25088
    v_mfma_f32_16x16x32_bf16 v[164:167], a[212:215], a[16:19], v[164:167]
    buffer_load_dwordx4 v39, s[16:19], s65 offen offset:3072 lds
    v_mfma_f32_16x16x32_bf16 v[168:171], a[212:215], a[32:35], v[168:171]
    ds_read_b64_tr_b16 a[240:241], v30 offset:28672
    v_mfma_f32_16x16x32_bf16 v[168:171], a[216:219], a[36:39], v[168:171]
    ds_read_b64_tr_b16 a[242:243], v30 offset:29184
    v_mfma_f32_16x16x32_bf16 v[168:171], a[220:223], a[40:43], v[168:171]
    v_mfma_f32_16x16x32_bf16 v[168:171], a[224:227], a[44:47], v[168:171]
    v_mfma_f32_16x16x32_bf16 v[172:175], a[224:227], a[60:63], v[172:175]
    v_mfma_f32_16x16x32_bf16 v[172:175], a[220:223], a[56:59], v[172:175]
    v_mfma_f32_16x16x32_bf16 v[172:175], a[216:219], a[52:55], v[172:175]
    s_add_u32 m0, s59, 131072
    v_mfma_f32_16x16x32_bf16 v[172:175], a[212:215], a[48:51], v[172:175]
    s_add_u32 s65, s67, 2097152
    v_smfmac_f32_16x16x64_bf16 v[176:179], a[208:211], a[212:219], v20
    buffer_load_dwordx4 v32, s[8:11], s65 offen offset:0 lds
    v_smfmac_f32_16x16x64_bf16 v[176:179], a[208:211], a[220:227], v20
    s_waitcnt lgkmcnt(0)
    v_mfma_f32_16x16x32_bf16 v[224:227], a[228:231], a[0:3], v[224:227]
    ds_read_b64_tr_b16 a[212:213], v29 offset:0
    v_mfma_f32_16x16x32_bf16 v[224:227], a[232:235], a[4:7], v[224:227]
    ds_read_b64_tr_b16 a[214:215], v29 offset:512
    v_mfma_f32_16x16x32_bf16 v[224:227], a[236:239], a[8:11], v[224:227]
    ds_read_b64_tr_b16 a[216:217], v29 offset:4096
    v_mfma_f32_16x16x32_bf16 v[224:227], a[240:243], a[12:15], v[224:227]
    buffer_load_dwordx4 v33, s[8:11], s65 offen offset:1024 lds
    v_mfma_f32_16x16x32_bf16 v[228:231], a[240:243], a[28:31], v[228:231]
    ds_read_b64_tr_b16 a[218:219], v29 offset:4608
    v_mfma_f32_16x16x32_bf16 v[228:231], a[236:239], a[24:27], v[228:231]
    ds_read_b64_tr_b16 a[220:221], v29 offset:8192
    v_mfma_f32_16x16x32_bf16 v[228:231], a[232:235], a[20:23], v[228:231]
    ds_read_b64_tr_b16 a[222:223], v29 offset:8704
    v_mfma_f32_16x16x32_bf16 v[228:231], a[228:231], a[16:19], v[228:231]
    buffer_load_dwordx4 v34, s[8:11], s65 offen offset:2048 lds
    v_mfma_f32_16x16x32_bf16 v[232:235], a[228:231], a[32:35], v[232:235]
    s_waitcnt vmcnt(11)
    ds_read_b64_tr_b16 a[224:225], v29 offset:12288
    ds_read_b128 a[64:67], v40 offset:0
    v_mfma_f32_16x16x32_bf16 v[232:235], a[232:235], a[36:39], v[232:235]
    ds_read_b64_tr_b16 a[226:227], v29 offset:12800
    ds_read_b128 a[68:71], v41 offset:0
    v_mfma_f32_16x16x32_bf16 v[232:235], a[236:239], a[40:43], v[232:235]
    buffer_load_dwordx4 v35, s[8:11], s65 offen offset:3072 lds
    v_mfma_f32_16x16x32_bf16 v[232:235], a[240:243], a[44:47], v[232:235]
    ds_read_b128 a[72:75], v42 offset:0
    ds_read_b128 a[76:79], v43 offset:0
    v_mfma_f32_16x16x32_bf16 v[236:239], a[240:243], a[60:63], v[236:239]
    s_add_u32 m0, s59, 135168
    ds_read_b128 a[80:83], v40 offset:4096
    ds_read_b128 a[84:87], v41 offset:4096
    v_mfma_f32_16x16x32_bf16 v[236:239], a[236:239], a[56:59], v[236:239]
    s_add_u32 s65, s67, 2228224
    ds_read_b128 a[88:91], v42 offset:4096
    ds_read_b128 a[92:95], v43 offset:4096
    v_mfma_f32_16x16x32_bf16 v[236:239], a[232:235], a[52:55], v[236:239]
    ds_read_b128 a[96:99], v40 offset:8192
    ds_read_b128 a[100:103], v41 offset:8192
    v_mfma_f32_16x16x32_bf16 v[236:239], a[228:231], a[48:51], v[236:239]
    buffer_load_dwordx4 v32, s[8:11], s65 offen offset:0 lds
    v_smfmac_f32_16x16x64_bf16 v[180:183], a[208:211], a[228:235], v20
    ds_read_b128 a[104:107], v42 offset:8192
    v_smfmac_f32_16x16x64_bf16 v[180:183], a[208:211], a[236:243], v20
    s_waitcnt lgkmcnt(10)
    ds_read_b128 a[108:111], v43 offset:8192
    v_mfma_f32_16x16x32_bf16 v[144:147], a[212:215], a[0:3], v[144:147]
    ds_read_b64_tr_b16 a[228:229], v29 offset:16384
    ds_read_b128 a[112:115], v40 offset:12288
    v_mfma_f32_16x16x32_bf16 v[144:147], a[216:219], a[4:7], v[144:147]
    ds_read_b64_tr_b16 a[230:231], v29 offset:16896
    ds_read_b128 a[116:119], v41 offset:12288
    v_mfma_f32_16x16x32_bf16 v[144:147], a[220:223], a[8:11], v[144:147]
    ds_read_b64_tr_b16 a[232:233], v29 offset:20480
    ds_read_b128 a[120:123], v42 offset:12288
    v_mfma_f32_16x16x32_bf16 v[144:147], a[224:227], a[12:15], v[144:147]
    buffer_load_dwordx4 v33, s[8:11], s65 offen offset:1024 lds
    v_mfma_f32_16x16x32_bf16 v[148:151], a[224:227], a[28:31], v[148:151]
    ds_read_b64_tr_b16 a[234:235], v29 offset:20992
    ds_read_b128 a[124:127], v43 offset:12288
    v_mfma_f32_16x16x32_bf16 v[148:151], a[220:223], a[24:27], v[148:151]
    ds_read_b64_tr_b16 a[236:237], v29 offset:24576
    v_mfma_f32_16x16x32_bf16 v[148:151], a[216:219], a[20:23], v[148:151]
    ds_read_b64_tr_b16 a[238:239], v29 offset:25088
    v_mfma_f32_16x16x32_bf16 v[148:151], a[212:215], a[16:19], v[148:151]
    buffer_load_dwordx4 v34, s[8:11], s65 offen offset:2048 lds
    v_mfma_f32_16x16x32_bf16 v[152:155], a[212:215], a[32:35], v[152:155]
    ds_read_b64_tr_b16 a[240:241], v29 offset:28672
    v_mfma_f32_16x16x32_bf16 v[152:155], a[216:219], a[36:39], v[152:155]
    ds_read_b64_tr_b16 a[242:243], v29 offset:29184
    v_mfma_f32_16x16x32_bf16 v[152:155], a[220:223], a[40:43], v[152:155]
    buffer_load_dwordx4 v35, s[8:11], s65 offen offset:3072 lds
    v_mfma_f32_16x16x32_bf16 v[152:155], a[224:227], a[44:47], v[152:155]
    v_mfma_f32_16x16x32_bf16 v[156:159], a[224:227], a[60:63], v[156:159]
    v_mfma_f32_16x16x32_bf16 v[156:159], a[220:223], a[56:59], v[156:159]
    v_mfma_f32_16x16x32_bf16 v[156:159], a[216:219], a[52:55], v[156:159]
    v_mfma_f32_16x16x32_bf16 v[156:159], a[212:215], a[48:51], v[156:159]
    s_waitcnt lgkmcnt(0)
    v_mfma_f32_16x16x32_bf16 v[208:211], a[228:231], a[0:3], v[208:211]
    s_waitcnt vmcnt(8) lgkmcnt(4)
    v_mfma_f32_16x16x32_bf16 v[208:211], a[232:235], a[4:7], v[208:211]
    s_barrier
    v_mfma_f32_16x16x32_bf16 v[208:211], a[236:239], a[8:11], v[208:211]
    ds_read_b64_tr_b16 a[212:213], v28 offset:32768
    v_mfma_f32_16x16x32_bf16 v[208:211], a[240:243], a[12:15], v[208:211]
    ds_read_b64_tr_b16 a[214:215], v28 offset:33280
    v_mfma_f32_16x16x32_bf16 v[212:215], a[240:243], a[28:31], v[212:215]
    ds_read_b64_tr_b16 a[216:217], v28 offset:36864
    v_mfma_f32_16x16x32_bf16 v[212:215], a[236:239], a[24:27], v[212:215]
    ds_read_b64_tr_b16 a[218:219], v28 offset:37376
    v_mfma_f32_16x16x32_bf16 v[212:215], a[232:235], a[20:23], v[212:215]
    ds_read_b64_tr_b16 a[220:221], v28 offset:40960
    v_mfma_f32_16x16x32_bf16 v[212:215], a[228:231], a[16:19], v[212:215]
    ds_read_b64_tr_b16 a[222:223], v28 offset:41472
    v_mfma_f32_16x16x32_bf16 v[216:219], a[228:231], a[32:35], v[216:219]
    ds_read_b64_tr_b16 a[224:225], v28 offset:45056
    v_mfma_f32_16x16x32_bf16 v[216:219], a[232:235], a[36:39], v[216:219]
    ds_read_b64_tr_b16 a[226:227], v28 offset:45568
    v_mfma_f32_16x16x32_bf16 v[216:219], a[236:239], a[40:43], v[216:219]
    buffer_load_dword v50, v51, s[40:43], 0 offen sc1
    v_mfma_f32_16x16x32_bf16 v[216:219], a[240:243], a[44:47], v[216:219]
    v_mfma_f32_16x16x32_bf16 v[220:223], a[240:243], a[60:63], v[220:223]
    v_mfma_f32_16x16x32_bf16 v[220:223], a[236:239], a[56:59], v[220:223]
    v_mfma_f32_16x16x32_bf16 v[220:223], a[232:235], a[52:55], v[220:223]
    v_mfma_f32_16x16x32_bf16 v[220:223], a[228:231], a[48:51], v[220:223]
    s_waitcnt lgkmcnt(0)
    v_mfma_f32_16x16x32_bf16 v[128:131], a[212:215], a[64:67], v[128:131]
    ds_read_b64_tr_b16 a[228:229], v28 offset:49152
    v_mfma_f32_16x16x32_bf16 v[128:131], a[216:219], a[68:71], v[128:131]
    s_add_u32 m0, s59, 65536
    ds_read_b64_tr_b16 a[230:231], v28 offset:49664
    v_mfma_f32_16x16x32_bf16 v[128:131], a[220:223], a[72:75], v[128:131]
    s_add_u32 s65, s67, 3145728
    ds_read_b64_tr_b16 a[232:233], v28 offset:53248
    v_mfma_f32_16x16x32_bf16 v[128:131], a[224:227], a[76:79], v[128:131]
    buffer_load_dwordx4 v32, s[8:11], s65 offen offset:0 lds
    v_mfma_f32_16x16x32_bf16 v[132:135], a[224:227], a[92:95], v[132:135]
    ds_read_b64_tr_b16 a[234:235], v28 offset:53760
    v_mfma_f32_16x16x32_bf16 v[132:135], a[220:223], a[88:91], v[132:135]
    ds_read_b64_tr_b16 a[236:237], v28 offset:57344
    v_mfma_f32_16x16x32_bf16 v[132:135], a[216:219], a[84:87], v[132:135]
    ds_read_b64_tr_b16 a[238:239], v28 offset:57856
    v_mfma_f32_16x16x32_bf16 v[132:135], a[212:215], a[80:83], v[132:135]
    buffer_load_dwordx4 v33, s[8:11], s65 offen offset:1024 lds
    v_mfma_f32_16x16x32_bf16 v[136:139], a[212:215], a[96:99], v[136:139]
    ds_read_b64_tr_b16 a[240:241], v28 offset:61440
    v_mfma_f32_16x16x32_bf16 v[136:139], a[216:219], a[100:103], v[136:139]
    ds_read_b64_tr_b16 a[242:243], v28 offset:61952
    v_mfma_f32_16x16x32_bf16 v[136:139], a[220:223], a[104:107], v[136:139]
    v_mfma_f32_16x16x32_bf16 v[136:139], a[224:227], a[108:111], v[136:139]
    buffer_load_dwordx4 v34, s[8:11], s65 offen offset:2048 lds
    v_mfma_f32_16x16x32_bf16 v[140:143], a[224:227], a[124:127], v[140:143]
    v_mfma_f32_16x16x32_bf16 v[140:143], a[220:223], a[120:123], v[140:143]
    v_mfma_f32_16x16x32_bf16 v[140:143], a[216:219], a[116:119], v[140:143]
    v_mfma_f32_16x16x32_bf16 v[140:143], a[212:215], a[112:115], v[140:143]
    buffer_load_dwordx4 v35, s[8:11], s65 offen offset:3072 lds
    v_smfmac_f32_16x16x64_bf16 a[192:195], a[208:211], a[212:219], v20
    s_add_u32 m0, s59, 69632
    v_smfmac_f32_16x16x64_bf16 a[192:195], a[208:211], a[220:227], v20
    s_waitcnt lgkmcnt(0)
    v_mfma_f32_16x16x32_bf16 v[192:195], a[228:231], a[64:67], v[192:195]
    s_add_u32 s65, s67, 3276800
    ds_read_b64_tr_b16 a[212:213], v30 offset:32768
    v_mfma_f32_16x16x32_bf16 v[192:195], a[232:235], a[68:71], v[192:195]
    ds_read_b64_tr_b16 a[214:215], v30 offset:33280
    v_mfma_f32_16x16x32_bf16 v[192:195], a[236:239], a[72:75], v[192:195]
    ds_read_b64_tr_b16 a[216:217], v30 offset:36864
    v_mfma_f32_16x16x32_bf16 v[192:195], a[240:243], a[76:79], v[192:195]
    buffer_load_dwordx4 v32, s[8:11], s65 offen offset:0 lds
    v_mfma_f32_16x16x32_bf16 v[196:199], a[240:243], a[92:95], v[196:199]
    ds_read_b64_tr_b16 a[218:219], v30 offset:37376
    v_mfma_f32_16x16x32_bf16 v[196:199], a[236:239], a[88:91], v[196:199]
    ds_read_b64_tr_b16 a[220:221], v30 offset:40960
    v_mfma_f32_16x16x32_bf16 v[196:199], a[232:235], a[84:87], v[196:199]
    ds_read_b64_tr_b16 a[222:223], v30 offset:41472
    v_mfma_f32_16x16x32_bf16 v[196:199], a[228:231], a[80:83], v[196:199]
    buffer_load_dwordx4 v33, s[8:11], s65 offen offset:1024 lds
    v_mfma_f32_16x16x32_bf16 v[200:203], a[228:231], a[96:99], v[200:203]
    ds_read_b64_tr_b16 a[224:225], v30 offset:45056
    v_mfma_f32_16x16x32_bf16 v[200:203], a[232:235], a[100:103], v[200:203]
    ds_read_b64_tr_b16 a[226:227], v30 offset:45568
    v_mfma_f32_16x16x32_bf16 v[200:203], a[236:239], a[104:107], v[200:203]
    buffer_load_dwordx4 v34, s[8:11], s65 offen offset:2048 lds
    v_mfma_f32_16x16x32_bf16 v[200:203], a[240:243], a[108:111], v[200:203]
    v_mfma_f32_16x16x32_bf16 v[204:207], a[240:243], a[124:127], v[204:207]
    v_mfma_f32_16x16x32_bf16 v[204:207], a[236:239], a[120:123], v[204:207]
    buffer_load_dwordx4 v35, s[8:11], s65 offen offset:3072 lds
    v_mfma_f32_16x16x32_bf16 v[204:207], a[232:235], a[116:119], v[204:207]
    v_mfma_f32_16x16x32_bf16 v[204:207], a[228:231], a[112:115], v[204:207]
    v_smfmac_f32_16x16x64_bf16 a[196:199], a[208:211], a[228:235], v20
    s_waitcnt vmcnt(8)
    v_cmp_gt_u32 vcc, 32, v50
    s_nop 0
    s_cmp_eq_u64 vcc, 0
    s_cbranch_scc0 L_spin_stS
L_back_stS:
    v_smfmac_f32_16x16x64_bf16 a[196:199], a[208:211], a[236:243], v20
    s_waitcnt lgkmcnt(0)
    v_mfma_f32_16x16x32_bf16 v[160:163], a[212:215], a[64:67], v[160:163]
    ds_read_b64_tr_b16 a[228:229], v30 offset:49152
    v_mfma_f32_16x16x32_bf16 v[160:163], a[216:219], a[68:71], v[160:163]
    ds_read_b64_tr_b16 a[230:231], v30 offset:49664
    v_mfma_f32_16x16x32_bf16 v[160:163], a[220:223], a[72:75], v[160:163]
    ds_read_b64_tr_b16 a[232:233], v30 offset:53248
    v_mfma_f32_16x16x32_bf16 v[160:163], a[224:227], a[76:79], v[160:163]
    buffer_load_dwordx2 v[56:57], v52, s[36:39], 0 offen offset:0 sc1
    v_mfma_f32_16x16x32_bf16 v[164:167], a[224:227], a[92:95], v[164:167]
    ds_read_b64_tr_b16 a[234:235], v30 offset:53760
    v_mfma_f32_16x16x32_bf16 v[164:167], a[220:223], a[88:91], v[164:167]
    ds_read_b64_tr_b16 a[236:237], v30 offset:57344
    v_mfma_f32_16x16x32_bf16 v[164:167], a[216:219], a[84:87], v[164:167]
    ds_read_b64_tr_b16 a[238:239], v30 offset:57856
    v_mfma_f32_16x16x32_bf16 v[164:167], a[212:215], a[80:83], v[164:167]
    buffer_load_dwordx2 v[58:59], v52, s[36:39], 0 offen offset:128 sc1
    v_mfma_f32_16x16x32_bf16 v[168:171], a[212:215], a[96:99], v[168:171]
    ds_read_b64_tr_b16 a[240:241], v30 offset:61440
    v_mfma_f32_16x16x32_bf16 v[168:171], a[216:219], a[100:103], v[168:171]
    ds_read_b64_tr_b16 a[242:243], v30 offset:61952
    v_mfma_f32_16x16x32_bf16 v[168:171], a[220:223], a[104:107], v[168:171]
    buffer_load_dwordx2 v[60:61], v52, s[36:39], 0 offen offset:256 sc1
    v_mfma_f32_16x16x32_bf16 v[168:171], a[224:227], a[108:111], v[168:171]
    buffer_load_dwordx2 v[62:63], v52, s[36:39], 0 offen offset:384 sc1
    v_mfma_f32_16x16x32_bf16 v[172:175], a[224:227], a[124:127], v[172:175]
    v_mfma_f32_16x16x32_bf16 v[172:175], a[220:223], a[120:123], v[172:175]
    s_add_u32 m0, s59, 0
    v_mfma_f32_16x16x32_bf16 v[172:175], a[216:219], a[116:119], v[172:175]
    v_mfma_f32_16x16x32_bf16 v[172:175], a[212:215], a[112:115], v[172:175]
    buffer_load_dwordx4 v14, s[20:23], s62 offen offset:0 lds
    v_smfmac_f32_16x16x64_bf16 v[176:179], a[208:211], a[212:219], v20
    v_smfmac_f32_16x16x64_bf16 v[176:179], a[208:211], a[220:227], v20
    s_waitcnt lgkmcnt(0)
    v_mfma_f32_16x16x32_bf16 v[224:227], a[228:231], a[64:67], v[224:227]
    ds_read_b64_tr_b16 a[212:213], v29 offset:32768
    v_accvgpr_read_b32 v22, a192
    v_mfma_f32_16x16x32_bf16 v[224:227], a[232:235], a[68:71], v[224:227]
    ds_read_b64_tr_b16 a[214:215], v29 offset:33280
    v_accvgpr_read_b32 v23, a193
    v_mfma_f32_16x16x32_bf16 v[224:227], a[236:239], a[72:75], v[224:227]
    ds_read_b64_tr_b16 a[216:217], v29 offset:36864
    v_add_f32 v22, v22, v23
    v_mfma_f32_16x16x32_bf16 v[224:227], a[240:243], a[76:79], v[224:227]
    buffer_load_dwordx4 v15, s[20:23], s62 offen offset:1024 lds
    v_mfma_f32_16x16x32_bf16 v[228:231], a[240:243], a[92:95], v[228:231]
    ds_read_b64_tr_b16 a[218:219], v29 offset:37376
    v_mfma_f32_16x16x32_bf16 v[228:231], a[236:239], a[88:91], v[228:231]
    ds_read_b64_tr_b16 a[220:221], v29 offset:40960
    v_mfma_f32_16x16x32_bf16 v[228:231], a[232:235], a[84:87], v[228:231]
    ds_read_b64_tr_b16 a[222:223], v29 offset:41472
    v_mfma_f32_16x16x32_bf16 v[228:231], a[228:231], a[80:83], v[228:231]
    ds_write_b32 v21, v22 offset:0
    v_accvgpr_read_b32 v22, a196
    v_mfma_f32_16x16x32_bf16 v[232:235], a[228:231], a[96:99], v[232:235]
    ds_read_b64_tr_b16 a[224:225], v29 offset:45056
    v_accvgpr_read_b32 v23, a197
    v_mfma_f32_16x16x32_bf16 v[232:235], a[232:235], a[100:103], v[232:235]
    ds_read_b64_tr_b16 a[226:227], v29 offset:45568
    v_add_f32 v22, v22, v23
    v_mfma_f32_16x16x32_bf16 v[232:235], a[236:239], a[104:107], v[232:235]
    ds_write_b32 v21, v22 offset:64
    v_mfma_f32_16x16x32_bf16 v[232:235], a[240:243], a[108:111], v[232:235]
    buffer_load_dwordx4 v16, s[20:23], s62 offen offset:2048 lds
    v_mfma_f32_16x16x32_bf16 v[236:239], a[240:243], a[124:127], v[236:239]
    v_mfma_f32_16x16x32_bf16 v[236:239], a[236:239], a[120:123], v[236:239]
    v_mfma_f32_16x16x32_bf16 v[236:239], a[232:235], a[116:119], v[236:239]
    v_mfma_f32_16x16x32_bf16 v[236:239], a[228:231], a[112:115], v[236:239]
    v_smfmac_f32_16x16x64_bf16 v[180:183], a[208:211], a[228:235], v20
    v_smfmac_f32_16x16x64_bf16 v[180:183], a[208:211], a[236:243], v20
    s_waitcnt lgkmcnt(1)
    v_mfma_f32_16x16x32_bf16 v[144:147], a[212:215], a[64:67], v[144:147]
    ds_read_b64_tr_b16 a[228:229], v29 offset:49152
    buffer_load_dwordx4 v17, s[20:23], s62 offen offset:3072 lds
    v_mfma_f32_16x16x32_bf16 v[144:147], a[216:219], a[68:71], v[144:147]
    s_add_u32 s62, s62, 4096
    ds_read_b64_tr_b16 a[230:231], v29 offset:49664
    v_mfma_f32_16x16x32_bf16 v[144:147], a[220:223], a[72:75], v[144:147]
    ds_read_b64_tr_b16 a[232:233], v29 offset:53248
    v_mfma_f32_16x16x32_bf16 v[144:147], a[224:227], a[76:79], v[144:147]
    v_mfma_f32_16x16x32_bf16 v[148:151], a[224:227], a[92:95], v[148:151]
    ds_read_b64_tr_b16 a[234:235], v29 offset:53760
    v_mfma_f32_16x16x32_bf16 v[148:151], a[220:223], a[88:91], v[148:151]
    s_add_u32 m0, s59, 4096
    ds_read_b64_tr_b16 a[236:237], v29 offset:57344
    v_mfma_f32_16x16x32_bf16 v[148:151], a[216:219], a[84:87], v[148:151]
    ds_read_b64_tr_b16 a[238:239], v29 offset:57856
    v_add_f32 v176, v176, v177
    v_mfma_f32_16x16x32_bf16 v[148:151], a[212:215], a[80:83], v[148:151]
    buffer_load_dwordx4 v14, s[20:23], s62 offen offset:0 lds
    v_mfma_f32_16x16x32_bf16 v[152:155], a[212:215], a[96:99], v[152:155]
    ds_read_b64_tr_b16 a[240:241], v29 offset:61440
    v_mfma_f32_16x16x32_bf16 v[152:155], a[216:219], a[100:103], v[152:155]
    ds_read_b64_tr_b16 a[242:243], v29 offset:61952
    v_mfma_f32_16x16x32_bf16 v[152:155], a[220:223], a[104:107], v[152:155]
    ds_write_b32 v21, v176 offset:512
    v_add_f32 v180, v180, v181
    v_mfma_f32_16x16x32_bf16 v[152:155], a[224:227], a[108:111], v[152:155]
    ds_write_b32 v21, v180 offset:576
    v_add_u32 v21, 98304, v21
    v_mfma_f32_16x16x32_bf16 v[156:159], a[224:227], a[124:127], v[156:159]
    s_waitcnt vmcnt(5)
    v_rsq_f32 v36, v57
    v_mfma_f32_16x16x32_bf16 v[156:159], a[220:223], a[120:123], v[156:159]
    v_rsq_f32 v37, v59
    v_mfma_f32_16x16x32_bf16 v[156:159], a[216:219], a[116:119], v[156:159]
    buffer_load_dwordx4 v15, s[20:23], s62 offen offset:1024 lds
    v_mfma_f32_16x16x32_bf16 v[156:159], a[212:215], a[112:115], v[156:159]
    s_waitcnt lgkmcnt(2)
    v_rsq_f32 v38, v61
    v_mfma_f32_16x16x32_bf16 v[208:211], a[228:231], a[64:67], v[208:211]
    s_waitcnt vmcnt(19) lgkmcnt(0)
    v_rsq_f32 v39, v63
    v_mfma_f32_16x16x32_bf16 v[208:211], a[232:235], a[68:71], v[208:211]
    s_barrier
    v_sub_f32 v32, 0, v56
    v_mov_b32 v44, v57
    v_mfma_f32_16x16x32_bf16 v[208:211], a[236:239], a[72:75], v[208:211]
    ds_read_b64_tr_b16 a[212:213], v24 offset:0
    v_sub_f32 v33, 0, v58
    v_mfma_f32_16x16x32_bf16 v[208:211], a[240:243], a[76:79], v[208:211]
    ds_read_b64_tr_b16 a[214:215], v24 offset:1024
    v_mov_b32 v45, v59
    v_mfma_f32_16x16x32_bf16 v[212:215], a[240:243], a[92:95], v[212:215]
    ds_read_b64_tr_b16 a[216:217], v24 offset:8192
    v_sub_f32 v34, 0, v60
    v_mfma_f32_16x16x32_bf16 v[212:215], a[236:239], a[88:91], v[212:215]
    ds_read_b64_tr_b16 a[218:219], v24 offset:9216
    buffer_load_dwordx4 v16, s[20:23], s62 offen offset:2048 lds
    v_mfma_f32_16x16x32_bf16 v[212:215], a[232:235], a[84:87], v[212:215]
    ds_read_b64_tr_b16 a[220:221], v24 offset:16384
    v_mov_b32 v46, v61
    v_mfma_f32_16x16x32_bf16 v[212:215], a[228:231], a[80:83], v[212:215]
    ds_read_b64_tr_b16 a[222:223], v24 offset:17408
    v_sub_f32 v35, 0, v62
    v_mfma_f32_16x16x32_bf16 v[216:219], a[228:231], a[96:99], v[216:219]
    ds_read_b64_tr_b16 a[224:225], v24 offset:24576
    v_mov_b32 v47, v63
    v_mfma_f32_16x16x32_bf16 v[216:219], a[232:235], a[100:103], v[216:219]
    ds_read_b64_tr_b16 a[226:227], v24 offset:25600
    v_mul_f32 v40, 0xbfb8aa3b, v36
    v_mfma_f32_16x16x32_bf16 v[216:219], a[236:239], a[104:107], v[216:219]
    v_mul_f32 v36, 0x3e0293ee, v36
    v_mul_f32 v41, 0xbfb8aa3b, v37
    v_mfma_f32_16x16x32_bf16 v[216:219], a[240:243], a[108:111], v[216:219]
    v_mul_f32 v37, 0x3e0293ee, v37
    v_mul_f32 v42, 0xbfb8aa3b, v38
    v_mfma_f32_16x16x32_bf16 v[220:223], a[240:243], a[124:127], v[220:223]
    buffer_load_dwordx4 v17, s[20:23], s62 offen offset:3072 lds
    v_mfma_f32_16x16x32_bf16 v[220:223], a[236:239], a[120:123], v[220:223]
    s_add_u32 s62, s62, 28672
    v_mul_f32 v38, 0x3e0293ee, v38
    v_mul_f32 v43, 0xbfb8aa3b, v39
    v_mfma_f32_16x16x32_bf16 v[220:223], a[232:235], a[116:119], v[220:223]
    v_mul_f32 v39, 0x3e0293ee, v39
    v_mfma_f32_16x16x32_bf16 v[220:223], a[228:231], a[112:115], v[220:223]
    s_waitcnt lgkmcnt(0)
    v_mfma_f32_16x16x32_bf16 v[64:67], a[212:215], a[0:3], v[64:67]
    ds_read_b64_tr_b16 a[228:229], v24 offset:8
    v_mfma_f32_16x16x32_bf16 v[64:67], a[216:219], a[4:7], v[64:67]
    ds_read_b64_tr_b16 a[230:231], v24 offset:1032
    v_mfma_f32_16x16x32_bf16 v[64:67], a[220:223], a[8:11], v[64:67]
    ds_read_b64_tr_b16 a[232:233], v24 offset:8200
    v_xor_b32 v28, 0, v54
    v_mfma_f32_16x16x32_bf16 v[64:67], a[224:227], a[12:15], v[64:67]
    v_xor_b32 v29, 128, v54
    v_xor_b32 v30, 512, v54
    v_mfma_f32_16x16x32_bf16 v[80:83], a[224:227], a[28:31], v[80:83]
    ds_read_b64_tr_b16 a[234:235], v24 offset:9224
    v_mfma_f32_16x16x32_bf16 v[80:83], a[220:223], a[24:27], v[80:83]
    ds_read_b64_tr_b16 a[236:237], v24 offset:16392
    v_mfma_f32_16x16x32_bf16 v[80:83], a[216:219], a[20:23], v[80:83]
    ds_read_b64_tr_b16 a[238:239], v24 offset:17416
    v_mfma_f32_16x16x32_bf16 v[80:83], a[212:215], a[16:19], v[80:83]
    ds_read_b128 v[48:51], v28 offset:0
    v_mfma_f32_16x16x32_bf16 v[96:99], a[212:215], a[32:35], v[96:99]
    ds_read_b64_tr_b16 a[240:241], v24 offset:24584
    v_mfma_f32_16x16x32_bf16 v[96:99], a[216:219], a[36:39], v[96:99]
    ds_read_b64_tr_b16 a[242:243], v24 offset:25608
    v_mfma_f32_16x16x32_bf16 v[96:99], a[220:223], a[40:43], v[96:99]
    ds_read_b128 v[52:55], v28 offset:64
    v_mfma_f32_16x16x32_bf16 v[96:99], a[224:227], a[44:47], v[96:99]
    ds_read_b128 v[56:59], v29 offset:0
    v_mfma_f32_16x16x32_bf16 v[112:115], a[224:227], a[60:63], v[112:115]
    ds_read_b128 v[60:63], v29 offset:64
    v_mfma_f32_16x16x32_bf16 v[112:115], a[220:223], a[56:59], v[112:115]
    v_mfma_f32_16x16x32_bf16 v[112:115], a[216:219], a[52:55], v[112:115]
    v_mfma_f32_16x16x32_bf16 v[112:115], a[212:215], a[48:51], v[112:115]
    v_smfmac_f32_16x16x64_bf16 a[200:203], a[208:211], a[212:219], v20
    s_waitcnt lgkmcnt(2)
    v_fmac_f32 v128, v48, v32
    v_smfmac_f32_16x16x64_bf16 a[200:203], a[208:211], a[220:227], v20
    s_waitcnt lgkmcnt(3)
    v_fmac_f32 v129, v49, v32
    v_mfma_f32_16x16x32_bf16 a[128:131], a[228:231], a[0:3], a[128:131]
    s_waitcnt lgkmcnt(0)
    ds_read_b64_tr_b16 a[212:213], v25 offset:0
    v_fmac_f32 v130, v50, v32
    v_mfma_f32_16x16x32_bf16 a[128:131], a[232:235], a[4:7], a[128:131]
    ds_read_b64_tr_b16 a[214:215], v25 offset:1024
    v_fmac_f32 v131, v51, v32
    v_mfma_f32_16x16x32_bf16 a[128:131], a[236:239], a[8:11], a[128:131]
    ds_read_b64_tr_b16 a[216:217], v25 offset:8192
    v_fmac_f32 v132, v48, v33
    v_mfma_f32_16x16x32_bf16 a[128:131], a[240:243], a[12:15], a[128:131]
    v_fmac_f32 v133, v49, v33
    v_fmac_f32 v134, v50, v33
    v_mfma_f32_16x16x32_bf16 a[144:147], a[240:243], a[28:31], a[144:147]
    ds_read_b64_tr_b16 a[218:219], v25 offset:9216
    v_fmac_f32 v135, v51, v33
    v_mfma_f32_16x16x32_bf16 a[144:147], a[236:239], a[24:27], a[144:147]
    ds_read_b64_tr_b16 a[220:221], v25 offset:16384
    v_fmac_f32 v136, v48, v34
    v_mfma_f32_16x16x32_bf16 a[144:147], a[232:235], a[20:23], a[144:147]
    ds_read_b64_tr_b16 a[222:223], v25 offset:17408
    v_fmac_f32 v137, v49, v34
    v_mfma_f32_16x16x32_bf16 a[144:147], a[228:231], a[16:19], a[144:147]
    v_fmac_f32 v138, v50, v34
    v_fmac_f32 v139, v51, v34
    v_mfma_f32_16x16x32_bf16 a[160:163], a[228:231], a[32:35], a[160:163]
    ds_read_b64_tr_b16 a[224:225], v25 offset:24576
    v_fmac_f32 v140, v48, v35
    v_mfma_f32_16x16x32_bf16 a[160:163], a[232:235], a[36:39], a[160:163]
    ds_read_b64_tr_b16 a[226:227], v25 offset:25600
    v_fmac_f32 v141, v49, v35
    v_mfma_f32_16x16x32_bf16 a[160:163], a[236:239], a[40:43], a[160:163]
    v_fmac_f32 v142, v50, v35
    v_fmac_f32 v143, v51, v35
    v_mfma_f32_16x16x32_bf16 a[160:163], a[240:243], a[44:47], a[160:163]
    v_fmac_f32 v192, v52, v32
    v_fmac_f32 v193, v53, v32
    v_mfma_f32_16x16x32_bf16 a[176:179], a[240:243], a[60:63], a[176:179]
    v_fmac_f32 v194, v54, v32
    v_fmac_f32 v195, v55, v32
    v_mfma_f32_16x16x32_bf16 a[176:179], a[236:239], a[56:59], a[176:179]
    v_fmac_f32 v196, v52, v33
    v_fmac_f32 v197, v53, v33
    v_mfma_f32_16x16x32_bf16 a[176:179], a[232:235], a[52:55], a[176:179]
    v_fmac_f32 v198, v54, v33
    v_fmac_f32 v199, v55, v33
    v_mfma_f32_16x16x32_bf16 a[176:179], a[228:231], a[48:51], a[176:179]
    v_fmac_f32 v200, v52, v34
    v_fmac_f32 v201, v53, v34
    v_smfmac_f32_16x16x64_bf16 a[204:207], a[208:211], a[228:235], v20
    v_fmac_f32 v202, v54, v34
    v_smfmac_f32_16x16x64_bf16 a[204:207], a[208:211], a[236:243], v20
    s_waitcnt lgkmcnt(0)
    v_fmac_f32 v203, v55, v34
    v_mfma_f32_16x16x32_bf16 v[68:71], a[212:215], a[0:3], v[68:71]
    ds_read_b64_tr_b16 a[228:229], v25 offset:8
    v_fmac_f32 v204, v52, v35
    v_mfma_f32_16x16x32_bf16 v[68:71], a[216:219], a[4:7], v[68:71]
    s_add_u32 m0, s59, 98304
    ds_read_b64_tr_b16 a[230:231], v25 offset:1032
    v_fmac_f32 v205, v53, v35
    v_mfma_f32_16x16x32_bf16 v[68:71], a[220:223], a[8:11], v[68:71]
    ds_read_b64_tr_b16 a[232:233], v25 offset:8200
    v_fmac_f32 v206, v54, v35
    v_mfma_f32_16x16x32_bf16 v[68:71], a[224:227], a[12:15], v[68:71]
    s_add_u32 s64, s92, s69
    buffer_load_dwordx4 v18, s[24:27], s63 offen offset:0 lds
    v_mfma_f32_16x16x32_bf16 v[84:87], a[224:227], a[28:31], v[84:87]
    s_and_b32 s66, s56, 1
    ds_read_b64_tr_b16 a[234:235], v25 offset:9224
    v_fmac_f32 v207, v55, v35
    v_mfma_f32_16x16x32_bf16 v[84:87], a[220:223], a[24:27], v[84:87]
    s_lshl_b32 s66, s66, 11
    ds_read_b64_tr_b16 a[236:237], v25 offset:16392
    v_fmac_f32 v144, v56, v32
    v_mfma_f32_16x16x32_bf16 v[84:87], a[216:219], a[20:23], v[84:87]
    ds_read_b64_tr_b16 a[238:239], v25 offset:17416
    v_fmac_f32 v145, v57, v32
    v_mfma_f32_16x16x32_bf16 v[84:87], a[212:215], a[16:19], v[84:87]
    ds_read_b128 v[48:51], v30 offset:0
    v_fmac_f32 v146, v58, v32
    v_mfma_f32_16x16x32_bf16 v[100:103], a[212:215], a[32:35], v[100:103]
    ds_read_b64_tr_b16 a[240:241], v25 offset:24584
    v_fmac_f32 v147, v59, v32
    v_mfma_f32_16x16x32_bf16 v[100:103], a[216:219], a[36:39], v[100:103]
    ds_read_b64_tr_b16 a[242:243], v25 offset:25608
    v_fmac_f32 v148, v56, v33
    v_mfma_f32_16x16x32_bf16 v[100:103], a[220:223], a[40:43], v[100:103]
    ds_read_b128 v[52:55], v30 offset:64
    v_fmac_f32 v149, v57, v33
    v_mfma_f32_16x16x32_bf16 v[100:103], a[224:227], a[44:47], v[100:103]
    v_fmac_f32 v150, v58, v33
    v_fmac_f32 v151, v59, v33
    v_mfma_f32_16x16x32_bf16 v[116:119], a[224:227], a[60:63], v[116:119]
    v_fmac_f32 v152, v56, v34
    v_fmac_f32 v153, v57, v34
    v_mfma_f32_16x16x32_bf16 v[116:119], a[220:223], a[56:59], v[116:119]
    v_fmac_f32 v154, v58, v34
    v_fmac_f32 v155, v59, v34
    v_mfma_f32_16x16x32_bf16 v[116:119], a[216:219], a[52:55], v[116:119]
    buffer_load_dwordx4 v19, s[24:27], s63 offen offset:1024 lds
    v_mfma_f32_16x16x32_bf16 v[116:119], a[212:215], a[48:51], v[116:119]
    s_waitcnt lgkmcnt(1)
    v_fmac_f32 v156, v56, v35
    v_fmac_f32 v157, v57, v35
    v_mfma_f32_16x16x32_bf16 a[132:135], a[228:231], a[0:3], a[132:135]
    s_waitcnt lgkmcnt(0)
    ds_read_b64_tr_b16 a[212:213], v26 offset:0
    v_fmac_f32 v158, v58, v35
    v_mfma_f32_16x16x32_bf16 a[132:135], a[232:235], a[4:7], a[132:135]
    ds_read_b64_tr_b16 a[214:215], v26 offset:1024
    v_fmac_f32 v159, v59, v35
    v_mfma_f32_16x16x32_bf16 a[132:135], a[236:239], a[8:11], a[132:135]
    ds_read_b64_tr_b16 a[216:217], v26 offset:8192
    v_fmac_f32 v208, v60, v32
    v_mfma_f32_16x16x32_bf16 a[132:135], a[240:243], a[12:15], a[132:135]
    v_fmac_f32 v209, v61, v32
    v_fmac_f32 v210, v62, v32
    v_mfma_f32_16x16x32_bf16 a[148:151], a[240:243], a[28:31], a[148:151]
    ds_read_b64_tr_b16 a[218:219], v26 offset:9216
    v_fmac_f32 v211, v63, v32
    v_mfma_f32_16x16x32_bf16 a[148:151], a[236:239], a[24:27], a[148:151]
    ds_read_b64_tr_b16 a[220:221], v26 offset:16384
    v_fmac_f32 v212, v60, v33
    v_mfma_f32_16x16x32_bf16 a[148:151], a[232:235], a[20:23], a[148:151]
    ds_read_b64_tr_b16 a[222:223], v26 offset:17408
    v_fmac_f32 v213, v61, v33
    v_mfma_f32_16x16x32_bf16 a[148:151], a[228:231], a[16:19], a[148:151]
    v_fmac_f32 v214, v62, v33
    v_fmac_f32 v215, v63, v33
    v_mfma_f32_16x16x32_bf16 a[164:167], a[228:231], a[32:35], a[164:167]
    ds_read_b64_tr_b16 a[224:225], v26 offset:24576
    v_fmac_f32 v216, v60, v34
    v_mfma_f32_16x16x32_bf16 a[164:167], a[232:235], a[36:39], a[164:167]
    ds_read_b64_tr_b16 a[226:227], v26 offset:25600
    v_fmac_f32 v217, v61, v34
    v_mfma_f32_16x16x32_bf16 a[164:167], a[236:239], a[40:43], a[164:167]
    buffer_load_dwordx4 v18, s[24:27], s63 offen offset:2048 lds
    v_mfma_f32_16x16x32_bf16 a[164:167], a[240:243], a[44:47], a[164:167]
    v_fmac_f32 v218, v62, v34
    v_fmac_f32 v219, v63, v34
    v_mfma_f32_16x16x32_bf16 a[180:183], a[240:243], a[60:63], a[180:183]
    v_fmac_f32 v220, v60, v35
    v_fmac_f32 v221, v61, v35
    v_mfma_f32_16x16x32_bf16 a[180:183], a[236:239], a[56:59], a[180:183]
    v_fmac_f32 v222, v62, v35
    v_fmac_f32 v223, v63, v35
    v_mfma_f32_16x16x32_bf16 a[180:183], a[232:235], a[52:55], a[180:183]
    v_fmac_f32 v160, v48, v32
    v_fmac_f32 v161, v49, v32
    v_mfma_f32_16x16x32_bf16 a[180:183], a[228:231], a[48:51], a[180:183]
    s_waitcnt lgkmcnt(0)
    v_fmac_f32 v162, v50, v32
    v_fmac_f32 v163, v51, v32
    v_mfma_f32_16x16x32_bf16 v[72:75], a[212:215], a[0:3], v[72:75]
    ds_read_b64_tr_b16 a[228:229], v26 offset:8
    v_fmac_f32 v164, v48, v33
    v_mfma_f32_16x16x32_bf16 v[72:75], a[216:219], a[4:7], v[72:75]
    ds_read_b64_tr_b16 a[230:231], v26 offset:1032
    v_fmac_f32 v165, v49, v33
    v_mfma_f32_16x16x32_bf16 v[72:75], a[220:223], a[8:11], v[72:75]
    ds_read_b64_tr_b16 a[232:233], v26 offset:8200
    v_fmac_f32 v166, v50, v33
    v_mfma_f32_16x16x32_bf16 v[72:75], a[224:227], a[12:15], v[72:75]
    buffer_load_dwordx4 v19, s[24:27], s63 offen offset:3072 lds
    v_mfma_f32_16x16x32_bf16 v[88:91], a[224:227], a[28:31], v[88:91]
    s_add_u32 s63, s63, 4096
    ds_read_b64_tr_b16 a[234:235], v26 offset:9224
    v_fmac_f32 v167, v51, v33
    v_mfma_f32_16x16x32_bf16 v[88:91], a[220:223], a[24:27], v[88:91]
    ds_read_b64_tr_b16 a[236:237], v26 offset:16392
    v_fmac_f32 v168, v48, v34
    v_mfma_f32_16x16x32_bf16 v[88:91], a[216:219], a[20:23], v[88:91]
    ds_read_b64_tr_b16 a[238:239], v26 offset:17416
    v_fmac_f32 v169, v49, v34
    v_mfma_f32_16x16x32_bf16 v[88:91], a[212:215], a[16:19], v[88:91]
    v_fmac_f32 v170, v50, v34
    v_fmac_f32 v171, v51, v34
    v_mfma_f32_16x16x32_bf16 v[104:107], a[212:215], a[32:35], v[104:107]
    ds_read_b64_tr_b16 a[240:241], v26 offset:24584
    v_fmac_f32 v172, v48, v35
    v_mfma_f32_16x16x32_bf16 v[104:107], a[216:219], a[36:39], v[104:107]
    ds_read_b64_tr_b16 a[242:243], v26 offset:25608
    v_fmac_f32 v173, v49, v35
    v_mfma_f32_16x16x32_bf16 v[104:107], a[220:223], a[40:43], v[104:107]
    v_fmac_f32 v174, v50, v35
    v_fmac_f32 v175, v51, v35
    v_mfma_f32_16x16x32_bf16 v[104:107], a[224:227], a[44:47], v[104:107]
    v_fmac_f32 v224, v52, v32
    v_fmac_f32 v225, v53, v32
    v_mfma_f32_16x16x32_bf16 v[120:123], a[224:227], a[60:63], v[120:123]
    v_fmac_f32 v226, v54, v32
    v_fmac_f32 v227, v55, v32
    v_mfma_f32_16x16x32_bf16 v[120:123], a[220:223], a[56:59], v[120:123]
    v_fmac_f32 v228, v52, v33
    v_fmac_f32 v229, v53, v33
    v_mfma_f32_16x16x32_bf16 v[120:123], a[216:219], a[52:55], v[120:123]
    s_add_u32 m0, s59, 102400
    v_fmac_f32 v230, v54, v33
    v_fmac_f32 v231, v55, v33
    v_mfma_f32_16x16x32_bf16 v[120:123], a[212:215], a[48:51], v[120:123]
    s_waitcnt lgkmcnt(0)
    buffer_load_dwordx4 v18, s[24:27], s63 offen offset:0 lds
    v_mfma_f32_16x16x32_bf16 a[136:139], a[228:231], a[0:3], a[136:139]
    ds_read_b64_tr_b16 a[212:213], v27 offset:0
    v_fmac_f32 v232, v52, v34
    v_mfma_f32_16x16x32_bf16 a[136:139], a[232:235], a[4:7], a[136:139]
    ds_read_b64_tr_b16 a[214:215], v27 offset:1024
    v_fmac_f32 v233, v53, v34
    v_mfma_f32_16x16x32_bf16 a[136:139], a[236:239], a[8:11], a[136:139]
    ds_read_b64_tr_b16 a[216:217], v27 offset:8192
    v_fmac_f32 v234, v54, v34
    v_mfma_f32_16x16x32_bf16 a[136:139], a[240:243], a[12:15], a[136:139]
    v_fmac_f32 v235, v55, v34
    v_fmac_f32 v236, v52, v35
    v_mfma_f32_16x16x32_bf16 a[152:155], a[240:243], a[28:31], a[152:155]
    ds_read_b64_tr_b16 a[218:219], v27 offset:9216
    v_fmac_f32 v237, v53, v35
    v_mfma_f32_16x16x32_bf16 a[152:155], a[236:239], a[24:27], a[152:155]
    ds_read_b64_tr_b16 a[220:221], v27 offset:16384
    v_fmac_f32 v238, v54, v35
    v_mfma_f32_16x16x32_bf16 a[152:155], a[232:235], a[20:23], a[152:155]
    ds_read_b64_tr_b16 a[222:223], v27 offset:17408
    v_fmac_f32 v239, v55, v35
    v_mfma_f32_16x16x32_bf16 a[152:155], a[228:231], a[16:19], a[152:155]
    v_add_u32 v30, 98304, v28
    v_add_u32 v28, s66, v1
    v_mfma_f32_16x16x32_bf16 a[168:171], a[228:231], a[32:35], a[168:171]
    s_xor_b32 s66, s56, s58
    ds_read_b64_tr_b16 a[224:225], v27 offset:24576
    v_mul_f32 v192, v192, v128
    v_mfma_f32_16x16x32_bf16 a[168:171], a[232:235], a[36:39], a[168:171]
    s_and_b32 s66, s66, 1
    ds_read_b64_tr_b16 a[226:227], v27 offset:25600
    v_mul_f32 v128, v40, v128
    v_mfma_f32_16x16x32_bf16 a[168:171], a[236:239], a[40:43], a[168:171]
    s_lshl_b32 s66, s66, 3
    v_exp_f32 v128, v128
    v_mfma_f32_16x16x32_bf16 a[168:171], a[240:243], a[44:47], a[168:171]
    s_add_u32 s66, s66, 1024
    buffer_load_dwordx4 v19, s[24:27], s63 offen offset:1024 lds
    v_mfma_f32_16x16x32_bf16 a[184:187], a[240:243], a[60:63], a[184:187]
    v_add_u32 v29, s66, v1
    v_mul_f32 v193, v193, v129
    v_mfma_f32_16x16x32_bf16 a[184:187], a[236:239], a[56:59], a[184:187]
    v_mul_f32 v129, v40, v129
    v_mul_f32 v194, v194, v130
    v_mfma_f32_16x16x32_bf16 a[184:187], a[232:235], a[52:55], a[184:187]
    v_exp_f32 v129, v129
    v_mfma_f32_16x16x32_bf16 a[184:187], a[228:231], a[48:51], a[184:187]
    s_waitcnt lgkmcnt(0)
    v_mul_f32 v130, v40, v130
    v_mul_f32 v195, v195, v131
    v_mfma_f32_16x16x32_bf16 v[76:79], a[212:215], a[0:3], v[76:79]
    ds_read_b64_tr_b16 a[228:229], v27 offset:8
    v_mul_f32 v131, v40, v131
    v_mfma_f32_16x16x32_bf16 v[76:79], a[216:219], a[4:7], v[76:79]
    ds_read_b64_tr_b16 a[230:231], v27 offset:1032
    v_mul_f32 v208, v208, v144
    v_mfma_f32_16x16x32_bf16 v[76:79], a[220:223], a[8:11], v[76:79]
    ds_read_b64_tr_b16 a[232:233], v27 offset:8200
    v_mul_f32 v144, v40, v144
    v_mfma_f32_16x16x32_bf16 v[76:79], a[224:227], a[12:15], v[76:79]
    v_exp_f32 v130, v130
    v_mfma_f32_16x16x32_bf16 v[92:95], a[224:227], a[28:31], v[92:95]
    ds_read_b64_tr_b16 a[234:235], v27 offset:9224
    v_mul_f32 v209, v209, v145
    v_mfma_f32_16x16x32_bf16 v[92:95], a[220:223], a[24:27], v[92:95]
    ds_read_b64_tr_b16 a[236:237], v27 offset:16392
    v_mul_f32 v145, v40, v145
    v_mfma_f32_16x16x32_bf16 v[92:95], a[216:219], a[20:23], v[92:95]
    ds_read_b64_tr_b16 a[238:239], v27 offset:17416
    v_mul_f32 v210, v210, v146
    v_mfma_f32_16x16x32_bf16 v[92:95], a[212:215], a[16:19], v[92:95]
    buffer_load_dwordx4 v18, s[24:27], s63 offen offset:2048 lds
    v_mfma_f32_16x16x32_bf16 v[108:111], a[212:215], a[32:35], v[108:111]
    ds_read_b64_tr_b16 a[240:241], v27 offset:24584
    v_mul_f32 v146, v40, v146
    v_mfma_f32_16x16x32_bf16 v[108:111], a[216:219], a[36:39], v[108:111]
    ds_read_b64_tr_b16 a[242:243], v27 offset:25608
    v_mul_f32 v211, v211, v147
    v_mfma_f32_16x16x32_bf16 v[108:111], a[220:223], a[40:43], v[108:111]
    v_exp_f32 v131, v131
    v_mfma_f32_16x16x32_bf16 v[108:111], a[224:227], a[44:47], v[108:111]
    v_exp_f32 v144, v144
    v_mfma_f32_16x16x32_bf16 v[124:127], a[224:227], a[60:63], v[124:127]
    v_exp_f32 v145, v145
    v_mfma_f32_16x16x32_bf16 v[124:127], a[220:223], a[56:59], v[124:127]
    v_exp_f32 v146, v146
    v_mfma_f32_16x16x32_bf16 v[124:127], a[216:219], a[52:55], v[124:127]
    v_mul_f32 v147, v40, v147
    v_fma_f32 v128, v128, v44, v44
    v_mfma_f32_16x16x32_bf16 v[124:127], a[212:215], a[48:51], v[124:127]
    s_waitcnt lgkmcnt(0)
    v_exp_f32 v147, v147
    v_mfma_f32_16x16x32_bf16 a[140:143], a[228:231], a[0:3], a[140:143]
    s_waitcnt vmcnt(19)
    v_add_u32 v24, 4294901760, v24
    v_add_u32 v25, 4294901760, v25
    v_mfma_f32_16x16x32_bf16 a[140:143], a[232:235], a[4:7], a[140:143]
    s_barrier
    v_add_u32 v26, 4294901760, v26
    v_add_u32 v27, 4294901760, v27
    v_mfma_f32_16x16x32_bf16 a[140:143], a[236:239], a[8:11], a[140:143]
    ds_read_b64_tr_b16 a[212:213], v24 offset:0
    buffer_load_dwordx4 v19, s[24:27], s63 offen offset:3072 lds
    v_mfma_f32_16x16x32_bf16 a[140:143], a[240:243], a[12:15], a[140:143]
    s_add_u32 s63, s63, 28672
    ds_read_b64_tr_b16 a[214:215], v24 offset:1024
    v_fma_f32 v129, v129, v44, v44
    v_mfma_f32_16x16x32_bf16 a[156:159], a[240:243], a[28:31], a[156:159]
    ds_read_b64_tr_b16 a[216:217], v24 offset:8192
    v_fma_f32 v130, v130, v44, v44
    v_mfma_f32_16x16x32_bf16 a[156:159], a[236:239], a[24:27], a[156:159]
    ds_read_b64_tr_b16 a[218:219], v24 offset:9216
    v_fma_f32 v131, v131, v44, v44
    v_mfma_f32_16x16x32_bf16 a[156:159], a[232:235], a[20:23], a[156:159]
    ds_read_b64_tr_b16 a[220:221], v24 offset:16384
    v_fma_f32 v144, v144, v44, v44
    v_mfma_f32_16x16x32_bf16 a[156:159], a[228:231], a[16:19], a[156:159]
    ds_read_b64_tr_b16 a[222:223], v24 offset:17408
    v_fma_f32 v145, v145, v44, v44
    v_mfma_f32_16x16x32_bf16 a[172:175], a[228:231], a[32:35], a[172:175]
    ds_read_b64_tr_b16 a[224:225], v24 offset:24576
    v_fma_f32 v146, v146, v44, v44
    v_mfma_f32_16x16x32_bf16 a[172:175], a[232:235], a[36:39], a[172:175]
    ds_read_b64_tr_b16 a[226:227], v24 offset:25600
    v_fma_f32 v147, v147, v44, v44
    v_mfma_f32_16x16x32_bf16 a[172:175], a[236:239], a[40:43], a[172:175]
    v_rcp_f32 v128, v128
    v_mfma_f32_16x16x32_bf16 a[172:175], a[240:243], a[44:47], a[172:175]
    v_rcp_f32 v129, v129
    v_mfma_f32_16x16x32_bf16 a[188:191], a[240:243], a[60:63], a[188:191]
    v_rcp_f32 v130, v130
    v_mfma_f32_16x16x32_bf16 a[188:191], a[236:239], a[56:59], a[188:191]
    v_rcp_f32 v131, v131
    v_mfma_f32_16x16x32_bf16 a[188:191], a[232:235], a[52:55], a[188:191]
    v_rcp_f32 v144, v144
    v_mfma_f32_16x16x32_bf16 a[188:191], a[228:231], a[48:51], a[188:191]
    s_waitcnt lgkmcnt(0)
    v_rcp_f32 v145, v145
    v_mfma_f32_16x16x32_bf16 v[64:67], a[212:215], a[64:67], v[64:67]
    ds_read_b64_tr_b16 a[228:229], v24 offset:8
    v_mul_f32 v128, v128, v192
    v_mfma_f32_16x16x32_bf16 v[64:67], a[216:219], a[68:71], v[64:67]
    ds_read_b64_tr_b16 a[230:231], v24 offset:1032
    v_mul_f32 v129, v129, v193
    v_mfma_f32_16x16x32_bf16 v[64:67], a[220:223], a[72:75], v[64:67]
    ds_read_b64_tr_b16 a[232:233], v24 offset:8200
    v_mul_f32 v130, v130, v194
    v_mfma_f32_16x16x32_bf16 v[64:67], a[224:227], a[76:79], v[64:67]
    v_rcp_f32 v146, v146
    v_mfma_f32_16x16x32_bf16 v[80:83], a[224:227], a[92:95], v[80:83]
    ds_read_b64_tr_b16 a[234:235], v24 offset:9224
    v_mul_f32 v131, v131, v195
    v_mfma_f32_16x16x32_bf16 v[80:83], a[220:223], a[88:91], v[80:83]
    ds_read_b64_tr_b16 a[236:237], v24 offset:16392
    v_mul_f32 v144, v144, v208
    v_mfma_f32_16x16x32_bf16 v[80:83], a[216:219], a[84:87], v[80:83]
    ds_read_b64_tr_b16 a[238:239], v24 offset:17416
    v_mul_f32 v145, v145, v209
    v_mfma_f32_16x16x32_bf16 v[80:83], a[212:215], a[80:83], v[80:83]
    v_rcp_f32 v147, v147
    v_mfma_f32_16x16x32_bf16 v[96:99], a[212:215], a[96:99], v[96:99]
    ds_read_b64_tr_b16 a[240:241], v24 offset:24584
    v_mul_f32 v146, v146, v210
    v_mfma_f32_16x16x32_bf16 v[96:99], a[216:219], a[100:103], v[96:99]
    ds_read_b64_tr_b16 a[242:243], v24 offset:25608
    v_mul_f32 v147, v147, v211
    v_mfma_f32_16x16x32_bf16 v[96:99], a[220:223], a[104:107], v[96:99]
    v_cvt_pk_bf16_f32 v128, v128, v129
    v_cvt_pk_bf16_f32 v129, v130, v131
    v_mfma_f32_16x16x32_bf16 v[96:99], a[224:227], a[108:111], v[96:99]
    v_cvt_pk_bf16_f32 v130, v144, v145
    v_cvt_pk_bf16_f32 v131, v146, v147
    v_mfma_f32_16x16x32_bf16 v[112:115], a[224:227], a[124:127], v[112:115]
    buffer_store_dwordx4 v[128:131], v28, s[28:31], s64 offen sc1
    v_mfma_f32_16x16x32_bf16 v[112:115], a[220:223], a[120:123], v[112:115]
    v_mul_f32 v224, v224, v160
    v_mul_f32 v160, v40, v160
    v_mfma_f32_16x16x32_bf16 v[112:115], a[216:219], a[116:119], v[112:115]
    v_exp_f32 v160, v160
    v_mfma_f32_16x16x32_bf16 v[112:115], a[212:215], a[112:115], v[112:115]
    v_mul_f32 v225, v225, v161
    v_mul_f32 v161, v40, v161
    v_smfmac_f32_16x16x64_bf16 a[200:203], a[208:211], a[212:219], v20
    v_mul_f32 v226, v226, v162
    v_smfmac_f32_16x16x64_bf16 a[200:203], a[208:211], a[220:227], v20
    s_waitcnt lgkmcnt(0)
    v_mul_f32 v162, v40, v162
    v_mfma_f32_16x16x32_bf16 a[128:131], a[228:231], a[64:67], a[128:131]
    ds_read_b64_tr_b16 a[212:213], v25 offset:0
    v_mul_f32 v227, v227, v163
    v_mfma_f32_16x16x32_bf16 a[128:131], a[232:235], a[68:71], a[128:131]
    ds_read_b64_tr_b16 a[214:215], v25 offset:1024
    v_mul_f32 v163, v40, v163
    v_mfma_f32_16x16x32_bf16 a[128:131], a[236:239], a[72:75], a[128:131]
    ds_read_b64_tr_b16 a[216:217], v25 offset:8192
    v_fma_f32 v160, v160, v44, v44
    v_mfma_f32_16x16x32_bf16 a[128:131], a[240:243], a[76:79], a[128:131]
    v_exp_f32 v161, v161
    v_mfma_f32_16x16x32_bf16 a[144:147], a[240:243], a[92:95], a[144:147]
    ds_read_b64_tr_b16 a[218:219], v25 offset:9216
    v_fma_f32 v161, v161, v44, v44
    v_mfma_f32_16x16x32_bf16 a[144:147], a[236:239], a[88:91], a[144:147]
    ds_read_b64_tr_b16 a[220:221], v25 offset:16384
    v_mul_f32 v196, v196, v132
    v_mfma_f32_16x16x32_bf16 a[144:147], a[232:235], a[84:87], a[144:147]
    ds_read_b64_tr_b16 a[222:223], v25 offset:17408
    v_mul_f32 v132, v41, v132
    v_mfma_f32_16x16x32_bf16 a[144:147], a[228:231], a[80:83], a[144:147]
    v_exp_f32 v162, v162
    v_mfma_f32_16x16x32_bf16 a[160:163], a[228:231], a[96:99], a[160:163]
    ds_read_b64_tr_b16 a[224:225], v25 offset:24576
    v_fma_f32 v162, v162, v44, v44
    v_mfma_f32_16x16x32_bf16 a[160:163], a[232:235], a[100:103], a[160:163]
    ds_read_b64_tr_b16 a[226:227], v25 offset:25600
    v_mul_f32 v197, v197, v133
    v_mfma_f32_16x16x32_bf16 a[160:163], a[236:239], a[104:107], a[160:163]
    v_exp_f32 v163, v163
    v_mfma_f32_16x16x32_bf16 a[160:163], a[240:243], a[108:111], a[160:163]
    v_rcp_f32 v160, v160
    v_mfma_f32_16x16x32_bf16 a[176:179], a[240:243], a[124:127], a[176:179]
    v_rcp_f32 v161, v161
    v_mfma_f32_16x16x32_bf16 a[176:179], a[236:239], a[120:123], a[176:179]
    v_rcp_f32 v162, v162
    v_mfma_f32_16x16x32_bf16 a[176:179], a[232:235], a[116:119], a[176:179]
    v_exp_f32 v132, v132
    v_mfma_f32_16x16x32_bf16 a[176:179], a[228:231], a[112:115], a[176:179]
    v_fma_f32 v163, v163, v44, v44
    v_mul_f32 v160, v160, v224
    v_smfmac_f32_16x16x64_bf16 a[204:207], a[208:211], a[228:235], v20
    v_mul_f32 v161, v161, v225
    v_smfmac_f32_16x16x64_bf16 a[204:207], a[208:211], a[236:243], v20
    s_waitcnt lgkmcnt(0)
    v_mul_f32 v162, v162, v226
    v_mfma_f32_16x16x32_bf16 v[68:71], a[212:215], a[64:67], v[68:71]
    ds_read_b64_tr_b16 a[228:229], v25 offset:8
    v_cvt_pk_bf16_f32 v160, v160, v161
    v_mfma_f32_16x16x32_bf16 v[68:71], a[216:219], a[68:71], v[68:71]
    s_add_u32 m0, s59, 32768
    ds_read_b64_tr_b16 a[230:231], v25 offset:1032
    v_mul_f32 v133, v41, v133
    v_mfma_f32_16x16x32_bf16 v[68:71], a[220:223], a[72:75], v[68:71]
    ds_read_b64_tr_b16 a[232:233], v25 offset:8200
    v_mul_f32 v198, v198, v134
    v_mfma_f32_16x16x32_bf16 v[68:71], a[224:227], a[76:79], v[68:71]
    buffer_load_dwordx4 v14, s[20:23], s62 offen offset:0 lds
    v_mfma_f32_16x16x32_bf16 v[84:87], a[224:227], a[92:95], v[84:87]
    ds_read_b64_tr_b16 a[234:235], v25 offset:9224
    v_mul_f32 v134, v41, v134
    v_mfma_f32_16x16x32_bf16 v[84:87], a[220:223], a[88:91], v[84:87]
    ds_read_b64_tr_b16 a[236:237], v25 offset:16392
    v_mul_f32 v199, v199, v135
    v_mfma_f32_16x16x32_bf16 v[84:87], a[216:219], a[84:87], v[84:87]
    ds_read_b64_tr_b16 a[238:239], v25 offset:17416
    v_mul_f32 v135, v41, v135
    v_mfma_f32_16x16x32_bf16 v[84:87], a[212:215], a[80:83], v[84:87]
    v_rcp_f32 v163, v163
    v_mfma_f32_16x16x32_bf16 v[100:103], a[212:215], a[96:99], v[100:103]
    ds_read_b64_tr_b16 a[240:241], v25 offset:24584
    v_mul_f32 v163, v163, v227
    v_mfma_f32_16x16x32_bf16 v[100:103], a[216:219], a[100:103], v[100:103]
    ds_read_b64_tr_b16 a[242:243], v25 offset:25608
    v_cvt_pk_bf16_f32 v161, v162, v163
    v_mfma_f32_16x16x32_bf16 v[100:103], a[220:223], a[104:107], v[100:103]
    buffer_store_dwordx2 v[160:161], v29, s[28:31], s64 offen sc1
    v_mfma_f32_16x16x32_bf16 v[100:103], a[224:227], a[108:111], v[100:103]
    s_add_u32 s64, s64, 188416
    v_exp_f32 v133, v133
    v_mfma_f32_16x16x32_bf16 v[116:119], a[224:227], a[124:127], v[116:119]
    v_exp_f32 v134, v134
    v_mfma_f32_16x16x32_bf16 v[116:119], a[220:223], a[120:123], v[116:119]
    v_exp_f32 v135, v135
    v_mfma_f32_16x16x32_bf16 v[116:119], a[216:219], a[116:119], v[116:119]
    buffer_load_dwordx4 v15, s[20:23], s62 offen offset:1024 lds
    v_mfma_f32_16x16x32_bf16 v[116:119], a[212:215], a[112:115], v[116:119]
    s_waitcnt lgkmcnt(0)
    v_mul_f32 v212, v212, v148
    v_mul_f32 v148, v41, v148
    v_mfma_f32_16x16x32_bf16 a[132:135], a[228:231], a[64:67], a[132:135]
    ds_read_b64_tr_b16 a[212:213], v26 offset:0
    v_accvgpr_read_b32 v22, a200
    v_mfma_f32_16x16x32_bf16 a[132:135], a[232:235], a[68:71], a[132:135]
    ds_read_b64_tr_b16 a[214:215], v26 offset:1024
    v_accvgpr_read_b32 v23, a201
    v_mfma_f32_16x16x32_bf16 a[132:135], a[236:239], a[72:75], a[132:135]
    ds_read_b64_tr_b16 a[216:217], v26 offset:8192
    v_add_f32 v22, v22, v23
    v_mfma_f32_16x16x32_bf16 a[132:135], a[240:243], a[76:79], a[132:135]
    ds_write_b32 v21, v22 offset:0
    v_accvgpr_read_b32 v22, a204
    v_mfma_f32_16x16x32_bf16 a[148:151], a[240:243], a[92:95], a[148:151]
    ds_read_b64_tr_b16 a[218:219], v26 offset:9216
    v_accvgpr_read_b32 v23, a205
    v_mfma_f32_16x16x32_bf16 a[148:151], a[236:239], a[88:91], a[148:151]
    ds_read_b64_tr_b16 a[220:221], v26 offset:16384
    v_add_f32 v22, v22, v23
    v_mfma_f32_16x16x32_bf16 a[148:151], a[232:235], a[84:87], a[148:151]
    ds_read_b64_tr_b16 a[222:223], v26 offset:17408
    v_mul_f32 v213, v213, v149
    v_mfma_f32_16x16x32_bf16 a[148:151], a[228:231], a[80:83], a[148:151]
    ds_write_b32 v21, v22 offset:64
    v_mul_f32 v149, v41, v149
    v_mfma_f32_16x16x32_bf16 a[164:167], a[228:231], a[96:99], a[164:167]
    ds_read_b64_tr_b16 a[224:225], v26 offset:24576
    v_mul_f32 v214, v214, v150
    v_mfma_f32_16x16x32_bf16 a[164:167], a[232:235], a[100:103], a[164:167]
    ds_read_b64_tr_b16 a[226:227], v26 offset:25600
    v_mul_f32 v150, v41, v150
    v_mfma_f32_16x16x32_bf16 a[164:167], a[236:239], a[104:107], a[164:167]
    buffer_load_dwordx4 v16, s[20:23], s62 offen offset:2048 lds
    v_mfma_f32_16x16x32_bf16 a[164:167], a[240:243], a[108:111], a[164:167]
    v_exp_f32 v148, v148
    v_mfma_f32_16x16x32_bf16 a[180:183], a[240:243], a[124:127], a[180:183]
    v_exp_f32 v149, v149
    v_mfma_f32_16x16x32_bf16 a[180:183], a[236:239], a[120:123], a[180:183]
    v_exp_f32 v150, v150
    v_mfma_f32_16x16x32_bf16 a[180:183], a[232:235], a[116:119], a[180:183]
    v_mul_f32 v215, v215, v151
    v_mul_f32 v151, v41, v151
    v_mfma_f32_16x16x32_bf16 a[180:183], a[228:231], a[112:115], a[180:183]
    s_waitcnt lgkmcnt(0)
    v_exp_f32 v151, v151
    v_mfma_f32_16x16x32_bf16 v[72:75], a[212:215], a[64:67], v[72:75]
    ds_read_b64_tr_b16 a[228:229], v26 offset:8
    v_fma_f32 v132, v132, v45, v45
    v_mfma_f32_16x16x32_bf16 v[72:75], a[216:219], a[68:71], v[72:75]
    ds_read_b64_tr_b16 a[230:231], v26 offset:1032
    v_fma_f32 v133, v133, v45, v45
    v_mfma_f32_16x16x32_bf16 v[72:75], a[220:223], a[72:75], v[72:75]
    ds_read_b64_tr_b16 a[232:233], v26 offset:8200
    v_fma_f32 v134, v134, v45, v45
    v_mfma_f32_16x16x32_bf16 v[72:75], a[224:227], a[76:79], v[72:75]
    buffer_load_dwordx4 v17, s[20:23], s62 offen offset:3072 lds
    v_mfma_f32_16x16x32_bf16 v[88:91], a[224:227], a[92:95], v[88:91]
    s_add_u32 s62, s62, 4096
    ds_read_b64_tr_b16 a[234:235], v26 offset:9224
    v_fma_f32 v135, v135, v45, v45
    v_mfma_f32_16x16x32_bf16 v[88:91], a[220:223], a[88:91], v[88:91]
    ds_read_b64_tr_b16 a[236:237], v26 offset:16392
    v_fma_f32 v148, v148, v45, v45
    v_mfma_f32_16x16x32_bf16 v[88:91], a[216:219], a[84:87], v[88:91]
    ds_read_b64_tr_b16 a[238:239], v26 offset:17416
    v_fma_f32 v149, v149, v45, v45
    v_mfma_f32_16x16x32_bf16 v[88:91], a[212:215], a[80:83], v[88:91]
    v_rcp_f32 v132, v132
    v_mfma_f32_16x16x32_bf16 v[104:107], a[212:215], a[96:99], v[104:107]
    ds_read_b64_tr_b16 a[240:241], v26 offset:24584
    v_fma_f32 v150, v150, v45, v45
    v_mfma_f32_16x16x32_bf16 v[104:107], a[216:219], a[100:103], v[104:107]
    ds_read_b64_tr_b16 a[242:243], v26 offset:25608
    v_fma_f32 v151, v151, v45, v45
    v_mfma_f32_16x16x32_bf16 v[104:107], a[220:223], a[104:107], v[104:107]
    v_rcp_f32 v133, v133
    v_mfma_f32_16x16x32_bf16 v[104:107], a[224:227], a[108:111], v[104:107]
    v_rcp_f32 v134, v134
    v_mfma_f32_16x16x32_bf16 v[120:123], a[224:227], a[124:127], v[120:123]
    v_rcp_f32 v135, v135
    v_mfma_f32_16x16x32_bf16 v[120:123], a[220:223], a[120:123], v[120:123]
    v_rcp_f32 v148, v148
    v_mfma_f32_16x16x32_bf16 v[120:123], a[216:219], a[116:119], v[120:123]
    s_add_u32 m0, s59, 36864
    v_rcp_f32 v149, v149
    v_mfma_f32_16x16x32_bf16 v[120:123], a[212:215], a[112:115], v[120:123]
    s_waitcnt lgkmcnt(0)
    buffer_load_dwordx4 v14, s[20:23], s62 offen offset:0 lds
    v_mfma_f32_16x16x32_bf16 a[136:139], a[228:231], a[64:67], a[136:139]
    ds_read_b64_tr_b16 a[212:213], v27 offset:0
    v_mul_f32 v132, v132, v196
    v_mfma_f32_16x16x32_bf16 a[136:139], a[232:235], a[68:71], a[136:139]
    ds_read_b64_tr_b16 a[214:215], v27 offset:1024
    v_mul_f32 v133, v133, v197
    v_mfma_f32_16x16x32_bf16 a[136:139], a[236:239], a[72:75], a[136:139]
    ds_read_b64_tr_b16 a[216:217], v27 offset:8192
    v_mul_f32 v134, v134, v198
    v_mfma_f32_16x16x32_bf16 a[136:139], a[240:243], a[76:79], a[136:139]
    v_rcp_f32 v150, v150
    v_mfma_f32_16x16x32_bf16 a[152:155], a[240:243], a[92:95], a[152:155]
    ds_read_b64_tr_b16 a[218:219], v27 offset:9216
    v_mul_f32 v135, v135, v199
    v_mfma_f32_16x16x32_bf16 a[152:155], a[236:239], a[88:91], a[152:155]
    ds_read_b64_tr_b16 a[220:221], v27 offset:16384
    v_mul_f32 v148, v148, v212
    v_mfma_f32_16x16x32_bf16 a[152:155], a[232:235], a[84:87], a[152:155]
    ds_read_b64_tr_b16 a[222:223], v27 offset:17408
    v_mul_f32 v149, v149, v213
    v_mfma_f32_16x16x32_bf16 a[152:155], a[228:231], a[80:83], a[152:155]
    v_rcp_f32 v151, v151
    v_mfma_f32_16x16x32_bf16 a[168:171], a[228:231], a[96:99], a[168:171]
    ds_read_b64_tr_b16 a[224:225], v27 offset:24576
    v_mul_f32 v150, v150, v214
    v_mfma_f32_16x16x32_bf16 a[168:171], a[232:235], a[100:103], a[168:171]
    ds_read_b64_tr_b16 a[226:227], v27 offset:25600
    v_mul_f32 v151, v151, v215
    v_mfma_f32_16x16x32_bf16 a[168:171], a[236:239], a[104:107], a[168:171]
    v_cvt_pk_bf16_f32 v132, v132, v133
    v_cvt_pk_bf16_f32 v133, v134, v135
    v_mfma_f32_16x16x32_bf16 a[168:171], a[240:243], a[108:111], a[168:171]
    buffer_load_dwordx4 v15, s[20:23], s62 offen offset:1024 lds
    v_mfma_f32_16x16x32_bf16 a[184:187], a[240:243], a[124:127], a[184:187]
    v_cvt_pk_bf16_f32 v134, v148, v149
    v_cvt_pk_bf16_f32 v135, v150, v151
    v_mfma_f32_16x16x32_bf16 a[184:187], a[236:239], a[120:123], a[184:187]
    buffer_store_dwordx4 v[132:135], v28, s[28:31], s64 offen sc1
    v_mfma_f32_16x16x32_bf16 a[184:187], a[232:235], a[116:119], a[184:187]
    v_mul_f32 v228, v228, v164
    v_mul_f32 v164, v41, v164
    v_mfma_f32_16x16x32_bf16 a[184:187], a[228:231], a[112:115], a[184:187]
    s_waitcnt lgkmcnt(0)
    v_exp_f32 v164, v164
    v_mfma_f32_16x16x32_bf16 v[76:79], a[212:215], a[64:67], v[76:79]
    ds_read_b64_tr_b16 a[228:229], v27 offset:8
    v_mul_f32 v229, v229, v165
    v_mfma_f32_16x16x32_bf16 v[76:79], a[216:219], a[68:71], v[76:79]
    ds_read_b64_tr_b16 a[230:231], v27 offset:1032
    v_mul_f32 v165, v41, v165
    v_mfma_f32_16x16x32_bf16 v[76:79], a[220:223], a[72:75], v[76:79]
    ds_read_b64_tr_b16 a[232:233], v27 offset:8200
    v_mul_f32 v230, v230, v166
    v_mfma_f32_16x16x32_bf16 v[76:79], a[224:227], a[76:79], v[76:79]
    v_exp_f32 v165, v165
    v_mfma_f32_16x16x32_bf16 v[92:95], a[224:227], a[92:95], v[92:95]
    ds_read_b64_tr_b16 a[234:235], v27 offset:9224
    v_mul_f32 v166, v41, v166
    v_mfma_f32_16x16x32_bf16 v[92:95], a[220:223], a[88:91], v[92:95]
    ds_read_b64_tr_b16 a[236:237], v27 offset:16392
    v_mul_f32 v231, v231, v167
    v_mfma_f32_16x16x32_bf16 v[92:95], a[216:219], a[84:87], v[92:95]
    ds_read_b64_tr_b16 a[238:239], v27 offset:17416
    v_mul_f32 v167, v41, v167
    v_mfma_f32_16x16x32_bf16 v[92:95], a[212:215], a[80:83], v[92:95]
    buffer_load_dwordx4 v16, s[20:23], s62 offen offset:2048 lds
    v_mfma_f32_16x16x32_bf16 v[108:111], a[212:215], a[96:99], v[108:111]
    ds_read_b64_tr_b16 a[240:241], v27 offset:24584
    v_fma_f32 v164, v164, v45, v45
    v_mfma_f32_16x16x32_bf16 v[108:111], a[216:219], a[100:103], v[108:111]
    ds_read_b64_tr_b16 a[242:243], v27 offset:25608
    v_fma_f32 v165, v165, v45, v45
    v_mfma_f32_16x16x32_bf16 v[108:111], a[220:223], a[104:107], v[108:111]
    v_exp_f32 v166, v166
    v_mfma_f32_16x16x32_bf16 v[108:111], a[224:227], a[108:111], v[108:111]
    v_exp_f32 v167, v167
    v_mfma_f32_16x16x32_bf16 v[124:127], a[224:227], a[124:127], v[124:127]
    v_rcp_f32 v164, v164
    v_mfma_f32_16x16x32_bf16 v[124:127], a[220:223], a[120:123], v[124:127]
    v_rcp_f32 v165, v165
    v_mfma_f32_16x16x32_bf16 v[124:127], a[216:219], a[116:119], v[124:127]
    v_fma_f32 v166, v166, v45, v45
    v_fma_f32 v167, v167, v45, v45
    v_mfma_f32_16x16x32_bf16 v[124:127], a[212:215], a[112:115], v[124:127]
    s_waitcnt lgkmcnt(0)
    v_rcp_f32 v166, v166
    v_mfma_f32_16x16x32_bf16 a[140:143], a[228:231], a[64:67], a[140:143]
    s_waitcnt vmcnt(18) lgkmcnt(15)
    v_rcp_f32 v167, v167
    v_mfma_f32_16x16x32_bf16 a[140:143], a[232:235], a[68:71], a[140:143]
    s_barrier
    buffer_load_dwordx4 v17, s[20:23], s62 offen offset:3072 lds
    v_mfma_f32_16x16x32_bf16 a[140:143], a[236:239], a[72:75], a[140:143]
    s_add_u32 s62, s62, 28672
    ds_read_b128 a[212:215], v2 offset:0
    v_mul_f32 v164, v164, v228
    v_mfma_f32_16x16x32_bf16 a[140:143], a[240:243], a[76:79], a[140:143]
    ds_read_b128 a[216:219], v3 offset:0
    v_mul_f32 v165, v165, v229
    v_mfma_f32_16x16x32_bf16 a[156:159], a[240:243], a[92:95], a[156:159]
    ds_read_b128 a[220:223], v4 offset:0
    v_mul_f32 v166, v166, v230
    v_mfma_f32_16x16x32_bf16 a[156:159], a[236:239], a[88:91], a[156:159]
    ds_read_b128 a[224:227], v5 offset:0
    v_mul_f32 v167, v167, v231
    v_mfma_f32_16x16x32_bf16 a[156:159], a[232:235], a[84:87], a[156:159]
    v_cvt_pk_bf16_f32 v164, v164, v165
    v_cvt_pk_bf16_f32 v165, v166, v167
    v_mfma_f32_16x16x32_bf16 a[156:159], a[228:231], a[80:83], a[156:159]
    buffer_store_dwordx2 v[164:165], v29, s[28:31], s64 offen sc1
    v_mfma_f32_16x16x32_bf16 a[172:175], a[228:231], a[96:99], a[172:175]
    s_add_u32 s64, s64, 188416
    v_mfma_f32_16x16x32_bf16 a[172:175], a[232:235], a[100:103], a[172:175]
    v_mfma_f32_16x16x32_bf16 a[172:175], a[236:239], a[104:107], a[172:175]
    v_mfma_f32_16x16x32_bf16 a[172:175], a[240:243], a[108:111], a[172:175]
    v_mfma_f32_16x16x32_bf16 a[188:191], a[240:243], a[124:127], a[188:191]
    v_mfma_f32_16x16x32_bf16 a[188:191], a[236:239], a[120:123], a[188:191]
    v_mfma_f32_16x16x32_bf16 a[188:191], a[232:235], a[116:119], a[188:191]
    v_mfma_f32_16x16x32_bf16 a[188:191], a[228:231], a[112:115], a[188:191]
    v_xor_b32 v24, 0, v30
    v_xor_b32 v25, 128, v30
    v_xor_b32 v26, 256, v30
    v_xor_b32 v27, 384, v30
    ds_read_b128 v[48:51], v24 offset:0
    ds_read_b128 v[52:55], v24 offset:64
    ds_read_b128 v[56:59], v25 offset:0
    ds_read_b128 v[60:63], v25 offset:64
    v_pk_mul_f32 v[200:201], v[200:201], v[136:137]
    v_pk_mul_f32 v[136:137], v[136:137], v[42:43] op_sel:[0,0] op_sel_hi:[1,0]
    v_pk_mul_f32 v[202:203], v[202:203], v[138:139]
    v_pk_mul_f32 v[138:139], v[138:139], v[42:43] op_sel:[0,0] op_sel_hi:[1,0]
    v_pk_mul_f32 v[216:217], v[216:217], v[152:153]
    v_pk_mul_f32 v[152:153], v[152:153], v[42:43] op_sel:[0,0] op_sel_hi:[1,0]
    v_pk_mul_f32 v[218:219], v[218:219], v[154:155]
    v_pk_mul_f32 v[154:155], v[154:155], v[42:43] op_sel:[0,0] op_sel_hi:[1,0]
    v_exp_f32 v136, v136
    v_exp_f32 v137, v137
    v_exp_f32 v138, v138
    v_exp_f32 v139, v139
    v_exp_f32 v152, v152
    v_exp_f32 v153, v153
    v_exp_f32 v154, v154
    v_exp_f32 v155, v155
    v_pk_fma_f32 v[136:137], v[136:137], v[46:47], v[46:47] op_sel:[0,0,0] op_sel_hi:[1,0,0]
    v_pk_fma_f32 v[138:139], v[138:139], v[46:47], v[46:47] op_sel:[0,0,0] op_sel_hi:[1,0,0]
    v_pk_fma_f32 v[152:153], v[152:153], v[46:47], v[46:47] op_sel:[0,0,0] op_sel_hi:[1,0,0]
    v_pk_fma_f32 v[154:155], v[154:155], v[46:47], v[46:47] op_sel:[0,0,0] op_sel_hi:[1,0,0]
    v_rcp_f32 v136, v136
    v_rcp_f32 v137, v137
    v_rcp_f32 v138, v138
    v_rcp_f32 v139, v139
    v_rcp_f32 v152, v152
    v_rcp_f32 v153, v153
    v_rcp_f32 v154, v154
    v_rcp_f32 v155, v155
    v_pk_mul_f32 v[136:137], v[136:137], v[200:201]
    v_pk_mul_f32 v[138:139], v[138:139], v[202:203]
    v_pk_mul_f32 v[152:153], v[152:153], v[216:217]
    v_pk_mul_f32 v[154:155], v[154:155], v[218:219]
    v_cvt_pk_bf16_f32 v136, v136, v137
    v_cvt_pk_bf16_f32 v137, v138, v139
    v_cvt_pk_bf16_f32 v138, v152, v153
    v_cvt_pk_bf16_f32 v139, v154, v155
    buffer_store_dwordx4 v[136:139], v28, s[28:31], s64 offen sc1
    s_waitcnt lgkmcnt(2)
    v_accvgpr_read_b32 v192, a128
    v_accvgpr_read_b32 v193, a129
    v_accvgpr_read_b32 v194, a130
    v_accvgpr_read_b32 v195, a131
    v_pk_fma_f32 v[64:65], v[48:49], v[32:33], v[64:65] op_sel:[0,0,0] op_sel_hi:[1,0,1]
    v_pk_fma_f32 v[66:67], v[50:51], v[32:33], v[66:67] op_sel:[0,0,0] op_sel_hi:[1,0,1]
    v_pk_fma_f32 v[192:193], v[52:53], v[32:33], v[192:193] op_sel:[0,0,0] op_sel_hi:[1,0,1]
    v_pk_fma_f32 v[194:195], v[54:55], v[32:33], v[194:195] op_sel:[0,0,0] op_sel_hi:[1,0,1]
    v_pk_mul_f32 v[64:65], v[64:65], v[36:37] op_sel:[0,0] op_sel_hi:[1,0]
    v_pk_mul_f32 v[66:67], v[66:67], v[36:37] op_sel:[0,0] op_sel_hi:[1,0]
    v_pk_mul_f32 v[192:193], v[192:193], v[36:37] op_sel:[0,0] op_sel_hi:[1,0]
    v_pk_mul_f32 v[194:195], v[194:195], v[36:37] op_sel:[0,0] op_sel_hi:[1,0]
    v_cvt_pk_bf16_f32 v64, v64, v65
    v_cvt_pk_bf16_f32 v65, v66, v67
    v_cvt_pk_bf16_f32 v66, v192, v193
    v_cvt_pk_bf16_f32 v67, v194, v195
    v_accvgpr_read_b32 v208, a144
    v_accvgpr_read_b32 v209, a145
    v_accvgpr_read_b32 v210, a146
    v_accvgpr_read_b32 v211, a147
    v_pk_fma_f32 v[80:81], v[48:49], v[32:33], v[80:81] op_sel:[0,1,0] op_sel_hi:[1,1,1]
    v_pk_fma_f32 v[82:83], v[50:51], v[32:33], v[82:83] op_sel:[0,1,0] op_sel_hi:[1,1,1]
    v_pk_fma_f32 v[208:209], v[52:53], v[32:33], v[208:209] op_sel:[0,1,0] op_sel_hi:[1,1,1]
    v_pk_fma_f32 v[210:211], v[54:55], v[32:33], v[210:211] op_sel:[0,1,0] op_sel_hi:[1,1,1]
    v_pk_mul_f32 v[80:81], v[80:81], v[36:37] op_sel:[0,1] op_sel_hi:[1,1]
    v_pk_mul_f32 v[82:83], v[82:83], v[36:37] op_sel:[0,1] op_sel_hi:[1,1]
    v_pk_mul_f32 v[208:209], v[208:209], v[36:37] op_sel:[0,1] op_sel_hi:[1,1]
    v_pk_mul_f32 v[210:211], v[210:211], v[36:37] op_sel:[0,1] op_sel_hi:[1,1]
    v_cvt_pk_bf16_f32 v80, v80, v81
    v_cvt_pk_bf16_f32 v81, v82, v83
    v_cvt_pk_bf16_f32 v82, v208, v209
    v_cvt_pk_bf16_f32 v83, v210, v211
    v_accvgpr_read_b32 v192, a160
    v_accvgpr_read_b32 v193, a161
    v_accvgpr_read_b32 v194, a162
    v_accvgpr_read_b32 v195, a163
    v_pk_fma_f32 v[96:97], v[48:49], v[34:35], v[96:97] op_sel:[0,0,0] op_sel_hi:[1,0,1]
    v_pk_fma_f32 v[98:99], v[50:51], v[34:35], v[98:99] op_sel:[0,0,0] op_sel_hi:[1,0,1]
    v_pk_fma_f32 v[192:193], v[52:53], v[34:35], v[192:193] op_sel:[0,0,0] op_sel_hi:[1,0,1]
    v_pk_fma_f32 v[194:195], v[54:55], v[34:35], v[194:195] op_sel:[0,0,0] op_sel_hi:[1,0,1]
    v_pk_mul_f32 v[96:97], v[96:97], v[38:39] op_sel:[0,0] op_sel_hi:[1,0]
    v_pk_mul_f32 v[98:99], v[98:99], v[38:39] op_sel:[0,0] op_sel_hi:[1,0]
    v_pk_mul_f32 v[192:193], v[192:193], v[38:39] op_sel:[0,0] op_sel_hi:[1,0]
    v_pk_mul_f32 v[194:195], v[194:195], v[38:39] op_sel:[0,0] op_sel_hi:[1,0]
    v_cvt_pk_bf16_f32 v96, v96, v97
    v_cvt_pk_bf16_f32 v97, v98, v99
    v_cvt_pk_bf16_f32 v98, v192, v193
    v_cvt_pk_bf16_f32 v99, v194, v195
    v_accvgpr_read_b32 v208, a176
    v_accvgpr_read_b32 v209, a177
    v_accvgpr_read_b32 v210, a178
    v_accvgpr_read_b32 v211, a179
    v_pk_fma_f32 v[112:113], v[48:49], v[34:35], v[112:113] op_sel:[0,1,0] op_sel_hi:[1,1,1]
    v_pk_fma_f32 v[114:115], v[50:51], v[34:35], v[114:115] op_sel:[0,1,0] op_sel_hi:[1,1,1]
    v_pk_fma_f32 v[208:209], v[52:53], v[34:35], v[208:209] op_sel:[0,1,0] op_sel_hi:[1,1,1]
    v_pk_fma_f32 v[210:211], v[54:55], v[34:35], v[210:211] op_sel:[0,1,0] op_sel_hi:[1,1,1]
    v_pk_mul_f32 v[112:113], v[112:113], v[38:39] op_sel:[0,1] op_sel_hi:[1,1]
    v_pk_mul_f32 v[114:115], v[114:115], v[38:39] op_sel:[0,1] op_sel_hi:[1,1]
    v_pk_mul_f32 v[208:209], v[208:209], v[38:39] op_sel:[0,1] op_sel_hi:[1,1]
    v_pk_mul_f32 v[210:211], v[210:211], v[38:39] op_sel:[0,1] op_sel_hi:[1,1]
    v_cvt_pk_bf16_f32 v112, v112, v113
    v_cvt_pk_bf16_f32 v113, v114, v115
    v_cvt_pk_bf16_f32 v114, v208, v209
    v_cvt_pk_bf16_f32 v115, v210, v211
    ds_read_b128 v[48:51], v26 offset:0
    ds_read_b128 v[52:55], v26 offset:64
    s_waitcnt lgkmcnt(2)
    v_accvgpr_read_b32 v192, a132
    v_accvgpr_read_b32 v193, a133
    v_accvgpr_read_b32 v194, a134
    v_accvgpr_read_b32 v195, a135
    v_pk_fma_f32 v[68:69], v[56:57], v[32:33], v[68:69] op_sel:[0,0,0] op_sel_hi:[1,0,1]
    v_pk_fma_f32 v[70:71], v[58:59], v[32:33], v[70:71] op_sel:[0,0,0] op_sel_hi:[1,0,1]
    v_pk_fma_f32 v[192:193], v[60:61], v[32:33], v[192:193] op_sel:[0,0,0] op_sel_hi:[1,0,1]
    v_pk_fma_f32 v[194:195], v[62:63], v[32:33], v[194:195] op_sel:[0,0,0] op_sel_hi:[1,0,1]
    v_pk_mul_f32 v[68:69], v[68:69], v[36:37] op_sel:[0,0] op_sel_hi:[1,0]
    v_pk_mul_f32 v[70:71], v[70:71], v[36:37] op_sel:[0,0] op_sel_hi:[1,0]
    v_pk_mul_f32 v[192:193], v[192:193], v[36:37] op_sel:[0,0] op_sel_hi:[1,0]
    v_pk_mul_f32 v[194:195], v[194:195], v[36:37] op_sel:[0,0] op_sel_hi:[1,0]
    v_cvt_pk_bf16_f32 v68, v68, v69
    v_cvt_pk_bf16_f32 v69, v70, v71
    v_cvt_pk_bf16_f32 v70, v192, v193
    v_cvt_pk_bf16_f32 v71, v194, v195
    v_accvgpr_read_b32 v208, a148
    v_accvgpr_read_b32 v209, a149
    v_accvgpr_read_b32 v210, a150
    v_accvgpr_read_b32 v211, a151
    v_pk_fma_f32 v[84:85], v[56:57], v[32:33], v[84:85] op_sel:[0,1,0] op_sel_hi:[1,1,1]
    v_pk_fma_f32 v[86:87], v[58:59], v[32:33], v[86:87] op_sel:[0,1,0] op_sel_hi:[1,1,1]
    v_pk_fma_f32 v[208:209], v[60:61], v[32:33], v[208:209] op_sel:[0,1,0] op_sel_hi:[1,1,1]
    v_pk_fma_f32 v[210:211], v[62:63], v[32:33], v[210:211] op_sel:[0,1,0] op_sel_hi:[1,1,1]
    v_pk_mul_f32 v[84:85], v[84:85], v[36:37] op_sel:[0,1] op_sel_hi:[1,1]
    v_pk_mul_f32 v[86:87], v[86:87], v[36:37] op_sel:[0,1] op_sel_hi:[1,1]
    v_pk_mul_f32 v[208:209], v[208:209], v[36:37] op_sel:[0,1] op_sel_hi:[1,1]
    v_pk_mul_f32 v[210:211], v[210:211], v[36:37] op_sel:[0,1] op_sel_hi:[1,1]
    v_cvt_pk_bf16_f32 v84, v84, v85
    v_cvt_pk_bf16_f32 v85, v86, v87
    v_cvt_pk_bf16_f32 v86, v208, v209
    v_cvt_pk_bf16_f32 v87, v210, v211
    v_accvgpr_read_b32 v192, a164
    v_accvgpr_read_b32 v193, a165
    v_accvgpr_read_b32 v194, a166
    v_accvgpr_read_b32 v195, a167
    v_pk_fma_f32 v[100:101], v[56:57], v[34:35], v[100:101] op_sel:[0,0,0] op_sel_hi:[1,0,1]
    v_pk_fma_f32 v[102:103], v[58:59], v[34:35], v[102:103] op_sel:[0,0,0] op_sel_hi:[1,0,1]
    v_pk_fma_f32 v[192:193], v[60:61], v[34:35], v[192:193] op_sel:[0,0,0] op_sel_hi:[1,0,1]
    v_pk_fma_f32 v[194:195], v[62:63], v[34:35], v[194:195] op_sel:[0,0,0] op_sel_hi:[1,0,1]
    v_pk_mul_f32 v[100:101], v[100:101], v[38:39] op_sel:[0,0] op_sel_hi:[1,0]
    v_pk_mul_f32 v[102:103], v[102:103], v[38:39] op_sel:[0,0] op_sel_hi:[1,0]
    v_pk_mul_f32 v[192:193], v[192:193], v[38:39] op_sel:[0,0] op_sel_hi:[1,0]
    v_pk_mul_f32 v[194:195], v[194:195], v[38:39] op_sel:[0,0] op_sel_hi:[1,0]
    v_cvt_pk_bf16_f32 v100, v100, v101
    v_cvt_pk_bf16_f32 v101, v102, v103
    v_cvt_pk_bf16_f32 v102, v192, v193
    v_cvt_pk_bf16_f32 v103, v194, v195
    v_accvgpr_read_b32 v208, a180
    v_accvgpr_read_b32 v209, a181
    v_accvgpr_read_b32 v210, a182
    v_accvgpr_read_b32 v211, a183
    v_pk_fma_f32 v[116:117], v[56:57], v[34:35], v[116:117] op_sel:[0,1,0] op_sel_hi:[1,1,1]
    v_pk_fma_f32 v[118:119], v[58:59], v[34:35], v[118:119] op_sel:[0,1,0] op_sel_hi:[1,1,1]
    v_pk_fma_f32 v[208:209], v[60:61], v[34:35], v[208:209] op_sel:[0,1,0] op_sel_hi:[1,1,1]
    v_pk_fma_f32 v[210:211], v[62:63], v[34:35], v[210:211] op_sel:[0,1,0] op_sel_hi:[1,1,1]
    v_pk_mul_f32 v[116:117], v[116:117], v[38:39] op_sel:[0,1] op_sel_hi:[1,1]
    v_pk_mul_f32 v[118:119], v[118:119], v[38:39] op_sel:[0,1] op_sel_hi:[1,1]
    v_pk_mul_f32 v[208:209], v[208:209], v[38:39] op_sel:[0,1] op_sel_hi:[1,1]
    v_pk_mul_f32 v[210:211], v[210:211], v[38:39] op_sel:[0,1] op_sel_hi:[1,1]
    v_cvt_pk_bf16_f32 v116, v116, v117
    v_cvt_pk_bf16_f32 v117, v118, v119
    v_cvt_pk_bf16_f32 v118, v208, v209
    v_cvt_pk_bf16_f32 v119, v210, v211
    ds_read_b128 v[56:59], v27 offset:0
    ds_read_b128 v[60:63], v27 offset:64
    s_waitcnt lgkmcnt(2)
    v_accvgpr_read_b32 v192, a136
    v_accvgpr_read_b32 v193, a137
    v_accvgpr_read_b32 v194, a138
    v_accvgpr_read_b32 v195, a139
    v_pk_fma_f32 v[72:73], v[48:49], v[32:33], v[72:73] op_sel:[0,0,0] op_sel_hi:[1,0,1]
    v_pk_fma_f32 v[74:75], v[50:51], v[32:33], v[74:75] op_sel:[0,0,0] op_sel_hi:[1,0,1]
    v_pk_fma_f32 v[192:193], v[52:53], v[32:33], v[192:193] op_sel:[0,0,0] op_sel_hi:[1,0,1]
    v_pk_fma_f32 v[194:195], v[54:55], v[32:33], v[194:195] op_sel:[0,0,0] op_sel_hi:[1,0,1]
    v_pk_mul_f32 v[72:73], v[72:73], v[36:37] op_sel:[0,0] op_sel_hi:[1,0]
    v_pk_mul_f32 v[74:75], v[74:75], v[36:37] op_sel:[0,0] op_sel_hi:[1,0]
    v_pk_mul_f32 v[192:193], v[192:193], v[36:37] op_sel:[0,0] op_sel_hi:[1,0]
    v_pk_mul_f32 v[194:195], v[194:195], v[36:37] op_sel:[0,0] op_sel_hi:[1,0]
    v_cvt_pk_bf16_f32 v72, v72, v73
    v_cvt_pk_bf16_f32 v73, v74, v75
    v_cvt_pk_bf16_f32 v74, v192, v193
    v_cvt_pk_bf16_f32 v75, v194, v195
    v_accvgpr_read_b32 v208, a152
    v_accvgpr_read_b32 v209, a153
    v_accvgpr_read_b32 v210, a154
    v_accvgpr_read_b32 v211, a155
    v_pk_fma_f32 v[88:89], v[48:49], v[32:33], v[88:89] op_sel:[0,1,0] op_sel_hi:[1,1,1]
    v_pk_fma_f32 v[90:91], v[50:51], v[32:33], v[90:91] op_sel:[0,1,0] op_sel_hi:[1,1,1]
    v_pk_fma_f32 v[208:209], v[52:53], v[32:33], v[208:209] op_sel:[0,1,0] op_sel_hi:[1,1,1]
    v_pk_fma_f32 v[210:211], v[54:55], v[32:33], v[210:211] op_sel:[0,1,0] op_sel_hi:[1,1,1]
    v_pk_mul_f32 v[88:89], v[88:89], v[36:37] op_sel:[0,1] op_sel_hi:[1,1]
    v_pk_mul_f32 v[90:91], v[90:91], v[36:37] op_sel:[0,1] op_sel_hi:[1,1]
    v_pk_mul_f32 v[208:209], v[208:209], v[36:37] op_sel:[0,1] op_sel_hi:[1,1]
    v_pk_mul_f32 v[210:211], v[210:211], v[36:37] op_sel:[0,1] op_sel_hi:[1,1]
    v_cvt_pk_bf16_f32 v88, v88, v89
    v_cvt_pk_bf16_f32 v89, v90, v91
    v_cvt_pk_bf16_f32 v90, v208, v209
    v_cvt_pk_bf16_f32 v91, v210, v211
    v_accvgpr_read_b32 v192, a168
    v_accvgpr_read_b32 v193, a169
    v_accvgpr_read_b32 v194, a170
    v_accvgpr_read_b32 v195, a171
    v_pk_fma_f32 v[104:105], v[48:49], v[34:35], v[104:105] op_sel:[0,0,0] op_sel_hi:[1,0,1]
    v_pk_fma_f32 v[106:107], v[50:51], v[34:35], v[106:107] op_sel:[0,0,0] op_sel_hi:[1,0,1]
    v_pk_fma_f32 v[192:193], v[52:53], v[34:35], v[192:193] op_sel:[0,0,0] op_sel_hi:[1,0,1]
    v_pk_fma_f32 v[194:195], v[54:55], v[34:35], v[194:195] op_sel:[0,0,0] op_sel_hi:[1,0,1]
    v_pk_mul_f32 v[104:105], v[104:105], v[38:39] op_sel:[0,0] op_sel_hi:[1,0]
    v_pk_mul_f32 v[106:107], v[106:107], v[38:39] op_sel:[0,0] op_sel_hi:[1,0]
    v_pk_mul_f32 v[192:193], v[192:193], v[38:39] op_sel:[0,0] op_sel_hi:[1,0]
    v_pk_mul_f32 v[194:195], v[194:195], v[38:39] op_sel:[0,0] op_sel_hi:[1,0]
    v_cvt_pk_bf16_f32 v104, v104, v105
    v_cvt_pk_bf16_f32 v105, v106, v107
    v_cvt_pk_bf16_f32 v106, v192, v193
    v_cvt_pk_bf16_f32 v107, v194, v195
    v_accvgpr_read_b32 v208, a184
    v_accvgpr_read_b32 v209, a185
    v_accvgpr_read_b32 v210, a186
    v_accvgpr_read_b32 v211, a187
    v_pk_fma_f32 v[120:121], v[48:49], v[34:35], v[120:121] op_sel:[0,1,0] op_sel_hi:[1,1,1]
    v_pk_fma_f32 v[122:123], v[50:51], v[34:35], v[122:123] op_sel:[0,1,0] op_sel_hi:[1,1,1]
    v_pk_fma_f32 v[208:209], v[52:53], v[34:35], v[208:209] op_sel:[0,1,0] op_sel_hi:[1,1,1]
    v_pk_fma_f32 v[210:211], v[54:55], v[34:35], v[210:211] op_sel:[0,1,0] op_sel_hi:[1,1,1]
    v_pk_mul_f32 v[120:121], v[120:121], v[38:39] op_sel:[0,1] op_sel_hi:[1,1]
    v_pk_mul_f32 v[122:123], v[122:123], v[38:39] op_sel:[0,1] op_sel_hi:[1,1]
    v_pk_mul_f32 v[208:209], v[208:209], v[38:39] op_sel:[0,1] op_sel_hi:[1,1]
    v_pk_mul_f32 v[210:211], v[210:211], v[38:39] op_sel:[0,1] op_sel_hi:[1,1]
    v_cvt_pk_bf16_f32 v120, v120, v121
    v_cvt_pk_bf16_f32 v121, v122, v123
    v_cvt_pk_bf16_f32 v122, v208, v209
    v_cvt_pk_bf16_f32 v123, v210, v211
    s_waitcnt lgkmcnt(0)
    v_accvgpr_read_b32 v192, a140
    v_accvgpr_read_b32 v193, a141
    v_accvgpr_read_b32 v194, a142
    v_accvgpr_read_b32 v195, a143
    v_pk_fma_f32 v[76:77], v[56:57], v[32:33], v[76:77] op_sel:[0,0,0] op_sel_hi:[1,0,1]
    v_pk_fma_f32 v[78:79], v[58:59], v[32:33], v[78:79] op_sel:[0,0,0] op_sel_hi:[1,0,1]
    v_pk_fma_f32 v[192:193], v[60:61], v[32:33], v[192:193] op_sel:[0,0,0] op_sel_hi:[1,0,1]
    v_pk_fma_f32 v[194:195], v[62:63], v[32:33], v[194:195] op_sel:[0,0,0] op_sel_hi:[1,0,1]
    v_pk_mul_f32 v[76:77], v[76:77], v[36:37] op_sel:[0,0] op_sel_hi:[1,0]
    v_pk_mul_f32 v[78:79], v[78:79], v[36:37] op_sel:[0,0] op_sel_hi:[1,0]
    v_pk_mul_f32 v[192:193], v[192:193], v[36:37] op_sel:[0,0] op_sel_hi:[1,0]
    v_pk_mul_f32 v[194:195], v[194:195], v[36:37] op_sel:[0,0] op_sel_hi:[1,0]
    v_cvt_pk_bf16_f32 v76, v76, v77
    v_cvt_pk_bf16_f32 v77, v78, v79
    v_cvt_pk_bf16_f32 v78, v192, v193
    v_cvt_pk_bf16_f32 v79, v194, v195
    v_accvgpr_read_b32 v208, a156
    v_accvgpr_read_b32 v209, a157
    v_accvgpr_read_b32 v210, a158
    v_accvgpr_read_b32 v211, a159
    v_pk_fma_f32 v[92:93], v[56:57], v[32:33], v[92:93] op_sel:[0,1,0] op_sel_hi:[1,1,1]
    v_pk_fma_f32 v[94:95], v[58:59], v[32:33], v[94:95] op_sel:[0,1,0] op_sel_hi:[1,1,1]
    v_pk_fma_f32 v[208:209], v[60:61], v[32:33], v[208:209] op_sel:[0,1,0] op_sel_hi:[1,1,1]
    v_pk_fma_f32 v[210:211], v[62:63], v[32:33], v[210:211] op_sel:[0,1,0] op_sel_hi:[1,1,1]
    v_pk_mul_f32 v[92:93], v[92:93], v[36:37] op_sel:[0,1] op_sel_hi:[1,1]
    v_pk_mul_f32 v[94:95], v[94:95], v[36:37] op_sel:[0,1] op_sel_hi:[1,1]
    v_pk_mul_f32 v[208:209], v[208:209], v[36:37] op_sel:[0,1] op_sel_hi:[1,1]
    v_pk_mul_f32 v[210:211], v[210:211], v[36:37] op_sel:[0,1] op_sel_hi:[1,1]
    v_cvt_pk_bf16_f32 v92, v92, v93
    v_cvt_pk_bf16_f32 v93, v94, v95
    v_cvt_pk_bf16_f32 v94, v208, v209
    v_cvt_pk_bf16_f32 v95, v210, v211
    v_accvgpr_read_b32 v192, a172
    v_accvgpr_read_b32 v193, a173
    v_accvgpr_read_b32 v194, a174
    v_accvgpr_read_b32 v195, a175
    v_pk_fma_f32 v[108:109], v[56:57], v[34:35], v[108:109] op_sel:[0,0,0] op_sel_hi:[1,0,1]
    v_pk_fma_f32 v[110:111], v[58:59], v[34:35], v[110:111] op_sel:[0,0,0] op_sel_hi:[1,0,1]
    v_pk_fma_f32 v[192:193], v[60:61], v[34:35], v[192:193] op_sel:[0,0,0] op_sel_hi:[1,0,1]
    v_pk_fma_f32 v[194:195], v[62:63], v[34:35], v[194:195] op_sel:[0,0,0] op_sel_hi:[1,0,1]
    v_pk_mul_f32 v[108:109], v[108:109], v[38:39] op_sel:[0,0] op_sel_hi:[1,0]
    v_pk_mul_f32 v[110:111], v[110:111], v[38:39] op_sel:[0,0] op_sel_hi:[1,0]
    v_pk_mul_f32 v[192:193], v[192:193], v[38:39] op_sel:[0,0] op_sel_hi:[1,0]
    v_pk_mul_f32 v[194:195], v[194:195], v[38:39] op_sel:[0,0] op_sel_hi:[1,0]
    v_cvt_pk_bf16_f32 v108, v108, v109
    v_cvt_pk_bf16_f32 v109, v110, v111
    v_cvt_pk_bf16_f32 v110, v192, v193
    v_cvt_pk_bf16_f32 v111, v194, v195
    v_accvgpr_read_b32 v208, a188
    v_accvgpr_read_b32 v209, a189
    v_accvgpr_read_b32 v210, a190
    v_accvgpr_read_b32 v211, a191
    v_pk_fma_f32 v[124:125], v[56:57], v[34:35], v[124:125] op_sel:[0,1,0] op_sel_hi:[1,1,1]
    v_pk_fma_f32 v[126:127], v[58:59], v[34:35], v[126:127] op_sel:[0,1,0] op_sel_hi:[1,1,1]
    v_pk_fma_f32 v[208:209], v[60:61], v[34:35], v[208:209] op_sel:[0,1,0] op_sel_hi:[1,1,1]
    v_pk_fma_f32 v[210:211], v[62:63], v[34:35], v[210:211] op_sel:[0,1,0] op_sel_hi:[1,1,1]
    v_pk_mul_f32 v[124:125], v[124:125], v[38:39] op_sel:[0,1] op_sel_hi:[1,1]
    v_pk_mul_f32 v[126:127], v[126:127], v[38:39] op_sel:[0,1] op_sel_hi:[1,1]
    v_pk_mul_f32 v[208:209], v[208:209], v[38:39] op_sel:[0,1] op_sel_hi:[1,1]
    v_pk_mul_f32 v[210:211], v[210:211], v[38:39] op_sel:[0,1] op_sel_hi:[1,1]
    v_cvt_pk_bf16_f32 v124, v124, v125
    v_cvt_pk_bf16_f32 v125, v126, v127
    v_cvt_pk_bf16_f32 v126, v208, v209
    v_cvt_pk_bf16_f32 v127, v210, v211
    v_pk_mul_f32 v[232:233], v[232:233], v[168:169]
    v_pk_mul_f32 v[168:169], v[168:169], v[42:43] op_sel:[0,0] op_sel_hi:[1,0]
    v_pk_mul_f32 v[234:235], v[234:235], v[170:171]
    v_pk_mul_f32 v[170:171], v[170:171], v[42:43] op_sel:[0,0] op_sel_hi:[1,0]
    v_exp_f32 v168, v168
    v_exp_f32 v169, v169
    v_mfma_f32_16x16x32_bf16 v[48:51], a[212:215], v[64:67], 0
    v_exp_f32 v170, v170
    v_mfma_f32_16x16x32_bf16 v[48:51], a[216:219], v[68:71], v[48:51]
    v_exp_f32 v171, v171
    v_pk_fma_f32 v[168:169], v[168:169], v[46:47], v[46:47] op_sel:[0,0,0] op_sel_hi:[1,0,0]
    v_pk_fma_f32 v[170:171], v[170:171], v[46:47], v[46:47] op_sel:[0,0,0] op_sel_hi:[1,0,0]
    v_rcp_f32 v168, v168
    v_rcp_f32 v169, v169
    v_mfma_f32_16x16x32_bf16 v[48:51], a[220:223], v[72:75], v[48:51]
    v_rcp_f32 v170, v170
    v_mfma_f32_16x16x32_bf16 v[48:51], a[224:227], v[76:79], v[48:51]
    v_rcp_f32 v171, v171
    v_pk_mul_f32 v[168:169], v[168:169], v[232:233]
    v_pk_mul_f32 v[170:171], v[170:171], v[234:235]
    v_cvt_pk_bf16_f32 v168, v168, v169
    v_cvt_pk_bf16_f32 v169, v170, v171
    buffer_store_dwordx2 v[168:169], v29, s[28:31], s64 offen sc1
    s_add_u32 s64, s64, 188416
    v_pk_mul_f32 v[204:205], v[204:205], v[140:141]
    v_pk_mul_f32 v[140:141], v[140:141], v[42:43] op_sel:[0,1] op_sel_hi:[1,1]
    v_pk_mul_f32 v[206:207], v[206:207], v[142:143]
    v_pk_mul_f32 v[142:143], v[142:143], v[42:43] op_sel:[0,1] op_sel_hi:[1,1]
    v_pk_mul_f32 v[220:221], v[220:221], v[156:157]
    v_pk_mul_f32 v[156:157], v[156:157], v[42:43] op_sel:[0,1] op_sel_hi:[1,1]
    v_pk_mul_f32 v[222:223], v[222:223], v[158:159]
    v_pk_mul_f32 v[158:159], v[158:159], v[42:43] op_sel:[0,1] op_sel_hi:[1,1]
    v_exp_f32 v140, v140
    v_exp_f32 v141, v141
    v_mfma_f32_16x16x32_bf16 v[52:55], a[224:227], v[92:95], 0
    v_exp_f32 v142, v142
    v_mfma_f32_16x16x32_bf16 v[52:55], a[220:223], v[88:91], v[52:55]
    v_exp_f32 v143, v143
    v_mfma_f32_16x16x32_bf16 v[52:55], a[216:219], v[84:87], v[52:55]
    v_exp_f32 v156, v156
    v_exp_f32 v157, v157
    v_exp_f32 v158, v158
    v_exp_f32 v159, v159
    v_pk_fma_f32 v[140:141], v[140:141], v[46:47], v[46:47] op_sel:[0,1,1] op_sel_hi:[1,1,1]
    v_pk_fma_f32 v[142:143], v[142:143], v[46:47], v[46:47] op_sel:[0,1,1] op_sel_hi:[1,1,1]
    v_pk_fma_f32 v[156:157], v[156:157], v[46:47], v[46:47] op_sel:[0,1,1] op_sel_hi:[1,1,1]
    v_pk_fma_f32 v[158:159], v[158:159], v[46:47], v[46:47] op_sel:[0,1,1] op_sel_hi:[1,1,1]
    v_rcp_f32 v140, v140
    v_rcp_f32 v141, v141
    v_mfma_f32_16x16x32_bf16 v[52:55], a[212:215], v[80:83], v[52:55]
    v_rcp_f32 v142, v142
    v_mfma_f32_16x16x32_bf16 v[56:59], a[212:215], v[96:99], 0
    v_rcp_f32 v143, v143
    v_mfma_f32_16x16x32_bf16 v[56:59], a[216:219], v[100:103], v[56:59]
    v_rcp_f32 v156, v156
    v_rcp_f32 v157, v157
    v_rcp_f32 v158, v158
    v_rcp_f32 v159, v159
    v_pk_mul_f32 v[140:141], v[140:141], v[204:205]
    v_pk_mul_f32 v[142:143], v[142:143], v[206:207]
    v_pk_mul_f32 v[156:157], v[156:157], v[220:221]
    v_pk_mul_f32 v[158:159], v[158:159], v[222:223]
    v_cvt_pk_bf16_f32 v140, v140, v141
    v_cvt_pk_bf16_f32 v141, v142, v143
    v_cvt_pk_bf16_f32 v142, v156, v157
    v_cvt_pk_bf16_f32 v143, v158, v159
    buffer_store_dwordx4 v[140:143], v28, s[28:31], s64 offen sc1
    v_pk_mul_f32 v[236:237], v[236:237], v[172:173]
    v_pk_mul_f32 v[172:173], v[172:173], v[42:43] op_sel:[0,1] op_sel_hi:[1,1]
    v_pk_mul_f32 v[238:239], v[238:239], v[174:175]
    v_pk_mul_f32 v[174:175], v[174:175], v[42:43] op_sel:[0,1] op_sel_hi:[1,1]
    v_exp_f32 v172, v172
    v_exp_f32 v173, v173
    v_mfma_f32_16x16x32_bf16 v[56:59], a[220:223], v[104:107], v[56:59]
    v_exp_f32 v174, v174
    v_mfma_f32_16x16x32_bf16 v[56:59], a[224:227], v[108:111], v[56:59]
    v_exp_f32 v175, v175
    v_pk_fma_f32 v[172:173], v[172:173], v[46:47], v[46:47] op_sel:[0,1,1] op_sel_hi:[1,1,1]
    v_pk_fma_f32 v[174:175], v[174:175], v[46:47], v[46:47] op_sel:[0,1,1] op_sel_hi:[1,1,1]
    v_rcp_f32 v172, v172
    v_rcp_f32 v173, v173
    v_mfma_f32_16x16x32_bf16 v[60:63], a[224:227], v[124:127], 0
    v_rcp_f32 v174, v174
    v_mfma_f32_16x16x32_bf16 v[60:63], a[220:223], v[120:123], v[60:63]
    v_rcp_f32 v175, v175
    v_pk_mul_f32 v[172:173], v[172:173], v[236:237]
    v_pk_mul_f32 v[174:175], v[174:175], v[238:239]
    v_cvt_pk_bf16_f32 v172, v172, v173
    v_cvt_pk_bf16_f32 v173, v174, v175
    buffer_store_dwordx2 v[172:173], v29, s[28:31], s64 offen sc1
    v_mfma_f32_16x16x32_bf16 v[60:63], a[216:219], v[116:119], v[60:63]
    v_mfma_f32_16x16x32_bf16 v[60:63], a[212:215], v[112:115], v[60:63]
    s_cmp_eq_u32 0, 0
L_proj_join:
    s_cbranch_scc0 L_proj_F
    s_cmp_lg_u32 s70, 0
    s_cbranch_scc1 L_truemax
    v_max3_f32 v48, v48, v49, v50
    v_max_f32 v48, v48, v51
    v_max3_f32 v52, v52, v53, v54
    v_max_f32 v52, v52, v55
    v_max3_f32 v56, v56, v57, v58
    v_max_f32 v56, v56, v59
    v_max3_f32 v60, v60, v61, v62
    v_max_f32 v60, v60, v63
    v_mov_b32 v24, v48
    v_mov_b32 v25, v52
    v_mov_b32 v26, v56
    v_mov_b32 v27, v60
    v_permlane32_swap_b32 v24, v48
    v_permlane32_swap_b32 v25, v52
    v_permlane32_swap_b32 v26, v56
    v_permlane32_swap_b32 v27, v60
    v_max_f32 v48, v48, v24
    v_max_f32 v52, v52, v25
    v_max_f32 v56, v56, v26
    v_max_f32 v60, v60, v27
    v_mov_b32 v24, v48
    v_mov_b32 v25, v52
    v_mov_b32 v26, v56
    v_mov_b32 v27, v60
    v_permlane16_swap_b32 v24, v48
    v_permlane16_swap_b32 v25, v52
    v_permlane16_swap_b32 v26, v56
    v_permlane16_swap_b32 v27, v60
    v_max_f32 v24, v48, v24
    v_max_f32 v25, v52, v25
    v_max_f32 v26, v56, v26
    v_max_f32 v27, v60, v27
    v_sub_f32 v48, 0x42000000, v24
    v_sub_f32 v49, 0x42000000, v24
    v_sub_f32 v50, 0x42000000, v24
    v_sub_f32 v51, 0x42000000, v24
    v_sub_f32 v52, 0x42000000, v25
    v_sub_f32 v53, 0x42000000, v25
    v_sub_f32 v54, 0x42000000, v25
    v_sub_f32 v55, 0x42000000, v25
    v_sub_f32 v56, 0x42000000, v26
    v_sub_f32 v57, 0x42000000, v26
    v_sub_f32 v58, 0x42000000, v26
    v_sub_f32 v59, 0x42000000, v26
    v_sub_f32 v60, 0x42000000, v27
    v_sub_f32 v61, 0x42000000, v27
    v_sub_f32 v62, 0x42000000, v27
    v_sub_f32 v63, 0x42000000, v27
L_att_start:
    v_mfma_f32_16x16x32_bf16 v[32:35], a[212:215], v[64:67], v[48:51]
    s_lshl_b32 s42, s57, 13
    v_and_b32 v28, 15, v0
    v_lshrrev_b32 v29, 6, v0
    v_mfma_f32_16x16x32_bf16 v[32:35], a[216:219], v[68:71], v[32:35]
    s_add_u32 s42, s42, 32768
    v_lshl_add_u32 v28, v29, 4, v28
    v_bfe_u32 v29, v0, 4, 2
    v_mfma_f32_16x16x32_bf16 v[32:35], a[220:223], v[72:75], v[32:35]
    s_sub_u32 s42, s42, s59
    v_lshlrev_b32 v29, 29, v29
    v_lshl_add_u32 v29, v28, 7, v29
    v_mfma_f32_16x16x32_bf16 v[32:35], a[224:227], v[76:79], v[32:35]
    s_lshr_b32 s40, s2, 3
    v_add_u32 v28, s42, v29
    v_bfe_u32 v30, v0, 4, 1
    v_mfma_f32_16x16x32_bf16 v[36:39], a[224:227], v[92:95], v[52:55]
    s_mul_i32 s41, s40, 14336
    buffer_load_dword a252, v28, s[24:27], s63 offen
    v_mfma_f32_16x16x32_bf16 v[36:39], a[220:223], v[88:91], v[36:39]
    s_lshl_b32 s40, s40, 15
    v_mul_u32_u24 v30, 0xffff, v30
    v_lshlrev_b32 v30, 13, v30
    v_mfma_f32_16x16x32_bf16 v[36:39], a[216:219], v[84:87], v[36:39]
    s_lshl_b32 s3, s95, 20
    ds_read_b128 a[228:231], v2 offset:4096
    ds_read_b128 a[232:235], v3 offset:4096
    v_mfma_f32_16x16x32_bf16 v[36:39], a[212:215], v[80:83], v[36:39]
    s_add_u32 s40, s40, s3
    ds_read_b128 a[236:239], v4 offset:4096
    ds_read_b128 a[240:243], v5 offset:4096
    v_mfma_f32_16x16x32_bf16 v[40:43], a[212:215], v[96:99], v[56:59]
    s_mul_i32 s3, s95, 458752
    v_exp_f32 v32, v32
    v_mfma_f32_16x16x32_bf16 v[40:43], a[216:219], v[100:103], v[40:43]
    s_add_u32 s41, s41, s3
    v_exp_f32 v33, v33
    v_mfma_f32_16x16x32_bf16 v[40:43], a[220:223], v[104:107], v[40:43]
    s_lshl_b32 s43, s57, 5
    v_exp_f32 v34, v34
    v_cvt_pk_bf16_f32 v128, v32, v33
    v_mfma_f32_16x16x32_bf16 v[40:43], a[224:227], v[108:111], v[40:43]
    s_add_u32 s43, s43, s56
    v_exp_f32 v35, v35
    v_mfma_f32_16x16x32_bf16 v[44:47], a[224:227], v[124:127], v[60:63]
    s_lshl_b32 s43, s43, 7
    v_cvt_pk_bf16_f32 v129, v34, v35
    v_exp_f32 v36, v36
    v_mfma_f32_16x16x32_bf16 v[44:47], a[220:223], v[120:123], v[44:47]
    s_add_u32 s43, s43, 32768
    v_exp_f32 v37, v37
    v_mfma_f32_16x16x32_bf16 v[44:47], a[216:219], v[116:119], v[44:47]
    s_lshr_b32 s18, s93, 1
    v_exp_f32 v38, v38
    v_cvt_pk_bf16_f32 v144, v36, v37
    v_mfma_f32_16x16x32_bf16 v[44:47], a[212:215], v[112:115], v[44:47]
    s_lshl_b32 s18, s18, 2
    v_exp_f32 v39, v39
    v_mfma_f32_32x32x16_bf16 a[0:15], a[248:251], a[248:251], 0
    s_add_u32 s18, s18, s95
    v_cvt_pk_bf16_f32 v145, v38, v39
    v_exp_f32 v40, v40
    v_sub_u32 v30, v29, v30
    v_add_u32 v30, s40, v30
    v_add_u32 v29, s41, v29
    v_mfma_f32_32x32x16_bf16 a[192:207], a[248:251], a[248:251], 0
    s_waitcnt lgkmcnt(0)
    v_exp_f32 v41, v41
    v_lshl_add_u32 v21, v0, 18, s43
    v_mov_b32 v22, 1
    v_and_b32 v23, 7, v0
    v_and_b32 v24, 8, v0
    v_mfma_f32_16x16x32_bf16 v[32:35], a[228:231], v[64:67], v[48:51]
    s_lshl_b32 s18, s18, 10
    v_exp_f32 v42, v42
    v_cvt_pk_bf16_f32 v160, v40, v41
    v_mfma_f32_16x16x32_bf16 v[32:35], a[232:235], v[68:71], v[32:35]
    s_add_u32 s18, s18, 32768
    v_exp_f32 v43, v43
    v_mfma_f32_16x16x32_bf16 v[32:35], a[236:239], v[72:75], v[32:35]
    s_mul_i32 s19, s94, 3584
    v_cvt_pk_bf16_f32 v161, v42, v43
    v_exp_f32 v44, v44
    v_mfma_f32_16x16x32_bf16 v[32:35], a[240:243], v[76:79], v[32:35]
    s_mov_b32 s64, 7
    v_exp_f32 v45, v45
    v_mfma_f32_16x16x32_bf16 v[36:39], a[240:243], v[92:95], v[52:55]
    s_mov_b32 s100, 0
    v_exp_f32 v46, v46
    v_cvt_pk_bf16_f32 v176, v44, v45
    v_mfma_f32_16x16x32_bf16 v[36:39], a[236:239], v[88:91], v[36:39]
    s_mov_b32 s101, 0
    v_exp_f32 v47, v47
    v_mfma_f32_16x16x32_bf16 v[36:39], a[232:235], v[84:87], v[36:39]
    s_add_u32 s32, s36, 33554432
    ds_read_b128 a[212:215], v2 offset:8192
    v_cvt_pk_bf16_f32 v177, v46, v47
    v_mfma_f32_16x16x32_bf16 v[36:39], a[228:231], v[80:83], v[36:39]
    s_addc_u32 s33, s37, 0
    ds_read_b128 a[216:219], v3 offset:8192
    ds_read_b128 a[220:223], v4 offset:8192
    v_mfma_f32_16x16x32_bf16 v[40:43], a[228:231], v[96:99], v[56:59]
    s_mov_b32 s34, 0x1000000
    ds_read_b128 a[224:227], v5 offset:8192
    v_exp_f32 v32, v32
    v_mfma_f32_16x16x32_bf16 v[40:43], a[232:235], v[100:103], v[40:43]
    s_lshl_b32 s65, s93, 2
    v_exp_f32 v33, v33
    v_mfma_f32_16x16x32_bf16 v[40:43], a[236:239], v[104:107], v[40:43]
    s_add_u32 s65, s65, s94
    v_exp_f32 v34, v34
    v_cvt_pk_bf16_f32 v130, v32, v33
    v_mfma_f32_16x16x32_bf16 v[40:43], a[240:243], v[108:111], v[40:43]
    s_lshl_b32 s65, s65, 2
    v_exp_f32 v35, v35
    v_mfma_f32_16x16x32_bf16 v[44:47], a[240:243], v[124:127], v[60:63]
    s_add_u32 s65, s65, s95
    v_cvt_pk_bf16_f32 v131, v34, v35
    v_exp_f32 v36, v36
    v_mfma_f32_16x16x32_bf16 v[44:47], a[236:239], v[120:123], v[44:47]
    s_lshl_b32 s65, s65, 16
    v_exp_f32 v37, v37
    v_mfma_f32_16x16x32_bf16 v[44:47], a[232:235], v[116:119], v[44:47]
    s_lshl_b32 s92, s58, 11
    v_exp_f32 v38, v38
    v_cvt_pk_bf16_f32 v146, v36, v37
    v_mfma_f32_16x16x32_bf16 v[44:47], a[228:231], v[112:115], v[44:47]
    s_add_u32 s92, s92, s65
    v_exp_f32 v39, v39
    v_mfma_f32_32x32x16_bf16 a[16:31], a[248:251], a[248:251], 0
    s_waitcnt lgkmcnt(0)
    v_cvt_pk_bf16_f32 v147, v38, v39
    v_exp_f32 v40, v40
    v_lshl_add_u32 v23, v23, 7, s18
    v_cmp_eq_u32 vcc, 0, v24
    v_and_b32 v24, 3, v0
    v_mfma_f32_16x16x32_bf16 v[32:35], a[212:215], v[64:67], v[48:51]
    s_lshl_b32 s65, s94, 8
    v_exp_f32 v41, v41
    v_mfma_f32_16x16x32_bf16 v[32:35], a[216:219], v[68:71], v[32:35]
    s_lshl_b32 s67, s58, 14
    v_exp_f32 v42, v42
    v_cvt_pk_bf16_f32 v162, v40, v41
    v_mfma_f32_16x16x32_bf16 v[32:35], a[220:223], v[72:75], v[32:35]
    s_add_u32 s67, s67, s65
    v_exp_f32 v43, v43
    v_mfma_f32_16x16x32_bf16 v[32:35], a[224:227], v[76:79], v[32:35]
    s_mul_i32 s68, s95, 458752
    v_cvt_pk_bf16_f32 v163, v42, v43
    v_exp_f32 v44, v44
    v_mfma_f32_16x16x32_bf16 v[36:39], a[224:227], v[92:95], v[52:55]
    s_add_u32 s68, s68, s67
    v_exp_f32 v45, v45
    v_mfma_f32_16x16x32_bf16 v[36:39], a[220:223], v[88:91], v[36:39]
    s_lshl_b32 s65, s95, 20
    v_exp_f32 v46, v46
    v_cvt_pk_bf16_f32 v178, v44, v45
    v_mfma_f32_16x16x32_bf16 v[36:39], a[216:219], v[84:87], v[36:39]
    s_add_u32 s67, s67, s65
    ds_read_b128 a[228:231], v2 offset:12288
    v_exp_f32 v47, v47
    v_mfma_f32_16x16x32_bf16 v[36:39], a[212:215], v[80:83], v[36:39]
    s_lshr_b32 s15, s93, 1
    ds_read_b128 a[232:235], v3 offset:12288
    v_cvt_pk_bf16_f32 v179, v46, v47
    v_mfma_f32_16x16x32_bf16 v[40:43], a[212:215], v[96:99], v[56:59]
    s_lshl_b32 s15, s15, 2
    ds_read_b128 a[236:239], v4 offset:12288
    v_exp_f32 v32, v32
    v_mfma_f32_16x16x32_bf16 v[40:43], a[216:219], v[100:103], v[40:43]
    s_and_b32 s65, s93, 1
    ds_read_b128 a[240:243], v5 offset:12288
    v_exp_f32 v33, v33
    v_mfma_f32_16x16x32_bf16 v[40:43], a[220:223], v[104:107], v[40:43]
    s_add_u32 s15, s15, s65
    v_exp_f32 v34, v34
    v_cvt_pk_bf16_f32 v132, v32, v33
    v_mfma_f32_16x16x32_bf16 v[40:43], a[224:227], v[108:111], v[40:43]
    s_lshl_b32 s15, s15, 2
    v_exp_f32 v35, v35
    v_mfma_f32_16x16x32_bf16 v[44:47], a[224:227], v[124:127], v[60:63]
    s_xor_b32 s65, s58, s95
    v_cvt_pk_bf16_f32 v133, v34, v35
    v_exp_f32 v36, v36
    v_mfma_f32_16x16x32_bf16 v[44:47], a[220:223], v[120:123], v[44:47]
    s_and_b32 s66, s65, 2
    v_exp_f32 v37, v37
    v_mfma_f32_16x16x32_bf16 v[44:47], a[216:219], v[116:119], v[44:47]
    s_add_u32 s65, s65, s66
    v_exp_f32 v38, v38
    v_cvt_pk_bf16_f32 v148, v36, v37
    v_mfma_f32_16x16x32_bf16 v[44:47], a[212:215], v[112:115], v[44:47]
    s_lshl_b32 s65, s65, 1
    v_exp_f32 v39, v39
    v_mfma_f32_32x32x16_bf16 a[32:47], a[248:251], a[248:251], 0
    s_waitcnt lgkmcnt(0)
    v_cvt_pk_bf16_f32 v149, v38, v39
    v_exp_f32 v40, v40
    v_lshlrev_b32 v24, 10, v24
    v_xor_b32 v24, s43, v24
    v_cndmask_b32 v23, v24, v23, vcc
    v_mfma_f32_16x16x32_bf16 v[32:35], a[228:231], v[64:67], v[48:51]
    s_add_u32 s65, s65, s15
    v_exp_f32 v41, v41
    v_mfma_f32_16x16x32_bf16 v[32:35], a[232:235], v[68:71], v[32:35]
    s_mul_i32 s61, s65, 188416
    v_exp_f32 v42, v42
    v_cvt_pk_bf16_f32 v164, v40, v41
    v_mfma_f32_16x16x32_bf16 v[32:35], a[236:239], v[72:75], v[32:35]
    s_mul_i32 s65, s95, 14336
    v_exp_f32 v43, v43
    v_mfma_f32_16x16x32_bf16 v[32:35], a[240:243], v[76:79], v[32:35]
    s_add_u32 s65, s65, 131072
    v_cvt_pk_bf16_f32 v165, v42, v43
    v_exp_f32 v44, v44
    v_mfma_f32_16x16x32_bf16 v[36:39], a[240:243], v[92:95], v[52:55]
    s_add_u32 s61, s61, s65
    v_exp_f32 v45, v45
    v_mfma_f32_16x16x32_bf16 v[36:39], a[236:239], v[88:91], v[36:39]
    s_lshl_b32 s65, s56, 12
    v_exp_f32 v46, v46
    v_cvt_pk_bf16_f32 v180, v44, v45
    v_mfma_f32_16x16x32_bf16 v[36:39], a[232:235], v[84:87], v[36:39]
    s_add_u32 s69, s69, s65
    ds_read_b128 a[212:215], v2 offset:16384
    v_exp_f32 v47, v47
    v_mfma_f32_16x16x32_bf16 v[36:39], a[228:231], v[80:83], v[36:39]
    s_mul_i32 s8, s94, 4096
    ds_read_b128 a[216:219], v3 offset:16384
    v_cvt_pk_bf16_f32 v181, v46, v47
    v_mfma_f32_16x16x32_bf16 v[40:43], a[228:231], v[96:99], v[56:59]
    s_mul_i32 s16, s94, 8192
    ds_read_b128 a[220:223], v4 offset:16384
    v_exp_f32 v32, v32
    v_mfma_f32_16x16x32_bf16 v[40:43], a[232:235], v[100:103], v[40:43]
    s_lshl_b32 s66, s16, 5
    ds_read_b128 a[224:227], v5 offset:16384
    v_exp_f32 v33, v33
    v_mfma_f32_16x16x32_bf16 v[40:43], a[236:239], v[104:107], v[40:43]
    s_xor_b32 s67, s67, s66
    v_exp_f32 v34, v34
    v_cvt_pk_bf16_f32 v134, v32, v33
    v_mfma_f32_16x16x32_bf16 v[40:43], a[240:243], v[108:111], v[40:43]
    s_add_u32 s9, s8, 2048
    v_exp_f32 v35, v35
    v_mfma_f32_16x16x32_bf16 v[44:47], a[240:243], v[124:127], v[60:63]
    s_cmp_eq_u32 s9, 14336
    v_cvt_pk_bf16_f32 v135, v34, v35
    v_exp_f32 v36, v36
    v_mfma_f32_16x16x32_bf16 v[44:47], a[236:239], v[120:123], v[44:47]
    s_cselect_b32 s9, 0, s9
    v_exp_f32 v37, v37
    v_mfma_f32_16x16x32_bf16 v[44:47], a[232:235], v[116:119], v[44:47]
    s_add_u32 s10, s9, 2048
    v_exp_f32 v38, v38
    v_cvt_pk_bf16_f32 v150, v36, v37
    v_mfma_f32_16x16x32_bf16 v[44:47], a[228:231], v[112:115], v[44:47]
    s_cmp_eq_u32 s10, 14336
    v_exp_f32 v39, v39
    v_mfma_f32_32x32x16_bf16 a[48:63], a[248:251], a[248:251], 0
    s_waitcnt lgkmcnt(0)
    v_cvt_pk_bf16_f32 v151, v38, v39
    v_exp_f32 v40, v40
    v_cndmask_b32 v31, 7, v22, vcc
    v_and_b32 v27, 31, v0
    v_min_u32 v27, 27, v27
    v_mfma_f32_16x16x32_bf16 v[32:35], a[212:215], v[64:67], v[48:51]
    s_cselect_b32 s10, 0, s10
    v_exp_f32 v41, v41
    v_mfma_f32_16x16x32_bf16 v[32:35], a[216:219], v[68:71], v[32:35]
    s_add_u32 s11, s10, 2048
    v_exp_f32 v42, v42
    v_cvt_pk_bf16_f32 v166, v40, v41
    v_mfma_f32_16x16x32_bf16 v[32:35], a[220:223], v[72:75], v[32:35]
    s_cmp_eq_u32 s11, 14336
    v_exp_f32 v43, v43
    v_mfma_f32_16x16x32_bf16 v[32:35], a[224:227], v[76:79], v[32:35]
    s_cselect_b32 s11, 0, s11
    v_cvt_pk_bf16_f32 v167, v42, v43
    v_exp_f32 v44, v44
    v_mfma_f32_16x16x32_bf16 v[36:39], a[224:227], v[92:95], v[52:55]
    s_add_u32 s12, s11, 2048
    v_exp_f32 v45, v45
    v_mfma_f32_16x16x32_bf16 v[36:39], a[220:223], v[88:91], v[36:39]
    s_cmp_eq_u32 s12, 14336
    v_exp_f32 v46, v46
    v_cvt_pk_bf16_f32 v182, v44, v45
    v_mfma_f32_16x16x32_bf16 v[36:39], a[216:219], v[84:87], v[36:39]
    s_cselect_b32 s12, 0, s12
    ds_read_b128 a[228:231], v2 offset:20480
    v_exp_f32 v47, v47
    v_mfma_f32_16x16x32_bf16 v[36:39], a[212:215], v[80:83], v[36:39]
    s_add_u32 s13, s12, 2048
    ds_read_b128 a[232:235], v3 offset:20480
    v_cvt_pk_bf16_f32 v183, v46, v47
    v_mfma_f32_16x16x32_bf16 v[40:43], a[212:215], v[96:99], v[56:59]
    s_cmp_eq_u32 s13, 14336
    ds_read_b128 a[236:239], v4 offset:20480
    v_exp_f32 v32, v32
    v_mfma_f32_16x16x32_bf16 v[40:43], a[216:219], v[100:103], v[40:43]
    s_cselect_b32 s13, 0, s13
    ds_read_b128 a[240:243], v5 offset:20480
    v_exp_f32 v33, v33
    v_mfma_f32_16x16x32_bf16 v[40:43], a[220:223], v[104:107], v[40:43]
    s_add_u32 s14, s13, 2048
    v_exp_f32 v34, v34
    v_cvt_pk_bf16_f32 v136, v32, v33
    v_mfma_f32_16x16x32_bf16 v[40:43], a[224:227], v[108:111], v[40:43]
    s_cmp_eq_u32 s14, 14336
    v_exp_f32 v35, v35
    v_mfma_f32_16x16x32_bf16 v[44:47], a[224:227], v[124:127], v[60:63]
    s_cselect_b32 s14, 0, s14
    v_cvt_pk_bf16_f32 v137, v34, v35
    v_exp_f32 v36, v36
    v_mfma_f32_16x16x32_bf16 v[44:47], a[220:223], v[120:123], v[44:47]
    s_xor_b32 s17, s16, 8192
    v_exp_f32 v37, v37
    v_mfma_f32_16x16x32_bf16 v[44:47], a[216:219], v[116:119], v[44:47]
    s_xor_b32 s18, s16, 16384
    v_exp_f32 v38, v38
    v_cvt_pk_bf16_f32 v152, v36, v37
    v_mfma_f32_16x16x32_bf16 v[44:47], a[212:215], v[112:115], v[44:47]
    v_exp_f32 v39, v39
    v_mfma_f32_32x32x16_bf16 a[64:79], a[248:251], a[248:251], 0
    s_waitcnt lgkmcnt(0)
    v_cvt_pk_bf16_f32 v153, v38, v39
    v_exp_f32 v40, v40
    v_lshl_add_u32 v27, v27, 7, s19
    v_bfe_u32 v26, v0, 5, 1
    v_mul_u32_u24 v26, 188416, v26
    v_mfma_f32_16x16x32_bf16 v[32:35], a[228:231], v[64:67], v[48:51]
    s_xor_b32 s19, s16, 24576
    v_exp_f32 v41, v41
    v_mfma_f32_16x16x32_bf16 v[32:35], a[232:235], v[68:71], v[32:35]
    s_lshr_b32 s65, s58, 1
    v_exp_f32 v42, v42
    v_cvt_pk_bf16_f32 v168, v40, v41
    v_mfma_f32_16x16x32_bf16 v[32:35], a[236:239], v[72:75], v[32:35]
    s_mul_i32 s65, s65, 188416
    v_exp_f32 v43, v43
    v_mfma_f32_16x16x32_bf16 v[32:35], a[240:243], v[76:79], v[32:35]
    s_and_b32 s3, s58, 1
    v_cvt_pk_bf16_f32 v169, v42, v43
    v_exp_f32 v44, v44
    v_mfma_f32_16x16x32_bf16 v[36:39], a[240:243], v[92:95], v[52:55]
    s_lshl_b32 s3, s3, 12
    v_exp_f32 v45, v45
    v_mfma_f32_16x16x32_bf16 v[36:39], a[236:239], v[88:91], v[36:39]
    s_add_u32 s3, s3, s65
    v_exp_f32 v46, v46
    v_cvt_pk_bf16_f32 v184, v44, v45
    v_mfma_f32_16x16x32_bf16 v[36:39], a[232:235], v[84:87], v[36:39]
    s_lshl_b32 s65, s95, 15
    ds_read_b128 a[212:215], v2 offset:24576
    v_exp_f32 v47, v47
    v_mfma_f32_16x16x32_bf16 v[36:39], a[228:231], v[80:83], v[36:39]
    s_add_u32 s3, s3, s65
    ds_read_b128 a[216:219], v3 offset:24576
    v_cvt_pk_bf16_f32 v185, v46, v47
    v_mfma_f32_16x16x32_bf16 v[40:43], a[228:231], v[96:99], v[56:59]
    s_xor_b32 s65, s95, 3
    ds_read_b128 a[220:223], v4 offset:24576
    v_exp_f32 v32, v32
    v_mfma_f32_16x16x32_bf16 v[40:43], a[232:235], v[100:103], v[40:43]
    s_and_b32 s66, s65, 2
    ds_read_b128 a[224:227], v5 offset:24576
    v_exp_f32 v33, v33
    v_mfma_f32_16x16x32_bf16 v[40:43], a[236:239], v[104:107], v[40:43]
    s_add_u32 s65, s65, s66
    v_exp_f32 v34, v34
    v_cvt_pk_bf16_f32 v138, v32, v33
    v_mfma_f32_16x16x32_bf16 v[40:43], a[240:243], v[108:111], v[40:43]
    s_lshl_b32 s65, s65, 1
    v_exp_f32 v35, v35
    v_mfma_f32_16x16x32_bf16 v[44:47], a[240:243], v[124:127], v[60:63]
    s_add_u32 s65, s65, s15
    v_cvt_pk_bf16_f32 v139, v34, v35
    v_exp_f32 v36, v36
    v_mfma_f32_16x16x32_bf16 v[44:47], a[236:239], v[120:123], v[44:47]
    s_mul_i32 s43, s65, 188416
    v_exp_f32 v37, v37
    v_mfma_f32_16x16x32_bf16 v[44:47], a[232:235], v[116:119], v[44:47]
    s_add_u32 s43, s43, s3
    v_exp_f32 v38, v38
    v_cvt_pk_bf16_f32 v154, v36, v37
    v_mfma_f32_16x16x32_bf16 v[44:47], a[228:231], v[112:115], v[44:47]
    s_xor_b32 s65, s95, 2
    v_exp_f32 v39, v39
    v_mfma_f32_32x32x16_bf16 a[80:95], a[248:251], a[248:251], 0
    s_waitcnt lgkmcnt(0)
    v_cvt_pk_bf16_f32 v155, v38, v39
    v_exp_f32 v40, v40
    v_add_u32 v27, v27, v26
    v_accvgpr_read_b32 v24, a254
    v_accvgpr_read_b32 v25, a255
    v_mfma_f32_16x16x32_bf16 v[32:35], a[212:215], v[64:67], v[48:51]
    s_and_b32 s66, s65, 2
    v_exp_f32 v41, v41
    v_mfma_f32_16x16x32_bf16 v[32:35], a[216:219], v[68:71], v[32:35]
    s_add_u32 s65, s65, s66
    v_exp_f32 v42, v42
    v_cvt_pk_bf16_f32 v170, v40, v41
    v_mfma_f32_16x16x32_bf16 v[32:35], a[220:223], v[72:75], v[32:35]
    s_lshl_b32 s65, s65, 1
    v_exp_f32 v43, v43
    v_mfma_f32_16x16x32_bf16 v[32:35], a[224:227], v[76:79], v[32:35]
    s_add_u32 s65, s65, s15
    v_cvt_pk_bf16_f32 v171, v42, v43
    v_exp_f32 v44, v44
    v_mfma_f32_16x16x32_bf16 v[36:39], a[224:227], v[92:95], v[52:55]
    s_mul_i32 s42, s65, 188416
    v_exp_f32 v45, v45
    v_mfma_f32_16x16x32_bf16 v[36:39], a[220:223], v[88:91], v[36:39]
    s_add_u32 s42, s42, s3
    v_exp_f32 v46, v46
    v_cvt_pk_bf16_f32 v186, v44, v45
    v_mfma_f32_16x16x32_bf16 v[36:39], a[216:219], v[84:87], v[36:39]
    s_xor_b32 s65, s95, 1
    ds_read_b128 a[228:231], v2 offset:28672
    v_exp_f32 v47, v47
    v_mfma_f32_16x16x32_bf16 v[36:39], a[212:215], v[80:83], v[36:39]
    s_and_b32 s66, s65, 2
    ds_read_b128 a[232:235], v3 offset:28672
    v_cvt_pk_bf16_f32 v187, v46, v47
    v_mfma_f32_16x16x32_bf16 v[40:43], a[212:215], v[96:99], v[56:59]
    s_add_u32 s65, s65, s66
    ds_read_b128 a[236:239], v4 offset:28672
    v_exp_f32 v32, v32
    v_mfma_f32_16x16x32_bf16 v[40:43], a[216:219], v[100:103], v[40:43]
    s_lshl_b32 s65, s65, 1
    ds_read_b128 a[240:243], v5 offset:28672
    v_exp_f32 v33, v33
    v_mfma_f32_16x16x32_bf16 v[40:43], a[220:223], v[104:107], v[40:43]
    s_add_u32 s65, s65, s15
    v_exp_f32 v34, v34
    v_cvt_pk_bf16_f32 v140, v32, v33
    v_mfma_f32_16x16x32_bf16 v[40:43], a[224:227], v[108:111], v[40:43]
    s_mul_i32 s41, s65, 188416
    v_exp_f32 v35, v35
    v_mfma_f32_16x16x32_bf16 v[44:47], a[224:227], v[124:127], v[60:63]
    s_add_u32 s41, s41, s3
    v_cvt_pk_bf16_f32 v141, v34, v35
    v_exp_f32 v36, v36
    v_mfma_f32_16x16x32_bf16 v[44:47], a[220:223], v[120:123], v[44:47]
    s_xor_b32 s65, s95, 0
    v_exp_f32 v37, v37
    v_mfma_f32_16x16x32_bf16 v[44:47], a[216:219], v[116:119], v[44:47]
    s_and_b32 s66, s65, 2
    v_exp_f32 v38, v38
    v_cvt_pk_bf16_f32 v156, v36, v37
    v_mfma_f32_16x16x32_bf16 v[44:47], a[212:215], v[112:115], v[44:47]
    s_add_u32 s65, s65, s66
    v_exp_f32 v39, v39
    v_mfma_f32_32x32x16_bf16 a[96:111], a[248:251], a[248:251], 0
    s_waitcnt lgkmcnt(0)
    v_cvt_pk_bf16_f32 v157, v38, v39
    v_exp_f32 v40, v40
    v_mfma_f32_16x16x32_bf16 v[32:35], a[228:231], v[64:67], v[48:51]
    s_lshl_b32 s65, s65, 1
    v_exp_f32 v41, v41
    v_mfma_f32_16x16x32_bf16 v[32:35], a[232:235], v[68:71], v[32:35]
    s_add_u32 s65, s65, s15
    v_exp_f32 v42, v42
    v_cvt_pk_bf16_f32 v172, v40, v41
    v_mfma_f32_16x16x32_bf16 v[32:35], a[236:239], v[72:75], v[32:35]
    s_mul_i32 s40, s65, 188416
    v_exp_f32 v43, v43
    v_mfma_f32_16x16x32_bf16 v[32:35], a[240:243], v[76:79], v[32:35]
    s_add_u32 s40, s40, s3
    v_cvt_pk_bf16_f32 v173, v42, v43
    v_exp_f32 v44, v44
    v_mfma_f32_16x16x32_bf16 v[36:39], a[240:243], v[92:95], v[52:55]
    s_waitcnt vmcnt(1) lgkmcnt(0)
    v_exp_f32 v45, v45
    v_mfma_f32_16x16x32_bf16 v[36:39], a[236:239], v[88:91], v[36:39]
    s_barrier
    v_exp_f32 v46, v46
    v_cvt_pk_bf16_f32 v188, v44, v45
    v_mfma_f32_16x16x32_bf16 v[36:39], a[232:235], v[84:87], v[36:39]
    s_lshl_b32 s15, s65, 14
    ds_read_b128 a[212:215], v2 offset:32768
    v_exp_f32 v47, v47
    v_mfma_f32_16x16x32_bf16 v[36:39], a[228:231], v[80:83], v[36:39]
    s_lshl_b32 s65, s94, 8
    ds_read_b128 a[216:219], v3 offset:32768
    v_cvt_pk_bf16_f32 v189, v46, v47
    v_mfma_f32_16x16x32_bf16 v[40:43], a[228:231], v[96:99], v[56:59]
    s_add_u32 s15, s15, s65
    ds_read_b128 a[220:223], v4 offset:32768
    v_exp_f32 v32, v32
    v_mfma_f32_16x16x32_bf16 v[40:43], a[232:235], v[100:103], v[40:43]
    s_lshl_b32 s65, s58, 6
    ds_read_b128 a[224:227], v5 offset:32768
    v_exp_f32 v33, v33
    v_mfma_f32_16x16x32_bf16 v[40:43], a[236:239], v[104:107], v[40:43]
    s_add_u32 s15, s15, s65
    ds_read_b64_tr_b16 a[128:129], v6 offset:0
    v_exp_f32 v34, v34
    v_cvt_pk_bf16_f32 v142, v32, v33
    v_mfma_f32_16x16x32_bf16 v[40:43], a[240:243], v[108:111], v[40:43]
    s_add_u32 s71, s15, 16384
    ds_read_b64_tr_b16 a[130:131], v6 offset:4096
    ds_read_b64_tr_b16 a[132:133], v6 offset:8192
    v_exp_f32 v35, v35
    v_mfma_f32_16x16x32_bf16 v[44:47], a[240:243], v[124:127], v[60:63]
    ds_read_b64_tr_b16 a[134:135], v6 offset:12288
    v_cvt_pk_bf16_f32 v143, v34, v35
    v_exp_f32 v36, v36
    v_mfma_f32_16x16x32_bf16 v[44:47], a[236:239], v[120:123], v[44:47]
    ds_read_b64_tr_b16 a[136:137], v6 offset:16384
    ds_read_b64_tr_b16 a[138:139], v6 offset:20480
    v_exp_f32 v37, v37
    v_mfma_f32_16x16x32_bf16 v[44:47], a[232:235], v[116:119], v[44:47]
    ds_read_b64_tr_b16 a[140:141], v6 offset:24576
    v_exp_f32 v38, v38
    v_cvt_pk_bf16_f32 v158, v36, v37
    v_mfma_f32_16x16x32_bf16 v[44:47], a[228:231], v[112:115], v[44:47]
    ds_read_b64_tr_b16 a[142:143], v6 offset:28672
    v_exp_f32 v39, v39
    v_mfma_f32_32x32x16_bf16 a[112:127], a[248:251], a[248:251], 0
    s_waitcnt lgkmcnt(8)
    v_cvt_pk_bf16_f32 v159, v38, v39
    v_exp_f32 v40, v40
    v_exp_f32 v41, v41
    v_exp_f32 v42, v42
    v_cvt_pk_bf16_f32 v174, v40, v41
    v_exp_f32 v43, v43
    s_nop 0
    v_cvt_pk_bf16_f32 v175, v42, v43

.p2align 6
L_att_loop:
    v_mfma_f32_16x16x32_bf16 v[32:35], a[212:215], v[64:67], v[48:51]
    v_exp_f32 v44, v44
    v_mfma_f32_16x16x32_bf16 v[32:35], a[216:219], v[68:71], v[32:35]
    ds_read_b128 a[228:231], v2 offset:36864
    v_mfma_f32_16x16x32_bf16 v[32:35], a[220:223], v[72:75], v[32:35]
    v_exp_f32 v45, v45
    v_mfma_f32_16x16x32_bf16 v[32:35], a[224:227], v[76:79], v[32:35]
    ds_read_b128 a[232:235], v3 offset:36864
    v_cvt_pk_bf16_f32 v190, v44, v45
    v_mfma_f32_16x16x32_bf16 v[36:39], a[224:227], v[92:95], v[52:55]
    s_add_u32 m0, s59, 0
    v_exp_f32 v46, v46
    v_mfma_f32_16x16x32_bf16 v[36:39], a[220:223], v[88:91], v[36:39]
    buffer_load_dwordx4 v14, s[20:23], s62 offen offset:0 lds
    v_mfma_f32_16x16x32_bf16 v[36:39], a[216:219], v[84:87], v[36:39]
    s_cmp_lt_u32 s64, 5
    v_exp_f32 v47, v47
    v_mfma_f32_16x16x32_bf16 v[36:39], a[212:215], v[80:83], v[36:39]
    s_subb_u32 s3, s64, 0
    ds_read_b128 a[236:239], v4 offset:36864
    v_cvt_pk_bf16_f32 v191, v46, v47
    v_mfma_f32_16x16x32_bf16 v[40:43], a[212:215], v[96:99], v[56:59]
    s_and_b32 s66, s3, 3
    v_exp_f32 v32, v32
    v_mfma_f32_16x16x32_bf16 v[40:43], a[216:219], v[100:103], v[40:43]
    s_lshl_b32 s66, s66, 3
    ds_read_b128 a[240:243], v5 offset:36864
    v_mfma_f32_16x16x32_bf16 v[40:43], a[220:223], v[104:107], v[40:43]
    s_or_b32 s66, s66, s3
    v_exp_f32 v33, v33
    v_mfma_f32_16x16x32_bf16 v[40:43], a[224:227], v[108:111], v[40:43]
    s_lshl_b32 s66, s66, 13
    ds_read_b64_tr_b16 a[144:145], v7 offset:0
    v_cvt_pk_bf16_f32 v192, v32, v33
    v_mfma_f32_16x16x32_bf16 v[44:47], a[224:227], v[124:127], v[60:63]
    s_xor_b32 s66, s66, s92
    v_exp_f32 v34, v34
    v_mfma_f32_16x16x32_bf16 v[44:47], a[220:223], v[120:123], v[44:47]
    s_cmp_gt_u32 s64, 1
    buffer_load_dwordx4 v15, s[20:23], s62 offen offset:1024 lds
    v_mfma_f32_16x16x32_bf16 v[44:47], a[216:219], v[116:119], v[44:47]
    s_cselect_b32 s66, s66, 0x40000000
    v_exp_f32 v35, v35
    v_mfma_f32_16x16x32_bf16 v[44:47], a[212:215], v[112:115], v[44:47]
    s_waitcnt lgkmcnt(5)
    ds_read_b64_tr_b16 a[146:147], v7 offset:4096
    v_cvt_pk_bf16_f32 v193, v34, v35
    v_mfma_f32_16x16x32_bf16 a[0:3], a[128:131], v[128:131], a[0:3]
    v_exp_f32 v36, v36
    v_mfma_f32_16x16x32_bf16 a[0:3], a[132:135], v[132:135], a[0:3]
    ds_read_b64_tr_b16 a[148:149], v7 offset:8192
    v_mfma_f32_16x16x32_bf16 a[0:3], a[136:139], v[136:139], a[0:3]
    v_exp_f32 v37, v37
    v_mfma_f32_16x16x32_bf16 a[0:3], a[140:143], v[140:143], a[0:3]
    ds_read_b64_tr_b16 a[150:151], v7 offset:12288
    v_cvt_pk_bf16_f32 v208, v36, v37
    v_mfma_f32_16x16x32_bf16 a[4:7], a[140:143], v[156:159], a[4:7]
    v_exp_f32 v38, v38
    v_mfma_f32_16x16x32_bf16 a[4:7], a[136:139], v[152:155], a[4:7]
    buffer_load_dwordx4 v16, s[20:23], s62 offen offset:2048 lds
    v_mfma_f32_16x16x32_bf16 a[4:7], a[132:135], v[148:151], a[4:7]
    v_exp_f32 v39, v39
    v_mfma_f32_16x16x32_bf16 a[4:7], a[128:131], v[144:147], a[4:7]
    ds_read_b64_tr_b16 a[152:153], v7 offset:16384
    v_cvt_pk_bf16_f32 v209, v38, v39
    v_mfma_f32_16x16x32_bf16 a[8:11], a[128:131], v[160:163], a[8:11]
    v_exp_f32 v40, v40
    v_mfma_f32_16x16x32_bf16 a[8:11], a[132:135], v[164:167], a[8:11]
    ds_read_b64_tr_b16 a[154:155], v7 offset:20480
    v_mfma_f32_16x16x32_bf16 a[8:11], a[136:139], v[168:171], a[8:11]
    v_exp_f32 v41, v41
    v_mfma_f32_16x16x32_bf16 a[8:11], a[140:143], v[172:175], a[8:11]
    ds_read_b64_tr_b16 a[156:157], v7 offset:24576
    v_cvt_pk_bf16_f32 v224, v40, v41
    v_mfma_f32_16x16x32_bf16 a[12:15], a[140:143], v[188:191], a[12:15]
    v_exp_f32 v42, v42
    v_mfma_f32_16x16x32_bf16 a[12:15], a[136:139], v[184:187], a[12:15]
    buffer_load_dwordx4 v17, s[20:23], s62 offen offset:3072 lds
    v_mfma_f32_16x16x32_bf16 a[12:15], a[132:135], v[180:183], a[12:15]
    s_add_u32 s62, s62, 4096
    v_exp_f32 v43, v43
    v_mfma_f32_16x16x32_bf16 a[12:15], a[128:131], v[176:179], a[12:15]
    s_waitcnt lgkmcnt(7)
    ds_read_b64_tr_b16 a[158:159], v7 offset:28672
    v_cvt_pk_bf16_f32 v225, v42, v43
    v_smfmac_f32_16x16x64_bf16 a[192:195], a[208:211], v[128:135], v20
    v_mfma_f32_16x16x32_bf16 v[32:35], a[228:231], v[64:67], v[48:51]
    v_exp_f32 v44, v44
    v_mfma_f32_16x16x32_bf16 v[32:35], a[232:235], v[68:71], v[32:35]
    ds_read_b128 a[212:215], v2 offset:40960
    v_mfma_f32_16x16x32_bf16 v[32:35], a[236:239], v[72:75], v[32:35]
    v_exp_f32 v45, v45
    v_mfma_f32_16x16x32_bf16 v[32:35], a[240:243], v[76:79], v[32:35]
    ds_read_b128 a[216:219], v3 offset:40960
    v_cvt_pk_bf16_f32 v240, v44, v45
    v_mfma_f32_16x16x32_bf16 v[36:39], a[240:243], v[92:95], v[52:55]
    s_add_u32 m0, s59, 4096
    v_exp_f32 v46, v46
    v_mfma_f32_16x16x32_bf16 v[36:39], a[236:239], v[88:91], v[36:39]
    buffer_load_dwordx4 v14, s[20:23], s62 offen offset:0 lds
    v_mfma_f32_16x16x32_bf16 v[36:39], a[232:235], v[84:87], v[36:39]
    v_exp_f32 v47, v47
    v_mfma_f32_16x16x32_bf16 v[36:39], a[228:231], v[80:83], v[36:39]
    ds_read_b128 a[220:223], v4 offset:40960
    v_cvt_pk_bf16_f32 v241, v46, v47
    v_mfma_f32_16x16x32_bf16 v[40:43], a[228:231], v[96:99], v[56:59]
    v_exp_f32 v32, v32
    v_mfma_f32_16x16x32_bf16 v[40:43], a[232:235], v[100:103], v[40:43]
    ds_read_b128 a[224:227], v5 offset:40960
    v_mfma_f32_16x16x32_bf16 v[40:43], a[236:239], v[104:107], v[40:43]
    v_exp_f32 v33, v33
    v_mfma_f32_16x16x32_bf16 v[40:43], a[240:243], v[108:111], v[40:43]
    ds_read_b64_tr_b16 a[128:129], v8 offset:0
    v_cvt_pk_bf16_f32 v194, v32, v33
    v_mfma_f32_16x16x32_bf16 v[44:47], a[240:243], v[124:127], v[60:63]
    v_exp_f32 v34, v34
    v_mfma_f32_16x16x32_bf16 v[44:47], a[236:239], v[120:123], v[44:47]
    buffer_load_dwordx4 v15, s[20:23], s62 offen offset:1024 lds
    v_mfma_f32_16x16x32_bf16 v[44:47], a[232:235], v[116:119], v[44:47]
    v_exp_f32 v35, v35
    v_mfma_f32_16x16x32_bf16 v[44:47], a[228:231], v[112:115], v[44:47]
    s_waitcnt lgkmcnt(5)
    ds_read_b64_tr_b16 a[130:131], v8 offset:4096
    v_cvt_pk_bf16_f32 v195, v34, v35
    v_mfma_f32_16x16x32_bf16 a[16:19], a[144:147], v[128:131], a[16:19]
    v_exp_f32 v36, v36
    v_mfma_f32_16x16x32_bf16 a[16:19], a[148:151], v[132:135], a[16:19]
    ds_read_b64_tr_b16 a[132:133], v8 offset:8192
    v_mfma_f32_16x16x32_bf16 a[16:19], a[152:155], v[136:139], a[16:19]
    v_exp_f32 v37, v37
    v_mfma_f32_16x16x32_bf16 a[16:19], a[156:159], v[140:143], a[16:19]
    ds_read_b64_tr_b16 a[134:135], v8 offset:12288
    v_cvt_pk_bf16_f32 v210, v36, v37
    v_mfma_f32_16x16x32_bf16 a[20:23], a[156:159], v[156:159], a[20:23]
    v_exp_f32 v38, v38
    v_mfma_f32_16x16x32_bf16 a[20:23], a[152:155], v[152:155], a[20:23]
    buffer_load_dwordx4 v16, s[20:23], s62 offen offset:2048 lds
    v_mfma_f32_16x16x32_bf16 a[20:23], a[148:151], v[148:151], a[20:23]
    v_exp_f32 v39, v39
    v_mfma_f32_16x16x32_bf16 a[20:23], a[144:147], v[144:147], a[20:23]
    ds_read_b64_tr_b16 a[136:137], v8 offset:16384
    v_cvt_pk_bf16_f32 v211, v38, v39
    v_mfma_f32_16x16x32_bf16 a[24:27], a[144:147], v[160:163], a[24:27]
    v_exp_f32 v40, v40
    v_mfma_f32_16x16x32_bf16 a[24:27], a[148:151], v[164:167], a[24:27]
    ds_read_b64_tr_b16 a[138:139], v8 offset:20480
    v_mfma_f32_16x16x32_bf16 a[24:27], a[152:155], v[168:171], a[24:27]
    v_exp_f32 v41, v41
    v_mfma_f32_16x16x32_bf16 a[24:27], a[156:159], v[172:175], a[24:27]
    ds_read_b64_tr_b16 a[140:141], v8 offset:24576
    v_cvt_pk_bf16_f32 v226, v40, v41
    v_mfma_f32_16x16x32_bf16 a[28:31], a[156:159], v[188:191], a[28:31]
    v_exp_f32 v42, v42
    v_mfma_f32_16x16x32_bf16 a[28:31], a[152:155], v[184:187], a[28:31]
    buffer_load_dwordx4 v17, s[20:23], s62 offen offset:3072 lds
    v_mfma_f32_16x16x32_bf16 a[28:31], a[148:151], v[180:183], a[28:31]
    s_add_u32 s62, s62, 28672
    v_exp_f32 v43, v43
    v_mfma_f32_16x16x32_bf16 a[28:31], a[144:147], v[176:179], a[28:31]
    s_waitcnt lgkmcnt(7)
    ds_read_b64_tr_b16 a[142:143], v8 offset:28672
    v_cvt_pk_bf16_f32 v227, v42, v43
    v_smfmac_f32_16x16x64_bf16 a[192:195], a[208:211], v[136:143], v20
    v_mfma_f32_16x16x32_bf16 v[32:35], a[212:215], v[64:67], v[48:51]
    v_exp_f32 v44, v44
    v_mfma_f32_16x16x32_bf16 v[32:35], a[216:219], v[68:71], v[32:35]
    ds_read_b128 a[228:231], v2 offset:45056
    v_mfma_f32_16x16x32_bf16 v[32:35], a[220:223], v[72:75], v[32:35]
    v_exp_f32 v45, v45
    v_mfma_f32_16x16x32_bf16 v[32:35], a[224:227], v[76:79], v[32:35]
    ds_read_b128 a[232:235], v3 offset:45056
    v_cvt_pk_bf16_f32 v242, v44, v45
    v_mfma_f32_16x16x32_bf16 v[36:39], a[224:227], v[92:95], v[52:55]
    s_add_u32 m0, s59, 131072
    v_exp_f32 v46, v46
    v_mfma_f32_16x16x32_bf16 v[36:39], a[220:223], v[88:91], v[36:39]
    buffer_load_dwordx4 v18, s[24:27], s63 offen offset:0 lds
    v_mfma_f32_16x16x32_bf16 v[36:39], a[216:219], v[84:87], v[36:39]
    v_exp_f32 v47, v47
    v_mfma_f32_16x16x32_bf16 v[36:39], a[212:215], v[80:83], v[36:39]
    ds_read_b128 a[236:239], v4 offset:45056
    v_cvt_pk_bf16_f32 v243, v46, v47
    v_mfma_f32_16x16x32_bf16 v[40:43], a[212:215], v[96:99], v[56:59]
    v_exp_f32 v32, v32
    v_mfma_f32_16x16x32_bf16 v[40:43], a[216:219], v[100:103], v[40:43]
    ds_read_b128 a[240:243], v5 offset:45056
    v_mfma_f32_16x16x32_bf16 v[40:43], a[220:223], v[104:107], v[40:43]
    v_exp_f32 v33, v33
    v_mfma_f32_16x16x32_bf16 v[40:43], a[224:227], v[108:111], v[40:43]
    ds_read_b64_tr_b16 a[144:145], v9 offset:0
    v_cvt_pk_bf16_f32 v196, v32, v33
    v_mfma_f32_16x16x32_bf16 v[44:47], a[224:227], v[124:127], v[60:63]
    v_exp_f32 v34, v34
    v_mfma_f32_16x16x32_bf16 v[44:47], a[220:223], v[120:123], v[44:47]
    buffer_load_dwordx4 v19, s[24:27], s63 offen offset:1024 lds
    v_mfma_f32_16x16x32_bf16 v[44:47], a[216:219], v[116:119], v[44:47]
    v_exp_f32 v35, v35
    v_mfma_f32_16x16x32_bf16 v[44:47], a[212:215], v[112:115], v[44:47]
    s_waitcnt lgkmcnt(5)
    ds_read_b64_tr_b16 a[146:147], v9 offset:4096
    v_cvt_pk_bf16_f32 v197, v34, v35
    v_mfma_f32_16x16x32_bf16 a[32:35], a[128:131], v[128:131], a[32:35]
    v_exp_f32 v36, v36
    v_mfma_f32_16x16x32_bf16 a[32:35], a[132:135], v[132:135], a[32:35]
    ds_read_b64_tr_b16 a[148:149], v9 offset:8192
    v_mfma_f32_16x16x32_bf16 a[32:35], a[136:139], v[136:139], a[32:35]
    v_exp_f32 v37, v37
    v_mfma_f32_16x16x32_bf16 a[32:35], a[140:143], v[140:143], a[32:35]
    ds_read_b64_tr_b16 a[150:151], v9 offset:12288
    v_cvt_pk_bf16_f32 v212, v36, v37
    v_mfma_f32_16x16x32_bf16 a[36:39], a[140:143], v[156:159], a[36:39]
    v_exp_f32 v38, v38
    v_mfma_f32_16x16x32_bf16 a[36:39], a[136:139], v[152:155], a[36:39]
    buffer_load_dwordx4 v18, s[24:27], s63 offen offset:2048 lds
    v_mfma_f32_16x16x32_bf16 a[36:39], a[132:135], v[148:151], a[36:39]
    v_exp_f32 v39, v39
    v_mfma_f32_16x16x32_bf16 a[36:39], a[128:131], v[144:147], a[36:39]
    ds_read_b64_tr_b16 a[152:153], v9 offset:16384
    v_cvt_pk_bf16_f32 v213, v38, v39
    v_mfma_f32_16x16x32_bf16 a[40:43], a[128:131], v[160:163], a[40:43]
    v_exp_f32 v40, v40
    v_mfma_f32_16x16x32_bf16 a[40:43], a[132:135], v[164:167], a[40:43]
    ds_read_b64_tr_b16 a[154:155], v9 offset:20480
    v_mfma_f32_16x16x32_bf16 a[40:43], a[136:139], v[168:171], a[40:43]
    v_exp_f32 v41, v41
    v_mfma_f32_16x16x32_bf16 a[40:43], a[140:143], v[172:175], a[40:43]
    ds_read_b64_tr_b16 a[156:157], v9 offset:24576
    v_cvt_pk_bf16_f32 v228, v40, v41
    v_mfma_f32_16x16x32_bf16 a[44:47], a[140:143], v[188:191], a[44:47]
    v_exp_f32 v42, v42
    v_mfma_f32_16x16x32_bf16 a[44:47], a[136:139], v[184:187], a[44:47]
    buffer_load_dwordx4 v19, s[24:27], s63 offen offset:3072 lds
    v_mfma_f32_16x16x32_bf16 a[44:47], a[132:135], v[180:183], a[44:47]
    s_add_u32 s63, s63, 4096
    v_exp_f32 v43, v43
    v_mfma_f32_16x16x32_bf16 a[44:47], a[128:131], v[176:179], a[44:47]
    s_waitcnt lgkmcnt(7)
    ds_read_b64_tr_b16 a[158:159], v9 offset:28672
    v_cvt_pk_bf16_f32 v229, v42, v43
    v_smfmac_f32_16x16x64_bf16 a[196:199], a[208:211], v[144:151], v20
    v_mfma_f32_16x16x32_bf16 v[32:35], a[228:231], v[64:67], v[48:51]
    v_exp_f32 v44, v44
    v_mfma_f32_16x16x32_bf16 v[32:35], a[232:235], v[68:71], v[32:35]
    ds_read_b128 a[212:215], v2 offset:49152
    v_mfma_f32_16x16x32_bf16 v[32:35], a[236:239], v[72:75], v[32:35]
    v_exp_f32 v45, v45
    v_mfma_f32_16x16x32_bf16 v[32:35], a[240:243], v[76:79], v[32:35]
    ds_read_b128 a[216:219], v3 offset:49152
    v_cvt_pk_bf16_f32 v244, v44, v45
    v_mfma_f32_16x16x32_bf16 v[36:39], a[240:243], v[92:95], v[52:55]
    s_add_u32 m0, s59, 135168
    v_exp_f32 v46, v46
    v_mfma_f32_16x16x32_bf16 v[36:39], a[236:239], v[88:91], v[36:39]
    buffer_load_dwordx4 v18, s[24:27], s63 offen offset:0 lds
    v_mfma_f32_16x16x32_bf16 v[36:39], a[232:235], v[84:87], v[36:39]
    v_exp_f32 v47, v47
    v_mfma_f32_16x16x32_bf16 v[36:39], a[228:231], v[80:83], v[36:39]
    ds_read_b128 a[220:223], v4 offset:49152
    v_cvt_pk_bf16_f32 v245, v46, v47
    v_mfma_f32_16x16x32_bf16 v[40:43], a[228:231], v[96:99], v[56:59]
    v_exp_f32 v32, v32
    v_mfma_f32_16x16x32_bf16 v[40:43], a[232:235], v[100:103], v[40:43]
    ds_read_b128 a[224:227], v5 offset:49152
    v_mfma_f32_16x16x32_bf16 v[40:43], a[236:239], v[104:107], v[40:43]
    v_exp_f32 v33, v33
    v_mfma_f32_16x16x32_bf16 v[40:43], a[240:243], v[108:111], v[40:43]
    ds_read_b64_tr_b16 a[128:129], v10 offset:0
    v_cvt_pk_bf16_f32 v198, v32, v33
    v_mfma_f32_16x16x32_bf16 v[44:47], a[240:243], v[124:127], v[60:63]
    v_exp_f32 v34, v34
    v_mfma_f32_16x16x32_bf16 v[44:47], a[236:239], v[120:123], v[44:47]
    buffer_load_dwordx4 v19, s[24:27], s63 offen offset:1024 lds
    v_mfma_f32_16x16x32_bf16 v[44:47], a[232:235], v[116:119], v[44:47]
    v_exp_f32 v35, v35
    v_mfma_f32_16x16x32_bf16 v[44:47], a[228:231], v[112:115], v[44:47]
    s_waitcnt lgkmcnt(5)
    ds_read_b64_tr_b16 a[130:131], v10 offset:4096
    v_cvt_pk_bf16_f32 v199, v34, v35
    v_mfma_f32_16x16x32_bf16 a[48:51], a[144:147], v[128:131], a[48:51]
    v_exp_f32 v36, v36
    v_mfma_f32_16x16x32_bf16 a[48:51], a[148:151], v[132:135], a[48:51]
    ds_read_b64_tr_b16 a[132:133], v10 offset:8192
    v_mfma_f32_16x16x32_bf16 a[48:51], a[152:155], v[136:139], a[48:51]
    v_exp_f32 v37, v37
    v_mfma_f32_16x16x32_bf16 a[48:51], a[156:159], v[140:143], a[48:51]
    ds_read_b64_tr_b16 a[134:135], v10 offset:12288
    v_cvt_pk_bf16_f32 v214, v36, v37
    v_mfma_f32_16x16x32_bf16 a[52:55], a[156:159], v[156:159], a[52:55]
    v_exp_f32 v38, v38
    v_mfma_f32_16x16x32_bf16 a[52:55], a[152:155], v[152:155], a[52:55]
    buffer_load_dwordx4 v18, s[24:27], s63 offen offset:2048 lds
    v_mfma_f32_16x16x32_bf16 a[52:55], a[148:151], v[148:151], a[52:55]
    v_exp_f32 v39, v39
    v_mfma_f32_16x16x32_bf16 a[52:55], a[144:147], v[144:147], a[52:55]
    ds_read_b64_tr_b16 a[136:137], v10 offset:16384
    v_cvt_pk_bf16_f32 v215, v38, v39
    v_mfma_f32_16x16x32_bf16 a[56:59], a[144:147], v[160:163], a[56:59]
    v_exp_f32 v40, v40
    v_mfma_f32_16x16x32_bf16 a[56:59], a[148:151], v[164:167], a[56:59]
    ds_read_b64_tr_b16 a[138:139], v10 offset:20480
    v_mfma_f32_16x16x32_bf16 a[56:59], a[152:155], v[168:171], a[56:59]
    v_exp_f32 v41, v41
    v_mfma_f32_16x16x32_bf16 a[56:59], a[156:159], v[172:175], a[56:59]
    ds_read_b64_tr_b16 a[140:141], v10 offset:24576
    v_cvt_pk_bf16_f32 v230, v40, v41
    v_mfma_f32_16x16x32_bf16 a[60:63], a[156:159], v[188:191], a[60:63]
    v_exp_f32 v42, v42
    v_mfma_f32_16x16x32_bf16 a[60:63], a[152:155], v[184:187], a[60:63]
    buffer_load_dwordx4 v19, s[24:27], s63 offen offset:3072 lds
    v_mfma_f32_16x16x32_bf16 a[60:63], a[148:151], v[180:183], a[60:63]
    s_add_u32 s63, s63, 28672
    v_exp_f32 v43, v43
    v_mfma_f32_16x16x32_bf16 a[60:63], a[144:147], v[176:179], a[60:63]
    s_waitcnt lgkmcnt(7)
    ds_read_b64_tr_b16 a[142:143], v10 offset:28672
    v_cvt_pk_bf16_f32 v231, v42, v43
    v_smfmac_f32_16x16x64_bf16 a[196:199], a[208:211], v[152:159], v20
    v_mfma_f32_16x16x32_bf16 v[32:35], a[212:215], v[64:67], v[48:51]
    v_exp_f32 v44, v44
    v_mfma_f32_16x16x32_bf16 v[32:35], a[216:219], v[68:71], v[32:35]
    ds_read_b128 a[228:231], v2 offset:53248
    v_mfma_f32_16x16x32_bf16 v[32:35], a[220:223], v[72:75], v[32:35]
    v_exp_f32 v45, v45
    v_mfma_f32_16x16x32_bf16 v[32:35], a[224:227], v[76:79], v[32:35]
    ds_read_b128 a[232:235], v3 offset:53248
    v_cvt_pk_bf16_f32 v246, v44, v45
    v_mfma_f32_16x16x32_bf16 v[36:39], a[224:227], v[92:95], v[52:55]
    v_exp_f32 v46, v46
    v_mfma_f32_16x16x32_bf16 v[36:39], a[220:223], v[88:91], v[36:39]
    buffer_load_dword a252, v28, s[20:23], s62 offen
    v_mfma_f32_16x16x32_bf16 v[36:39], a[216:219], v[84:87], v[36:39]
    v_exp_f32 v47, v47
    v_mfma_f32_16x16x32_bf16 v[36:39], a[212:215], v[80:83], v[36:39]
    ds_read_b128 a[236:239], v4 offset:53248
    v_cvt_pk_bf16_f32 v247, v46, v47
    v_mfma_f32_16x16x32_bf16 v[40:43], a[212:215], v[96:99], v[56:59]
    v_exp_f32 v32, v32
    v_mfma_f32_16x16x32_bf16 v[40:43], a[216:219], v[100:103], v[40:43]
    ds_read_b128 a[240:243], v5 offset:53248
    v_mfma_f32_16x16x32_bf16 v[40:43], a[220:223], v[104:107], v[40:43]
    v_exp_f32 v33, v33
    v_mfma_f32_16x16x32_bf16 v[40:43], a[224:227], v[108:111], v[40:43]
    s_cmp_le_u32 s64, 2
    ds_read_b64_tr_b16 a[144:145], v11 offset:0
    v_cvt_pk_bf16_f32 v200, v32, v33
    v_mfma_f32_16x16x32_bf16 v[44:47], a[224:227], v[124:127], v[60:63]
    s_cselect_b32 s65, s100, 0x40000000
    v_exp_f32 v34, v34
    v_mfma_f32_16x16x32_bf16 v[44:47], a[220:223], v[120:123], v[44:47]
    buffer_load_dword a252, v30, s[44:47], s65 offen
    v_mfma_f32_16x16x32_bf16 v[44:47], a[216:219], v[116:119], v[44:47]
    s_add_u32 s100, s100, 16384
    v_exp_f32 v35, v35
    v_mfma_f32_16x16x32_bf16 v[44:47], a[212:215], v[112:115], v[44:47]
    s_waitcnt lgkmcnt(5)
    ds_read_b64_tr_b16 a[146:147], v11 offset:4096
    v_cvt_pk_bf16_f32 v201, v34, v35
    v_mfma_f32_16x16x32_bf16 a[64:67], a[128:131], v[128:131], a[64:67]
    s_and_b32 s100, s100, 32767
    v_exp_f32 v36, v36
    v_mfma_f32_16x16x32_bf16 a[64:67], a[132:135], v[132:135], a[64:67]
    ds_read_b64_tr_b16 a[148:149], v11 offset:8192
    v_mfma_f32_16x16x32_bf16 a[64:67], a[136:139], v[136:139], a[64:67]
    v_exp_f32 v37, v37
    v_mfma_f32_16x16x32_bf16 a[64:67], a[140:143], v[140:143], a[64:67]
    ds_read_b64_tr_b16 a[150:151], v11 offset:12288
    v_cvt_pk_bf16_f32 v216, v36, v37
    v_mfma_f32_16x16x32_bf16 a[68:71], a[140:143], v[156:159], a[68:71]
    v_exp_f32 v38, v38
    v_mfma_f32_16x16x32_bf16 a[68:71], a[136:139], v[152:155], a[68:71]
    global_load_dword a252, v[24:25], off
    v_mfma_f32_16x16x32_bf16 a[68:71], a[132:135], v[148:151], a[68:71]
    v_exp_f32 v39, v39
    v_mfma_f32_16x16x32_bf16 a[68:71], a[128:131], v[144:147], a[68:71]
    ds_read_b64_tr_b16 a[152:153], v11 offset:16384
    v_cvt_pk_bf16_f32 v217, v38, v39
    v_mfma_f32_16x16x32_bf16 a[72:75], a[128:131], v[160:163], a[72:75]
    v_exp_f32 v40, v40
    v_mfma_f32_16x16x32_bf16 a[72:75], a[132:135], v[164:167], a[72:75]
    ds_read_b64_tr_b16 a[154:155], v11 offset:20480
    v_mfma_f32_16x16x32_bf16 a[72:75], a[136:139], v[168:171], a[72:75]
    v_exp_f32 v41, v41
    v_mfma_f32_16x16x32_bf16 a[72:75], a[140:143], v[172:175], a[72:75]
    ds_read_b64_tr_b16 a[156:157], v11 offset:24576
    v_cvt_pk_bf16_f32 v232, v40, v41
    v_mfma_f32_16x16x32_bf16 a[76:79], a[140:143], v[188:191], a[76:79]
    v_exp_f32 v42, v42
    v_mfma_f32_16x16x32_bf16 a[76:79], a[136:139], v[184:187], a[76:79]
    ds_read_b64_tr_b16 a[158:159], v11 offset:28672
    v_mfma_f32_16x16x32_bf16 a[76:79], a[132:135], v[180:183], a[76:79]
    v_exp_f32 v43, v43
    v_mfma_f32_16x16x32_bf16 a[76:79], a[128:131], v[176:179], a[76:79]
    s_waitcnt lgkmcnt(8)
    v_cvt_pk_bf16_f32 v233, v42, v43
    v_smfmac_f32_16x16x64_bf16 a[200:203], a[208:211], v[160:167], v20
    v_mfma_f32_16x16x32_bf16 v[32:35], a[228:231], v[64:67], v[48:51]
    v_exp_f32 v44, v44
    v_mfma_f32_16x16x32_bf16 v[32:35], a[232:235], v[68:71], v[32:35]
    ds_read_b128 a[212:215], v2 offset:57344
    v_mfma_f32_16x16x32_bf16 v[32:35], a[236:239], v[72:75], v[32:35]
    v_exp_f32 v45, v45
    v_mfma_f32_16x16x32_bf16 v[32:35], a[240:243], v[76:79], v[32:35]
    ds_read_b128 a[216:219], v3 offset:57344
    v_cvt_pk_bf16_f32 v248, v44, v45
    v_mfma_f32_16x16x32_bf16 v[36:39], a[240:243], v[92:95], v[52:55]
    v_exp_f32 v46, v46
    v_mfma_f32_16x16x32_bf16 v[36:39], a[236:239], v[88:91], v[36:39]
    ds_read_b128 a[220:223], v4 offset:57344
    v_mfma_f32_16x16x32_bf16 v[36:39], a[232:235], v[84:87], v[36:39]
    v_exp_f32 v47, v47
    v_mfma_f32_16x16x32_bf16 v[36:39], a[228:231], v[80:83], v[36:39]
    ds_read_b128 a[224:227], v5 offset:57344
    v_cvt_pk_bf16_f32 v249, v46, v47
    v_mfma_f32_16x16x32_bf16 v[40:43], a[228:231], v[96:99], v[56:59]
    v_exp_f32 v32, v32
    v_mfma_f32_16x16x32_bf16 v[40:43], a[232:235], v[100:103], v[40:43]
    ds_read_b64_tr_b16 a[128:129], v12 offset:0
    v_mfma_f32_16x16x32_bf16 v[40:43], a[236:239], v[104:107], v[40:43]
    v_exp_f32 v33, v33
    v_mfma_f32_16x16x32_bf16 v[40:43], a[240:243], v[108:111], v[40:43]
    ds_read_b64_tr_b16 a[130:131], v12 offset:4096
    v_cvt_pk_bf16_f32 v202, v32, v33
    v_mfma_f32_16x16x32_bf16 v[44:47], a[240:243], v[124:127], v[60:63]
    v_exp_f32 v34, v34
    v_mfma_f32_16x16x32_bf16 v[44:47], a[236:239], v[120:123], v[44:47]
    ds_read_b64_tr_b16 a[132:133], v12 offset:8192
    v_mfma_f32_16x16x32_bf16 v[44:47], a[232:235], v[116:119], v[44:47]
    v_exp_f32 v35, v35
    v_mfma_f32_16x16x32_bf16 v[44:47], a[228:231], v[112:115], v[44:47]
    s_waitcnt lgkmcnt(7)
    ds_read_b64_tr_b16 a[134:135], v12 offset:12288
    v_cvt_pk_bf16_f32 v203, v34, v35
    v_mfma_f32_16x16x32_bf16 a[80:83], a[144:147], v[128:131], a[80:83]
    v_exp_f32 v36, v36
    v_mfma_f32_16x16x32_bf16 a[80:83], a[148:151], v[132:135], a[80:83]
    ds_read_b64_tr_b16 a[136:137], v12 offset:16384
    v_mfma_f32_16x16x32_bf16 a[80:83], a[152:155], v[136:139], a[80:83]
    v_exp_f32 v37, v37
    v_mfma_f32_16x16x32_bf16 a[80:83], a[156:159], v[140:143], a[80:83]
    ds_read_b64_tr_b16 a[138:139], v12 offset:20480
    v_cvt_pk_bf16_f32 v218, v36, v37
    v_mfma_f32_16x16x32_bf16 a[84:87], a[156:159], v[156:159], a[84:87]
    v_exp_f32 v38, v38
    v_mfma_f32_16x16x32_bf16 a[84:87], a[152:155], v[152:155], a[84:87]
    ds_read_b64_tr_b16 a[140:141], v12 offset:24576
    v_mfma_f32_16x16x32_bf16 a[84:87], a[148:151], v[148:151], a[84:87]
    v_exp_f32 v39, v39
    v_mfma_f32_16x16x32_bf16 a[84:87], a[144:147], v[144:147], a[84:87]
    ds_read_b64_tr_b16 a[142:143], v12 offset:28672
    v_cvt_pk_bf16_f32 v219, v38, v39
    v_mfma_f32_16x16x32_bf16 a[88:91], a[144:147], v[160:163], a[88:91]
    v_exp_f32 v40, v40
    v_mfma_f32_16x16x32_bf16 a[88:91], a[148:151], v[164:167], a[88:91]
    v_mfma_f32_16x16x32_bf16 a[88:91], a[152:155], v[168:171], a[88:91]
    v_exp_f32 v41, v41
    v_mfma_f32_16x16x32_bf16 a[88:91], a[156:159], v[172:175], a[88:91]
    v_cvt_pk_bf16_f32 v234, v40, v41
    v_mfma_f32_16x16x32_bf16 a[92:95], a[156:159], v[188:191], a[92:95]
    v_exp_f32 v42, v42
    v_mfma_f32_16x16x32_bf16 a[92:95], a[152:155], v[184:187], a[92:95]
    v_mfma_f32_16x16x32_bf16 a[92:95], a[148:151], v[180:183], a[92:95]
    v_exp_f32 v43, v43
    v_mfma_f32_16x16x32_bf16 a[92:95], a[144:147], v[176:179], a[92:95]
    s_waitcnt lgkmcnt(8)
    v_cvt_pk_bf16_f32 v235, v42, v43
    v_smfmac_f32_16x16x64_bf16 a[200:203], a[208:211], v[168:175], v20
    v_mfma_f32_16x16x32_bf16 v[32:35], a[212:215], v[64:67], v[48:51]
    v_exp_f32 v44, v44
    v_mfma_f32_16x16x32_bf16 v[32:35], a[216:219], v[68:71], v[32:35]
    ds_read_b128 a[228:231], v2 offset:61440
    v_mfma_f32_16x16x32_bf16 v[32:35], a[220:223], v[72:75], v[32:35]
    v_exp_f32 v45, v45
    v_mfma_f32_16x16x32_bf16 v[32:35], a[224:227], v[76:79], v[32:35]
    ds_read_b128 a[232:235], v3 offset:61440
    v_cvt_pk_bf16_f32 v250, v44, v45
    v_mfma_f32_16x16x32_bf16 v[36:39], a[224:227], v[92:95], v[52:55]
    v_exp_f32 v46, v46
    v_mfma_f32_16x16x32_bf16 v[36:39], a[220:223], v[88:91], v[36:39]
    ds_read_b128 a[236:239], v4 offset:61440
    v_mfma_f32_16x16x32_bf16 v[36:39], a[216:219], v[84:87], v[36:39]
    v_exp_f32 v47, v47
    v_mfma_f32_16x16x32_bf16 v[36:39], a[212:215], v[80:83], v[36:39]
    ds_read_b128 a[240:243], v5 offset:61440
    v_cvt_pk_bf16_f32 v251, v46, v47
    v_mfma_f32_16x16x32_bf16 v[40:43], a[212:215], v[96:99], v[56:59]
    v_exp_f32 v32, v32
    v_mfma_f32_16x16x32_bf16 v[40:43], a[216:219], v[100:103], v[40:43]
    ds_read_b64_tr_b16 a[144:145], v13 offset:0
    v_mfma_f32_16x16x32_bf16 v[40:43], a[220:223], v[104:107], v[40:43]
    v_exp_f32 v33, v33
    v_mfma_f32_16x16x32_bf16 v[40:43], a[224:227], v[108:111], v[40:43]
    ds_read_b64_tr_b16 a[146:147], v13 offset:4096
    v_cvt_pk_bf16_f32 v204, v32, v33
    v_mfma_f32_16x16x32_bf16 v[44:47], a[224:227], v[124:127], v[60:63]
    v_exp_f32 v34, v34
    v_mfma_f32_16x16x32_bf16 v[44:47], a[220:223], v[120:123], v[44:47]
    ds_read_b64_tr_b16 a[148:149], v13 offset:8192
    v_mfma_f32_16x16x32_bf16 v[44:47], a[216:219], v[116:119], v[44:47]
    v_exp_f32 v35, v35
    v_mfma_f32_16x16x32_bf16 v[44:47], a[212:215], v[112:115], v[44:47]
    s_waitcnt lgkmcnt(7)
    ds_read_b64_tr_b16 a[150:151], v13 offset:12288
    v_cvt_pk_bf16_f32 v205, v34, v35
    v_mfma_f32_16x16x32_bf16 a[96:99], a[128:131], v[128:131], a[96:99]
    v_exp_f32 v36, v36
    v_mfma_f32_16x16x32_bf16 a[96:99], a[132:135], v[132:135], a[96:99]
    ds_read_b64_tr_b16 a[152:153], v13 offset:16384
    v_mfma_f32_16x16x32_bf16 a[96:99], a[136:139], v[136:139], a[96:99]
    v_exp_f32 v37, v37
    v_mfma_f32_16x16x32_bf16 a[96:99], a[140:143], v[140:143], a[96:99]
    ds_read_b64_tr_b16 a[154:155], v13 offset:20480
    v_cvt_pk_bf16_f32 v220, v36, v37
    v_mfma_f32_16x16x32_bf16 a[100:103], a[140:143], v[156:159], a[100:103]
    v_exp_f32 v38, v38
    v_mfma_f32_16x16x32_bf16 a[100:103], a[136:139], v[152:155], a[100:103]
    ds_read_b64_tr_b16 a[156:157], v13 offset:24576
    v_mfma_f32_16x16x32_bf16 a[100:103], a[132:135], v[148:151], a[100:103]
    v_exp_f32 v39, v39
    v_mfma_f32_16x16x32_bf16 a[100:103], a[128:131], v[144:147], a[100:103]
    ds_read_b64_tr_b16 a[158:159], v13 offset:28672
    v_cvt_pk_bf16_f32 v221, v38, v39
    v_mfma_f32_16x16x32_bf16 a[104:107], a[128:131], v[160:163], a[104:107]
    v_exp_f32 v40, v40
    v_mfma_f32_16x16x32_bf16 a[104:107], a[132:135], v[164:167], a[104:107]
    v_mfma_f32_16x16x32_bf16 a[104:107], a[136:139], v[168:171], a[104:107]
    v_exp_f32 v41, v41
    v_mfma_f32_16x16x32_bf16 a[104:107], a[140:143], v[172:175], a[104:107]
    v_cvt_pk_bf16_f32 v236, v40, v41
    v_mfma_f32_16x16x32_bf16 a[108:111], a[140:143], v[188:191], a[108:111]
    v_exp_f32 v42, v42
    v_mfma_f32_16x16x32_bf16 a[108:111], a[136:139], v[184:187], a[108:111]
    v_mfma_f32_16x16x32_bf16 a[108:111], a[132:135], v[180:183], a[108:111]
    v_exp_f32 v43, v43
    v_mfma_f32_16x16x32_bf16 a[108:111], a[128:131], v[176:179], a[108:111]
    s_waitcnt lgkmcnt(8)
    v_cvt_pk_bf16_f32 v237, v42, v43
    v_smfmac_f32_16x16x64_bf16 a[204:207], a[208:211], v[176:183], v20
    v_mfma_f32_16x16x32_bf16 v[32:35], a[228:231], v[64:67], v[48:51]
    v_exp_f32 v44, v44
    v_mfma_f32_16x16x32_bf16 v[32:35], a[232:235], v[68:71], v[32:35]
    v_mfma_f32_16x16x32_bf16 v[32:35], a[236:239], v[72:75], v[32:35]
    v_exp_f32 v45, v45
    v_mfma_f32_16x16x32_bf16 v[32:35], a[240:243], v[76:79], v[32:35]
    v_cvt_pk_bf16_f32 v252, v44, v45
    v_mfma_f32_16x16x32_bf16 v[36:39], a[240:243], v[92:95], v[52:55]
    v_exp_f32 v46, v46
    v_mfma_f32_16x16x32_bf16 v[36:39], a[236:239], v[88:91], v[36:39]
    s_waitcnt vmcnt(3) lgkmcnt(0)
    v_mfma_f32_16x16x32_bf16 v[36:39], a[232:235], v[84:87], v[36:39]
    s_barrier
    v_exp_f32 v47, v47
    v_mfma_f32_16x16x32_bf16 v[36:39], a[228:231], v[80:83], v[36:39]
    ds_read_b128 a[212:215], v2 offset:0
    v_cvt_pk_bf16_f32 v253, v46, v47
    v_mfma_f32_16x16x32_bf16 v[40:43], a[228:231], v[96:99], v[56:59]
    v_exp_f32 v32, v32
    v_mfma_f32_16x16x32_bf16 v[40:43], a[232:235], v[100:103], v[40:43]
    ds_read_b128 a[216:219], v3 offset:0
    v_mfma_f32_16x16x32_bf16 v[40:43], a[236:239], v[104:107], v[40:43]
    v_exp_f32 v33, v33
    v_mfma_f32_16x16x32_bf16 v[40:43], a[240:243], v[108:111], v[40:43]
    ds_read_b128 a[220:223], v4 offset:0
    v_cvt_pk_bf16_f32 v206, v32, v33
    v_mfma_f32_16x16x32_bf16 v[44:47], a[240:243], v[124:127], v[60:63]
    v_exp_f32 v34, v34
    v_mfma_f32_16x16x32_bf16 v[44:47], a[236:239], v[120:123], v[44:47]
    ds_read_b128 a[224:227], v5 offset:0
    v_mfma_f32_16x16x32_bf16 v[44:47], a[232:235], v[116:119], v[44:47]
    v_exp_f32 v35, v35
    v_mfma_f32_16x16x32_bf16 v[44:47], a[228:231], v[112:115], v[44:47]
    s_waitcnt lgkmcnt(4)
    ds_read_b64_tr_b16 a[128:129], v6 offset:32768
    v_cvt_pk_bf16_f32 v207, v34, v35
    v_mfma_f32_16x16x32_bf16 a[112:115], a[144:147], v[128:131], a[112:115]
    v_exp_f32 v36, v36
    v_mfma_f32_16x16x32_bf16 a[112:115], a[148:151], v[132:135], a[112:115]
    ds_read_b64_tr_b16 a[130:131], v6 offset:36864
    v_mfma_f32_16x16x32_bf16 a[112:115], a[152:155], v[136:139], a[112:115]
    v_exp_f32 v37, v37
    v_mfma_f32_16x16x32_bf16 a[112:115], a[156:159], v[140:143], a[112:115]
    ds_read_b64_tr_b16 a[132:133], v6 offset:40960
    v_cvt_pk_bf16_f32 v222, v36, v37
    v_mfma_f32_16x16x32_bf16 a[116:119], a[156:159], v[156:159], a[116:119]
    v_exp_f32 v38, v38
    v_mfma_f32_16x16x32_bf16 a[116:119], a[152:155], v[152:155], a[116:119]
    ds_read_b64_tr_b16 a[134:135], v6 offset:45056
    v_mfma_f32_16x16x32_bf16 a[116:119], a[148:151], v[148:151], a[116:119]
    v_exp_f32 v39, v39
    v_mfma_f32_16x16x32_bf16 a[116:119], a[144:147], v[144:147], a[116:119]
    ds_read_b64_tr_b16 a[136:137], v6 offset:49152
    v_cvt_pk_bf16_f32 v223, v38, v39
    v_mfma_f32_16x16x32_bf16 a[120:123], a[144:147], v[160:163], a[120:123]
    v_exp_f32 v40, v40
    v_mfma_f32_16x16x32_bf16 a[120:123], a[148:151], v[164:167], a[120:123]
    ds_read_b64_tr_b16 a[138:139], v6 offset:53248
    v_mfma_f32_16x16x32_bf16 a[120:123], a[152:155], v[168:171], a[120:123]
    v_exp_f32 v41, v41
    v_mfma_f32_16x16x32_bf16 a[120:123], a[156:159], v[172:175], a[120:123]
    ds_read_b64_tr_b16 a[140:141], v6 offset:57344
    v_cvt_pk_bf16_f32 v238, v40, v41
    v_mfma_f32_16x16x32_bf16 a[124:127], a[156:159], v[188:191], a[124:127]
    v_exp_f32 v42, v42
    v_mfma_f32_16x16x32_bf16 a[124:127], a[152:155], v[184:187], a[124:127]
    ds_read_b64_tr_b16 a[142:143], v6 offset:61440
    v_mfma_f32_16x16x32_bf16 a[124:127], a[148:151], v[180:183], a[124:127]
    v_exp_f32 v43, v43
    v_mfma_f32_16x16x32_bf16 a[124:127], a[144:147], v[176:179], a[124:127]
    s_waitcnt lgkmcnt(8)
    v_cvt_pk_bf16_f32 v239, v42, v43
    v_smfmac_f32_16x16x64_bf16 a[204:207], a[208:211], v[184:191], v20
    v_mfma_f32_16x16x32_bf16 v[32:35], a[212:215], v[64:67], v[48:51]
    v_exp_f32 v44, v44
    v_mfma_f32_16x16x32_bf16 v[32:35], a[216:219], v[68:71], v[32:35]
    ds_read_b128 a[228:231], v2 offset:4096
    v_mfma_f32_16x16x32_bf16 v[32:35], a[220:223], v[72:75], v[32:35]
    v_exp_f32 v45, v45
    v_mfma_f32_16x16x32_bf16 v[32:35], a[224:227], v[76:79], v[32:35]
    ds_read_b128 a[232:235], v3 offset:4096
    v_cvt_pk_bf16_f32 v254, v44, v45
    v_mfma_f32_16x16x32_bf16 v[36:39], a[224:227], v[92:95], v[52:55]
    s_add_u32 m0, s59, 32768
    v_exp_f32 v46, v46
    v_mfma_f32_16x16x32_bf16 v[36:39], a[220:223], v[88:91], v[36:39]
    buffer_load_dwordx4 v14, s[20:23], s62 offen offset:0 lds
    v_mfma_f32_16x16x32_bf16 v[36:39], a[216:219], v[84:87], v[36:39]
    v_exp_f32 v47, v47
    v_mfma_f32_16x16x32_bf16 v[36:39], a[212:215], v[80:83], v[36:39]
    ds_read_b128 a[236:239], v4 offset:4096
    v_cvt_pk_bf16_f32 v255, v46, v47
    v_mfma_f32_16x16x32_bf16 v[40:43], a[212:215], v[96:99], v[56:59]
    v_exp_f32 v32, v32
    v_mfma_f32_16x16x32_bf16 v[40:43], a[216:219], v[100:103], v[40:43]
    ds_read_b128 a[240:243], v5 offset:4096
    v_mfma_f32_16x16x32_bf16 v[40:43], a[220:223], v[104:107], v[40:43]
    v_exp_f32 v33, v33
    v_mfma_f32_16x16x32_bf16 v[40:43], a[224:227], v[108:111], v[40:43]
    ds_read_b64_tr_b16 a[144:145], v7 offset:32768
    v_cvt_pk_bf16_f32 v128, v32, v33
    v_mfma_f32_16x16x32_bf16 v[44:47], a[224:227], v[124:127], v[60:63]
    v_exp_f32 v34, v34
    v_mfma_f32_16x16x32_bf16 v[44:47], a[220:223], v[120:123], v[44:47]
    buffer_load_dwordx4 v15, s[20:23], s62 offen offset:1024 lds
    v_mfma_f32_16x16x32_bf16 v[44:47], a[216:219], v[116:119], v[44:47]
    v_exp_f32 v35, v35
    v_mfma_f32_16x16x32_bf16 v[44:47], a[212:215], v[112:115], v[44:47]
    s_waitcnt lgkmcnt(5)
    ds_read_b64_tr_b16 a[146:147], v7 offset:36864
    v_cvt_pk_bf16_f32 v129, v34, v35
    v_mfma_f32_16x16x32_bf16 a[0:3], a[128:131], v[192:195], a[0:3]
    v_exp_f32 v36, v36
    v_mfma_f32_16x16x32_bf16 a[0:3], a[132:135], v[196:199], a[0:3]
    ds_read_b64_tr_b16 a[148:149], v7 offset:40960
    v_mfma_f32_16x16x32_bf16 a[0:3], a[136:139], v[200:203], a[0:3]
    v_exp_f32 v37, v37
    v_mfma_f32_16x16x32_bf16 a[0:3], a[140:143], v[204:207], a[0:3]
    ds_read_b64_tr_b16 a[150:151], v7 offset:45056
    v_cvt_pk_bf16_f32 v144, v36, v37
    v_mfma_f32_16x16x32_bf16 a[4:7], a[140:143], v[220:223], a[4:7]
    v_exp_f32 v38, v38
    v_mfma_f32_16x16x32_bf16 a[4:7], a[136:139], v[216:219], a[4:7]
    buffer_load_dwordx4 v16, s[20:23], s62 offen offset:2048 lds
    v_mfma_f32_16x16x32_bf16 a[4:7], a[132:135], v[212:215], a[4:7]
    v_exp_f32 v39, v39
    v_mfma_f32_16x16x32_bf16 a[4:7], a[128:131], v[208:211], a[4:7]
    ds_read_b64_tr_b16 a[152:153], v7 offset:49152
    v_cvt_pk_bf16_f32 v145, v38, v39
    v_mfma_f32_16x16x32_bf16 a[8:11], a[128:131], v[224:227], a[8:11]
    v_exp_f32 v40, v40
    v_mfma_f32_16x16x32_bf16 a[8:11], a[132:135], v[228:231], a[8:11]
    ds_read_b64_tr_b16 a[154:155], v7 offset:53248
    v_mfma_f32_16x16x32_bf16 a[8:11], a[136:139], v[232:235], a[8:11]
    v_exp_f32 v41, v41
    v_mfma_f32_16x16x32_bf16 a[8:11], a[140:143], v[236:239], a[8:11]
    ds_read_b64_tr_b16 a[156:157], v7 offset:57344
    v_cvt_pk_bf16_f32 v160, v40, v41
    v_mfma_f32_16x16x32_bf16 a[12:15], a[140:143], v[252:255], a[12:15]
    v_exp_f32 v42, v42
    v_mfma_f32_16x16x32_bf16 a[12:15], a[136:139], v[248:251], a[12:15]
    buffer_load_dwordx4 v17, s[20:23], s62 offen offset:3072 lds
    v_mfma_f32_16x16x32_bf16 a[12:15], a[132:135], v[244:247], a[12:15]
    s_add_u32 s62, s62, 4096
    v_exp_f32 v43, v43
    v_mfma_f32_16x16x32_bf16 a[12:15], a[128:131], v[240:243], a[12:15]
    s_waitcnt lgkmcnt(7)
    ds_read_b64_tr_b16 a[158:159], v7 offset:61440
    v_cvt_pk_bf16_f32 v161, v42, v43
    v_smfmac_f32_16x16x64_bf16 a[192:195], a[208:211], v[192:199], v20
    v_mfma_f32_16x16x32_bf16 v[32:35], a[228:231], v[64:67], v[48:51]
    v_exp_f32 v44, v44
    v_mfma_f32_16x16x32_bf16 v[32:35], a[232:235], v[68:71], v[32:35]
    ds_read_b128 a[212:215], v2 offset:8192
    v_mfma_f32_16x16x32_bf16 v[32:35], a[236:239], v[72:75], v[32:35]
    v_exp_f32 v45, v45
    v_mfma_f32_16x16x32_bf16 v[32:35], a[240:243], v[76:79], v[32:35]
    ds_read_b128 a[216:219], v3 offset:8192
    v_cvt_pk_bf16_f32 v176, v44, v45
    v_mfma_f32_16x16x32_bf16 v[36:39], a[240:243], v[92:95], v[52:55]
    s_add_u32 m0, s59, 36864
    v_exp_f32 v46, v46
    v_mfma_f32_16x16x32_bf16 v[36:39], a[236:239], v[88:91], v[36:39]
    buffer_load_dwordx4 v14, s[20:23], s62 offen offset:0 lds
    v_mfma_f32_16x16x32_bf16 v[36:39], a[232:235], v[84:87], v[36:39]
    v_exp_f32 v47, v47
    v_mfma_f32_16x16x32_bf16 v[36:39], a[228:231], v[80:83], v[36:39]
    ds_read_b128 a[220:223], v4 offset:8192
    v_cvt_pk_bf16_f32 v177, v46, v47
    v_mfma_f32_16x16x32_bf16 v[40:43], a[228:231], v[96:99], v[56:59]
    v_exp_f32 v32, v32
    v_mfma_f32_16x16x32_bf16 v[40:43], a[232:235], v[100:103], v[40:43]
    ds_read_b128 a[224:227], v5 offset:8192
    v_mfma_f32_16x16x32_bf16 v[40:43], a[236:239], v[104:107], v[40:43]
    v_exp_f32 v33, v33
    v_mfma_f32_16x16x32_bf16 v[40:43], a[240:243], v[108:111], v[40:43]
    ds_read_b64_tr_b16 a[128:129], v8 offset:32768
    v_cvt_pk_bf16_f32 v130, v32, v33
    v_mfma_f32_16x16x32_bf16 v[44:47], a[240:243], v[124:127], v[60:63]
    v_exp_f32 v34, v34
    v_mfma_f32_16x16x32_bf16 v[44:47], a[236:239], v[120:123], v[44:47]
    buffer_load_dwordx4 v15, s[20:23], s62 offen offset:1024 lds
    v_mfma_f32_16x16x32_bf16 v[44:47], a[232:235], v[116:119], v[44:47]
    v_exp_f32 v35, v35
    v_mfma_f32_16x16x32_bf16 v[44:47], a[228:231], v[112:115], v[44:47]
    s_waitcnt lgkmcnt(5)
    ds_read_b64_tr_b16 a[130:131], v8 offset:36864
    v_cvt_pk_bf16_f32 v131, v34, v35
    v_mfma_f32_16x16x32_bf16 a[16:19], a[144:147], v[192:195], a[16:19]
    v_exp_f32 v36, v36
    v_mfma_f32_16x16x32_bf16 a[16:19], a[148:151], v[196:199], a[16:19]
    ds_read_b64_tr_b16 a[132:133], v8 offset:40960
    v_mfma_f32_16x16x32_bf16 a[16:19], a[152:155], v[200:203], a[16:19]
    v_exp_f32 v37, v37
    v_mfma_f32_16x16x32_bf16 a[16:19], a[156:159], v[204:207], a[16:19]
    ds_read_b64_tr_b16 a[134:135], v8 offset:45056
    v_cvt_pk_bf16_f32 v146, v36, v37
    v_mfma_f32_16x16x32_bf16 a[20:23], a[156:159], v[220:223], a[20:23]
    v_exp_f32 v38, v38
    v_mfma_f32_16x16x32_bf16 a[20:23], a[152:155], v[216:219], a[20:23]
    buffer_load_dwordx4 v16, s[20:23], s62 offen offset:2048 lds
    v_mfma_f32_16x16x32_bf16 a[20:23], a[148:151], v[212:215], a[20:23]
    v_exp_f32 v39, v39
    v_mfma_f32_16x16x32_bf16 a[20:23], a[144:147], v[208:211], a[20:23]
    ds_read_b64_tr_b16 a[136:137], v8 offset:49152
    v_cvt_pk_bf16_f32 v147, v38, v39
    v_mfma_f32_16x16x32_bf16 a[24:27], a[144:147], v[224:227], a[24:27]
    v_exp_f32 v40, v40
    v_mfma_f32_16x16x32_bf16 a[24:27], a[148:151], v[228:231], a[24:27]
    ds_read_b64_tr_b16 a[138:139], v8 offset:53248
    v_mfma_f32_16x16x32_bf16 a[24:27], a[152:155], v[232:235], a[24:27]
    v_exp_f32 v41, v41
    v_mfma_f32_16x16x32_bf16 a[24:27], a[156:159], v[236:239], a[24:27]
    ds_read_b64_tr_b16 a[140:141], v8 offset:57344
    v_cvt_pk_bf16_f32 v162, v40, v41
    v_mfma_f32_16x16x32_bf16 a[28:31], a[156:159], v[252:255], a[28:31]
    v_exp_f32 v42, v42
    v_mfma_f32_16x16x32_bf16 a[28:31], a[152:155], v[248:251], a[28:31]
    buffer_load_dwordx4 v17, s[20:23], s62 offen offset:3072 lds
    v_mfma_f32_16x16x32_bf16 a[28:31], a[148:151], v[244:247], a[28:31]
    s_add_u32 s62, s62, 28672
    v_exp_f32 v43, v43
    v_mfma_f32_16x16x32_bf16 a[28:31], a[144:147], v[240:243], a[28:31]
    s_waitcnt lgkmcnt(7)
    ds_read_b64_tr_b16 a[142:143], v8 offset:61440
    v_cvt_pk_bf16_f32 v163, v42, v43
    v_smfmac_f32_16x16x64_bf16 a[192:195], a[208:211], v[200:207], v20
    v_mfma_f32_16x16x32_bf16 v[32:35], a[212:215], v[64:67], v[48:51]
    v_exp_f32 v44, v44
    v_mfma_f32_16x16x32_bf16 v[32:35], a[216:219], v[68:71], v[32:35]
    ds_read_b128 a[228:231], v2 offset:12288
    v_mfma_f32_16x16x32_bf16 v[32:35], a[220:223], v[72:75], v[32:35]
    v_exp_f32 v45, v45
    v_mfma_f32_16x16x32_bf16 v[32:35], a[224:227], v[76:79], v[32:35]
    ds_read_b128 a[232:235], v3 offset:12288
    v_cvt_pk_bf16_f32 v178, v44, v45
    v_mfma_f32_16x16x32_bf16 v[36:39], a[224:227], v[92:95], v[52:55]
    s_add_u32 m0, s59, 98304
    v_exp_f32 v46, v46
    v_mfma_f32_16x16x32_bf16 v[36:39], a[220:223], v[88:91], v[36:39]
    buffer_load_dwordx4 v18, s[24:27], s63 offen offset:0 lds
    v_mfma_f32_16x16x32_bf16 v[36:39], a[216:219], v[84:87], v[36:39]
    v_exp_f32 v47, v47
    v_mfma_f32_16x16x32_bf16 v[36:39], a[212:215], v[80:83], v[36:39]
    ds_read_b128 a[236:239], v4 offset:12288
    v_cvt_pk_bf16_f32 v179, v46, v47
    v_mfma_f32_16x16x32_bf16 v[40:43], a[212:215], v[96:99], v[56:59]
    v_exp_f32 v32, v32
    v_mfma_f32_16x16x32_bf16 v[40:43], a[216:219], v[100:103], v[40:43]
    ds_read_b128 a[240:243], v5 offset:12288
    v_mfma_f32_16x16x32_bf16 v[40:43], a[220:223], v[104:107], v[40:43]
    v_exp_f32 v33, v33
    v_mfma_f32_16x16x32_bf16 v[40:43], a[224:227], v[108:111], v[40:43]
    ds_read_b64_tr_b16 a[144:145], v9 offset:32768
    v_cvt_pk_bf16_f32 v132, v32, v33
    v_mfma_f32_16x16x32_bf16 v[44:47], a[224:227], v[124:127], v[60:63]
    v_exp_f32 v34, v34
    v_mfma_f32_16x16x32_bf16 v[44:47], a[220:223], v[120:123], v[44:47]
    buffer_load_dwordx4 v19, s[24:27], s63 offen offset:1024 lds
    v_mfma_f32_16x16x32_bf16 v[44:47], a[216:219], v[116:119], v[44:47]
    v_exp_f32 v35, v35
    v_mfma_f32_16x16x32_bf16 v[44:47], a[212:215], v[112:115], v[44:47]
    s_waitcnt lgkmcnt(5)
    ds_read_b64_tr_b16 a[146:147], v9 offset:36864
    v_cvt_pk_bf16_f32 v133, v34, v35
    v_mfma_f32_16x16x32_bf16 a[32:35], a[128:131], v[192:195], a[32:35]
    v_exp_f32 v36, v36
    v_mfma_f32_16x16x32_bf16 a[32:35], a[132:135], v[196:199], a[32:35]
    ds_read_b64_tr_b16 a[148:149], v9 offset:40960
    v_mfma_f32_16x16x32_bf16 a[32:35], a[136:139], v[200:203], a[32:35]
    v_exp_f32 v37, v37
    v_mfma_f32_16x16x32_bf16 a[32:35], a[140:143], v[204:207], a[32:35]
    ds_read_b64_tr_b16 a[150:151], v9 offset:45056
    v_cvt_pk_bf16_f32 v148, v36, v37
    v_mfma_f32_16x16x32_bf16 a[36:39], a[140:143], v[220:223], a[36:39]
    v_exp_f32 v38, v38
    v_mfma_f32_16x16x32_bf16 a[36:39], a[136:139], v[216:219], a[36:39]
    buffer_load_dwordx4 v18, s[24:27], s63 offen offset:2048 lds
    v_mfma_f32_16x16x32_bf16 a[36:39], a[132:135], v[212:215], a[36:39]
    v_exp_f32 v39, v39
    v_mfma_f32_16x16x32_bf16 a[36:39], a[128:131], v[208:211], a[36:39]
    ds_read_b64_tr_b16 a[152:153], v9 offset:49152
    v_cvt_pk_bf16_f32 v149, v38, v39
    v_mfma_f32_16x16x32_bf16 a[40:43], a[128:131], v[224:227], a[40:43]
    v_exp_f32 v40, v40
    v_mfma_f32_16x16x32_bf16 a[40:43], a[132:135], v[228:231], a[40:43]
    ds_read_b64_tr_b16 a[154:155], v9 offset:53248
    v_mfma_f32_16x16x32_bf16 a[40:43], a[136:139], v[232:235], a[40:43]
    v_exp_f32 v41, v41
    v_mfma_f32_16x16x32_bf16 a[40:43], a[140:143], v[236:239], a[40:43]
    ds_read_b64_tr_b16 a[156:157], v9 offset:57344
    v_cvt_pk_bf16_f32 v164, v40, v41
    v_mfma_f32_16x16x32_bf16 a[44:47], a[140:143], v[252:255], a[44:47]
    v_exp_f32 v42, v42
    v_mfma_f32_16x16x32_bf16 a[44:47], a[136:139], v[248:251], a[44:47]
    buffer_load_dwordx4 v19, s[24:27], s63 offen offset:3072 lds
    v_mfma_f32_16x16x32_bf16 a[44:47], a[132:135], v[244:247], a[44:47]
    s_add_u32 s63, s63, 4096
    v_exp_f32 v43, v43
    v_mfma_f32_16x16x32_bf16 a[44:47], a[128:131], v[240:243], a[44:47]
    s_waitcnt lgkmcnt(7)
    ds_read_b64_tr_b16 a[158:159], v9 offset:61440
    v_cvt_pk_bf16_f32 v165, v42, v43
    v_smfmac_f32_16x16x64_bf16 a[196:199], a[208:211], v[208:215], v20
    v_mfma_f32_16x16x32_bf16 v[32:35], a[228:231], v[64:67], v[48:51]
    v_exp_f32 v44, v44
    v_mfma_f32_16x16x32_bf16 v[32:35], a[232:235], v[68:71], v[32:35]
    ds_read_b128 a[212:215], v2 offset:16384
    v_mfma_f32_16x16x32_bf16 v[32:35], a[236:239], v[72:75], v[32:35]
    v_exp_f32 v45, v45
    v_mfma_f32_16x16x32_bf16 v[32:35], a[240:243], v[76:79], v[32:35]
    ds_read_b128 a[216:219], v3 offset:16384
    v_cvt_pk_bf16_f32 v180, v44, v45
    v_mfma_f32_16x16x32_bf16 v[36:39], a[240:243], v[92:95], v[52:55]
    s_add_u32 m0, s59, 102400
    v_exp_f32 v46, v46
    v_mfma_f32_16x16x32_bf16 v[36:39], a[236:239], v[88:91], v[36:39]
    buffer_load_dwordx4 v18, s[24:27], s63 offen offset:0 lds
    v_mfma_f32_16x16x32_bf16 v[36:39], a[232:235], v[84:87], v[36:39]
    v_exp_f32 v47, v47
    v_mfma_f32_16x16x32_bf16 v[36:39], a[228:231], v[80:83], v[36:39]
    ds_read_b128 a[220:223], v4 offset:16384
    v_cvt_pk_bf16_f32 v181, v46, v47
    v_mfma_f32_16x16x32_bf16 v[40:43], a[228:231], v[96:99], v[56:59]
    v_exp_f32 v32, v32
    v_mfma_f32_16x16x32_bf16 v[40:43], a[232:235], v[100:103], v[40:43]
    ds_read_b128 a[224:227], v5 offset:16384
    v_mfma_f32_16x16x32_bf16 v[40:43], a[236:239], v[104:107], v[40:43]
    v_exp_f32 v33, v33
    v_mfma_f32_16x16x32_bf16 v[40:43], a[240:243], v[108:111], v[40:43]
    ds_read_b64_tr_b16 a[128:129], v10 offset:32768
    v_cvt_pk_bf16_f32 v134, v32, v33
    v_mfma_f32_16x16x32_bf16 v[44:47], a[240:243], v[124:127], v[60:63]
    v_exp_f32 v34, v34
    v_mfma_f32_16x16x32_bf16 v[44:47], a[236:239], v[120:123], v[44:47]
    buffer_load_dwordx4 v19, s[24:27], s63 offen offset:1024 lds
    v_mfma_f32_16x16x32_bf16 v[44:47], a[232:235], v[116:119], v[44:47]
    v_exp_f32 v35, v35
    v_mfma_f32_16x16x32_bf16 v[44:47], a[228:231], v[112:115], v[44:47]
    s_waitcnt lgkmcnt(5)
    ds_read_b64_tr_b16 a[130:131], v10 offset:36864
    v_cvt_pk_bf16_f32 v135, v34, v35
    v_mfma_f32_16x16x32_bf16 a[48:51], a[144:147], v[192:195], a[48:51]
    v_exp_f32 v36, v36
    v_mfma_f32_16x16x32_bf16 a[48:51], a[148:151], v[196:199], a[48:51]
    ds_read_b64_tr_b16 a[132:133], v10 offset:40960
    v_mfma_f32_16x16x32_bf16 a[48:51], a[152:155], v[200:203], a[48:51]
    v_exp_f32 v37, v37
    v_mfma_f32_16x16x32_bf16 a[48:51], a[156:159], v[204:207], a[48:51]
    ds_read_b64_tr_b16 a[134:135], v10 offset:45056
    v_cvt_pk_bf16_f32 v150, v36, v37
    v_mfma_f32_16x16x32_bf16 a[52:55], a[156:159], v[220:223], a[52:55]
    v_exp_f32 v38, v38
    v_mfma_f32_16x16x32_bf16 a[52:55], a[152:155], v[216:219], a[52:55]
    buffer_load_dwordx4 v18, s[24:27], s63 offen offset:2048 lds
    v_mfma_f32_16x16x32_bf16 a[52:55], a[148:151], v[212:215], a[52:55]
    v_exp_f32 v39, v39
    v_mfma_f32_16x16x32_bf16 a[52:55], a[144:147], v[208:211], a[52:55]
    ds_read_b64_tr_b16 a[136:137], v10 offset:49152
    v_cvt_pk_bf16_f32 v151, v38, v39
    v_mfma_f32_16x16x32_bf16 a[56:59], a[144:147], v[224:227], a[56:59]
    v_exp_f32 v40, v40
    v_mfma_f32_16x16x32_bf16 a[56:59], a[148:151], v[228:231], a[56:59]
    ds_read_b64_tr_b16 a[138:139], v10 offset:53248
    v_mfma_f32_16x16x32_bf16 a[56:59], a[152:155], v[232:235], a[56:59]
    v_exp_f32 v41, v41
    v_mfma_f32_16x16x32_bf16 a[56:59], a[156:159], v[236:239], a[56:59]
    ds_read_b64_tr_b16 a[140:141], v10 offset:57344
    v_cvt_pk_bf16_f32 v166, v40, v41
    v_mfma_f32_16x16x32_bf16 a[60:63], a[156:159], v[252:255], a[60:63]
    v_exp_f32 v42, v42
    v_mfma_f32_16x16x32_bf16 a[60:63], a[152:155], v[248:251], a[60:63]
    buffer_load_dwordx4 v19, s[24:27], s63 offen offset:3072 lds
    v_mfma_f32_16x16x32_bf16 a[60:63], a[148:151], v[244:247], a[60:63]
    s_add_u32 s63, s63, 28672
    v_exp_f32 v43, v43
    v_mfma_f32_16x16x32_bf16 a[60:63], a[144:147], v[240:243], a[60:63]
    s_waitcnt lgkmcnt(7)
    ds_read_b64_tr_b16 a[142:143], v10 offset:61440
    v_cvt_pk_bf16_f32 v167, v42, v43
    v_smfmac_f32_16x16x64_bf16 a[196:199], a[208:211], v[216:223], v20
    v_mfma_f32_16x16x32_bf16 v[32:35], a[212:215], v[64:67], v[48:51]
    v_exp_f32 v44, v44
    v_mfma_f32_16x16x32_bf16 v[32:35], a[216:219], v[68:71], v[32:35]
    ds_read_b128 a[228:231], v2 offset:20480
    v_mfma_f32_16x16x32_bf16 v[32:35], a[220:223], v[72:75], v[32:35]
    v_exp_f32 v45, v45
    v_mfma_f32_16x16x32_bf16 v[32:35], a[224:227], v[76:79], v[32:35]
    ds_read_b128 a[232:235], v3 offset:20480
    v_cvt_pk_bf16_f32 v182, v44, v45
    v_mfma_f32_16x16x32_bf16 v[36:39], a[224:227], v[92:95], v[52:55]
    v_exp_f32 v46, v46
    v_mfma_f32_16x16x32_bf16 v[36:39], a[220:223], v[88:91], v[36:39]
    buffer_load_dword a252, v28, s[24:27], s63 offen
    v_mfma_f32_16x16x32_bf16 v[36:39], a[216:219], v[84:87], v[36:39]
    v_exp_f32 v47, v47
    v_mfma_f32_16x16x32_bf16 v[36:39], a[212:215], v[80:83], v[36:39]
    ds_read_b128 a[236:239], v4 offset:20480
    v_cvt_pk_bf16_f32 v183, v46, v47
    v_mfma_f32_16x16x32_bf16 v[40:43], a[212:215], v[96:99], v[56:59]
    v_exp_f32 v32, v32
    v_mfma_f32_16x16x32_bf16 v[40:43], a[216:219], v[100:103], v[40:43]
    ds_read_b128 a[240:243], v5 offset:20480
    v_mfma_f32_16x16x32_bf16 v[40:43], a[220:223], v[104:107], v[40:43]
    v_exp_f32 v33, v33
    v_mfma_f32_16x16x32_bf16 v[40:43], a[224:227], v[108:111], v[40:43]
    s_cmp_le_u32 s64, 2
    ds_read_b64_tr_b16 a[144:145], v11 offset:32768
    v_cvt_pk_bf16_f32 v136, v32, v33
    v_mfma_f32_16x16x32_bf16 v[44:47], a[224:227], v[124:127], v[60:63]
    s_cselect_b32 s65, s101, 0x40000000
    v_exp_f32 v34, v34
    v_mfma_f32_16x16x32_bf16 v[44:47], a[220:223], v[120:123], v[44:47]
    buffer_load_dword a252, v29, s[48:51], s65 offen
    v_mfma_f32_16x16x32_bf16 v[44:47], a[216:219], v[116:119], v[44:47]
    s_add_u32 s101, s101, 8192
    v_exp_f32 v35, v35
    v_mfma_f32_16x16x32_bf16 v[44:47], a[212:215], v[112:115], v[44:47]
    s_waitcnt lgkmcnt(5)
    ds_read_b64_tr_b16 a[146:147], v11 offset:36864
    v_cvt_pk_bf16_f32 v137, v34, v35
    v_mfma_f32_16x16x32_bf16 a[64:67], a[128:131], v[192:195], a[64:67]
    s_and_b32 s101, s101, 16383
    v_exp_f32 v36, v36
    v_mfma_f32_16x16x32_bf16 a[64:67], a[132:135], v[196:199], a[64:67]
    ds_read_b64_tr_b16 a[148:149], v11 offset:40960
    v_mfma_f32_16x16x32_bf16 a[64:67], a[136:139], v[200:203], a[64:67]
    v_exp_f32 v37, v37
    v_mfma_f32_16x16x32_bf16 a[64:67], a[140:143], v[204:207], a[64:67]
    ds_read_b64_tr_b16 a[150:151], v11 offset:45056
    v_cvt_pk_bf16_f32 v152, v36, v37
    v_mfma_f32_16x16x32_bf16 a[68:71], a[140:143], v[220:223], a[68:71]
    v_exp_f32 v38, v38
    v_mfma_f32_16x16x32_bf16 a[68:71], a[136:139], v[216:219], a[68:71]
    buffer_store_dword v22, v21, s[36:39], 0 offen sc1
    v_mfma_f32_16x16x32_bf16 a[68:71], a[132:135], v[212:215], a[68:71]
    v_exp_f32 v39, v39
    v_mfma_f32_16x16x32_bf16 a[68:71], a[128:131], v[208:211], a[68:71]
    ds_read_b64_tr_b16 a[152:153], v11 offset:49152
    v_cvt_pk_bf16_f32 v153, v38, v39
    v_mfma_f32_16x16x32_bf16 a[72:75], a[128:131], v[224:227], a[72:75]
    v_exp_f32 v40, v40
    v_mfma_f32_16x16x32_bf16 a[72:75], a[132:135], v[228:231], a[72:75]
    ds_read_b64_tr_b16 a[154:155], v11 offset:53248
    v_mfma_f32_16x16x32_bf16 a[72:75], a[136:139], v[232:235], a[72:75]
    v_exp_f32 v41, v41
    v_mfma_f32_16x16x32_bf16 a[72:75], a[140:143], v[236:239], a[72:75]
    ds_read_b64_tr_b16 a[156:157], v11 offset:57344
    v_cvt_pk_bf16_f32 v168, v40, v41
    v_mfma_f32_16x16x32_bf16 a[76:79], a[140:143], v[252:255], a[76:79]
    v_exp_f32 v42, v42
    v_mfma_f32_16x16x32_bf16 a[76:79], a[136:139], v[248:251], a[76:79]
    buffer_store_dwordx4 a[244:247], v1, s[32:35], s66 offen sc1
    v_mfma_f32_16x16x32_bf16 a[76:79], a[132:135], v[244:247], a[76:79]
    v_exp_f32 v43, v43
    v_mfma_f32_16x16x32_bf16 a[76:79], a[128:131], v[240:243], a[76:79]
    s_waitcnt lgkmcnt(7)
    ds_read_b64_tr_b16 a[158:159], v11 offset:61440
    v_cvt_pk_bf16_f32 v169, v42, v43
    v_smfmac_f32_16x16x64_bf16 a[200:203], a[208:211], v[224:231], v20
    v_mfma_f32_16x16x32_bf16 v[32:35], a[228:231], v[64:67], v[48:51]
    v_exp_f32 v44, v44
    v_mfma_f32_16x16x32_bf16 v[32:35], a[232:235], v[68:71], v[32:35]
    ds_read_b128 a[212:215], v2 offset:24576
    v_mfma_f32_16x16x32_bf16 v[32:35], a[236:239], v[72:75], v[32:35]
    v_exp_f32 v45, v45
    v_mfma_f32_16x16x32_bf16 v[32:35], a[240:243], v[76:79], v[32:35]
    ds_read_b128 a[216:219], v3 offset:24576
    v_cvt_pk_bf16_f32 v184, v44, v45
    v_mfma_f32_16x16x32_bf16 v[36:39], a[240:243], v[92:95], v[52:55]
    v_exp_f32 v46, v46
    v_mfma_f32_16x16x32_bf16 v[36:39], a[236:239], v[88:91], v[36:39]
    buffer_store_dwordx4 a[244:247], v1, s[32:35], s66 offen offset:1024 sc1
    v_mfma_f32_16x16x32_bf16 v[36:39], a[232:235], v[84:87], v[36:39]
    v_exp_f32 v47, v47
    v_mfma_f32_16x16x32_bf16 v[36:39], a[228:231], v[80:83], v[36:39]
    ds_read_b128 a[220:223], v4 offset:24576
    v_cvt_pk_bf16_f32 v185, v46, v47
    v_mfma_f32_16x16x32_bf16 v[40:43], a[228:231], v[96:99], v[56:59]
    v_exp_f32 v32, v32
    v_mfma_f32_16x16x32_bf16 v[40:43], a[232:235], v[100:103], v[40:43]
    ds_read_b128 a[224:227], v5 offset:24576
    v_mfma_f32_16x16x32_bf16 v[40:43], a[236:239], v[104:107], v[40:43]
    v_exp_f32 v33, v33
    v_mfma_f32_16x16x32_bf16 v[40:43], a[240:243], v[108:111], v[40:43]
    ds_read_b64_tr_b16 a[128:129], v12 offset:32768
    v_cvt_pk_bf16_f32 v138, v32, v33
    v_mfma_f32_16x16x32_bf16 v[44:47], a[240:243], v[124:127], v[60:63]
    v_exp_f32 v34, v34
    v_mfma_f32_16x16x32_bf16 v[44:47], a[236:239], v[120:123], v[44:47]
    ds_read_b64_tr_b16 a[130:131], v12 offset:36864
    v_mfma_f32_16x16x32_bf16 v[44:47], a[232:235], v[116:119], v[44:47]
    v_exp_f32 v35, v35
    v_mfma_f32_16x16x32_bf16 v[44:47], a[228:231], v[112:115], v[44:47]
    s_waitcnt lgkmcnt(6)
    ds_read_b64_tr_b16 a[132:133], v12 offset:40960
    v_cvt_pk_bf16_f32 v139, v34, v35
    v_mfma_f32_16x16x32_bf16 a[80:83], a[144:147], v[192:195], a[80:83]
    v_exp_f32 v36, v36
    v_mfma_f32_16x16x32_bf16 a[80:83], a[148:151], v[196:199], a[80:83]
    ds_read_b64_tr_b16 a[134:135], v12 offset:45056
    v_mfma_f32_16x16x32_bf16 a[80:83], a[152:155], v[200:203], a[80:83]
    v_exp_f32 v37, v37
    v_mfma_f32_16x16x32_bf16 a[80:83], a[156:159], v[204:207], a[80:83]
    ds_read_b64_tr_b16 a[136:137], v12 offset:49152
    v_cvt_pk_bf16_f32 v154, v36, v37
    v_mfma_f32_16x16x32_bf16 a[84:87], a[156:159], v[220:223], a[84:87]
    v_exp_f32 v38, v38
    v_mfma_f32_16x16x32_bf16 a[84:87], a[152:155], v[216:219], a[84:87]
    ds_read_b64_tr_b16 a[138:139], v12 offset:53248
    v_mfma_f32_16x16x32_bf16 a[84:87], a[148:151], v[212:215], a[84:87]
    v_exp_f32 v39, v39
    v_mfma_f32_16x16x32_bf16 a[84:87], a[144:147], v[208:211], a[84:87]
    ds_read_b64_tr_b16 a[140:141], v12 offset:57344
    v_cvt_pk_bf16_f32 v155, v38, v39
    v_mfma_f32_16x16x32_bf16 a[88:91], a[144:147], v[224:227], a[88:91]
    v_exp_f32 v40, v40
    v_mfma_f32_16x16x32_bf16 a[88:91], a[148:151], v[228:231], a[88:91]
    ds_read_b64_tr_b16 a[142:143], v12 offset:61440
    v_mfma_f32_16x16x32_bf16 a[88:91], a[152:155], v[232:235], a[88:91]
    v_exp_f32 v41, v41
    v_mfma_f32_16x16x32_bf16 a[88:91], a[156:159], v[236:239], a[88:91]
    v_cvt_pk_bf16_f32 v170, v40, v41
    v_mfma_f32_16x16x32_bf16 a[92:95], a[156:159], v[252:255], a[92:95]
    v_exp_f32 v42, v42
    v_mfma_f32_16x16x32_bf16 a[92:95], a[152:155], v[248:251], a[92:95]
    v_mfma_f32_16x16x32_bf16 a[92:95], a[148:151], v[244:247], a[92:95]
    v_exp_f32 v43, v43
    v_mfma_f32_16x16x32_bf16 a[92:95], a[144:147], v[240:243], a[92:95]
    s_waitcnt lgkmcnt(8)
    v_cvt_pk_bf16_f32 v171, v42, v43
    v_smfmac_f32_16x16x64_bf16 a[200:203], a[208:211], v[232:239], v20
    v_mfma_f32_16x16x32_bf16 v[32:35], a[212:215], v[64:67], v[48:51]
    v_exp_f32 v44, v44
    v_mfma_f32_16x16x32_bf16 v[32:35], a[216:219], v[68:71], v[32:35]
    ds_read_b128 a[228:231], v2 offset:28672
    v_mfma_f32_16x16x32_bf16 v[32:35], a[220:223], v[72:75], v[32:35]
    v_exp_f32 v45, v45
    v_mfma_f32_16x16x32_bf16 v[32:35], a[224:227], v[76:79], v[32:35]
    ds_read_b128 a[232:235], v3 offset:28672
    v_cvt_pk_bf16_f32 v186, v44, v45
    v_mfma_f32_16x16x32_bf16 v[36:39], a[224:227], v[92:95], v[52:55]
    v_exp_f32 v46, v46
    v_mfma_f32_16x16x32_bf16 v[36:39], a[220:223], v[88:91], v[36:39]
    ds_read_b128 a[236:239], v4 offset:28672
    v_mfma_f32_16x16x32_bf16 v[36:39], a[216:219], v[84:87], v[36:39]
    v_exp_f32 v47, v47
    v_mfma_f32_16x16x32_bf16 v[36:39], a[212:215], v[80:83], v[36:39]
    ds_read_b128 a[240:243], v5 offset:28672
    v_cvt_pk_bf16_f32 v187, v46, v47
    v_mfma_f32_16x16x32_bf16 v[40:43], a[212:215], v[96:99], v[56:59]
    v_exp_f32 v32, v32
    v_mfma_f32_16x16x32_bf16 v[40:43], a[216:219], v[100:103], v[40:43]
    ds_read_b64_tr_b16 a[144:145], v13 offset:32768
    v_mfma_f32_16x16x32_bf16 v[40:43], a[220:223], v[104:107], v[40:43]
    v_exp_f32 v33, v33
    v_mfma_f32_16x16x32_bf16 v[40:43], a[224:227], v[108:111], v[40:43]
    ds_read_b64_tr_b16 a[146:147], v13 offset:36864
    v_cvt_pk_bf16_f32 v140, v32, v33
    v_mfma_f32_16x16x32_bf16 v[44:47], a[224:227], v[124:127], v[60:63]
    v_exp_f32 v34, v34
    v_mfma_f32_16x16x32_bf16 v[44:47], a[220:223], v[120:123], v[44:47]
    ds_read_b64_tr_b16 a[148:149], v13 offset:40960
    v_mfma_f32_16x16x32_bf16 v[44:47], a[216:219], v[116:119], v[44:47]
    v_exp_f32 v35, v35
    v_mfma_f32_16x16x32_bf16 v[44:47], a[212:215], v[112:115], v[44:47]
    s_waitcnt lgkmcnt(7)
    ds_read_b64_tr_b16 a[150:151], v13 offset:45056
    v_cvt_pk_bf16_f32 v141, v34, v35
    v_mfma_f32_16x16x32_bf16 a[96:99], a[128:131], v[192:195], a[96:99]
    v_exp_f32 v36, v36
    v_mfma_f32_16x16x32_bf16 a[96:99], a[132:135], v[196:199], a[96:99]
    ds_read_b64_tr_b16 a[152:153], v13 offset:49152
    v_mfma_f32_16x16x32_bf16 a[96:99], a[136:139], v[200:203], a[96:99]
    v_exp_f32 v37, v37
    v_mfma_f32_16x16x32_bf16 a[96:99], a[140:143], v[204:207], a[96:99]
    ds_read_b64_tr_b16 a[154:155], v13 offset:53248
    v_cvt_pk_bf16_f32 v156, v36, v37
    v_mfma_f32_16x16x32_bf16 a[100:103], a[140:143], v[220:223], a[100:103]
    v_exp_f32 v38, v38
    v_mfma_f32_16x16x32_bf16 a[100:103], a[136:139], v[216:219], a[100:103]
    ds_read_b64_tr_b16 a[156:157], v13 offset:57344
    v_mfma_f32_16x16x32_bf16 a[100:103], a[132:135], v[212:215], a[100:103]
    v_exp_f32 v39, v39
    v_mfma_f32_16x16x32_bf16 a[100:103], a[128:131], v[208:211], a[100:103]
    ds_read_b64_tr_b16 a[158:159], v13 offset:61440
    v_cvt_pk_bf16_f32 v157, v38, v39
    v_mfma_f32_16x16x32_bf16 a[104:107], a[128:131], v[224:227], a[104:107]
    v_exp_f32 v40, v40
    v_mfma_f32_16x16x32_bf16 a[104:107], a[132:135], v[228:231], a[104:107]
    v_mfma_f32_16x16x32_bf16 a[104:107], a[136:139], v[232:235], a[104:107]
    v_exp_f32 v41, v41
    v_mfma_f32_16x16x32_bf16 a[104:107], a[140:143], v[236:239], a[104:107]
    v_cvt_pk_bf16_f32 v172, v40, v41
    v_mfma_f32_16x16x32_bf16 a[108:111], a[140:143], v[252:255], a[108:111]
    v_exp_f32 v42, v42
    v_mfma_f32_16x16x32_bf16 a[108:111], a[136:139], v[248:251], a[108:111]
    v_mfma_f32_16x16x32_bf16 a[108:111], a[132:135], v[244:247], a[108:111]
    v_exp_f32 v43, v43
    v_mfma_f32_16x16x32_bf16 a[108:111], a[128:131], v[240:243], a[108:111]
    s_waitcnt lgkmcnt(8)
    v_cvt_pk_bf16_f32 v173, v42, v43
    v_smfmac_f32_16x16x64_bf16 a[204:207], a[208:211], v[240:247], v20
    v_mfma_f32_16x16x32_bf16 v[32:35], a[228:231], v[64:67], v[48:51]
    v_exp_f32 v44, v44
    v_mfma_f32_16x16x32_bf16 v[32:35], a[232:235], v[68:71], v[32:35]
    v_mfma_f32_16x16x32_bf16 v[32:35], a[236:239], v[72:75], v[32:35]
    v_exp_f32 v45, v45
    v_mfma_f32_16x16x32_bf16 v[32:35], a[240:243], v[76:79], v[32:35]
    v_cvt_pk_bf16_f32 v188, v44, v45
    v_add_u32 v22, 1, v22
    v_mfma_f32_16x16x32_bf16 v[36:39], a[240:243], v[92:95], v[52:55]
    v_exp_f32 v46, v46
    v_mfma_f32_16x16x32_bf16 v[36:39], a[236:239], v[88:91], v[36:39]
    s_waitcnt vmcnt(5) lgkmcnt(0)
    v_mfma_f32_16x16x32_bf16 v[36:39], a[232:235], v[84:87], v[36:39]
    s_barrier
    v_exp_f32 v47, v47
    v_mfma_f32_16x16x32_bf16 v[36:39], a[228:231], v[80:83], v[36:39]
    ds_read_b128 a[212:215], v2 offset:32768
    v_cvt_pk_bf16_f32 v189, v46, v47
    v_mfma_f32_16x16x32_bf16 v[40:43], a[228:231], v[96:99], v[56:59]
    v_exp_f32 v32, v32
    v_mfma_f32_16x16x32_bf16 v[40:43], a[232:235], v[100:103], v[40:43]
    ds_read_b128 a[216:219], v3 offset:32768
    v_mfma_f32_16x16x32_bf16 v[40:43], a[236:239], v[104:107], v[40:43]
    v_exp_f32 v33, v33
    v_mfma_f32_16x16x32_bf16 v[40:43], a[240:243], v[108:111], v[40:43]
    ds_read_b128 a[220:223], v4 offset:32768
    v_cvt_pk_bf16_f32 v142, v32, v33
    v_mfma_f32_16x16x32_bf16 v[44:47], a[240:243], v[124:127], v[60:63]
    v_exp_f32 v34, v34
    v_mfma_f32_16x16x32_bf16 v[44:47], a[236:239], v[120:123], v[44:47]
    ds_read_b128 a[224:227], v5 offset:32768
    v_mfma_f32_16x16x32_bf16 v[44:47], a[232:235], v[116:119], v[44:47]
    v_exp_f32 v35, v35
    v_mfma_f32_16x16x32_bf16 v[44:47], a[228:231], v[112:115], v[44:47]
    s_waitcnt lgkmcnt(4)
    ds_read_b64_tr_b16 a[128:129], v6 offset:0
    v_cvt_pk_bf16_f32 v143, v34, v35
    v_mfma_f32_16x16x32_bf16 a[112:115], a[144:147], v[192:195], a[112:115]
    v_exp_f32 v36, v36
    v_mfma_f32_16x16x32_bf16 a[112:115], a[148:151], v[196:199], a[112:115]
    ds_read_b64_tr_b16 a[130:131], v6 offset:4096
    v_mfma_f32_16x16x32_bf16 a[112:115], a[152:155], v[200:203], a[112:115]
    v_exp_f32 v37, v37
    v_mfma_f32_16x16x32_bf16 a[112:115], a[156:159], v[204:207], a[112:115]
    ds_read_b64_tr_b16 a[132:133], v6 offset:8192
    v_cvt_pk_bf16_f32 v158, v36, v37
    v_mfma_f32_16x16x32_bf16 a[116:119], a[156:159], v[220:223], a[116:119]
    v_exp_f32 v38, v38
    v_mfma_f32_16x16x32_bf16 a[116:119], a[152:155], v[216:219], a[116:119]
    ds_read_b64_tr_b16 a[134:135], v6 offset:12288
    v_mfma_f32_16x16x32_bf16 a[116:119], a[148:151], v[212:215], a[116:119]
    v_exp_f32 v39, v39
    v_mfma_f32_16x16x32_bf16 a[116:119], a[144:147], v[208:211], a[116:119]
    ds_read_b64_tr_b16 a[136:137], v6 offset:16384
    v_cvt_pk_bf16_f32 v159, v38, v39
    v_mfma_f32_16x16x32_bf16 a[120:123], a[144:147], v[224:227], a[120:123]
    v_exp_f32 v40, v40
    v_mfma_f32_16x16x32_bf16 a[120:123], a[148:151], v[228:231], a[120:123]
    ds_read_b64_tr_b16 a[138:139], v6 offset:20480
    v_mfma_f32_16x16x32_bf16 a[120:123], a[152:155], v[232:235], a[120:123]
    v_exp_f32 v41, v41
    v_mfma_f32_16x16x32_bf16 a[120:123], a[156:159], v[236:239], a[120:123]
    ds_read_b64_tr_b16 a[140:141], v6 offset:24576
    v_cvt_pk_bf16_f32 v174, v40, v41
    v_mfma_f32_16x16x32_bf16 a[124:127], a[156:159], v[252:255], a[124:127]
    v_exp_f32 v42, v42
    v_mfma_f32_16x16x32_bf16 a[124:127], a[152:155], v[248:251], a[124:127]
    s_sub_u32 s64, s64, 1
    ds_read_b64_tr_b16 a[142:143], v6 offset:28672
    v_mfma_f32_16x16x32_bf16 a[124:127], a[148:151], v[244:247], a[124:127]
    s_cmp_lg_u32 s64, 0
    v_exp_f32 v43, v43
    v_mfma_f32_16x16x32_bf16 a[124:127], a[144:147], v[240:243], a[124:127]
    s_waitcnt lgkmcnt(8)
    v_cvt_pk_bf16_f32 v175, v42, v43
    v_smfmac_f32_16x16x64_bf16 a[204:207], a[208:211], v[248:255], v20
    s_cbranch_scc1 L_att_loop
L_att_last:
    v_mfma_f32_16x16x32_bf16 v[32:35], a[212:215], v[64:67], v[48:51]
    v_exp_f32 v44, v44
    v_bfe_u32 v24, v0, 4, 2
    v_mfma_f32_16x16x32_bf16 v[32:35], a[216:219], v[68:71], v[32:35]
    ds_read_b128 a[228:231], v2 offset:36864
    v_mul_u32_u24 v24, 768, v24
    v_add_u32 v14, v18, v24
    v_mfma_f32_16x16x32_bf16 v[32:35], a[220:223], v[72:75], v[32:35]
    v_exp_f32 v45, v45
    v_add_u32 v15, v19, v24
    v_mfma_f32_16x16x32_bf16 v[32:35], a[224:227], v[76:79], v[32:35]
    ds_read_b128 a[232:235], v3 offset:36864
    v_cvt_pk_bf16_f32 v190, v44, v45
    v_add_u32 v15, 3072, v15
    v_mfma_f32_16x16x32_bf16 v[36:39], a[224:227], v[92:95], v[52:55]
    s_add_u32 m0, s59, 131072
    v_exp_f32 v46, v46
    v_add_u32 v16, 6144, v14
    v_mfma_f32_16x16x32_bf16 v[36:39], a[220:223], v[88:91], v[36:39]
    buffer_load_dwordx4 v18, s[24:27], s63 offen offset:0 lds
    v_mfma_f32_16x16x32_bf16 v[36:39], a[216:219], v[84:87], v[36:39]
    v_exp_f32 v47, v47
    v_add_u32 v17, 6144, v15
    v_mfma_f32_16x16x32_bf16 v[36:39], a[212:215], v[80:83], v[36:39]
    ds_read_b128 a[236:239], v4 offset:36864
    v_cvt_pk_bf16_f32 v191, v46, v47
    v_add_u32 v30, 186368, v1
    v_mfma_f32_16x16x32_bf16 v[40:43], a[212:215], v[96:99], v[56:59]
    v_exp_f32 v32, v32
    v_mfma_f32_16x16x32_bf16 v[40:43], a[216:219], v[100:103], v[40:43]
    v_exp_f32 v33, v33
    v_mfma_f32_16x16x32_bf16 v[40:43], a[220:223], v[104:107], v[40:43]
    buffer_load_dwordx4 v19, s[24:27], s63 offen offset:1024 lds
    v_mfma_f32_16x16x32_bf16 v[40:43], a[224:227], v[108:111], v[40:43]
    v_exp_f32 v34, v34
    v_cvt_pk_bf16_f32 v192, v32, v33
    v_mfma_f32_16x16x32_bf16 v[44:47], a[224:227], v[124:127], v[60:63]
    ds_read_b64_tr_b16 a[144:145], v7 offset:0
    v_exp_f32 v35, v35
    v_mfma_f32_16x16x32_bf16 v[44:47], a[220:223], v[120:123], v[44:47]
    ds_read_b128 a[240:243], v5 offset:36864
    v_cvt_pk_bf16_f32 v193, v34, v35
    v_mfma_f32_16x16x32_bf16 v[44:47], a[216:219], v[116:119], v[44:47]
    ds_read_b64_tr_b16 a[146:147], v7 offset:4096
    v_exp_f32 v36, v36
    v_mfma_f32_16x16x32_bf16 v[44:47], a[212:215], v[112:115], v[44:47]
    s_waitcnt lgkmcnt(6)
    ds_read_b64_tr_b16 a[148:149], v7 offset:8192
    v_exp_f32 v37, v37
    v_mfma_f32_16x16x32_bf16 a[0:3], a[128:131], v[128:131], a[0:3]
    ds_read_b64_tr_b16 a[150:151], v7 offset:12288
    v_cvt_pk_bf16_f32 v208, v36, v37
    v_mfma_f32_16x16x32_bf16 a[0:3], a[132:135], v[132:135], a[0:3]
    ds_read_b64_tr_b16 a[152:153], v7 offset:16384
    v_exp_f32 v38, v38
    v_mfma_f32_16x16x32_bf16 a[0:3], a[136:139], v[136:139], a[0:3]
    v_exp_f32 v39, v39
    v_mfma_f32_16x16x32_bf16 a[0:3], a[140:143], v[140:143], a[0:3]
    buffer_load_dwordx4 v18, s[24:27], s63 offen offset:2048 lds
    v_mfma_f32_16x16x32_bf16 a[4:7], a[140:143], v[156:159], a[4:7]
    v_cvt_pk_bf16_f32 v209, v38, v39
    v_exp_f32 v40, v40
    v_mfma_f32_16x16x32_bf16 a[4:7], a[136:139], v[152:155], a[4:7]
    v_exp_f32 v41, v41
    v_mfma_f32_16x16x32_bf16 a[4:7], a[132:135], v[148:151], a[4:7]
    ds_read_b64_tr_b16 a[154:155], v7 offset:20480
    v_cvt_pk_bf16_f32 v224, v40, v41
    v_mfma_f32_16x16x32_bf16 a[4:7], a[128:131], v[144:147], a[4:7]
    v_exp_f32 v42, v42
    v_smfmac_f32_16x16x64_bf16 a[192:195], a[208:211], v[128:135], v20
    s_waitcnt lgkmcnt(5)
    buffer_load_dwordx4 v19, s[24:27], s63 offen offset:3072 lds
    v_mfma_f32_16x16x32_bf16 v[32:35], a[228:231], v[64:67], v[48:51]
    s_add_u32 s63, s63, 4096
    v_exp_f32 v43, v43
    v_mfma_f32_16x16x32_bf16 v[32:35], a[232:235], v[68:71], v[32:35]
    ds_read_b128 a[212:215], v2 offset:40960
    v_cvt_pk_bf16_f32 v225, v42, v43
    v_mfma_f32_16x16x32_bf16 v[32:35], a[236:239], v[72:75], v[32:35]
    v_exp_f32 v44, v44
    v_mfma_f32_16x16x32_bf16 v[32:35], a[240:243], v[76:79], v[32:35]
    v_exp_f32 v45, v45
    v_mfma_f32_16x16x32_bf16 v[36:39], a[240:243], v[92:95], v[52:55]
    ds_read_b128 a[216:219], v3 offset:40960
    v_cvt_pk_bf16_f32 v240, v44, v45
    v_mfma_f32_16x16x32_bf16 v[36:39], a[236:239], v[88:91], v[36:39]
    v_exp_f32 v46, v46
    v_mfma_f32_16x16x32_bf16 v[36:39], a[232:235], v[84:87], v[36:39]
    v_exp_f32 v47, v47
    v_mfma_f32_16x16x32_bf16 v[36:39], a[228:231], v[80:83], v[36:39]
    ds_read_b128 a[220:223], v4 offset:40960
    v_cvt_pk_bf16_f32 v241, v46, v47
    v_mfma_f32_16x16x32_bf16 v[40:43], a[228:231], v[96:99], v[56:59]
    v_exp_f32 v32, v32
    v_mfma_f32_16x16x32_bf16 v[40:43], a[232:235], v[100:103], v[40:43]
    s_add_u32 m0, s59, 135168
    v_exp_f32 v33, v33
    v_mfma_f32_16x16x32_bf16 v[40:43], a[236:239], v[104:107], v[40:43]
    buffer_load_dwordx4 v18, s[24:27], s63 offen offset:0 lds
    v_mfma_f32_16x16x32_bf16 v[40:43], a[240:243], v[108:111], v[40:43]
    v_exp_f32 v34, v34
    v_cvt_pk_bf16_f32 v194, v32, v33
    v_mfma_f32_16x16x32_bf16 v[44:47], a[240:243], v[124:127], v[60:63]
    v_exp_f32 v35, v35
    v_mfma_f32_16x16x32_bf16 v[44:47], a[236:239], v[120:123], v[44:47]
    ds_read_b128 a[224:227], v5 offset:40960
    v_cvt_pk_bf16_f32 v195, v34, v35
    v_mfma_f32_16x16x32_bf16 v[44:47], a[232:235], v[116:119], v[44:47]
    v_exp_f32 v36, v36
    v_mfma_f32_16x16x32_bf16 v[44:47], a[228:231], v[112:115], v[44:47]
    v_exp_f32 v37, v37
    v_mfma_f32_16x16x32_bf16 a[8:11], a[128:131], v[160:163], a[8:11]
    ds_read_b64_tr_b16 a[156:157], v7 offset:24576
    v_cvt_pk_bf16_f32 v210, v36, v37
    v_mfma_f32_16x16x32_bf16 a[8:11], a[132:135], v[164:167], a[8:11]
    v_exp_f32 v38, v38
    v_mfma_f32_16x16x32_bf16 a[8:11], a[136:139], v[168:171], a[8:11]
    v_exp_f32 v39, v39
    v_mfma_f32_16x16x32_bf16 a[8:11], a[140:143], v[172:175], a[8:11]
    buffer_load_dwordx4 v19, s[24:27], s63 offen offset:1024 lds
    v_mfma_f32_16x16x32_bf16 a[12:15], a[140:143], v[188:191], a[12:15]
    v_cvt_pk_bf16_f32 v211, v38, v39
    v_exp_f32 v40, v40
    v_mfma_f32_16x16x32_bf16 a[12:15], a[136:139], v[184:187], a[12:15]
    v_exp_f32 v41, v41
    v_mfma_f32_16x16x32_bf16 a[12:15], a[132:135], v[180:183], a[12:15]
    ds_read_b64_tr_b16 a[158:159], v7 offset:28672
    v_cvt_pk_bf16_f32 v226, v40, v41
    v_mfma_f32_16x16x32_bf16 a[12:15], a[128:131], v[176:179], a[12:15]
    v_exp_f32 v42, v42
    v_smfmac_f32_16x16x64_bf16 a[192:195], a[208:211], v[136:143], v20
    s_waitcnt lgkmcnt(2)
    buffer_load_dwordx4 v18, s[24:27], s63 offen offset:2048 lds
    v_mfma_f32_16x16x32_bf16 v[32:35], a[212:215], v[64:67], v[48:51]
    v_exp_f32 v43, v43
    v_mfma_f32_16x16x32_bf16 v[32:35], a[216:219], v[68:71], v[32:35]
    s_lshl_b32 s65, s58, 6
    ds_read_b128 a[228:231], v2 offset:45056
    v_cvt_pk_bf16_f32 v227, v42, v43
    v_mfma_f32_16x16x32_bf16 v[32:35], a[220:223], v[72:75], v[32:35]
    s_or_b32 s65, s65, 98304
    v_exp_f32 v44, v44
    v_xor_b32 v25, s65, v6
    v_mfma_f32_16x16x32_bf16 v[32:35], a[224:227], v[76:79], v[32:35]
    v_exp_f32 v45, v45
    v_xor_b32 v26, s65, v7
    v_mfma_f32_16x16x32_bf16 v[36:39], a[224:227], v[92:95], v[52:55]
    ds_read_b128 a[232:235], v3 offset:45056
    v_cvt_pk_bf16_f32 v242, v44, v45
    v_add_u32 v27, 0x10000, v25
    v_mfma_f32_16x16x32_bf16 v[36:39], a[220:223], v[88:91], v[36:39]
    v_exp_f32 v46, v46
    v_add_u32 v28, 0x10000, v26
    v_mfma_f32_16x16x32_bf16 v[36:39], a[216:219], v[84:87], v[36:39]
    v_exp_f32 v47, v47
    v_mfma_f32_16x16x32_bf16 v[36:39], a[212:215], v[80:83], v[36:39]
    ds_read_b128 a[236:239], v4 offset:45056
    v_cvt_pk_bf16_f32 v243, v46, v47
    v_mfma_f32_16x16x32_bf16 v[40:43], a[212:215], v[96:99], v[56:59]
    v_exp_f32 v32, v32
    v_mfma_f32_16x16x32_bf16 v[40:43], a[216:219], v[100:103], v[40:43]
    v_exp_f32 v33, v33
    v_mfma_f32_16x16x32_bf16 v[40:43], a[220:223], v[104:107], v[40:43]
    buffer_load_dwordx4 v19, s[24:27], s63 offen offset:3072 lds
    v_mfma_f32_16x16x32_bf16 v[40:43], a[224:227], v[108:111], v[40:43]
    s_add_u32 s63, s63, 28672
    v_exp_f32 v34, v34
    v_cvt_pk_bf16_f32 v196, v32, v33
    v_mfma_f32_16x16x32_bf16 v[44:47], a[224:227], v[124:127], v[60:63]
    ds_read_b64_tr_b16 a[128:129], v8 offset:0
    v_exp_f32 v35, v35
    v_mfma_f32_16x16x32_bf16 v[44:47], a[220:223], v[120:123], v[44:47]
    ds_read_b128 a[240:243], v5 offset:45056
    v_cvt_pk_bf16_f32 v197, v34, v35
    v_mfma_f32_16x16x32_bf16 v[44:47], a[216:219], v[116:119], v[44:47]
    ds_read_b64_tr_b16 a[130:131], v8 offset:4096
    v_exp_f32 v36, v36
    v_mfma_f32_16x16x32_bf16 v[44:47], a[212:215], v[112:115], v[44:47]
    s_waitcnt lgkmcnt(6)
    ds_read_b64_tr_b16 a[132:133], v8 offset:8192
    v_exp_f32 v37, v37
    v_mfma_f32_16x16x32_bf16 a[16:19], a[144:147], v[128:131], a[16:19]
    ds_read_b64_tr_b16 a[134:135], v8 offset:12288
    v_cvt_pk_bf16_f32 v212, v36, v37
    v_mfma_f32_16x16x32_bf16 a[16:19], a[148:151], v[132:135], a[16:19]
    s_add_u32 m0, s60, 0
    ds_read_b64_tr_b16 a[136:137], v8 offset:16384
    v_exp_f32 v38, v38
    v_mfma_f32_16x16x32_bf16 a[16:19], a[152:155], v[136:139], a[16:19]
    s_xor_b32 s66, s67, 0
    v_exp_f32 v39, v39
    v_mfma_f32_16x16x32_bf16 a[16:19], a[156:159], v[140:143], a[16:19]
    buffer_load_dwordx4 v14, s[44:47], s66 offen offset:0 lds
    v_mfma_f32_16x16x32_bf16 a[20:23], a[156:159], v[156:159], a[20:23]
    v_cvt_pk_bf16_f32 v213, v38, v39
    v_exp_f32 v40, v40
    v_mfma_f32_16x16x32_bf16 a[20:23], a[152:155], v[152:155], a[20:23]
    v_exp_f32 v41, v41
    v_mfma_f32_16x16x32_bf16 a[20:23], a[148:151], v[148:151], a[20:23]
    ds_read_b64_tr_b16 a[138:139], v8 offset:20480
    v_cvt_pk_bf16_f32 v228, v40, v41
    v_mfma_f32_16x16x32_bf16 a[20:23], a[144:147], v[144:147], a[20:23]
    v_exp_f32 v42, v42
    v_smfmac_f32_16x16x64_bf16 a[196:199], a[208:211], v[144:151], v20
    s_waitcnt lgkmcnt(5)
    buffer_load_dwordx4 v15, s[44:47], s66 offen offset:1024 lds
    v_mfma_f32_16x16x32_bf16 v[32:35], a[228:231], v[64:67], v[48:51]
    v_exp_f32 v43, v43
    v_mfma_f32_16x16x32_bf16 v[32:35], a[232:235], v[68:71], v[32:35]
    ds_read_b128 a[212:215], v2 offset:49152
    v_cvt_pk_bf16_f32 v229, v42, v43
    v_mfma_f32_16x16x32_bf16 v[32:35], a[236:239], v[72:75], v[32:35]
    v_exp_f32 v44, v44
    v_mfma_f32_16x16x32_bf16 v[32:35], a[240:243], v[76:79], v[32:35]
    v_exp_f32 v45, v45
    v_mfma_f32_16x16x32_bf16 v[36:39], a[240:243], v[92:95], v[52:55]
    ds_read_b128 a[216:219], v3 offset:49152
    v_cvt_pk_bf16_f32 v244, v44, v45
    v_mfma_f32_16x16x32_bf16 v[36:39], a[236:239], v[88:91], v[36:39]
    v_exp_f32 v46, v46
    v_mfma_f32_16x16x32_bf16 v[36:39], a[232:235], v[84:87], v[36:39]
    v_exp_f32 v47, v47
    v_mfma_f32_16x16x32_bf16 v[36:39], a[228:231], v[80:83], v[36:39]
    ds_read_b128 a[220:223], v4 offset:49152
    v_cvt_pk_bf16_f32 v245, v46, v47
    v_mfma_f32_16x16x32_bf16 v[40:43], a[228:231], v[96:99], v[56:59]
    v_exp_f32 v32, v32
    v_mfma_f32_16x16x32_bf16 v[40:43], a[232:235], v[100:103], v[40:43]
    v_exp_f32 v33, v33
    v_mfma_f32_16x16x32_bf16 v[40:43], a[236:239], v[104:107], v[40:43]
    buffer_load_dwordx4 v16, s[44:47], s66 offen offset:2048 lds
    v_mfma_f32_16x16x32_bf16 v[40:43], a[240:243], v[108:111], v[40:43]
    v_exp_f32 v34, v34
    v_cvt_pk_bf16_f32 v198, v32, v33
    v_mfma_f32_16x16x32_bf16 v[44:47], a[240:243], v[124:127], v[60:63]
    v_exp_f32 v35, v35
    v_mfma_f32_16x16x32_bf16 v[44:47], a[236:239], v[120:123], v[44:47]
    ds_read_b128 a[224:227], v5 offset:49152
    v_cvt_pk_bf16_f32 v199, v34, v35
    v_mfma_f32_16x16x32_bf16 v[44:47], a[232:235], v[116:119], v[44:47]
    v_exp_f32 v36, v36
    v_mfma_f32_16x16x32_bf16 v[44:47], a[228:231], v[112:115], v[44:47]
    v_exp_f32 v37, v37
    v_mfma_f32_16x16x32_bf16 a[24:27], a[144:147], v[160:163], a[24:27]
    ds_read_b64_tr_b16 a[140:141], v8 offset:24576
    v_cvt_pk_bf16_f32 v214, v36, v37
    v_mfma_f32_16x16x32_bf16 a[24:27], a[148:151], v[164:167], a[24:27]
    v_exp_f32 v38, v38
    v_mfma_f32_16x16x32_bf16 a[24:27], a[152:155], v[168:171], a[24:27]
    v_exp_f32 v39, v39
    v_mfma_f32_16x16x32_bf16 a[24:27], a[156:159], v[172:175], a[24:27]
    buffer_load_dwordx4 v17, s[44:47], s66 offen offset:3072 lds
    v_mfma_f32_16x16x32_bf16 a[28:31], a[156:159], v[188:191], a[28:31]
    v_cvt_pk_bf16_f32 v215, v38, v39
    v_exp_f32 v40, v40
    v_mfma_f32_16x16x32_bf16 a[28:31], a[152:155], v[184:187], a[28:31]
    v_exp_f32 v41, v41
    v_mfma_f32_16x16x32_bf16 a[28:31], a[148:151], v[180:183], a[28:31]
    s_add_u32 m0, s60, 16384
    ds_read_b64_tr_b16 a[142:143], v8 offset:28672
    v_cvt_pk_bf16_f32 v230, v40, v41
    v_mfma_f32_16x16x32_bf16 a[28:31], a[144:147], v[176:179], a[28:31]
    s_xor_b32 s66, s67, 65536
    v_exp_f32 v42, v42
    v_smfmac_f32_16x16x64_bf16 a[196:199], a[208:211], v[152:159], v20
    s_waitcnt lgkmcnt(2)
    buffer_load_dwordx4 v14, s[44:47], s66 offen offset:0 lds
    v_mfma_f32_16x16x32_bf16 v[32:35], a[212:215], v[64:67], v[48:51]
    v_exp_f32 v43, v43
    v_mfma_f32_16x16x32_bf16 v[32:35], a[216:219], v[68:71], v[32:35]
    ds_read_b128 a[228:231], v2 offset:53248
    v_cvt_pk_bf16_f32 v231, v42, v43
    v_mfma_f32_16x16x32_bf16 v[32:35], a[220:223], v[72:75], v[32:35]
    v_exp_f32 v44, v44
    v_mfma_f32_16x16x32_bf16 v[32:35], a[224:227], v[76:79], v[32:35]
    v_exp_f32 v45, v45
    v_mfma_f32_16x16x32_bf16 v[36:39], a[224:227], v[92:95], v[52:55]
    ds_read_b128 a[232:235], v3 offset:53248
    v_cvt_pk_bf16_f32 v246, v44, v45
    v_mfma_f32_16x16x32_bf16 v[36:39], a[220:223], v[88:91], v[36:39]
    v_exp_f32 v46, v46
    v_mfma_f32_16x16x32_bf16 v[36:39], a[216:219], v[84:87], v[36:39]
    v_exp_f32 v47, v47
    v_mfma_f32_16x16x32_bf16 v[36:39], a[212:215], v[80:83], v[36:39]
    ds_read_b128 a[236:239], v4 offset:53248
    v_cvt_pk_bf16_f32 v247, v46, v47
    v_mfma_f32_16x16x32_bf16 v[40:43], a[212:215], v[96:99], v[56:59]
    v_exp_f32 v32, v32
    v_mfma_f32_16x16x32_bf16 v[40:43], a[216:219], v[100:103], v[40:43]
    v_exp_f32 v33, v33
    v_mfma_f32_16x16x32_bf16 v[40:43], a[220:223], v[104:107], v[40:43]
    buffer_load_dwordx4 v15, s[44:47], s66 offen offset:1024 lds
    v_mfma_f32_16x16x32_bf16 v[40:43], a[224:227], v[108:111], v[40:43]
    v_exp_f32 v34, v34
    v_cvt_pk_bf16_f32 v200, v32, v33
    v_mfma_f32_16x16x32_bf16 v[44:47], a[224:227], v[124:127], v[60:63]
    ds_read_b64_tr_b16 a[144:145], v9 offset:0
    v_exp_f32 v35, v35
    v_mfma_f32_16x16x32_bf16 v[44:47], a[220:223], v[120:123], v[44:47]
    ds_read_b128 a[240:243], v5 offset:53248
    v_cvt_pk_bf16_f32 v201, v34, v35
    v_mfma_f32_16x16x32_bf16 v[44:47], a[216:219], v[116:119], v[44:47]
    ds_read_b64_tr_b16 a[146:147], v9 offset:4096
    v_exp_f32 v36, v36
    v_mfma_f32_16x16x32_bf16 v[44:47], a[212:215], v[112:115], v[44:47]
    s_waitcnt lgkmcnt(6)
    ds_read_b64_tr_b16 a[148:149], v9 offset:8192
    v_exp_f32 v37, v37
    v_mfma_f32_16x16x32_bf16 a[32:35], a[128:131], v[128:131], a[32:35]
    ds_read_b64_tr_b16 a[150:151], v9 offset:12288
    v_cvt_pk_bf16_f32 v216, v36, v37
    v_mfma_f32_16x16x32_bf16 a[32:35], a[132:135], v[132:135], a[32:35]
    ds_read_b64_tr_b16 a[152:153], v9 offset:16384
    v_exp_f32 v38, v38
    v_mfma_f32_16x16x32_bf16 a[32:35], a[136:139], v[136:139], a[32:35]
    v_exp_f32 v39, v39
    v_mfma_f32_16x16x32_bf16 a[32:35], a[140:143], v[140:143], a[32:35]
    buffer_load_dwordx4 v16, s[44:47], s66 offen offset:2048 lds
    v_mfma_f32_16x16x32_bf16 a[36:39], a[140:143], v[156:159], a[36:39]
    v_cvt_pk_bf16_f32 v217, v38, v39
    v_exp_f32 v40, v40
    v_mfma_f32_16x16x32_bf16 a[36:39], a[136:139], v[152:155], a[36:39]
    v_exp_f32 v41, v41
    v_mfma_f32_16x16x32_bf16 a[36:39], a[132:135], v[148:151], a[36:39]
    ds_read_b64_tr_b16 a[154:155], v9 offset:20480
    v_cvt_pk_bf16_f32 v232, v40, v41
    v_mfma_f32_16x16x32_bf16 a[36:39], a[128:131], v[144:147], a[36:39]
    v_exp_f32 v42, v42
    v_smfmac_f32_16x16x64_bf16 a[200:203], a[208:211], v[160:167], v20
    s_waitcnt lgkmcnt(5)
    buffer_load_dwordx4 v17, s[44:47], s66 offen offset:3072 lds
    v_mfma_f32_16x16x32_bf16 v[32:35], a[228:231], v[64:67], v[48:51]
    v_exp_f32 v43, v43
    v_mfma_f32_16x16x32_bf16 v[32:35], a[232:235], v[68:71], v[32:35]
    ds_read_b128 a[212:215], v2 offset:57344
    v_cvt_pk_bf16_f32 v233, v42, v43
    v_mfma_f32_16x16x32_bf16 v[32:35], a[236:239], v[72:75], v[32:35]
    v_exp_f32 v44, v44
    v_mfma_f32_16x16x32_bf16 v[32:35], a[240:243], v[76:79], v[32:35]
    v_exp_f32 v45, v45
    v_mfma_f32_16x16x32_bf16 v[36:39], a[240:243], v[92:95], v[52:55]
    ds_read_b128 a[216:219], v3 offset:57344
    v_cvt_pk_bf16_f32 v248, v44, v45
    v_mfma_f32_16x16x32_bf16 v[36:39], a[236:239], v[88:91], v[36:39]
    v_exp_f32 v46, v46
    v_mfma_f32_16x16x32_bf16 v[36:39], a[232:235], v[84:87], v[36:39]
    v_exp_f32 v47, v47
    v_mfma_f32_16x16x32_bf16 v[36:39], a[228:231], v[80:83], v[36:39]
    ds_read_b128 a[220:223], v4 offset:57344
    v_cvt_pk_bf16_f32 v249, v46, v47
    v_mfma_f32_16x16x32_bf16 v[40:43], a[228:231], v[96:99], v[56:59]
    s_add_u32 m0, s60, 65536
    v_exp_f32 v32, v32
    v_mfma_f32_16x16x32_bf16 v[40:43], a[232:235], v[100:103], v[40:43]
    s_xor_b32 s66, s67, 131072
    v_exp_f32 v33, v33
    v_mfma_f32_16x16x32_bf16 v[40:43], a[236:239], v[104:107], v[40:43]
    buffer_load_dwordx4 v14, s[44:47], s66 offen offset:0 lds
    v_mfma_f32_16x16x32_bf16 v[40:43], a[240:243], v[108:111], v[40:43]
    v_exp_f32 v34, v34
    v_cvt_pk_bf16_f32 v202, v32, v33
    v_mfma_f32_16x16x32_bf16 v[44:47], a[240:243], v[124:127], v[60:63]
    v_exp_f32 v35, v35
    v_mfma_f32_16x16x32_bf16 v[44:47], a[236:239], v[120:123], v[44:47]
    ds_read_b128 a[224:227], v5 offset:57344
    v_cvt_pk_bf16_f32 v203, v34, v35
    v_mfma_f32_16x16x32_bf16 v[44:47], a[232:235], v[116:119], v[44:47]
    v_exp_f32 v36, v36
    v_mfma_f32_16x16x32_bf16 v[44:47], a[228:231], v[112:115], v[44:47]
    v_exp_f32 v37, v37
    v_mfma_f32_16x16x32_bf16 a[40:43], a[128:131], v[160:163], a[40:43]
    ds_read_b64_tr_b16 a[156:157], v9 offset:24576
    v_cvt_pk_bf16_f32 v218, v36, v37
    v_mfma_f32_16x16x32_bf16 a[40:43], a[132:135], v[164:167], a[40:43]
    v_exp_f32 v38, v38
    v_mfma_f32_16x16x32_bf16 a[40:43], a[136:139], v[168:171], a[40:43]
    v_exp_f32 v39, v39
    v_mfma_f32_16x16x32_bf16 a[40:43], a[140:143], v[172:175], a[40:43]
    buffer_load_dwordx4 v15, s[44:47], s66 offen offset:1024 lds
    v_mfma_f32_16x16x32_bf16 a[44:47], a[140:143], v[188:191], a[44:47]
    s_waitcnt vmcnt(2)
    v_cvt_pk_bf16_f32 v219, v38, v39
    v_exp_f32 v40, v40
    v_mfma_f32_16x16x32_bf16 a[44:47], a[136:139], v[184:187], a[44:47]
    s_barrier
    v_exp_f32 v41, v41
    v_mfma_f32_16x16x32_bf16 a[44:47], a[132:135], v[180:183], a[44:47]
    ds_read_b64_tr_b16 a[158:159], v9 offset:28672
    v_cvt_pk_bf16_f32 v234, v40, v41
    v_mfma_f32_16x16x32_bf16 a[44:47], a[128:131], v[176:179], a[44:47]
    ds_read_b64_tr_b16 a[160:161], v25 offset:0
    v_exp_f32 v42, v42
    v_smfmac_f32_16x16x64_bf16 a[200:203], a[208:211], v[168:175], v20
    s_waitcnt lgkmcnt(3)
    buffer_load_dwordx4 v16, s[44:47], s66 offen offset:2048 lds
    v_mfma_f32_16x16x32_bf16 v[32:35], a[212:215], v[64:67], v[48:51]
    ds_read_b64_tr_b16 a[128:129], v6 offset:32768
    v_exp_f32 v43, v43
    v_mfma_f32_16x16x32_bf16 v[32:35], a[216:219], v[68:71], v[32:35]
    ds_read_b128 a[228:231], v2 offset:61440
    v_cvt_pk_bf16_f32 v235, v42, v43
    v_mfma_f32_16x16x32_bf16 v[32:35], a[220:223], v[72:75], v[32:35]
    ds_read_b64_tr_b16 a[130:131], v6 offset:36864
    v_exp_f32 v44, v44
    v_mfma_f32_16x16x32_bf16 v[32:35], a[224:227], v[76:79], v[32:35]
    ds_read_b64_tr_b16 a[132:133], v6 offset:40960
    v_exp_f32 v45, v45
    v_mfma_f32_16x16x32_bf16 v[36:39], a[224:227], v[92:95], v[52:55]
    ds_read_b128 a[232:235], v3 offset:61440
    v_cvt_pk_bf16_f32 v250, v44, v45
    v_mfma_f32_16x16x32_bf16 v[36:39], a[220:223], v[88:91], v[36:39]
    ds_read_b64_tr_b16 a[162:163], v25 offset:4096
    v_exp_f32 v46, v46
    v_mfma_f32_16x16x32_bf16 v[36:39], a[216:219], v[84:87], v[36:39]
    ds_read_b64_tr_b16 a[164:165], v26 offset:0
    v_exp_f32 v47, v47
    v_mfma_f32_16x16x32_bf16 v[36:39], a[212:215], v[80:83], v[36:39]
    ds_read_b128 a[236:239], v4 offset:61440
    v_cvt_pk_bf16_f32 v251, v46, v47
    v_mfma_f32_16x16x32_bf16 v[40:43], a[212:215], v[96:99], v[56:59]
    ds_read_b64_tr_b16 a[166:167], v26 offset:4096
    v_exp_f32 v32, v32
    v_mfma_f32_16x16x32_bf16 v[40:43], a[216:219], v[100:103], v[40:43]
    ds_read_b64_tr_b16 a[168:169], v25 offset:8192
    v_exp_f32 v33, v33
    v_mfma_f32_16x16x32_bf16 v[40:43], a[220:223], v[104:107], v[40:43]
    buffer_load_dwordx4 v17, s[44:47], s66 offen offset:3072 lds
    v_mfma_f32_16x16x32_bf16 v[40:43], a[224:227], v[108:111], v[40:43]
    v_exp_f32 v34, v34
    v_cvt_pk_bf16_f32 v204, v32, v33
    v_mfma_f32_16x16x32_bf16 v[44:47], a[224:227], v[124:127], v[60:63]
    ds_read_b64_tr_b16 a[170:171], v25 offset:12288
    v_exp_f32 v35, v35
    v_mfma_f32_16x16x32_bf16 v[44:47], a[220:223], v[120:123], v[44:47]
    ds_read_b128 a[240:243], v5 offset:61440
    v_cvt_pk_bf16_f32 v205, v34, v35
    v_mfma_f32_16x16x32_bf16 v[44:47], a[216:219], v[116:119], v[44:47]
    ds_read_b64_tr_b16 a[172:173], v26 offset:8192
    v_exp_f32 v36, v36
    v_mfma_f32_16x16x32_bf16 v[44:47], a[212:215], v[112:115], v[44:47]
    s_waitcnt lgkmcnt(14)
    ds_read_b64_tr_b16 a[174:175], v26 offset:12288
    v_exp_f32 v37, v37
    v_mfma_f32_16x16x32_bf16 a[48:51], a[144:147], v[128:131], a[48:51]
    ds_read_b64_tr_b16 a[134:135], v6 offset:45056
    v_cvt_pk_bf16_f32 v220, v36, v37
    v_mfma_f32_16x16x32_bf16 a[48:51], a[148:151], v[132:135], a[48:51]
    s_add_u32 m0, s60, 81920
    ds_read_b64_tr_b16 a[212:213], v7 offset:32768
    v_exp_f32 v38, v38
    v_mfma_f32_16x16x32_bf16 a[48:51], a[152:155], v[136:139], a[48:51]
    s_xor_b32 s66, s67, 196608
    ds_read_b64_tr_b16 a[214:215], v7 offset:36864
    v_exp_f32 v39, v39
    v_mfma_f32_16x16x32_bf16 a[48:51], a[156:159], v[140:143], a[48:51]
    buffer_load_dwordx4 v14, s[44:47], s66 offen offset:0 lds
    v_mfma_f32_16x16x32_bf16 a[52:55], a[156:159], v[156:159], a[52:55]
    v_cvt_pk_bf16_f32 v221, v38, v39
    v_exp_f32 v40, v40
    v_mfma_f32_16x16x32_bf16 a[52:55], a[152:155], v[152:155], a[52:55]
    ds_read_b64_tr_b16 a[216:217], v7 offset:40960
    v_exp_f32 v41, v41
    v_mfma_f32_16x16x32_bf16 a[52:55], a[148:151], v[148:151], a[52:55]
    ds_read_b64_tr_b16 a[136:137], v6 offset:49152
    v_cvt_pk_bf16_f32 v236, v40, v41
    v_mfma_f32_16x16x32_bf16 a[52:55], a[144:147], v[144:147], a[52:55]
    ds_read_b64_tr_b16 a[218:219], v7 offset:45056
    v_exp_f32 v42, v42
    v_smfmac_f32_16x16x64_bf16 a[204:207], a[208:211], v[176:183], v20
    s_waitcnt lgkmcnt(8)
    buffer_load_dwordx4 v15, s[44:47], s66 offen offset:1024 lds
    v_mfma_f32_16x16x32_bf16 v[32:35], a[228:231], v[64:67], v[48:51]
    ds_read_b64_tr_b16 a[220:221], v7 offset:49152
    v_exp_f32 v43, v43
    v_mfma_f32_16x16x32_bf16 v[32:35], a[232:235], v[68:71], v[32:35]
    ds_read_b64_tr_b16 a[138:139], v6 offset:53248
    v_cvt_pk_bf16_f32 v237, v42, v43
    v_mfma_f32_16x16x32_bf16 v[32:35], a[236:239], v[72:75], v[32:35]
    ds_read_b64_tr_b16 a[222:223], v7 offset:53248
    v_exp_f32 v44, v44
    v_mfma_f32_16x16x32_bf16 v[32:35], a[240:243], v[76:79], v[32:35]
    ds_read_b64_tr_b16 a[176:177], v25 offset:16384
    v_exp_f32 v45, v45
    v_mfma_f32_16x16x32_bf16 v[36:39], a[240:243], v[92:95], v[52:55]
    ds_read_b64_tr_b16 a[140:141], v6 offset:57344
    v_cvt_pk_bf16_f32 v252, v44, v45
    v_mfma_f32_16x16x32_bf16 v[36:39], a[236:239], v[88:91], v[36:39]
    ds_read_b64_tr_b16 a[178:179], v25 offset:20480
    v_exp_f32 v46, v46
    v_mfma_f32_16x16x32_bf16 v[36:39], a[232:235], v[84:87], v[36:39]
    ds_read_b64_tr_b16 a[180:181], v26 offset:16384
    v_exp_f32 v47, v47
    v_mfma_f32_16x16x32_bf16 v[36:39], a[228:231], v[80:83], v[36:39]
    ds_read_b64_tr_b16 a[142:143], v6 offset:61440
    v_cvt_pk_bf16_f32 v253, v46, v47
    v_mfma_f32_16x16x32_bf16 v[40:43], a[228:231], v[96:99], v[56:59]
    ds_read_b64_tr_b16 a[182:183], v26 offset:20480
    v_exp_f32 v32, v32
    v_mfma_f32_16x16x32_bf16 v[40:43], a[232:235], v[100:103], v[40:43]
    ds_read_b64_tr_b16 a[184:185], v25 offset:24576
    v_exp_f32 v33, v33
    v_mfma_f32_16x16x32_bf16 v[40:43], a[236:239], v[104:107], v[40:43]
    buffer_load_dwordx4 v16, s[44:47], s66 offen offset:2048 lds
    v_mfma_f32_16x16x32_bf16 v[40:43], a[240:243], v[108:111], v[40:43]
    v_exp_f32 v34, v34
    v_cvt_pk_bf16_f32 v206, v32, v33
    v_mfma_f32_16x16x32_bf16 v[44:47], a[240:243], v[124:127], v[60:63]
    ds_read_b64_tr_b16 a[186:187], v25 offset:28672
    v_exp_f32 v35, v35
    v_mfma_f32_16x16x32_bf16 v[44:47], a[236:239], v[120:123], v[44:47]
    ds_read_b64_tr_b16 a[224:225], v7 offset:57344
    v_cvt_pk_bf16_f32 v207, v34, v35
    v_mfma_f32_16x16x32_bf16 v[44:47], a[232:235], v[116:119], v[44:47]
    ds_read_b64_tr_b16 a[188:189], v26 offset:24576
    v_exp_f32 v36, v36
    v_mfma_f32_16x16x32_bf16 v[44:47], a[228:231], v[112:115], v[44:47]
    v_exp_f32 v37, v37
    v_mfma_f32_16x16x32_bf16 a[56:59], a[144:147], v[160:163], a[56:59]
    ds_read_b64_tr_b16 a[226:227], v7 offset:61440
    v_cvt_pk_bf16_f32 v222, v36, v37
    v_mfma_f32_16x16x32_bf16 a[56:59], a[148:151], v[164:167], a[56:59]
    v_exp_f32 v38, v38
    v_mfma_f32_16x16x32_bf16 a[56:59], a[152:155], v[168:171], a[56:59]
    v_exp_f32 v39, v39
    v_mfma_f32_16x16x32_bf16 a[56:59], a[156:159], v[172:175], a[56:59]
    buffer_load_dwordx4 v17, s[44:47], s66 offen offset:3072 lds
    v_mfma_f32_16x16x32_bf16 a[60:63], a[156:159], v[188:191], a[60:63]
    v_cvt_pk_bf16_f32 v223, v38, v39
    v_exp_f32 v40, v40
    v_mfma_f32_16x16x32_bf16 a[60:63], a[152:155], v[184:187], a[60:63]
    v_exp_f32 v41, v41
    v_mfma_f32_16x16x32_bf16 a[60:63], a[148:151], v[180:183], a[60:63]
    ds_read_b64_tr_b16 a[190:191], v26 offset:28672
    v_cvt_pk_bf16_f32 v238, v40, v41
    v_mfma_f32_16x16x32_bf16 a[60:63], a[144:147], v[176:179], a[60:63]
    v_exp_f32 v42, v42
    v_smfmac_f32_16x16x64_bf16 a[204:207], a[208:211], v[184:191], v20
    buffer_load_dword v29, v23, s[36:39], 0 offen sc1
    v_smfmac_f32_16x16x64_bf16 a[192:195], a[208:211], v[192:199], v20
    v_exp_f32 v43, v43
    v_smfmac_f32_16x16x64_bf16 a[192:195], a[208:211], v[200:207], v20
    s_waitcnt lgkmcnt(1)
    v_cvt_pk_bf16_f32 v239, v42, v43
    v_mfma_f32_16x16x32_bf16 a[0:3], a[128:131], v[192:195], a[0:3]
    s_waitcnt lgkmcnt(0)
    v_exp_f32 v44, v44
    v_mfma_f32_16x16x32_bf16 a[0:3], a[132:135], v[196:199], a[0:3]
    s_barrier
    v_exp_f32 v45, v45
    v_mfma_f32_16x16x32_bf16 a[0:3], a[136:139], v[200:203], a[0:3]
    ds_read_b64_tr_b16 a[144:145], v8 offset:32768
    v_cvt_pk_bf16_f32 v254, v44, v45
    v_mfma_f32_16x16x32_bf16 a[0:3], a[140:143], v[204:207], a[0:3]
    v_exp_f32 v46, v46
    v_mfma_f32_16x16x32_bf16 a[16:19], a[224:227], v[204:207], a[16:19]
    s_add_u32 m0, s60, 0
    v_exp_f32 v47, v47
    v_mfma_f32_16x16x32_bf16 a[16:19], a[220:223], v[200:203], a[16:19]
    s_lshl_b32 s66, s8, 5
    v_cvt_pk_bf16_f32 v255, v46, v47
    v_mfma_f32_16x16x32_bf16 a[16:19], a[216:219], v[196:199], a[16:19]
    s_add_u32 s66, s66, s68
    ds_read_b64_tr_b16 a[146:147], v8 offset:36864
    v_mfma_f32_16x16x32_bf16 a[16:19], a[212:215], v[192:195], a[16:19]
    buffer_load_dwordx4 v14, s[48:51], s66 offen offset:0 lds
    v_smfmac_f32_16x16x64_bf16 a[196:199], a[208:211], v[208:215], v20
    v_smfmac_f32_16x16x64_bf16 a[196:199], a[208:211], v[216:223], v20
    v_accvgpr_read_b32 v52, a192
    v_accvgpr_read_b32 v48, a193
    v_mfma_f32_16x16x32_bf16 a[20:23], a[212:215], v[208:211], a[20:23]
    ds_read_b64_tr_b16 a[148:149], v8 offset:40960
    v_add_f32 v52, v52, v48
    v_rcp_f32 v48, v52
    v_mfma_f32_16x16x32_bf16 a[20:23], a[216:219], v[212:215], a[20:23]
    ds_read_b64_tr_b16 a[150:151], v8 offset:45056
    v_accvgpr_read_b32 v32, a0
    v_accvgpr_read_b32 v33, a1
    v_mfma_f32_16x16x32_bf16 a[20:23], a[220:223], v[216:219], a[20:23]
    buffer_load_dwordx4 v15, s[48:51], s66 offen offset:1024 lds
    v_mfma_f32_16x16x32_bf16 a[20:23], a[224:227], v[220:223], a[20:23]
    ds_read_b64_tr_b16 a[152:153], v8 offset:49152
    v_accvgpr_read_b32 v34, a2
    v_accvgpr_read_b32 v35, a3
    v_mfma_f32_16x16x32_bf16 a[4:7], a[140:143], v[220:223], a[4:7]
    ds_read_b64_tr_b16 a[154:155], v8 offset:53248
    v_accvgpr_read_b32 v36, a16
    v_accvgpr_read_b32 v37, a17
    v_mfma_f32_16x16x32_bf16 a[4:7], a[136:139], v[216:219], a[4:7]
    ds_read_b64_tr_b16 a[156:157], v8 offset:57344
    v_accvgpr_read_b32 v38, a18
    v_accvgpr_read_b32 v39, a19
    v_mfma_f32_16x16x32_bf16 a[4:7], a[132:135], v[212:215], a[4:7]
    ds_read_b64_tr_b16 a[158:159], v8 offset:61440
    v_mul_f32 v32, v32, v48
    v_mul_f32 v33, v33, v48
    v_mfma_f32_16x16x32_bf16 a[4:7], a[128:131], v[208:211], a[4:7]
    buffer_load_dwordx4 v16, s[48:51], s66 offen offset:2048 lds
    v_smfmac_f32_16x16x64_bf16 a[200:203], a[208:211], v[224:231], v20
    v_mul_f32 v34, v34, v48
    v_mul_f32 v35, v35, v48
    v_smfmac_f32_16x16x64_bf16 a[200:203], a[208:211], v[232:239], v20
    v_mul_f32 v36, v36, v48
    v_mul_f32 v37, v37, v48
    v_mfma_f32_16x16x32_bf16 a[8:11], a[128:131], v[224:227], a[8:11]
    ds_read_b64_tr_b16 a[228:229], v9 offset:32768
    v_mul_f32 v38, v38, v48
    v_mul_f32 v39, v39, v48
    v_mfma_f32_16x16x32_bf16 a[8:11], a[132:135], v[228:231], a[8:11]
    ds_read_b64_tr_b16 a[230:231], v9 offset:36864
    v_cvt_pk_bf16_f32 v64, v32, v33
    v_mfma_f32_16x16x32_bf16 a[8:11], a[136:139], v[232:235], a[8:11]
    buffer_load_dwordx4 v17, s[48:51], s66 offen offset:3072 lds
    v_mfma_f32_16x16x32_bf16 a[8:11], a[140:143], v[236:239], a[8:11]
    ds_read_b64_tr_b16 a[232:233], v9 offset:40960
    v_cvt_pk_bf16_f32 v65, v34, v35
    v_mfma_f32_16x16x32_bf16 a[24:27], a[224:227], v[236:239], a[24:27]
    ds_read_b64_tr_b16 a[234:235], v9 offset:45056
    v_cvt_pk_bf16_f32 v66, v36, v37
    v_mfma_f32_16x16x32_bf16 a[24:27], a[220:223], v[232:235], a[24:27]
    ds_read_b64_tr_b16 a[236:237], v9 offset:49152
    v_cvt_pk_bf16_f32 v67, v38, v39
    v_mfma_f32_16x16x32_bf16 a[24:27], a[216:219], v[228:231], a[24:27]
    s_add_u32 s64, s69, 0
    ds_read_b64_tr_b16 a[238:239], v9 offset:53248
    v_accvgpr_read_b32 v53, a196
    v_accvgpr_read_b32 v49, a197
    v_mfma_f32_16x16x32_bf16 a[24:27], a[212:215], v[224:227], a[24:27]
    s_add_u32 m0, s60, 32768
    buffer_store_dwordx4 v[64:67], v1, s[28:31], s64 offen offset:0 sc1
    v_smfmac_f32_16x16x64_bf16 a[204:207], a[208:211], v[240:247], v20
    s_lshl_b32 s66, s9, 5
    v_add_f32 v53, v53, v49
    v_rcp_f32 v49, v53
    v_smfmac_f32_16x16x64_bf16 a[204:207], a[208:211], v[248:255], v20
    s_add_u32 s66, s66, s68
    v_accvgpr_read_b32 v44, a20
    v_accvgpr_read_b32 v45, a21
    v_mfma_f32_16x16x32_bf16 a[28:31], a[212:215], v[240:243], a[28:31]
    buffer_load_dwordx4 v14, s[48:51], s66 offen offset:0 lds
    v_mfma_f32_16x16x32_bf16 a[28:31], a[216:219], v[244:247], a[28:31]
    ds_read_b64_tr_b16 a[240:241], v9 offset:57344
    v_accvgpr_read_b32 v46, a22
    v_accvgpr_read_b32 v47, a23
    v_mfma_f32_16x16x32_bf16 a[28:31], a[220:223], v[248:251], a[28:31]
    ds_read_b64_tr_b16 a[242:243], v9 offset:61440
    v_accvgpr_read_b32 v40, a4
    v_accvgpr_read_b32 v41, a5
    v_mfma_f32_16x16x32_bf16 a[28:31], a[224:227], v[252:255], a[28:31]
    v_accvgpr_read_b32 v42, a6
    v_accvgpr_read_b32 v43, a7
    v_mfma_f32_16x16x32_bf16 a[12:15], a[140:143], v[252:255], a[12:15]
    v_mul_f32 v44, v44, v49
    v_mul_f32 v45, v45, v49
    v_mfma_f32_16x16x32_bf16 a[12:15], a[136:139], v[248:251], a[12:15]
    buffer_load_dwordx4 v15, s[48:51], s66 offen offset:1024 lds
    v_mfma_f32_16x16x32_bf16 a[12:15], a[132:135], v[244:247], a[12:15]
    v_mul_f32 v46, v46, v49
    v_mul_f32 v47, v47, v49
    v_mfma_f32_16x16x32_bf16 a[12:15], a[128:131], v[240:243], a[12:15]
    v_mul_f32 v40, v40, v49
    v_mul_f32 v41, v41, v49
    v_mfma_f32_16x16x32_bf16 a[244:247], a[248:251], v[64:67], 0
    s_waitcnt lgkmcnt(0)
    v_mul_f32 v42, v42, v49
    v_mul_f32 v43, v43, v49
    v_mfma_f32_16x16x32_bf16 a[32:35], a[144:147], v[192:195], a[32:35]
    ds_read_b64_tr_b16 a[128:129], v10 offset:0
    v_cvt_pk_bf16_f32 v68, v40, v41
    v_mfma_f32_16x16x32_bf16 a[32:35], a[148:151], v[196:199], a[32:35]
    buffer_load_dwordx4 v16, s[48:51], s66 offen offset:2048 lds
    v_mfma_f32_16x16x32_bf16 a[32:35], a[152:155], v[200:203], a[32:35]
    ds_read_b64_tr_b16 a[130:131], v10 offset:4096
    v_cvt_pk_bf16_f32 v69, v42, v43
    v_mfma_f32_16x16x32_bf16 a[32:35], a[156:159], v[204:207], a[32:35]
    ds_read_b64_tr_b16 a[132:133], v10 offset:8192
    v_cvt_pk_bf16_f32 v70, v44, v45
    v_mfma_f32_16x16x32_bf16 a[48:51], a[240:243], v[204:207], a[48:51]
    ds_read_b64_tr_b16 a[134:135], v10 offset:12288
    v_cvt_pk_bf16_f32 v71, v46, v47
    v_mfma_f32_16x16x32_bf16 a[48:51], a[236:239], v[200:203], a[48:51]
    s_add_u32 s64, s69, 188416
    ds_read_b64_tr_b16 a[136:137], v10 offset:16384
    v_accvgpr_read_b32 v54, a200
    v_accvgpr_read_b32 v50, a201
    v_add_f32 v54, v54, v50
    v_mfma_f32_16x16x32_bf16 a[48:51], a[232:235], v[196:199], a[48:51]
    buffer_store_dwordx4 v[68:71], v1, s[28:31], s64 offen offset:0 sc1
    v_mfma_f32_16x16x32_bf16 a[48:51], a[228:231], v[192:195], a[48:51]
    buffer_load_dwordx4 v17, s[48:51], s66 offen offset:3072 lds
    v_mfma_f32_16x16x32_bf16 a[244:247], a[248:251], v[68:71], a[244:247]
    s_add_u32 m0, s60, 16384
    ds_read_b64_tr_b16 a[138:139], v10 offset:20480
    v_rcp_f32 v50, v54
    v_accvgpr_read_b32 v32, a8
    v_accvgpr_read_b32 v33, a9
    v_mfma_f32_16x16x32_bf16 a[52:55], a[228:231], v[208:211], a[52:55]
    s_waitcnt vmcnt(11)
    ds_read_b64_tr_b16 a[140:141], v10 offset:24576
    v_accvgpr_read_b32 v34, a10
    v_accvgpr_read_b32 v35, a11
    v_accvgpr_read_b32 v36, a24
    v_mfma_f32_16x16x32_bf16 a[52:55], a[232:235], v[212:215], a[52:55]
    s_barrier
    ds_read_b64_tr_b16 a[142:143], v10 offset:28672
    v_accvgpr_read_b32 v37, a25
    v_accvgpr_read_b32 v38, a26
    v_accvgpr_read_b32 v39, a27
    v_mfma_f32_16x16x32_bf16 a[52:55], a[236:239], v[216:219], a[52:55]
    s_add_u32 s62, s61, s8
    s_waitcnt vmcnt(10)
    v_cmp_gt_u32 vcc, v31, v29
    s_nop 0
    s_cmp_eq_u64 vcc, 0
    s_cbranch_scc0 L_spin_h
L_back_h:
    v_mul_f32 v32, v32, v50
    v_mul_f32 v33, v33, v50
    v_mfma_f32_16x16x32_bf16 a[52:55], a[240:243], v[220:223], a[52:55]
    buffer_load_dwordx4 v1, s[28:31], s62 offen offset:0 sc1 lds
    v_mfma_f32_16x16x32_bf16 a[36:39], a[156:159], v[220:223], a[36:39]
    ds_read_b64_tr_b16 a[212:213], v10 offset:32768
    v_mul_f32 v34, v34, v50
    v_mul_f32 v35, v35, v50
    v_mfma_f32_16x16x32_bf16 a[36:39], a[152:155], v[216:219], a[36:39]
    ds_read_b64_tr_b16 a[214:215], v10 offset:36864
    v_mul_f32 v36, v36, v50
    v_mul_f32 v37, v37, v50
    v_mfma_f32_16x16x32_bf16 a[36:39], a[148:151], v[212:215], a[36:39]
    ds_read_b64_tr_b16 a[216:217], v10 offset:40960
    v_mul_f32 v38, v38, v50
    v_mul_f32 v39, v39, v50
    v_mfma_f32_16x16x32_bf16 a[36:39], a[144:147], v[208:211], a[36:39]
    ds_read_b64_tr_b16 a[218:219], v10 offset:45056
    v_cvt_pk_bf16_f32 v72, v32, v33
    v_cvt_pk_bf16_f32 v73, v34, v35
    v_mfma_f32_16x16x32_bf16 a[40:43], a[144:147], v[224:227], a[40:43]
    buffer_load_dwordx4 v1, s[28:31], s62 offen offset:1024 sc1 lds
    v_mfma_f32_16x16x32_bf16 a[40:43], a[148:151], v[228:231], a[40:43]
    ds_read_b64_tr_b16 a[220:221], v10 offset:49152
    v_cvt_pk_bf16_f32 v74, v36, v37
    v_cvt_pk_bf16_f32 v75, v38, v39
    v_mfma_f32_16x16x32_bf16 a[40:43], a[152:155], v[232:235], a[40:43]
    s_add_u32 s64, s69, 376832
    ds_read_b64_tr_b16 a[222:223], v10 offset:53248
    v_accvgpr_read_b32 v55, a204
    v_accvgpr_read_b32 v51, a205
    v_mfma_f32_16x16x32_bf16 a[40:43], a[156:159], v[236:239], a[40:43]
    buffer_store_dwordx4 v[72:75], v1, s[28:31], s64 offen offset:0 sc1
    v_mfma_f32_16x16x32_bf16 a[56:59], a[240:243], v[236:239], a[56:59]
    ds_read_b64_tr_b16 a[224:225], v10 offset:57344
    v_add_f32 v55, v55, v51
    v_rcp_f32 v51, v55
    v_mfma_f32_16x16x32_bf16 a[56:59], a[236:239], v[232:235], a[56:59]
    buffer_load_dwordx4 v30, s[28:31], s62 offen offset:2048 sc1 lds
    v_mfma_f32_16x16x32_bf16 a[56:59], a[232:235], v[228:231], a[56:59]
    ds_read_b64_tr_b16 a[226:227], v10 offset:61440
    v_accvgpr_read_b32 v44, a28
    v_accvgpr_read_b32 v45, a29
    v_mfma_f32_16x16x32_bf16 a[56:59], a[228:231], v[224:227], a[56:59]
    v_accvgpr_read_b32 v46, a30
    v_accvgpr_read_b32 v47, a31
    v_accvgpr_read_b32 v40, a12
    v_mfma_f32_16x16x32_bf16 a[244:247], a[248:251], v[72:75], a[244:247]
    v_accvgpr_read_b32 v41, a13
    v_accvgpr_read_b32 v42, a14
    v_accvgpr_read_b32 v43, a15
    v_mfma_f32_16x16x32_bf16 a[60:63], a[228:231], v[240:243], a[60:63]
    v_mul_f32 v44, v44, v51
    v_mul_f32 v45, v45, v51
    v_mul_f32 v46, v46, v51
    v_mfma_f32_16x16x32_bf16 a[60:63], a[232:235], v[244:247], a[60:63]
    buffer_load_dwordx4 v30, s[28:31], s62 offen offset:3072 sc1 lds
    v_mfma_f32_16x16x32_bf16 a[60:63], a[236:239], v[248:251], a[60:63]
    v_mul_f32 v47, v47, v51
    v_mul_f32 v40, v40, v51
    v_mul_f32 v41, v41, v51
    v_mfma_f32_16x16x32_bf16 a[60:63], a[240:243], v[252:255], a[60:63]
    v_mul_f32 v42, v42, v51
    v_mul_f32 v43, v43, v51
    v_mfma_f32_16x16x32_bf16 a[44:47], a[156:159], v[252:255], a[44:47]
    s_add_u32 m0, s60, 49152
    v_cvt_pk_bf16_f32 v76, v40, v41
    v_cvt_pk_bf16_f32 v77, v42, v43
    v_mfma_f32_16x16x32_bf16 a[44:47], a[152:155], v[248:251], a[44:47]
    s_add_u32 s62, s61, s9
    v_cvt_pk_bf16_f32 v78, v44, v45
    v_cvt_pk_bf16_f32 v79, v46, v47
    v_mfma_f32_16x16x32_bf16 a[44:47], a[148:151], v[244:247], a[44:47]
    s_add_u32 s64, s69, 565248
    buffer_load_dwordx4 v1, s[28:31], s62 offen offset:0 sc1 lds
    v_mfma_f32_16x16x32_bf16 a[44:47], a[144:147], v[240:243], a[44:47]
    s_waitcnt lgkmcnt(0)
    ds_read_b64_tr_b16 a[0:1], v27 offset:0
    ds_read_b64_tr_b16 a[2:3], v27 offset:4096
    v_accvgpr_read_b32 v32, a32
    v_accvgpr_read_b32 v33, a33
    v_mfma_f32_16x16x32_bf16 a[64:67], a[128:131], v[128:131], a[64:67]
    buffer_store_dwordx4 v[76:79], v1, s[28:31], s64 offen offset:0 sc1
    v_mfma_f32_16x16x32_bf16 a[64:67], a[132:135], v[132:135], a[64:67]
    ds_read_b64_tr_b16 a[144:145], v11 offset:0
    ds_read_b64_tr_b16 a[4:5], v28 offset:0
    v_accvgpr_read_b32 v34, a34
    v_accvgpr_read_b32 v35, a35
    v_mfma_f32_16x16x32_bf16 a[64:67], a[136:139], v[136:139], a[64:67]
    ds_read_b64_tr_b16 a[146:147], v11 offset:4096
    ds_read_b64_tr_b16 a[6:7], v28 offset:4096
    v_accvgpr_read_b32 v36, a48
    v_accvgpr_read_b32 v37, a49
    v_mfma_f32_16x16x32_bf16 a[64:67], a[140:143], v[140:143], a[64:67]
    buffer_load_dwordx4 v1, s[28:31], s62 offen offset:1024 sc1 lds
    v_mfma_f32_16x16x32_bf16 a[64:67], a[212:215], v[192:195], a[64:67]
    ds_read_b64_tr_b16 a[148:149], v11 offset:8192
    ds_read_b64_tr_b16 a[8:9], v27 offset:8192
    v_accvgpr_read_b32 v38, a50
    v_accvgpr_read_b32 v39, a51
    v_mfma_f32_16x16x32_bf16 a[64:67], a[216:219], v[196:199], a[64:67]
    ds_read_b64_tr_b16 a[150:151], v11 offset:12288
    ds_read_b64_tr_b16 a[10:11], v27 offset:12288
    v_mul_f32 v32, v32, v48
    v_mul_f32 v33, v33, v48
    v_mfma_f32_16x16x32_bf16 a[64:67], a[220:223], v[200:203], a[64:67]
    ds_read_b64_tr_b16 a[152:153], v11 offset:16384
    ds_read_b64_tr_b16 a[12:13], v28 offset:8192
    v_mul_f32 v34, v34, v48
    v_mul_f32 v35, v35, v48
    v_mfma_f32_16x16x32_bf16 a[64:67], a[224:227], v[204:207], a[64:67]
    ds_read_b64_tr_b16 a[154:155], v11 offset:20480
    ds_read_b64_tr_b16 a[14:15], v28 offset:12288
    v_mul_f32 v36, v36, v48
    v_mul_f32 v37, v37, v48
    v_mfma_f32_16x16x32_bf16 a[244:247], a[248:251], v[76:79], a[244:247]
    buffer_load_dwordx4 v30, s[28:31], s62 offen offset:2048 sc1 lds
    v_mfma_f32_16x16x32_bf16 a[68:71], a[224:227], v[220:223], a[68:71]
    ds_read_b64_tr_b16 a[156:157], v11 offset:24576
    ds_read_b64_tr_b16 a[16:17], v27 offset:16384
    v_mul_f32 v38, v38, v48
    v_mul_f32 v39, v39, v48
    v_mfma_f32_16x16x32_bf16 a[68:71], a[220:223], v[216:219], a[68:71]
    ds_read_b64_tr_b16 a[158:159], v11 offset:28672
    ds_read_b64_tr_b16 a[18:19], v27 offset:20480
    v_cvt_pk_bf16_f32 v80, v32, v33
    v_cvt_pk_bf16_f32 v81, v34, v35
    v_mfma_f32_16x16x32_bf16 a[68:71], a[216:219], v[212:215], a[68:71]
    ds_read_b64_tr_b16 a[228:229], v11 offset:32768
    ds_read_b64_tr_b16 a[20:21], v28 offset:16384
    v_cvt_pk_bf16_f32 v82, v36, v37
    v_mfma_f32_16x16x32_bf16 a[68:71], a[212:215], v[208:211], a[68:71]
    ds_read_b64_tr_b16 a[230:231], v11 offset:36864
    ds_read_b64_tr_b16 a[22:23], v28 offset:20480
    v_cvt_pk_bf16_f32 v83, v38, v39
    v_mfma_f32_16x16x32_bf16 a[68:71], a[140:143], v[156:159], a[68:71]
    buffer_load_dwordx4 v30, s[28:31], s62 offen offset:3072 sc1 lds
    v_mfma_f32_16x16x32_bf16 a[68:71], a[136:139], v[152:155], a[68:71]
    s_add_u32 s64, s69, 0
    ds_read_b64_tr_b16 a[232:233], v11 offset:40960
    ds_read_b64_tr_b16 a[24:25], v27 offset:24576
    v_accvgpr_read_b32 v44, a52
    v_mfma_f32_16x16x32_bf16 a[68:71], a[132:135], v[148:151], a[68:71]
    buffer_store_dwordx4 v[80:83], v1, s[28:31], s64 offen offset:1024 sc1
    v_mfma_f32_16x16x32_bf16 a[68:71], a[128:131], v[144:147], a[68:71]
    ds_read_b64_tr_b16 a[234:235], v11 offset:45056
    ds_read_b64_tr_b16 a[26:27], v27 offset:28672
    v_accvgpr_read_b32 v45, a53
    v_mfma_f32_16x16x32_bf16 a[244:247], a[248:251], v[80:83], a[244:247]
    ds_read_b64_tr_b16 a[236:237], v11 offset:49152
    ds_read_b64_tr_b16 a[28:29], v28 offset:24576
    v_accvgpr_read_b32 v46, a54
    v_mfma_f32_16x16x32_bf16 a[72:75], a[128:131], v[160:163], a[72:75]
    ds_read_b64_tr_b16 a[238:239], v11 offset:53248
    ds_read_b64_tr_b16 a[30:31], v28 offset:28672
    v_accvgpr_read_b32 v47, a55
    v_mfma_f32_16x16x32_bf16 a[72:75], a[132:135], v[164:167], a[72:75]
    ds_read_b64_tr_b16 a[240:241], v11 offset:57344
    v_accvgpr_read_b32 v40, a36
    v_mfma_f32_16x16x32_bf16 a[72:75], a[136:139], v[168:171], a[72:75]
    ds_read_b64_tr_b16 a[242:243], v11 offset:61440
    v_accvgpr_read_b32 v41, a37
    v_mfma_f32_16x16x32_bf16 a[72:75], a[140:143], v[172:175], a[72:75]
    v_accvgpr_read_b32 v42, a38
    v_accvgpr_read_b32 v43, a39
    v_mfma_f32_16x16x32_bf16 a[72:75], a[212:215], v[224:227], a[72:75]
    v_mul_f32 v44, v44, v49
    v_mul_f32 v45, v45, v49
    v_mfma_f32_16x16x32_bf16 a[72:75], a[216:219], v[228:231], a[72:75]
    v_mul_f32 v46, v46, v49
    v_mul_f32 v47, v47, v49
    v_mfma_f32_16x16x32_bf16 a[72:75], a[220:223], v[232:235], a[72:75]
    v_mul_f32 v40, v40, v49
    v_mul_f32 v41, v41, v49
    v_mfma_f32_16x16x32_bf16 a[72:75], a[224:227], v[236:239], a[72:75]
    v_mul_f32 v42, v42, v49
    v_mul_f32 v43, v43, v49
    v_mfma_f32_16x16x32_bf16 a[76:79], a[224:227], v[252:255], a[76:79]
    s_waitcnt lgkmcnt(2)
    v_cvt_pk_bf16_f32 v84, v40, v41
    v_cvt_pk_bf16_f32 v85, v42, v43
    v_mfma_f32_16x16x32_bf16 a[76:79], a[220:223], v[248:251], a[76:79]
    s_barrier
    v_cvt_pk_bf16_f32 v86, v44, v45
    v_cvt_pk_bf16_f32 v87, v46, v47
    v_mfma_f32_16x16x32_bf16 a[76:79], a[216:219], v[244:247], a[76:79]
    s_add_u32 s64, s69, 188416
    v_accvgpr_read_b32 v32, a40
    v_accvgpr_read_b32 v33, a41
    v_accvgpr_read_b32 v34, a42
    v_mfma_f32_16x16x32_bf16 a[76:79], a[212:215], v[240:243], a[76:79]
    s_add_u32 m0, s60, 65536
    s_xor_b32 s66, s67, 262144
    buffer_store_dwordx4 v[84:87], v1, s[28:31], s64 offen offset:1024 sc1
    v_mfma_f32_16x16x32_bf16 a[76:79], a[140:143], v[188:191], a[76:79]
    buffer_load_dwordx4 v14, s[44:47], s66 offen offset:0 lds
    v_mfma_f32_16x16x32_bf16 a[76:79], a[136:139], v[184:187], a[76:79]
    v_accvgpr_read_b32 v35, a43
    v_accvgpr_read_b32 v36, a56
    v_accvgpr_read_b32 v37, a57
    v_mfma_f32_16x16x32_bf16 a[76:79], a[132:135], v[180:183], a[76:79]
    v_accvgpr_read_b32 v38, a58
    v_accvgpr_read_b32 v39, a59
    v_mul_f32 v32, v32, v50
    v_mfma_f32_16x16x32_bf16 a[76:79], a[128:131], v[176:179], a[76:79]
    v_mul_f32 v33, v33, v50
    v_mul_f32 v34, v34, v50
    v_mul_f32 v35, v35, v50
    v_mfma_f32_16x16x32_bf16 a[244:247], a[248:251], v[84:87], a[244:247]
    s_waitcnt lgkmcnt(0)
    v_mul_f32 v36, v36, v50
    v_mul_f32 v37, v37, v50
    v_mfma_f32_16x16x32_bf16 a[80:83], a[144:147], v[128:131], a[80:83]
    ds_read_b64_tr_b16 a[128:129], v12 offset:0
    v_mul_f32 v38, v38, v50
    v_mfma_f32_16x16x32_bf16 a[80:83], a[148:151], v[132:135], a[80:83]
    ds_read_b64_tr_b16 a[130:131], v12 offset:4096
    v_mul_f32 v39, v39, v50
    v_mfma_f32_16x16x32_bf16 a[80:83], a[152:155], v[136:139], a[80:83]
    ds_read_b64_tr_b16 a[132:133], v12 offset:8192
    v_cvt_pk_bf16_f32 v88, v32, v33
    v_mfma_f32_16x16x32_bf16 a[80:83], a[156:159], v[140:143], a[80:83]
    buffer_load_dwordx4 v15, s[44:47], s66 offen offset:1024 lds
    v_mfma_f32_16x16x32_bf16 a[80:83], a[228:231], v[192:195], a[80:83]
    ds_read_b64_tr_b16 a[134:135], v12 offset:12288
    v_cvt_pk_bf16_f32 v89, v34, v35
    v_mfma_f32_16x16x32_bf16 a[80:83], a[232:235], v[196:199], a[80:83]
    ds_read_b64_tr_b16 a[136:137], v12 offset:16384
    v_cvt_pk_bf16_f32 v90, v36, v37
    v_mfma_f32_16x16x32_bf16 a[80:83], a[236:239], v[200:203], a[80:83]
    ds_read_b64_tr_b16 a[138:139], v12 offset:20480
    v_cvt_pk_bf16_f32 v91, v38, v39
    v_mfma_f32_16x16x32_bf16 a[80:83], a[240:243], v[204:207], a[80:83]
    s_add_u32 s64, s69, 376832
    ds_read_b64_tr_b16 a[140:141], v12 offset:24576
    v_accvgpr_read_b32 v44, a60
    v_accvgpr_read_b32 v45, a61
    v_mfma_f32_16x16x32_bf16 a[84:87], a[240:243], v[220:223], a[84:87]
    buffer_store_dwordx4 v[88:91], v1, s[28:31], s64 offen offset:1024 sc1
    v_mfma_f32_16x16x32_bf16 a[84:87], a[236:239], v[216:219], a[84:87]
    ds_read_b64_tr_b16 a[142:143], v12 offset:28672
    v_accvgpr_read_b32 v46, a62
    v_accvgpr_read_b32 v47, a63
    v_mfma_f32_16x16x32_bf16 a[84:87], a[232:235], v[212:215], a[84:87]
    ds_read_b64_tr_b16 a[212:213], v12 offset:32768
    v_accvgpr_read_b32 v40, a44
    v_accvgpr_read_b32 v41, a45
    v_mfma_f32_16x16x32_bf16 a[84:87], a[228:231], v[208:211], a[84:87]
    buffer_load_dwordx4 v16, s[44:47], s66 offen offset:2048 lds
    v_mfma_f32_16x16x32_bf16 a[84:87], a[156:159], v[156:159], a[84:87]
    ds_read_b64_tr_b16 a[214:215], v12 offset:36864
    v_accvgpr_read_b32 v42, a46
    v_accvgpr_read_b32 v43, a47
    v_mfma_f32_16x16x32_bf16 a[84:87], a[152:155], v[152:155], a[84:87]
    ds_read_b64_tr_b16 a[216:217], v12 offset:40960
    v_mul_f32 v44, v44, v51
    v_mul_f32 v45, v45, v51
    v_mfma_f32_16x16x32_bf16 a[84:87], a[148:151], v[148:151], a[84:87]
    ds_read_b64_tr_b16 a[218:219], v12 offset:45056
    v_mul_f32 v46, v46, v51
    v_mul_f32 v47, v47, v51
    v_mfma_f32_16x16x32_bf16 a[84:87], a[144:147], v[144:147], a[84:87]
    ds_read_b64_tr_b16 a[220:221], v12 offset:49152
    v_mul_f32 v40, v40, v51
    v_mfma_f32_16x16x32_bf16 a[244:247], a[248:251], v[88:91], a[244:247]
    ds_read_b64_tr_b16 a[222:223], v12 offset:53248
    v_mul_f32 v41, v41, v51
    v_mfma_f32_16x16x32_bf16 a[88:91], a[144:147], v[160:163], a[88:91]
    ds_read_b64_tr_b16 a[224:225], v12 offset:57344
    v_mul_f32 v42, v42, v51
    v_mfma_f32_16x16x32_bf16 a[88:91], a[148:151], v[164:167], a[88:91]
    ds_read_b64_tr_b16 a[226:227], v12 offset:61440
    v_mul_f32 v43, v43, v51
    v_mfma_f32_16x16x32_bf16 a[88:91], a[152:155], v[168:171], a[88:91]
    buffer_load_dwordx4 v17, s[44:47], s66 offen offset:3072 lds
    v_mfma_f32_16x16x32_bf16 a[88:91], a[156:159], v[172:175], a[88:91]
    v_cvt_pk_bf16_f32 v92, v40, v41
    v_cvt_pk_bf16_f32 v93, v42, v43
    v_mfma_f32_16x16x32_bf16 a[88:91], a[228:231], v[224:227], a[88:91]
    v_cvt_pk_bf16_f32 v94, v44, v45
    v_cvt_pk_bf16_f32 v95, v46, v47
    v_mfma_f32_16x16x32_bf16 a[88:91], a[232:235], v[228:231], a[88:91]
    s_add_u32 s64, s69, 565248
    v_accvgpr_read_b32 v32, a64
    v_accvgpr_read_b32 v33, a65
    v_mfma_f32_16x16x32_bf16 a[88:91], a[236:239], v[232:235], a[88:91]
    buffer_store_dwordx4 v[92:95], v1, s[28:31], s64 offen offset:1024 sc1
    v_mfma_f32_16x16x32_bf16 a[88:91], a[240:243], v[236:239], a[88:91]
    v_accvgpr_read_b32 v34, a66
    v_accvgpr_read_b32 v35, a67
    v_mfma_f32_16x16x32_bf16 a[244:247], a[248:251], v[92:95], a[244:247]
    s_add_u32 m0, s60, 81920
    v_accvgpr_read_b32 v36, a80
    v_accvgpr_read_b32 v37, a81
    v_mfma_f32_16x16x32_bf16 a[92:95], a[240:243], v[252:255], a[92:95]
    s_xor_b32 s66, s67, 327680
    v_accvgpr_read_b32 v38, a82
    v_accvgpr_read_b32 v39, a83
    v_mfma_f32_16x16x32_bf16 a[92:95], a[236:239], v[248:251], a[92:95]
    buffer_load_dwordx4 v14, s[44:47], s66 offen offset:0 lds
    v_mfma_f32_16x16x32_bf16 a[92:95], a[232:235], v[244:247], a[92:95]
    v_mul_f32 v32, v32, v48
    v_mul_f32 v33, v33, v48
    v_mfma_f32_16x16x32_bf16 a[92:95], a[228:231], v[240:243], a[92:95]
    v_mul_f32 v34, v34, v48
    v_mul_f32 v35, v35, v48
    v_mfma_f32_16x16x32_bf16 a[92:95], a[156:159], v[188:191], a[92:95]
    v_mul_f32 v36, v36, v48
    v_mul_f32 v37, v37, v48
    v_mfma_f32_16x16x32_bf16 a[92:95], a[152:155], v[184:187], a[92:95]
    v_mul_f32 v38, v38, v48
    v_mul_f32 v39, v39, v48
    v_mfma_f32_16x16x32_bf16 a[92:95], a[148:151], v[180:183], a[92:95]
    v_cvt_pk_bf16_f32 v96, v32, v33
    v_cvt_pk_bf16_f32 v97, v34, v35
    v_mfma_f32_16x16x32_bf16 a[92:95], a[144:147], v[176:179], a[92:95]
    s_waitcnt lgkmcnt(0)
    v_cvt_pk_bf16_f32 v98, v36, v37
    v_cvt_pk_bf16_f32 v99, v38, v39
    v_mfma_f32_16x16x32_bf16 a[96:99], a[128:131], v[128:131], a[96:99]
    ds_read_b64_tr_b16 a[144:145], v13 offset:0
    v_mfma_f32_16x16x32_bf16 a[96:99], a[132:135], v[132:135], a[96:99]
    buffer_load_dwordx4 v15, s[44:47], s66 offen offset:1024 lds
    v_mfma_f32_16x16x32_bf16 a[96:99], a[136:139], v[136:139], a[96:99]
    s_add_u32 s64, s69, 0
    ds_read_b64_tr_b16 a[146:147], v13 offset:4096
    v_accvgpr_read_b32 v40, a68
    v_accvgpr_read_b32 v41, a69
    v_mfma_f32_16x16x32_bf16 a[96:99], a[140:143], v[140:143], a[96:99]
    buffer_store_dwordx4 v[96:99], v1, s[28:31], s64 offen offset:2048 sc1
    v_mfma_f32_16x16x32_bf16 a[96:99], a[212:215], v[192:195], a[96:99]
    ds_read_b64_tr_b16 a[148:149], v13 offset:8192
    v_accvgpr_read_b32 v42, a70
    v_accvgpr_read_b32 v43, a71
    v_mfma_f32_16x16x32_bf16 a[96:99], a[216:219], v[196:199], a[96:99]
    ds_read_b64_tr_b16 a[150:151], v13 offset:12288
    v_accvgpr_read_b32 v44, a84
    v_accvgpr_read_b32 v45, a85
    v_mfma_f32_16x16x32_bf16 a[96:99], a[220:223], v[200:203], a[96:99]
    ds_read_b64_tr_b16 a[152:153], v13 offset:16384
    v_accvgpr_read_b32 v46, a86
    v_accvgpr_read_b32 v47, a87
    v_mfma_f32_16x16x32_bf16 a[96:99], a[224:227], v[204:207], a[96:99]
    ds_read_b64_tr_b16 a[154:155], v13 offset:20480
    v_mul_f32 v40, v40, v49
    v_mul_f32 v41, v41, v49
    v_mfma_f32_16x16x32_bf16 a[244:247], a[248:251], v[96:99], a[244:247]
    ds_read_b64_tr_b16 a[156:157], v13 offset:24576
    v_mul_f32 v42, v42, v49
    v_mul_f32 v43, v43, v49
    v_mfma_f32_16x16x32_bf16 a[100:103], a[224:227], v[220:223], a[100:103]
    buffer_load_dwordx4 v16, s[44:47], s66 offen offset:2048 lds
    v_mfma_f32_16x16x32_bf16 a[100:103], a[220:223], v[216:219], a[100:103]
    ds_read_b64_tr_b16 a[158:159], v13 offset:28672
    v_mul_f32 v44, v44, v49
    v_mul_f32 v45, v45, v49
    v_mfma_f32_16x16x32_bf16 a[100:103], a[216:219], v[212:215], a[100:103]
    ds_read_b64_tr_b16 a[228:229], v13 offset:32768
    v_mul_f32 v46, v46, v49
    v_mul_f32 v47, v47, v49
    v_mfma_f32_16x16x32_bf16 a[100:103], a[212:215], v[208:211], a[100:103]
    ds_read_b64_tr_b16 a[230:231], v13 offset:36864
    v_cvt_pk_bf16_f32 v100, v40, v41
    v_mfma_f32_16x16x32_bf16 a[100:103], a[140:143], v[156:159], a[100:103]
    ds_read_b64_tr_b16 a[232:233], v13 offset:40960
    v_cvt_pk_bf16_f32 v101, v42, v43
    v_mfma_f32_16x16x32_bf16 a[100:103], a[136:139], v[152:155], a[100:103]
    ds_read_b64_tr_b16 a[234:235], v13 offset:45056
    v_cvt_pk_bf16_f32 v102, v44, v45
    v_mfma_f32_16x16x32_bf16 a[100:103], a[132:135], v[148:151], a[100:103]
    ds_read_b64_tr_b16 a[236:237], v13 offset:49152
    v_cvt_pk_bf16_f32 v103, v46, v47
    v_mfma_f32_16x16x32_bf16 a[100:103], a[128:131], v[144:147], a[100:103]
    s_add_u32 s64, s69, 188416
    ds_read_b64_tr_b16 a[238:239], v13 offset:53248
    v_accvgpr_read_b32 v32, a72
    v_mfma_f32_16x16x32_bf16 a[104:107], a[128:131], v[160:163], a[104:107]
    buffer_store_dwordx4 v[100:103], v1, s[28:31], s64 offen offset:2048 sc1
    v_mfma_f32_16x16x32_bf16 a[104:107], a[132:135], v[164:167], a[104:107]
    buffer_load_dwordx4 v17, s[44:47], s66 offen offset:3072 lds
    v_mfma_f32_16x16x32_bf16 a[104:107], a[136:139], v[168:171], a[104:107]
    ds_read_b64_tr_b16 a[240:241], v13 offset:57344
    v_accvgpr_read_b32 v33, a73
    v_mfma_f32_16x16x32_bf16 a[104:107], a[140:143], v[172:175], a[104:107]
    ds_read_b64_tr_b16 a[242:243], v13 offset:61440
    v_accvgpr_read_b32 v34, a74
    v_mfma_f32_16x16x32_bf16 a[104:107], a[212:215], v[224:227], a[104:107]
    v_accvgpr_read_b32 v35, a75
    v_accvgpr_read_b32 v36, a88
    v_mfma_f32_16x16x32_bf16 a[104:107], a[216:219], v[228:231], a[104:107]
    v_accvgpr_read_b32 v37, a89
    v_accvgpr_read_b32 v38, a90
    v_mfma_f32_16x16x32_bf16 a[104:107], a[220:223], v[232:235], a[104:107]
    v_accvgpr_read_b32 v39, a91
    v_mul_f32 v32, v32, v50
    v_mfma_f32_16x16x32_bf16 a[104:107], a[224:227], v[236:239], a[104:107]
    v_mul_f32 v33, v33, v50
    v_mul_f32 v34, v34, v50
    v_mfma_f32_16x16x32_bf16 a[244:247], a[248:251], v[100:103], a[244:247]
    v_mul_f32 v35, v35, v50
    v_mul_f32 v36, v36, v50
    v_mfma_f32_16x16x32_bf16 a[108:111], a[224:227], v[252:255], a[108:111]
    v_mul_f32 v37, v37, v50
    v_mul_f32 v38, v38, v50
    v_mfma_f32_16x16x32_bf16 a[108:111], a[220:223], v[248:251], a[108:111]
    v_mul_f32 v39, v39, v50
    v_cvt_pk_bf16_f32 v104, v32, v33
    v_mfma_f32_16x16x32_bf16 a[108:111], a[216:219], v[244:247], a[108:111]
    v_cvt_pk_bf16_f32 v105, v34, v35
    v_cvt_pk_bf16_f32 v106, v36, v37
    v_mfma_f32_16x16x32_bf16 a[108:111], a[212:215], v[240:243], a[108:111]
    v_cvt_pk_bf16_f32 v107, v38, v39
    v_mfma_f32_16x16x32_bf16 a[108:111], a[140:143], v[188:191], a[108:111]
    s_add_u32 s64, s69, 376832
    v_accvgpr_read_b32 v40, a76
    v_accvgpr_read_b32 v41, a77
    v_mfma_f32_16x16x32_bf16 a[108:111], a[136:139], v[184:187], a[108:111]
    buffer_store_dwordx4 v[104:107], v1, s[28:31], s64 offen offset:2048 sc1
    v_mfma_f32_16x16x32_bf16 a[108:111], a[132:135], v[180:183], a[108:111]
    v_accvgpr_read_b32 v42, a78
    v_accvgpr_read_b32 v43, a79
    v_mfma_f32_16x16x32_bf16 a[108:111], a[128:131], v[176:179], a[108:111]
    v_accvgpr_read_b32 v44, a92
    v_accvgpr_read_b32 v45, a93
    v_mfma_f32_16x16x32_bf16 a[244:247], a[248:251], v[104:107], a[244:247]
    s_waitcnt lgkmcnt(0)
    v_accvgpr_read_b32 v46, a94
    v_accvgpr_read_b32 v47, a95
    v_mfma_f32_16x16x32_bf16 a[112:115], a[144:147], v[128:131], a[112:115]
    s_barrier
    v_mul_f32 v40, v40, v51
    v_mul_f32 v41, v41, v51
    v_mfma_f32_16x16x32_bf16 a[112:115], a[148:151], v[132:135], a[112:115]
    s_add_u32 m0, s60, 98304
    v_mul_f32 v42, v42, v51
    v_mul_f32 v43, v43, v51
    v_mfma_f32_16x16x32_bf16 a[112:115], a[152:155], v[136:139], a[112:115]
    s_lshl_b32 s66, s10, 5
    v_mul_f32 v44, v44, v51
    v_mul_f32 v45, v45, v51
    v_mfma_f32_16x16x32_bf16 a[112:115], a[156:159], v[140:143], a[112:115]
    s_add_u32 s66, s66, s68
    v_mul_f32 v46, v46, v51
    v_mfma_f32_16x16x32_bf16 a[112:115], a[228:231], v[192:195], a[112:115]
    buffer_load_dwordx4 v14, s[48:51], s66 offen offset:0 lds
    v_mfma_f32_16x16x32_bf16 a[112:115], a[232:235], v[196:199], a[112:115]
    v_mul_f32 v47, v47, v51
    v_mfma_f32_16x16x32_bf16 a[112:115], a[236:239], v[200:203], a[112:115]
    v_cvt_pk_bf16_f32 v108, v40, v41
    v_mfma_f32_16x16x32_bf16 a[112:115], a[240:243], v[204:207], a[112:115]
    v_cvt_pk_bf16_f32 v109, v42, v43
    v_mfma_f32_16x16x32_bf16 a[116:119], a[240:243], v[220:223], a[116:119]
    v_cvt_pk_bf16_f32 v110, v44, v45
    v_mfma_f32_16x16x32_bf16 a[116:119], a[236:239], v[216:219], a[116:119]
    v_cvt_pk_bf16_f32 v111, v46, v47
    v_mfma_f32_16x16x32_bf16 a[116:119], a[232:235], v[212:215], a[116:119]
    s_add_u32 s64, s69, 565248
    v_accvgpr_read_b32 v32, a96
    v_accvgpr_read_b32 v33, a97
    v_accvgpr_read_b32 v34, a98
    v_mfma_f32_16x16x32_bf16 a[116:119], a[228:231], v[208:211], a[116:119]
    buffer_store_dwordx4 v[108:111], v1, s[28:31], s64 offen offset:2048 sc1
    v_mfma_f32_16x16x32_bf16 a[116:119], a[156:159], v[156:159], a[116:119]
    buffer_load_dwordx4 v15, s[48:51], s66 offen offset:1024 lds
    v_mfma_f32_16x16x32_bf16 a[116:119], a[152:155], v[152:155], a[116:119]
    v_accvgpr_read_b32 v35, a99
    v_accvgpr_read_b32 v36, a112
    v_accvgpr_read_b32 v37, a113
    v_mfma_f32_16x16x32_bf16 a[116:119], a[148:151], v[148:151], a[116:119]
    v_accvgpr_read_b32 v38, a114
    v_accvgpr_read_b32 v39, a115
    v_mul_f32 v32, v32, v48
    v_mfma_f32_16x16x32_bf16 a[116:119], a[144:147], v[144:147], a[116:119]
    v_mul_f32 v33, v33, v48
    v_mul_f32 v34, v34, v48
    v_mul_f32 v35, v35, v48
    v_mfma_f32_16x16x32_bf16 a[244:247], a[248:251], v[108:111], a[244:247]
    v_mul_f32 v36, v36, v48
    v_mul_f32 v37, v37, v48
    v_mul_f32 v38, v38, v48
    v_mfma_f32_16x16x32_bf16 a[120:123], a[144:147], v[160:163], a[120:123]
    v_mul_f32 v39, v39, v48
    v_cvt_pk_bf16_f32 v112, v32, v33
    v_cvt_pk_bf16_f32 v113, v34, v35
    v_mfma_f32_16x16x32_bf16 a[120:123], a[148:151], v[164:167], a[120:123]
    v_cvt_pk_bf16_f32 v114, v36, v37
    v_cvt_pk_bf16_f32 v115, v38, v39
    v_mfma_f32_16x16x32_bf16 a[120:123], a[152:155], v[168:171], a[120:123]
    s_add_u32 s64, s69, 0
    buffer_load_dwordx4 v16, s[48:51], s66 offen offset:2048 lds
    v_mfma_f32_16x16x32_bf16 a[120:123], a[156:159], v[172:175], a[120:123]
    buffer_store_dwordx4 v[112:115], v1, s[28:31], s64 offen offset:3072 sc1
    v_mfma_f32_16x16x32_bf16 a[120:123], a[228:231], v[224:227], a[120:123]
    v_accvgpr_read_b32 v40, a100
    v_accvgpr_read_b32 v41, a101
    v_accvgpr_read_b32 v42, a102
    v_accvgpr_read_b32 v43, a103
    v_mfma_f32_16x16x32_bf16 a[120:123], a[232:235], v[228:231], a[120:123]
    v_accvgpr_read_b32 v44, a116
    v_accvgpr_read_b32 v45, a117
    v_accvgpr_read_b32 v46, a118
    v_accvgpr_read_b32 v47, a119
    v_mfma_f32_16x16x32_bf16 a[120:123], a[236:239], v[232:235], a[120:123]
    v_mul_f32 v40, v40, v49
    v_mul_f32 v41, v41, v49
    v_mul_f32 v42, v42, v49
    v_mul_f32 v43, v43, v49
    v_mfma_f32_16x16x32_bf16 a[120:123], a[240:243], v[236:239], a[120:123]
    v_mul_f32 v44, v44, v49
    v_mul_f32 v45, v45, v49
    v_mul_f32 v46, v46, v49
    v_mul_f32 v47, v47, v49
    v_mfma_f32_16x16x32_bf16 a[124:127], a[240:243], v[252:255], a[124:127]
    v_cvt_pk_bf16_f32 v116, v40, v41
    v_cvt_pk_bf16_f32 v117, v42, v43
    v_cvt_pk_bf16_f32 v118, v44, v45
    v_cvt_pk_bf16_f32 v119, v46, v47
    v_mfma_f32_16x16x32_bf16 a[124:127], a[236:239], v[248:251], a[124:127]
    buffer_load_dwordx4 v17, s[48:51], s66 offen offset:3072 lds
    v_mfma_f32_16x16x32_bf16 a[124:127], a[232:235], v[244:247], a[124:127]
    s_add_u32 s64, s69, 188416
    v_accvgpr_read_b32 v32, a104
    v_accvgpr_read_b32 v33, a105
    v_accvgpr_read_b32 v34, a106
    v_accvgpr_read_b32 v35, a107
    v_mfma_f32_16x16x32_bf16 a[124:127], a[228:231], v[240:243], a[124:127]
    buffer_store_dwordx4 v[116:119], v1, s[28:31], s64 offen offset:3072 sc1
    v_mfma_f32_16x16x32_bf16 a[124:127], a[156:159], v[188:191], a[124:127]
    v_accvgpr_read_b32 v36, a120
    v_accvgpr_read_b32 v37, a121
    v_accvgpr_read_b32 v38, a122
    v_accvgpr_read_b32 v39, a123
    v_mfma_f32_16x16x32_bf16 a[124:127], a[152:155], v[184:187], a[124:127]
    v_mul_f32 v32, v32, v50
    v_mul_f32 v33, v33, v50
    v_mul_f32 v34, v34, v50
    v_mul_f32 v35, v35, v50
    v_mfma_f32_16x16x32_bf16 a[124:127], a[148:151], v[180:183], a[124:127]
    v_mul_f32 v36, v36, v50
    v_mul_f32 v37, v37, v50
    v_mul_f32 v38, v38, v50
    v_mul_f32 v39, v39, v50
    v_mfma_f32_16x16x32_bf16 a[124:127], a[144:147], v[176:179], a[124:127]
    v_cvt_pk_bf16_f32 v120, v32, v33
    v_cvt_pk_bf16_f32 v121, v34, v35
    v_cvt_pk_bf16_f32 v122, v36, v37
    v_cvt_pk_bf16_f32 v123, v38, v39
    v_accvgpr_read_b32 v40, a108
    v_accvgpr_read_b32 v41, a109
    v_accvgpr_read_b32 v42, a110
    v_accvgpr_read_b32 v43, a111
    v_accvgpr_read_b32 v44, a124
    v_accvgpr_read_b32 v45, a125
    v_accvgpr_read_b32 v46, a126
    v_accvgpr_read_b32 v47, a127
    v_mfma_f32_16x16x32_bf16 a[244:247], a[248:251], v[112:115], a[244:247]
    v_mul_f32 v40, v40, v51
    v_mul_f32 v41, v41, v51
    v_mul_f32 v42, v42, v51
    v_mul_f32 v43, v43, v51
    v_mfma_f32_16x16x32_bf16 a[244:247], a[248:251], v[116:119], a[244:247]
    v_mul_f32 v44, v44, v51
    v_mul_f32 v45, v45, v51
    v_mul_f32 v46, v46, v51
    v_mul_f32 v47, v47, v51
    v_mfma_f32_16x16x32_bf16 a[244:247], a[248:251], v[120:123], a[244:247]
    v_cvt_pk_bf16_f32 v124, v40, v41
    v_cvt_pk_bf16_f32 v125, v42, v43
    v_cvt_pk_bf16_f32 v126, v44, v45
    v_cvt_pk_bf16_f32 v127, v46, v47
    s_add_u32 s64, s69, 376832
    buffer_store_dwordx4 v[120:123], v1, s[28:31], s64 offen offset:3072 sc1
    s_add_u32 s64, s69, 565248
    buffer_store_dwordx4 v[124:127], v1, s[28:31], s64 offen offset:3072 sc1
    v_mfma_f32_16x16x32_bf16 a[244:247], a[248:251], v[124:127], a[244:247]
    s_mov_b32 s65, 0x7b800000
    v_max3_f32 v24, v52, v53, v54
    v_max_f32 v24, v24, v55
    s_nop 4
    v_accvgpr_read_b32 v25, a244
    v_add_f32 v24, v24, v25
    v_cmp_nlt_f32 vcc, v24, s65
    s_nop 0
    s_cmp_lg_u64 vcc, 0
    s_cselect_b32 s65, 1, 0
    v_mov_b32 v24, s65
    v_and_b32 v25, 3, v0
    v_lshlrev_b32 v25, 12, v25
    s_add_u32 s65, s58, 28672
    s_lshl_b32 s65, s65, 2
    v_add_u32 v25, s65, v25
    ds_write_b32 v25, v24
    s_add_u32 s65, s60, 114688
    v_mov_b32 v25, s65
    s_lshl_b32 s65, s58, 6
    s_or_b32 s65, s65, 98304
    s_and_b32 s66, s93, 1
    s_lshl_b32 s66, s66, 12
    v_xor_b32 v6, s65, v6
    v_xor_b32 v7, s65, v7
    v_add_u32 v8, 65536, v6
    v_add_u32 v9, 65536, v7
    v_add_u32 v10, 131072, v6
    v_add_u32 v11, 131072, v7
    v_xor_b32 v48, s66, v6
    v_xor_b32 v50, 0x1000, v48
    v_xor_b32 v49, s66, v7
    v_xor_b32 v51, 0x1000, v49
    v_add_u32 v12, 0, v1
    v_xor_b32 v52, s66, v8
    v_xor_b32 v54, 0x1000, v52
    v_xor_b32 v53, s66, v9
    v_xor_b32 v55, 0x1000, v53
    v_add_u32 v13, 65536, v1
    v_xor_b32 v56, s66, v10
    v_xor_b32 v58, 0x1000, v56
    v_xor_b32 v57, s66, v11
    v_xor_b32 v59, 0x1000, v57
    v_add_u32 v20, 131072, v1
    s_waitcnt vmcnt(29) lgkmcnt(0)
    s_barrier
    ds_read_b128 v[2:5], v25
    ds_read_b64_tr_b16 v[32:33], v48 offset:0
    ds_read_b64_tr_b16 v[34:35], v50 offset:0
    ds_read_b64_tr_b16 v[36:37], v48 offset:8192
    ds_read_b64_tr_b16 v[38:39], v50 offset:8192
    ds_read_b64_tr_b16 v[40:41], v49 offset:0
    ds_read_b64_tr_b16 v[42:43], v51 offset:0
    ds_read_b64_tr_b16 v[44:45], v49 offset:8192
    ds_read_b64_tr_b16 v[46:47], v51 offset:8192
    ds_read_b128 v[64:67], v12 offset:16384
    ds_read_b128 v[68:71], v12 offset:17408
    ds_read_b128 v[72:75], v12 offset:18432
    ds_read_b128 v[76:79], v12 offset:19456
    ds_read_b128 v[80:83], v12 offset:20480
    ds_read_b128 v[84:87], v12 offset:21504
    ds_read_b128 v[88:91], v12 offset:22528
    ds_read_b128 v[92:95], v12 offset:23552
    ds_read_b128 v[96:99], v12 offset:24576
    ds_read_b128 v[100:103], v12 offset:25600
    ds_read_b128 v[104:107], v12 offset:26624
    ds_read_b128 v[108:111], v12 offset:27648
    ds_read_b128 v[112:115], v12 offset:28672
    ds_read_b128 v[116:119], v12 offset:29696
    ds_read_b128 v[120:123], v12 offset:30720
    ds_read_b128 v[124:127], v12 offset:31744
    s_waitcnt lgkmcnt(15)
    v_or_b32 v2, v2, v3
    v_or3_b32 v2, v2, v4, v5
    s_nop 0
    v_readfirstlane_b32 s65, v2
    s_nop 0
    s_andn2_b32 s65, s65, s70
    s_cmp_lg_u32 s65, 0
    s_cbranch_scc1 L_fallback
    s_add_u32 m0, s60, 114688
    s_add_u32 s62, s61, s10
    buffer_load_dwordx4 v1, s[28:31], s62 offen offset:0 sc1 lds
    buffer_load_dwordx4 v1, s[28:31], s62 offen offset:1024 sc1 lds
    buffer_load_dwordx4 v30, s[28:31], s62 offen offset:2048 sc1 lds
    buffer_load_dwordx4 v30, s[28:31], s62 offen offset:3072 sc1 lds
    s_add_u32 m0, s60, 131072
    s_xor_b32 s66, s67, 393216
    buffer_load_dwordx4 v14, s[44:47], s66 offen offset:0 lds
    buffer_load_dwordx4 v15, s[44:47], s66 offen offset:1024 lds
    buffer_load_dwordx4 v16, s[44:47], s66 offen offset:2048 lds
    buffer_load_dwordx4 v17, s[44:47], s66 offen offset:3072 lds
    s_add_u32 m0, s60, 147456
    s_xor_b32 s66, s67, 458752
    buffer_load_dwordx4 v14, s[44:47], s66 offen offset:0 lds
    buffer_load_dwordx4 v15, s[44:47], s66 offen offset:1024 lds
    buffer_load_dwordx4 v16, s[44:47], s66 offen offset:2048 lds
    buffer_load_dwordx4 v17, s[44:47], s66 offen offset:3072 lds
    s_and_b32 s65, s56, 7
    s_mul_i32 s65, s65, 124
    s_sub_u32 s65, 32768, s65
    v_add_u32 v26, s65, v21
    v_mov_b32 v25, 1
    v_and_b32 v23, 7, v0
    s_lshr_b32 s65, s93, 1
    s_lshl_b32 s65, s65, 2
    s_add_u32 s65, s65, s95
    s_lshl_b32 s65, s65, 10
    s_add_u32 s65, s65, 65536
    v_lshl_add_u32 v23, v23, 2, s65
    s_add_u32 s100, s36, s65
    s_addc_u32 s101, s37, 0
    v_and_b32 v27, 3, v0
    v_lshlrev_b32 v27, 4, v27
    v_bfe_u32 v24, v0, 2, 4
    v_lshl_add_u32 v27, v24, 10, v27
    s_waitcnt lgkmcnt(0)
    v_mfma_f32_16x16x32_bf16 v[192:195], v[32:35], v[64:67], 0
    s_waitcnt vmcnt(12)
    v_mfma_f32_16x16x32_bf16 v[192:195], v[36:39], v[68:71], v[192:195]
    s_barrier
    v_mfma_f32_16x16x32_bf16 v[196:199], v[44:47], v[68:71], 0
    ds_read_b64_tr_b16 a[224:225], v48 offset:32768
    ds_read_b64_tr_b16 a[226:227], v50 offset:32768
    v_mfma_f32_16x16x32_bf16 v[196:199], v[40:43], v[64:67], v[196:199]
    buffer_store_dword v25, v26, s[36:39], 0 offen sc1
    ds_read_b64_tr_b16 a[228:229], v48 offset:40960
    v_mfma_f32_16x16x32_bf16 v[204:207], v[40:43], v[72:75], 0
    s_add_u32 m0, s60, 0
    ds_read_b64_tr_b16 a[230:231], v50 offset:40960
    ds_read_b64_tr_b16 a[232:233], v49 offset:32768
    v_mfma_f32_16x16x32_bf16 v[204:207], v[44:47], v[76:79], v[204:207]
    s_lshl_b32 s66, s11, 5
    ds_read_b64_tr_b16 a[234:235], v51 offset:32768
    ds_read_b64_tr_b16 a[236:237], v49 offset:40960
    v_mfma_f32_16x16x32_bf16 v[200:203], v[36:39], v[76:79], 0
    s_add_u32 s66, s66, s68
    ds_read_b64_tr_b16 a[238:239], v51 offset:40960
    ds_read_b128 v[128:131], v12 offset:49152
    v_mfma_f32_16x16x32_bf16 v[200:203], v[32:35], v[72:75], v[200:203]
    buffer_load_dwordx4 v14, s[48:51], s66 offen offset:0 lds
    ds_read_b128 v[132:135], v12 offset:50176
    v_mfma_f32_16x16x32_bf16 v[208:211], v[32:35], v[80:83], 0
    ds_read_b128 v[136:139], v12 offset:51200
    ds_read_b128 v[140:143], v12 offset:52224
    v_mfma_f32_16x16x32_bf16 v[208:211], v[36:39], v[84:87], v[208:211]
    buffer_load_dwordx4 v15, s[48:51], s66 offen offset:1024 lds
    ds_read_b128 v[144:147], v12 offset:53248
    v_mfma_f32_16x16x32_bf16 v[212:215], v[44:47], v[84:87], 0
    ds_read_b128 v[148:151], v12 offset:54272
    ds_read_b128 v[152:155], v12 offset:55296
    v_mfma_f32_16x16x32_bf16 v[212:215], v[40:43], v[80:83], v[212:215]
    ds_read_b128 v[156:159], v12 offset:56320
    ds_read_b128 v[160:163], v12 offset:57344
    v_mfma_f32_16x16x32_bf16 v[220:223], v[40:43], v[88:91], 0
    buffer_load_dwordx4 v16, s[48:51], s66 offen offset:2048 lds
    ds_read_b128 v[164:167], v12 offset:58368
    v_mfma_f32_16x16x32_bf16 v[220:223], v[44:47], v[92:95], v[220:223]
    ds_read_b128 v[168:171], v12 offset:59392
    ds_read_b128 v[172:175], v12 offset:60416
    v_mfma_f32_16x16x32_bf16 v[216:219], v[36:39], v[92:95], 0
    ds_read_b128 v[176:179], v12 offset:61440
    ds_read_b128 v[180:183], v12 offset:62464
    v_mfma_f32_16x16x32_bf16 v[216:219], v[32:35], v[88:91], v[216:219]
    ds_read_b128 v[184:187], v12 offset:63488
    ds_read_b128 v[188:191], v12 offset:64512
    v_mfma_f32_16x16x32_bf16 v[224:227], v[32:35], v[96:99], 0
    buffer_load_dwordx4 v17, s[48:51], s66 offen offset:3072 lds
    ds_read_b64_tr_b16 a[32:33], v8 offset:0
    v_mfma_f32_16x16x32_bf16 v[224:227], v[36:39], v[100:103], v[224:227]
    s_add_u32 m0, s60, 16384
    ds_read_b64_tr_b16 a[34:35], v8 offset:4096
    ds_read_b64_tr_b16 a[36:37], v9 offset:0
    v_mfma_f32_16x16x32_bf16 v[228:231], v[44:47], v[100:103], 0
    s_add_u32 s62, s61, s11
    ds_read_b64_tr_b16 a[38:39], v9 offset:4096
    ds_read_b64_tr_b16 a[40:41], v8 offset:8192
    v_mfma_f32_16x16x32_bf16 v[228:231], v[40:43], v[96:99], v[228:231]
    buffer_load_dwordx4 v1, s[28:31], s62 offen offset:0 sc1 lds
    ds_read_b64_tr_b16 a[42:43], v8 offset:12288
    v_mfma_f32_16x16x32_bf16 v[236:239], v[40:43], v[104:107], 0
    ds_read_b64_tr_b16 a[44:45], v9 offset:8192
    ds_read_b64_tr_b16 a[46:47], v9 offset:12288
    v_mfma_f32_16x16x32_bf16 v[236:239], v[44:47], v[108:111], v[236:239]
    ds_read_b64_tr_b16 a[48:49], v8 offset:16384
    ds_read_b64_tr_b16 a[50:51], v8 offset:20480
    v_mfma_f32_16x16x32_bf16 v[232:235], v[36:39], v[108:111], 0
    buffer_load_dwordx4 v1, s[28:31], s62 offen offset:1024 sc1 lds
    ds_read_b64_tr_b16 a[52:53], v9 offset:16384
    v_mfma_f32_16x16x32_bf16 v[232:235], v[32:35], v[104:107], v[232:235]
    ds_read_b64_tr_b16 a[54:55], v9 offset:20480
    ds_read_b64_tr_b16 a[56:57], v8 offset:24576
    v_mfma_f32_16x16x32_bf16 v[240:243], v[32:35], v[112:115], 0
    ds_read_b64_tr_b16 a[58:59], v8 offset:28672
    ds_read_b64_tr_b16 a[60:61], v9 offset:24576
    v_mfma_f32_16x16x32_bf16 v[240:243], v[36:39], v[116:119], v[240:243]
    buffer_load_dwordx4 v30, s[28:31], s62 offen offset:2048 sc1 lds
    ds_read_b64_tr_b16 a[62:63], v9 offset:28672
    v_mfma_f32_16x16x32_bf16 v[244:247], v[44:47], v[116:119], 0
    v_mfma_f32_16x16x32_bf16 v[244:247], v[40:43], v[112:115], v[244:247]
    v_mfma_f32_16x16x32_bf16 v[252:255], v[40:43], v[120:123], 0
    v_mfma_f32_16x16x32_bf16 v[252:255], v[44:47], v[124:127], v[252:255]
    buffer_load_dwordx4 v30, s[28:31], s62 offen offset:3072 sc1 lds
    v_mfma_f32_16x16x32_bf16 v[248:251], v[36:39], v[124:127], 0
    v_mfma_f32_16x16x32_bf16 v[248:251], v[32:35], v[120:123], v[248:251]
    s_waitcnt lgkmcnt(0)
    v_mfma_f32_16x16x32_bf16 v[192:195], a[224:227], v[128:131], v[192:195]
    s_waitcnt vmcnt(9)
    v_mfma_f32_16x16x32_bf16 v[192:195], a[228:231], v[132:135], v[192:195]
    s_barrier
    v_mfma_f32_16x16x32_bf16 v[196:199], a[236:239], v[132:135], v[196:199]
    s_add_u32 m0, s60, 32768
    ds_read_b64_tr_b16 v[32:33], v52 offset:32768
    ds_read_b64_tr_b16 v[34:35], v54 offset:32768
    ds_read_b64_tr_b16 v[36:37], v52 offset:40960
    v_mfma_f32_16x16x32_bf16 v[196:199], a[232:235], v[128:131], v[196:199]
    s_xor_b32 s66, s67, 524288
    ds_read_b64_tr_b16 v[38:39], v54 offset:40960
    ds_read_b64_tr_b16 v[40:41], v53 offset:32768
    ds_read_b64_tr_b16 v[42:43], v55 offset:32768
    v_mfma_f32_16x16x32_bf16 v[204:207], a[232:235], v[136:139], v[204:207]
    buffer_load_dwordx4 v14, s[44:47], s66 offen offset:0 lds
    ds_read_b64_tr_b16 v[44:45], v53 offset:40960
    v_mfma_f32_16x16x32_bf16 v[204:207], a[236:239], v[140:143], v[204:207]
    buffer_load_dwordx4 v15, s[44:47], s66 offen offset:1024 lds
    ds_read_b64_tr_b16 v[46:47], v55 offset:40960
    v_mfma_f32_16x16x32_bf16 v[200:203], a[228:231], v[140:143], v[200:203]
    buffer_load_dwordx4 v16, s[44:47], s66 offen offset:2048 lds
    ds_read_b128 v[64:67], v13 offset:49152
    v_mfma_f32_16x16x32_bf16 v[200:203], a[224:227], v[136:139], v[200:203]
    ds_read_b128 v[68:71], v13 offset:50176
    ds_read_b128 v[72:75], v13 offset:51200
    ds_read_b128 v[76:79], v13 offset:52224
    v_mfma_f32_16x16x32_bf16 v[208:211], a[224:227], v[144:147], v[208:211]
    buffer_load_dwordx4 v17, s[44:47], s66 offen offset:3072 lds
    ds_read_b128 v[80:83], v13 offset:53248
    v_mfma_f32_16x16x32_bf16 v[208:211], a[228:231], v[148:151], v[208:211]
    s_add_u32 m0, s60, 49152
    ds_read_b128 v[84:87], v13 offset:54272
    ds_read_b128 v[88:91], v13 offset:55296
    ds_read_b128 v[92:95], v13 offset:56320
    v_mfma_f32_16x16x32_bf16 v[212:215], a[236:239], v[148:151], v[212:215]
    s_xor_b32 s66, s67, 589824
    ds_read_b128 v[96:99], v13 offset:57344
    ds_read_b128 v[100:103], v13 offset:58368
    ds_read_b128 v[104:107], v13 offset:59392
    v_mfma_f32_16x16x32_bf16 v[212:215], a[232:235], v[144:147], v[212:215]
    buffer_load_dwordx4 v14, s[44:47], s66 offen offset:0 lds
    ds_read_b128 v[108:111], v13 offset:60416
    v_mfma_f32_16x16x32_bf16 v[220:223], a[232:235], v[152:155], v[220:223]
    buffer_load_dwordx4 v15, s[44:47], s66 offen offset:1024 lds
    ds_read_b128 v[112:115], v13 offset:61440
    v_mfma_f32_16x16x32_bf16 v[220:223], a[236:239], v[156:159], v[220:223]
    buffer_load_dwordx4 v16, s[44:47], s66 offen offset:2048 lds
    ds_read_b128 v[116:119], v13 offset:62464
    v_mfma_f32_16x16x32_bf16 v[216:219], a[228:231], v[156:159], v[216:219]
    ds_read_b128 v[120:123], v13 offset:63488
    ds_read_b128 v[124:127], v13 offset:64512
    v_mfma_f32_16x16x32_bf16 v[216:219], a[224:227], v[152:155], v[216:219]
    buffer_load_dwordx4 v17, s[44:47], s66 offen offset:3072 lds
    ds_read_b64_tr_b16 a[64:65], v10 offset:0
    v_mfma_f32_16x16x32_bf16 v[224:227], a[224:227], v[160:163], v[224:227]
    s_add_u32 m0, s60, 65536
    ds_read_b64_tr_b16 a[66:67], v10 offset:4096
    ds_read_b64_tr_b16 a[68:69], v11 offset:0
    v_mfma_f32_16x16x32_bf16 v[224:227], a[228:231], v[164:167], v[224:227]
    s_lshl_b32 s66, s12, 5
    ds_read_b64_tr_b16 a[70:71], v11 offset:4096
    ds_read_b64_tr_b16 a[72:73], v10 offset:8192
    v_mfma_f32_16x16x32_bf16 v[228:231], a[236:239], v[164:167], v[228:231]
    s_add_u32 s66, s66, s68
    ds_read_b64_tr_b16 a[74:75], v10 offset:12288
    ds_read_b64_tr_b16 a[76:77], v11 offset:8192
    v_mfma_f32_16x16x32_bf16 v[228:231], a[232:235], v[160:163], v[228:231]
    buffer_load_dwordx4 v14, s[48:51], s66 offen offset:0 lds
    ds_read_b64_tr_b16 a[78:79], v11 offset:12288
    v_mfma_f32_16x16x32_bf16 v[236:239], a[232:235], v[168:171], v[236:239]
    buffer_load_dwordx4 v15, s[48:51], s66 offen offset:1024 lds
    ds_read_b64_tr_b16 a[80:81], v10 offset:16384
    v_mfma_f32_16x16x32_bf16 v[236:239], a[236:239], v[172:175], v[236:239]
    buffer_load_dwordx4 v16, s[48:51], s66 offen offset:2048 lds
    ds_read_b64_tr_b16 a[82:83], v10 offset:20480
    v_mfma_f32_16x16x32_bf16 v[232:235], a[228:231], v[172:175], v[232:235]
    buffer_load_dwordx4 v17, s[48:51], s66 offen offset:3072 lds
    ds_read_b64_tr_b16 a[84:85], v11 offset:16384
    v_mfma_f32_16x16x32_bf16 v[232:235], a[224:227], v[168:171], v[232:235]
    s_add_u32 m0, s60, 81920
    ds_read_b64_tr_b16 a[86:87], v11 offset:20480
    ds_read_b64_tr_b16 a[88:89], v10 offset:24576
    v_mfma_f32_16x16x32_bf16 v[240:243], a[224:227], v[176:179], v[240:243]
    s_add_u32 s62, s61, s12
    ds_read_b64_tr_b16 a[90:91], v10 offset:28672
    ds_read_b64_tr_b16 a[92:93], v11 offset:24576
    v_mfma_f32_16x16x32_bf16 v[240:243], a[228:231], v[180:183], v[240:243]
    buffer_load_dwordx4 v1, s[28:31], s62 offen offset:0 sc1 lds
    ds_read_b64_tr_b16 a[94:95], v11 offset:28672
    v_mfma_f32_16x16x32_bf16 v[244:247], a[236:239], v[180:183], v[244:247]
    buffer_load_dwordx4 v1, s[28:31], s62 offen offset:1024 sc1 lds
    v_mfma_f32_16x16x32_bf16 v[244:247], a[232:235], v[176:179], v[244:247]
    buffer_load_dwordx4 v30, s[28:31], s62 offen offset:2048 sc1 lds
    v_mfma_f32_16x16x32_bf16 v[252:255], a[232:235], v[184:187], v[252:255]
    v_mfma_f32_16x16x32_bf16 v[252:255], a[236:239], v[188:191], v[252:255]
    buffer_load_dwordx4 v30, s[28:31], s62 offen offset:3072 sc1 lds
    v_mfma_f32_16x16x32_bf16 v[248:251], a[228:231], v[188:191], v[248:251]
    v_mfma_f32_16x16x32_bf16 v[248:251], a[224:227], v[184:187], v[248:251]
    s_waitcnt lgkmcnt(0)
    v_mfma_f32_16x16x32_bf16 v[192:195], v[32:35], v[64:67], v[192:195]
    s_waitcnt vmcnt(8)
    v_mfma_f32_16x16x32_bf16 v[192:195], v[36:39], v[68:71], v[192:195]
    s_barrier
    v_mfma_f32_16x16x32_bf16 v[196:199], v[44:47], v[68:71], v[196:199]
    s_add_u32 m0, s60, 98304
    ds_read_b64_tr_b16 a[224:225], v48 offset:0
    ds_read_b64_tr_b16 a[226:227], v50 offset:0
    ds_read_b64_tr_b16 a[228:229], v48 offset:8192
    v_mfma_f32_16x16x32_bf16 v[196:199], v[40:43], v[64:67], v[196:199]
    s_xor_b32 s66, s67, 655360
    ds_read_b64_tr_b16 a[230:231], v50 offset:8192
    ds_read_b64_tr_b16 a[232:233], v49 offset:0
    ds_read_b64_tr_b16 a[234:235], v51 offset:0
    v_mfma_f32_16x16x32_bf16 v[204:207], v[40:43], v[72:75], v[204:207]
    buffer_load_dwordx4 v14, s[44:47], s66 offen offset:0 lds
    ds_read_b64_tr_b16 a[236:237], v49 offset:8192
    v_mfma_f32_16x16x32_bf16 v[204:207], v[44:47], v[76:79], v[204:207]
    buffer_load_dwordx4 v15, s[44:47], s66 offen offset:1024 lds
    ds_read_b64_tr_b16 a[238:239], v51 offset:8192
    v_mfma_f32_16x16x32_bf16 v[200:203], v[36:39], v[76:79], v[200:203]
    buffer_load_dwordx4 v16, s[44:47], s66 offen offset:2048 lds
    ds_read_b128 v[128:131], v12 offset:16384
    v_mfma_f32_16x16x32_bf16 v[200:203], v[32:35], v[72:75], v[200:203]
    ds_read_b128 v[132:135], v12 offset:17408
    ds_read_b128 v[136:139], v12 offset:18432
    ds_read_b128 v[140:143], v12 offset:19456
    v_mfma_f32_16x16x32_bf16 v[208:211], v[32:35], v[80:83], v[208:211]
    buffer_load_dwordx4 v17, s[44:47], s66 offen offset:3072 lds
    ds_read_b128 v[144:147], v12 offset:20480
    v_mfma_f32_16x16x32_bf16 v[208:211], v[36:39], v[84:87], v[208:211]
    s_add_u32 m0, s60, 114688
    ds_read_b128 v[148:151], v12 offset:21504
    ds_read_b128 v[152:155], v12 offset:22528
    ds_read_b128 v[156:159], v12 offset:23552
    v_mfma_f32_16x16x32_bf16 v[212:215], v[44:47], v[84:87], v[212:215]
    s_xor_b32 s66, s67, 720896
    ds_read_b128 v[160:163], v12 offset:24576
    ds_read_b128 v[164:167], v12 offset:25600
    ds_read_b128 v[168:171], v12 offset:26624
    v_mfma_f32_16x16x32_bf16 v[212:215], v[40:43], v[80:83], v[212:215]
    buffer_load_dwordx4 v14, s[44:47], s66 offen offset:0 lds
    ds_read_b128 v[172:175], v12 offset:27648
    v_mfma_f32_16x16x32_bf16 v[220:223], v[40:43], v[88:91], v[220:223]
    buffer_load_dwordx4 v15, s[44:47], s66 offen offset:1024 lds
    ds_read_b128 v[176:179], v12 offset:28672
    v_mfma_f32_16x16x32_bf16 v[220:223], v[44:47], v[92:95], v[220:223]
    buffer_load_dwordx4 v16, s[44:47], s66 offen offset:2048 lds
    ds_read_b128 v[180:183], v12 offset:29696
    v_mfma_f32_16x16x32_bf16 v[216:219], v[36:39], v[92:95], v[216:219]
    ds_read_b128 v[184:187], v12 offset:30720
    ds_read_b128 v[188:191], v12 offset:31744
    v_mfma_f32_16x16x32_bf16 v[216:219], v[32:35], v[88:91], v[216:219]
    buffer_load_dwordx4 v17, s[44:47], s66 offen offset:3072 lds
    ds_read_b64_tr_b16 a[96:97], v6 offset:32768
    v_mfma_f32_16x16x32_bf16 v[224:227], v[32:35], v[96:99], v[224:227]
    s_add_u32 m0, s60, 131072
    ds_read_b64_tr_b16 a[98:99], v6 offset:36864
    ds_read_b64_tr_b16 a[100:101], v7 offset:32768
    v_mfma_f32_16x16x32_bf16 v[224:227], v[36:39], v[100:103], v[224:227]
    s_lshl_b32 s66, s13, 5
    ds_read_b64_tr_b16 a[102:103], v7 offset:36864
    ds_read_b64_tr_b16 a[104:105], v6 offset:40960
    v_mfma_f32_16x16x32_bf16 v[228:231], v[44:47], v[100:103], v[228:231]
    s_add_u32 s66, s66, s68
    ds_read_b64_tr_b16 a[106:107], v6 offset:45056
    ds_read_b64_tr_b16 a[108:109], v7 offset:40960
    v_mfma_f32_16x16x32_bf16 v[228:231], v[40:43], v[96:99], v[228:231]
    buffer_load_dwordx4 v14, s[48:51], s66 offen offset:0 lds
    ds_read_b64_tr_b16 a[110:111], v7 offset:45056
    v_mfma_f32_16x16x32_bf16 v[236:239], v[40:43], v[104:107], v[236:239]
    buffer_load_dwordx4 v15, s[48:51], s66 offen offset:1024 lds
    ds_read_b64_tr_b16 a[112:113], v6 offset:49152
    v_mfma_f32_16x16x32_bf16 v[236:239], v[44:47], v[108:111], v[236:239]
    buffer_load_dwordx4 v16, s[48:51], s66 offen offset:2048 lds
    ds_read_b64_tr_b16 a[114:115], v6 offset:53248
    v_mfma_f32_16x16x32_bf16 v[232:235], v[36:39], v[108:111], v[232:235]
    buffer_load_dwordx4 v17, s[48:51], s66 offen offset:3072 lds
    ds_read_b64_tr_b16 a[116:117], v7 offset:49152
    v_mfma_f32_16x16x32_bf16 v[232:235], v[32:35], v[104:107], v[232:235]
    s_add_u32 m0, s60, 147456
    ds_read_b64_tr_b16 a[118:119], v7 offset:53248
    ds_read_b64_tr_b16 a[120:121], v6 offset:57344
    v_mfma_f32_16x16x32_bf16 v[240:243], v[32:35], v[112:115], v[240:243]
    s_add_u32 s62, s61, s13
    ds_read_b64_tr_b16 a[122:123], v6 offset:61440
    ds_read_b64_tr_b16 a[124:125], v7 offset:57344
    v_mfma_f32_16x16x32_bf16 v[240:243], v[36:39], v[116:119], v[240:243]
    buffer_load_dwordx4 v1, s[28:31], s62 offen offset:0 sc1 lds
    ds_read_b64_tr_b16 a[126:127], v7 offset:61440
    v_mfma_f32_16x16x32_bf16 v[244:247], v[44:47], v[116:119], v[244:247]
    buffer_load_dwordx4 v1, s[28:31], s62 offen offset:1024 sc1 lds
    v_mfma_f32_16x16x32_bf16 v[244:247], v[40:43], v[112:115], v[244:247]
    buffer_load_dwordx4 v30, s[28:31], s62 offen offset:2048 sc1 lds
    v_mfma_f32_16x16x32_bf16 v[252:255], v[40:43], v[120:123], v[252:255]
    v_mfma_f32_16x16x32_bf16 v[252:255], v[44:47], v[124:127], v[252:255]
    buffer_load_dwordx4 v30, s[28:31], s62 offen offset:3072 sc1 lds
    v_mfma_f32_16x16x32_bf16 v[248:251], v[36:39], v[124:127], v[248:251]
    v_mfma_f32_16x16x32_bf16 v[248:251], v[32:35], v[120:123], v[248:251]
    s_waitcnt lgkmcnt(0)
    v_mfma_f32_16x16x32_bf16 v[192:195], a[224:227], v[128:131], v[192:195]
    s_waitcnt vmcnt(8)
    v_mfma_f32_16x16x32_bf16 v[192:195], a[228:231], v[132:135], v[192:195]
    s_barrier
    v_mfma_f32_16x16x32_bf16 v[196:199], a[236:239], v[132:135], v[196:199]
    s_load_dwordx8 s[20:27], s[100:101], 0 glc
    ds_read_b64_tr_b16 v[32:33], v52 offset:0
    ds_read_b64_tr_b16 v[34:35], v54 offset:0
    ds_read_b64_tr_b16 v[36:37], v52 offset:8192
    v_mfma_f32_16x16x32_bf16 v[196:199], a[232:235], v[128:131], v[196:199]
    s_add_u32 m0, s60, 0
    ds_read_b64_tr_b16 v[38:39], v54 offset:8192
    ds_read_b64_tr_b16 v[40:41], v53 offset:0
    ds_read_b64_tr_b16 v[42:43], v55 offset:0
    v_mfma_f32_16x16x32_bf16 v[204:207], a[232:235], v[136:139], v[204:207]
    s_xor_b32 s66, s67, 786432
    ds_read_b64_tr_b16 v[44:45], v53 offset:8192
    ds_read_b64_tr_b16 v[46:47], v55 offset:8192
    ds_read_b128 v[64:67], v13 offset:16384
    v_mfma_f32_16x16x32_bf16 v[204:207], a[236:239], v[140:143], v[204:207]
    buffer_load_dwordx4 v14, s[44:47], s66 offen offset:0 lds
    ds_read_b128 v[68:71], v13 offset:17408
    v_mfma_f32_16x16x32_bf16 v[200:203], a[228:231], v[140:143], v[200:203]
    buffer_load_dwordx4 v15, s[44:47], s66 offen offset:1024 lds
    ds_read_b128 v[72:75], v13 offset:18432
    v_mfma_f32_16x16x32_bf16 v[200:203], a[224:227], v[136:139], v[200:203]
    buffer_load_dwordx4 v16, s[44:47], s66 offen offset:2048 lds
    ds_read_b128 v[76:79], v13 offset:19456
    v_mfma_f32_16x16x32_bf16 v[208:211], a[224:227], v[144:147], v[208:211]
    buffer_load_dwordx4 v17, s[44:47], s66 offen offset:3072 lds
    ds_read_b128 v[80:83], v13 offset:20480
    v_mfma_f32_16x16x32_bf16 v[208:211], a[228:231], v[148:151], v[208:211]
    s_add_u32 m0, s60, 16384
    ds_read_b128 v[84:87], v13 offset:21504
    ds_read_b128 v[88:91], v13 offset:22528
    ds_read_b128 v[92:95], v13 offset:23552
    v_mfma_f32_16x16x32_bf16 v[212:215], a[236:239], v[148:151], v[212:215]
    s_xor_b32 s66, s67, 851968
    ds_read_b128 v[96:99], v13 offset:24576
    ds_read_b128 v[100:103], v13 offset:25600
    ds_read_b128 v[104:107], v13 offset:26624
    v_mfma_f32_16x16x32_bf16 v[212:215], a[232:235], v[144:147], v[212:215]
    buffer_load_dwordx4 v14, s[44:47], s66 offen offset:0 lds
    ds_read_b128 v[108:111], v13 offset:27648
    v_mfma_f32_16x16x32_bf16 v[220:223], a[232:235], v[152:155], v[220:223]
    buffer_load_dwordx4 v15, s[44:47], s66 offen offset:1024 lds
    ds_read_b128 v[112:115], v13 offset:28672
    v_mfma_f32_16x16x32_bf16 v[220:223], a[236:239], v[156:159], v[220:223]
    buffer_load_dwordx4 v16, s[44:47], s66 offen offset:2048 lds
    ds_read_b128 v[116:119], v13 offset:29696
    v_mfma_f32_16x16x32_bf16 v[216:219], a[228:231], v[156:159], v[216:219]
    ds_read_b128 v[120:123], v13 offset:30720
    ds_read_b128 v[124:127], v13 offset:31744
    v_mfma_f32_16x16x32_bf16 v[216:219], a[224:227], v[152:155], v[216:219]
    buffer_load_dwordx4 v17, s[44:47], s66 offen offset:3072 lds
    ds_read_b64_tr_b16 a[128:129], v8 offset:32768
    v_mfma_f32_16x16x32_bf16 v[224:227], a[224:227], v[160:163], v[224:227]
    s_add_u32 m0, s60, 32768
    ds_read_b64_tr_b16 a[130:131], v8 offset:36864
    ds_read_b64_tr_b16 a[132:133], v9 offset:32768
    v_mfma_f32_16x16x32_bf16 v[224:227], a[228:231], v[164:167], v[224:227]
    s_lshl_b32 s66, s14, 5
    ds_read_b64_tr_b16 a[134:135], v9 offset:36864
    ds_read_b64_tr_b16 a[136:137], v8 offset:40960
    v_mfma_f32_16x16x32_bf16 v[228:231], a[236:239], v[164:167], v[228:231]
    s_add_u32 s66, s66, s68
    ds_read_b64_tr_b16 a[138:139], v8 offset:45056
    ds_read_b64_tr_b16 a[140:141], v9 offset:40960
    v_mfma_f32_16x16x32_bf16 v[228:231], a[232:235], v[160:163], v[228:231]
    buffer_load_dwordx4 v14, s[48:51], s66 offen offset:0 lds
    ds_read_b64_tr_b16 a[142:143], v9 offset:45056
    v_mfma_f32_16x16x32_bf16 v[236:239], a[232:235], v[168:171], v[236:239]
    buffer_load_dwordx4 v15, s[48:51], s66 offen offset:1024 lds
    ds_read_b64_tr_b16 a[144:145], v8 offset:49152
    v_mfma_f32_16x16x32_bf16 v[236:239], a[236:239], v[172:175], v[236:239]
    buffer_load_dwordx4 v16, s[48:51], s66 offen offset:2048 lds
    ds_read_b64_tr_b16 a[146:147], v8 offset:53248
    v_mfma_f32_16x16x32_bf16 v[232:235], a[228:231], v[172:175], v[232:235]
    buffer_load_dwordx4 v17, s[48:51], s66 offen offset:3072 lds
    ds_read_b64_tr_b16 a[148:149], v9 offset:49152
    v_mfma_f32_16x16x32_bf16 v[232:235], a[224:227], v[168:171], v[232:235]
    s_add_u32 m0, s60, 49152
    ds_read_b64_tr_b16 a[150:151], v9 offset:53248
    ds_read_b64_tr_b16 a[152:153], v8 offset:57344
    v_mfma_f32_16x16x32_bf16 v[240:243], a[224:227], v[176:179], v[240:243]
    s_add_u32 s62, s61, s14
    ds_read_b64_tr_b16 a[154:155], v8 offset:61440
    ds_read_b64_tr_b16 a[156:157], v9 offset:57344
    v_mfma_f32_16x16x32_bf16 v[240:243], a[228:231], v[180:183], v[240:243]
    buffer_load_dwordx4 v1, s[28:31], s62 offen offset:0 sc1 lds
    ds_read_b64_tr_b16 a[158:159], v9 offset:61440
    v_mfma_f32_16x16x32_bf16 v[244:247], a[236:239], v[180:183], v[244:247]
    buffer_load_dwordx4 v1, s[28:31], s62 offen offset:1024 sc1 lds
    v_mfma_f32_16x16x32_bf16 v[244:247], a[232:235], v[176:179], v[244:247]
    buffer_load_dwordx4 v30, s[28:31], s62 offen offset:2048 sc1 lds
    v_mfma_f32_16x16x32_bf16 v[252:255], a[232:235], v[184:187], v[252:255]
    v_mfma_f32_16x16x32_bf16 v[252:255], a[236:239], v[188:191], v[252:255]
    buffer_load_dwordx4 v30, s[28:31], s62 offen offset:3072 sc1 lds
    v_mfma_f32_16x16x32_bf16 v[248:251], a[228:231], v[188:191], v[248:251]
    v_mfma_f32_16x16x32_bf16 v[248:251], a[224:227], v[184:187], v[248:251]
    s_waitcnt lgkmcnt(0)
    v_mfma_f32_16x16x32_bf16 v[192:195], v[32:35], v[64:67], v[192:195]
    s_waitcnt vmcnt(8)
    v_mfma_f32_16x16x32_bf16 v[192:195], v[36:39], v[68:71], v[192:195]
    s_barrier
    v_mfma_f32_16x16x32_bf16 v[196:199], v[44:47], v[68:71], v[196:199]
    s_and_b64 s[20:21], s[20:21], s[22:23]
    s_and_b64 s[24:25], s[24:25], s[26:27]
    s_and_b64 s[20:21], s[20:21], s[24:25]
    s_and_b32 s20, s20, s21
    s_cbranch_scc0 L_spin_o
L_back_o:
    ds_read_b64_tr_b16 a[224:225], v56 offset:0
    ds_read_b64_tr_b16 a[226:227], v58 offset:0
    v_mfma_f32_16x16x32_bf16 v[196:199], v[40:43], v[64:67], v[196:199]
    s_add_u32 m0, s60, 65536
    ds_read_b64_tr_b16 a[228:229], v56 offset:8192
    ds_read_b64_tr_b16 a[230:231], v58 offset:8192
    ds_read_b64_tr_b16 a[232:233], v57 offset:0
    v_mfma_f32_16x16x32_bf16 v[204:207], v[40:43], v[72:75], v[204:207]
    s_xor_b32 s66, s67, 983040
    ds_read_b64_tr_b16 a[234:235], v59 offset:0
    ds_read_b64_tr_b16 a[236:237], v57 offset:8192
    ds_read_b64_tr_b16 a[238:239], v59 offset:8192
    v_mfma_f32_16x16x32_bf16 v[204:207], v[44:47], v[76:79], v[204:207]
    buffer_load_dwordx4 v14, s[44:47], s66 offen offset:0 lds
    ds_read_b128 v[128:131], v20 offset:16384
    v_mfma_f32_16x16x32_bf16 v[200:203], v[36:39], v[76:79], v[200:203]
    buffer_load_dwordx4 v15, s[44:47], s66 offen offset:1024 lds
    ds_read_b128 v[132:135], v20 offset:17408
    v_mfma_f32_16x16x32_bf16 v[200:203], v[32:35], v[72:75], v[200:203]
    ds_read_b128 v[136:139], v20 offset:18432
    ds_read_b128 v[140:143], v20 offset:19456
    ds_read_b128 v[144:147], v20 offset:20480
    v_mfma_f32_16x16x32_bf16 v[208:211], v[32:35], v[80:83], v[208:211]
    buffer_load_dwordx4 v16, s[44:47], s66 offen offset:2048 lds
    ds_read_b128 v[148:151], v20 offset:21504
    v_mfma_f32_16x16x32_bf16 v[208:211], v[36:39], v[84:87], v[208:211]
    buffer_load_dwordx4 v17, s[44:47], s66 offen offset:3072 lds
    ds_read_b128 v[152:155], v20 offset:22528
    v_mfma_f32_16x16x32_bf16 v[212:215], v[44:47], v[84:87], v[212:215]
    s_add_u32 m0, s60, 81920
    ds_read_b128 v[156:159], v20 offset:23552
    ds_read_b128 v[160:163], v20 offset:24576
    ds_read_b128 v[164:167], v20 offset:25600
    v_mfma_f32_16x16x32_bf16 v[212:215], v[40:43], v[80:83], v[212:215]
    s_xor_b32 s66, s67, 917504
    ds_read_b128 v[168:171], v20 offset:26624
    ds_read_b128 v[172:175], v20 offset:27648
    ds_read_b128 v[176:179], v20 offset:28672
    v_mfma_f32_16x16x32_bf16 v[220:223], v[40:43], v[88:91], v[220:223]
    buffer_load_dwordx4 v14, s[44:47], s66 offen offset:0 lds
    ds_read_b128 v[180:183], v20 offset:29696
    v_mfma_f32_16x16x32_bf16 v[220:223], v[44:47], v[92:95], v[220:223]
    buffer_load_dwordx4 v15, s[44:47], s66 offen offset:1024 lds
    ds_read_b128 v[184:187], v20 offset:30720
    v_mfma_f32_16x16x32_bf16 v[216:219], v[36:39], v[92:95], v[216:219]
    buffer_load_dwordx4 v16, s[44:47], s66 offen offset:2048 lds
    ds_read_b128 v[188:191], v20 offset:31744
    v_mfma_f32_16x16x32_bf16 v[216:219], v[32:35], v[88:91], v[216:219]
    ds_read_b64_tr_b16 a[192:193], v6 offset:0
    ds_read_b64_tr_b16 a[194:195], v6 offset:4096
    v_mfma_f32_16x16x32_bf16 v[224:227], v[32:35], v[96:99], v[224:227]
    buffer_load_dwordx4 v17, s[44:47], s66 offen offset:3072 lds
    ds_read_b64_tr_b16 a[196:197], v7 offset:0
    v_mfma_f32_16x16x32_bf16 v[224:227], v[36:39], v[100:103], v[224:227]
    s_add_u32 m0, s60, 98304
    ds_read_b64_tr_b16 a[198:199], v7 offset:4096
    ds_read_b64_tr_b16 a[200:201], v6 offset:8192
    v_mfma_f32_16x16x32_bf16 v[228:231], v[44:47], v[100:103], v[228:231]
    s_add_u32 s62, s41, s16
    ds_read_b64_tr_b16 a[202:203], v6 offset:12288
    ds_read_b64_tr_b16 a[204:205], v7 offset:8192
    v_mfma_f32_16x16x32_bf16 v[228:231], v[40:43], v[96:99], v[228:231]
    buffer_load_dwordx4 v1, s[28:31], s62 offen offset:0 sc1 lds
    ds_read_b64_tr_b16 a[206:207], v7 offset:12288
    v_mfma_f32_16x16x32_bf16 v[236:239], v[40:43], v[104:107], v[236:239]
    buffer_load_dwordx4 v1, s[28:31], s62 offen offset:1024 sc1 lds
    ds_read_b64_tr_b16 a[208:209], v6 offset:16384
    v_mfma_f32_16x16x32_bf16 v[236:239], v[44:47], v[108:111], v[236:239]
    buffer_load_dwordx4 v1, s[28:31], s62 offen offset:2048 sc1 lds
    ds_read_b64_tr_b16 a[210:211], v6 offset:20480
    v_mfma_f32_16x16x32_bf16 v[232:235], v[36:39], v[108:111], v[232:235]
    buffer_load_dwordx4 v1, s[28:31], s62 offen offset:3072 sc1 lds
    ds_read_b64_tr_b16 a[212:213], v7 offset:16384
    v_mfma_f32_16x16x32_bf16 v[232:235], v[32:35], v[104:107], v[232:235]
    s_add_u32 m0, s60, 114688
    ds_read_b64_tr_b16 a[214:215], v7 offset:20480
    ds_read_b64_tr_b16 a[216:217], v6 offset:24576
    v_mfma_f32_16x16x32_bf16 v[240:243], v[32:35], v[112:115], v[240:243]
    s_add_u32 s62, s41, s17
    ds_read_b64_tr_b16 a[218:219], v6 offset:28672
    ds_read_b64_tr_b16 a[220:221], v7 offset:24576
    v_mfma_f32_16x16x32_bf16 v[240:243], v[36:39], v[116:119], v[240:243]
    buffer_load_dwordx4 v1, s[28:31], s62 offen offset:0 sc1 lds
    ds_read_b64_tr_b16 a[222:223], v7 offset:28672
    v_mfma_f32_16x16x32_bf16 v[244:247], v[44:47], v[116:119], v[244:247]
    buffer_load_dwordx4 v1, s[28:31], s62 offen offset:1024 sc1 lds
    v_mfma_f32_16x16x32_bf16 v[244:247], v[40:43], v[112:115], v[244:247]
    buffer_load_dwordx4 v1, s[28:31], s62 offen offset:2048 sc1 lds
    v_mfma_f32_16x16x32_bf16 v[252:255], v[40:43], v[120:123], v[252:255]
    v_mfma_f32_16x16x32_bf16 v[252:255], v[44:47], v[124:127], v[252:255]
    buffer_load_dwordx4 v1, s[28:31], s62 offen offset:3072 sc1 lds
    v_mfma_f32_16x16x32_bf16 v[248:251], v[36:39], v[124:127], v[248:251]
    v_mfma_f32_16x16x32_bf16 v[248:251], v[32:35], v[120:123], v[248:251]
    s_waitcnt lgkmcnt(0)
    v_mfma_f32_16x16x32_bf16 v[192:195], a[224:227], v[128:131], v[192:195]
    s_waitcnt vmcnt(12)
    v_mfma_f32_16x16x32_bf16 v[192:195], a[228:231], v[132:135], v[192:195]
    s_barrier
    v_mfma_f32_16x16x32_bf16 v[196:199], a[236:239], v[132:135], v[196:199]
    s_add_u32 m0, s60, 131072
    ds_read_b64_tr_b16 v[32:33], v48 offset:32768
    ds_read_b64_tr_b16 v[34:35], v50 offset:32768
    v_mfma_f32_16x16x32_bf16 v[196:199], a[232:235], v[128:131], v[196:199]
    s_add_u32 s62, s41, s18
    ds_read_b64_tr_b16 v[36:37], v48 offset:40960
    ds_read_b64_tr_b16 v[38:39], v50 offset:40960
    v_mfma_f32_16x16x32_bf16 v[204:207], a[232:235], v[136:139], v[204:207]
    buffer_load_dwordx4 v1, s[28:31], s62 offen offset:0 sc1 lds
    v_mfma_f32_16x16x32_bf16 v[204:207], a[236:239], v[140:143], v[204:207]
    ds_read_b64_tr_b16 v[40:41], v49 offset:32768
    ds_read_b64_tr_b16 v[42:43], v51 offset:32768
    v_mfma_f32_16x16x32_bf16 v[200:203], a[228:231], v[140:143], v[200:203]
    buffer_load_dwordx4 v1, s[28:31], s62 offen offset:1024 sc1 lds
    v_mfma_f32_16x16x32_bf16 v[200:203], a[224:227], v[136:139], v[200:203]
    ds_read_b64_tr_b16 v[44:45], v49 offset:40960
    ds_read_b64_tr_b16 v[46:47], v51 offset:40960
    v_mfma_f32_16x16x32_bf16 v[208:211], a[224:227], v[144:147], v[208:211]
    ds_read_b128 v[64:67], v12 offset:49152
    ds_read_b128 v[68:71], v12 offset:50176
    v_mfma_f32_16x16x32_bf16 v[208:211], a[228:231], v[148:151], v[208:211]
    ds_read_b128 v[72:75], v12 offset:51200
    ds_read_b128 v[76:79], v12 offset:52224
    v_mfma_f32_16x16x32_bf16 v[212:215], a[236:239], v[148:151], v[212:215]
    buffer_load_dwordx4 v1, s[28:31], s62 offen offset:2048 sc1 lds
    v_mfma_f32_16x16x32_bf16 v[212:215], a[232:235], v[144:147], v[212:215]
    ds_read_b128 v[80:83], v12 offset:53248
    ds_read_b128 v[84:87], v12 offset:54272
    v_mfma_f32_16x16x32_bf16 v[220:223], a[232:235], v[152:155], v[220:223]
    ds_read_b128 v[88:91], v12 offset:55296
    ds_read_b128 v[92:95], v12 offset:56320
    v_mfma_f32_16x16x32_bf16 v[220:223], a[236:239], v[156:159], v[220:223]
    ds_read_b128 v[96:99], v12 offset:57344
    ds_read_b128 v[100:103], v12 offset:58368
    v_mfma_f32_16x16x32_bf16 v[216:219], a[228:231], v[156:159], v[216:219]
    buffer_load_dwordx4 v1, s[28:31], s62 offen offset:3072 sc1 lds
    v_mfma_f32_16x16x32_bf16 v[216:219], a[224:227], v[152:155], v[216:219]
    s_add_u32 m0, s60, 147456
    ds_read_b128 v[104:107], v12 offset:59392
    ds_read_b128 v[108:111], v12 offset:60416
    v_mfma_f32_16x16x32_bf16 v[224:227], a[224:227], v[160:163], v[224:227]
    s_add_u32 s62, s41, s19
    ds_read_b128 v[112:115], v12 offset:61440
    ds_read_b128 v[116:119], v12 offset:62464
    v_mfma_f32_16x16x32_bf16 v[224:227], a[228:231], v[164:167], v[224:227]
    buffer_load_dwordx4 v1, s[28:31], s62 offen offset:0 sc1 lds
    v_mfma_f32_16x16x32_bf16 v[228:231], a[236:239], v[164:167], v[228:231]
    ds_read_b128 v[120:123], v12 offset:63488
    ds_read_b128 v[124:127], v12 offset:64512
    v_mfma_f32_16x16x32_bf16 v[228:231], a[232:235], v[160:163], v[228:231]
    ds_read_b64_tr_b16 a[240:241], v8 offset:0
    ds_read_b64_tr_b16 a[242:243], v8 offset:4096
    v_mfma_f32_16x16x32_bf16 v[236:239], a[232:235], v[168:171], v[236:239]
    ds_read_b64_tr_b16 a[244:245], v9 offset:0
    ds_read_b64_tr_b16 a[246:247], v9 offset:4096
    v_mfma_f32_16x16x32_bf16 v[236:239], a[236:239], v[172:175], v[236:239]
    buffer_load_dwordx4 v1, s[28:31], s62 offen offset:1024 sc1 lds
    v_mfma_f32_16x16x32_bf16 v[232:235], a[228:231], v[172:175], v[232:235]
    ds_read_b64_tr_b16 a[248:249], v8 offset:8192
    ds_read_b64_tr_b16 a[250:251], v8 offset:12288
    v_mfma_f32_16x16x32_bf16 v[232:235], a[224:227], v[168:171], v[232:235]
    ds_read_b64_tr_b16 a[252:253], v9 offset:8192
    v_mfma_f32_16x16x32_bf16 v[240:243], a[224:227], v[176:179], v[240:243]
    ds_read_b64_tr_b16 a[254:255], v9 offset:12288
    v_mfma_f32_16x16x32_bf16 v[240:243], a[228:231], v[180:183], v[240:243]
    buffer_load_dwordx4 v1, s[28:31], s62 offen offset:2048 sc1 lds
    v_mfma_f32_16x16x32_bf16 v[244:247], a[236:239], v[180:183], v[244:247]
    v_mfma_f32_16x16x32_bf16 v[244:247], a[232:235], v[176:179], v[244:247]
    v_mfma_f32_16x16x32_bf16 v[252:255], a[232:235], v[184:187], v[252:255]
    v_mfma_f32_16x16x32_bf16 v[252:255], a[236:239], v[188:191], v[252:255]
    buffer_load_dwordx4 v1, s[28:31], s62 offen offset:3072 sc1 lds
    v_mfma_f32_16x16x32_bf16 v[248:251], a[228:231], v[188:191], v[248:251]
    v_mfma_f32_16x16x32_bf16 v[248:251], a[224:227], v[184:187], v[248:251]
    s_waitcnt lgkmcnt(0)
    v_mfma_f32_16x16x32_bf16 v[208:211], v[32:35], v[80:83], v[208:211]
    s_waitcnt vmcnt(12)
    v_mfma_f32_16x16x32_bf16 v[208:211], v[36:39], v[84:87], v[208:211]
    s_barrier
    v_mfma_f32_16x16x32_bf16 v[212:215], v[44:47], v[84:87], v[212:215]
    ds_read_b64_tr_b16 a[224:225], v8 offset:16384
    v_mfma_f32_16x16x32_bf16 v[212:215], v[40:43], v[80:83], v[212:215]
    ds_read_b64_tr_b16 a[226:227], v8 offset:20480
    v_mfma_f32_16x16x32_bf16 v[220:223], v[40:43], v[88:91], v[220:223]
    ds_read_b64_tr_b16 a[228:229], v9 offset:16384
    v_mfma_f32_16x16x32_bf16 v[220:223], v[44:47], v[92:95], v[220:223]
    ds_read_b64_tr_b16 a[230:231], v9 offset:20480
    v_mfma_f32_16x16x32_bf16 v[216:219], v[36:39], v[92:95], v[216:219]
    ds_read_b64_tr_b16 a[232:233], v8 offset:24576
    v_mfma_f32_16x16x32_bf16 v[216:219], v[32:35], v[88:91], v[216:219]
    ds_read_b64_tr_b16 a[234:235], v8 offset:28672
    v_mfma_f32_16x16x32_bf16 v[224:227], v[32:35], v[96:99], v[224:227]
    ds_read_b64_tr_b16 a[236:237], v9 offset:24576
    v_mfma_f32_16x16x32_bf16 v[224:227], v[36:39], v[100:103], v[224:227]
    ds_read_b64_tr_b16 a[238:239], v9 offset:28672
    v_mfma_f32_16x16x32_bf16 v[228:231], v[44:47], v[100:103], v[228:231]
    ds_read_b128 v[128:131], v13 offset:32768
    v_mfma_f32_16x16x32_bf16 v[228:231], v[40:43], v[96:99], v[228:231]
    ds_read_b128 v[132:135], v13 offset:33792
    v_cvt_pk_bf16_f32 v208, v208, v209
    v_mfma_f32_16x16x32_bf16 v[236:239], v[40:43], v[104:107], v[236:239]
    ds_read_b128 v[136:139], v13 offset:34816
    v_cvt_pk_bf16_f32 v209, v210, v211
    v_mfma_f32_16x16x32_bf16 v[236:239], v[44:47], v[108:111], v[236:239]
    ds_read_b128 v[140:143], v13 offset:35840
    v_cvt_pk_bf16_f32 v210, v212, v213
    v_mfma_f32_16x16x32_bf16 v[232:235], v[36:39], v[108:111], v[232:235]
    ds_read_b128 v[144:147], v13 offset:36864
    v_cvt_pk_bf16_f32 v211, v214, v215
    v_mfma_f32_16x16x32_bf16 v[232:235], v[32:35], v[104:107], v[232:235]
    ds_read_b128 v[148:151], v13 offset:37888
    v_cvt_pk_bf16_f32 v212, v216, v217
    v_mfma_f32_16x16x32_bf16 v[240:243], v[32:35], v[112:115], v[240:243]
    ds_read_b128 v[152:155], v13 offset:38912
    v_cvt_pk_bf16_f32 v213, v218, v219
    v_mfma_f32_16x16x32_bf16 v[240:243], v[36:39], v[116:119], v[240:243]
    ds_read_b128 v[156:159], v13 offset:39936
    v_cvt_pk_bf16_f32 v214, v220, v221
    v_mfma_f32_16x16x32_bf16 v[244:247], v[44:47], v[116:119], v[244:247]
    ds_read_b128 v[160:163], v13 offset:40960
    v_cvt_pk_bf16_f32 v215, v222, v223
    v_mfma_f32_16x16x32_bf16 v[244:247], v[40:43], v[112:115], v[244:247]
    ds_read_b128 v[164:167], v13 offset:41984
    v_min_u32 v208, -2, v208
    v_mfma_f32_16x16x32_bf16 v[252:255], v[40:43], v[120:123], v[252:255]
    ds_read_b128 v[168:171], v13 offset:43008
    v_min_u32 v209, -2, v209
    v_mfma_f32_16x16x32_bf16 v[252:255], v[44:47], v[124:127], v[252:255]
    ds_read_b128 v[172:175], v13 offset:44032
    v_min_u32 v210, -2, v210
    v_mfma_f32_16x16x32_bf16 v[248:251], v[36:39], v[124:127], v[248:251]
    ds_read_b128 v[176:179], v13 offset:45056
    v_min_u32 v211, -2, v211
    v_mfma_f32_16x16x32_bf16 v[248:251], v[32:35], v[120:123], v[248:251]
    ds_read_b128 v[180:183], v13 offset:46080
    v_min_u32 v212, -2, v212
    v_mfma_f32_16x16x32_bf16 v[192:195], v[32:35], v[64:67], v[192:195]
    ds_read_b128 v[184:187], v13 offset:47104
    v_min_u32 v213, -2, v213
    v_mfma_f32_16x16x32_bf16 v[192:195], v[36:39], v[68:71], v[192:195]
    ds_read_b128 v[188:191], v13 offset:48128
    v_min_u32 v214, -2, v214
    v_mfma_f32_16x16x32_bf16 v[196:199], v[44:47], v[68:71], v[196:199]
    v_min_u32 v215, -2, v215
    v_cvt_pk_bf16_f32 v224, v224, v225
    v_mfma_f32_16x16x32_bf16 v[196:199], v[40:43], v[64:67], v[196:199]
    v_cvt_pk_bf16_f32 v225, v226, v227
    v_cvt_pk_bf16_f32 v226, v228, v229
    v_mfma_f32_16x16x32_bf16 v[204:207], v[40:43], v[72:75], v[204:207]
    v_cvt_pk_bf16_f32 v227, v230, v231
    v_cvt_pk_bf16_f32 v228, v232, v233
    v_mfma_f32_16x16x32_bf16 v[204:207], v[44:47], v[76:79], v[204:207]
    v_cvt_pk_bf16_f32 v229, v234, v235
    v_cvt_pk_bf16_f32 v230, v236, v237
    v_mfma_f32_16x16x32_bf16 v[200:203], v[36:39], v[76:79], v[200:203]
    v_cvt_pk_bf16_f32 v231, v238, v239
    v_mfma_f32_16x16x32_bf16 v[200:203], v[32:35], v[72:75], v[200:203]
    s_waitcnt lgkmcnt(0)
    v_mfma_f32_16x16x32_bf16 v[32:35], a[160:163], v[128:131], 0
    s_waitcnt vmcnt(8)
    v_min_u32 v224, -2, v224
    v_min_u32 v225, -2, v225
    v_min_u32 v226, -2, v226
    v_mfma_f32_16x16x32_bf16 v[32:35], a[168:171], v[132:135], v[32:35]
    s_barrier
    v_min_u32 v227, -2, v227
    v_min_u32 v228, -2, v228
    v_min_u32 v229, -2, v229
    v_mfma_f32_16x16x32_bf16 v[32:35], a[176:179], v[136:139], v[32:35]
    s_add_u32 m0, s60, 0
    ds_read_b128 v[64:67], v13 offset:49152
    v_min_u32 v230, -2, v230
    v_min_u32 v231, -2, v231
    v_mfma_f32_16x16x32_bf16 v[32:35], a[184:187], v[140:143], v[32:35]
    s_add_u32 s62, s42, s16
    ds_read_b128 v[68:71], v13 offset:50176
    v_cvt_pk_bf16_f32 v240, v240, v241
    v_cvt_pk_bf16_f32 v241, v242, v243
    v_mfma_f32_16x16x32_bf16 v[32:35], a[0:3], v[144:147], v[32:35]
    buffer_load_dwordx4 v1, s[28:31], s62 offen offset:0 sc1 lds
    v_cvt_pk_bf16_f32 v242, v244, v245
    v_mfma_f32_16x16x32_bf16 v[32:35], a[8:11], v[148:151], v[32:35]
    buffer_load_dwordx4 v1, s[28:31], s62 offen offset:1024 sc1 lds
    v_cvt_pk_bf16_f32 v243, v246, v247
    v_mfma_f32_16x16x32_bf16 v[32:35], a[16:19], v[152:155], v[32:35]
    ds_read_b128 v[72:75], v13 offset:51200
    v_cvt_pk_bf16_f32 v244, v248, v249
    v_cvt_pk_bf16_f32 v245, v250, v251
    v_mfma_f32_16x16x32_bf16 v[32:35], a[24:27], v[156:159], v[32:35]
    ds_read_b128 v[76:79], v13 offset:52224
    v_cvt_pk_bf16_f32 v246, v252, v253
    v_cvt_pk_bf16_f32 v247, v254, v255
    v_mfma_f32_16x16x32_bf16 v[36:39], a[28:31], v[156:159], 0
    buffer_load_dwordx4 v1, s[28:31], s62 offen offset:2048 sc1 lds
    v_min_u32 v240, -2, v240
    v_mfma_f32_16x16x32_bf16 v[36:39], a[20:23], v[152:155], v[36:39]
    ds_read_b128 v[80:83], v13 offset:53248
    v_min_u32 v241, -2, v241
    v_min_u32 v242, -2, v242
    v_mfma_f32_16x16x32_bf16 v[36:39], a[12:15], v[148:151], v[36:39]
    ds_read_b128 v[84:87], v13 offset:54272
    v_min_u32 v243, -2, v243
    v_min_u32 v244, -2, v244
    v_mfma_f32_16x16x32_bf16 v[36:39], a[4:7], v[144:147], v[36:39]
    buffer_load_dwordx4 v1, s[28:31], s62 offen offset:3072 sc1 lds
    v_min_u32 v245, -2, v245
    v_mfma_f32_16x16x32_bf16 v[36:39], a[188:191], v[140:143], v[36:39]
    s_xor_b32 s64, s92, 106496
    ds_read_b128 v[88:91], v13 offset:55296
    v_min_u32 v246, -2, v246
    v_min_u32 v247, -2, v247
    v_mfma_f32_16x16x32_bf16 v[36:39], a[180:183], v[136:139], v[36:39]
    ds_read_b128 v[92:95], v13 offset:56320
    v_mfma_f32_16x16x32_bf16 v[36:39], a[172:175], v[132:135], v[36:39]
    buffer_store_dwordx4 v[208:211], v1, s[32:35], s64 offen offset:0 sc1
    v_mfma_f32_16x16x32_bf16 v[36:39], a[164:167], v[128:131], v[36:39]
    ds_read_b128 v[96:99], v13 offset:57344
    v_mfma_f32_16x16x32_bf16 v[44:47], a[164:167], v[160:163], 0
    ds_read_b128 v[100:103], v13 offset:58368
    v_mfma_f32_16x16x32_bf16 v[44:47], a[172:175], v[164:167], v[44:47]
    buffer_store_dwordx4 v[212:215], v1, s[32:35], s64 offen offset:1024 sc1
    v_mfma_f32_16x16x32_bf16 v[44:47], a[180:183], v[168:171], v[44:47]
    s_xor_b32 s64, s92, 180224
    ds_read_b128 v[104:107], v13 offset:59392
    v_mfma_f32_16x16x32_bf16 v[44:47], a[188:191], v[172:175], v[44:47]
    ds_read_b128 v[108:111], v13 offset:60416
    v_mfma_f32_16x16x32_bf16 v[44:47], a[4:7], v[176:179], v[44:47]
    buffer_store_dwordx4 v[224:227], v1, s[32:35], s64 offen offset:0 sc1
    v_mfma_f32_16x16x32_bf16 v[44:47], a[12:15], v[180:183], v[44:47]
    ds_read_b128 v[112:115], v13 offset:61440
    v_mfma_f32_16x16x32_bf16 v[44:47], a[20:23], v[184:187], v[44:47]
    ds_read_b128 v[116:119], v13 offset:62464
    v_mfma_f32_16x16x32_bf16 v[44:47], a[28:31], v[188:191], v[44:47]
    buffer_store_dwordx4 v[228:231], v1, s[32:35], s64 offen offset:1024 sc1
    v_mfma_f32_16x16x32_bf16 v[40:43], a[24:27], v[188:191], 0
    s_xor_b32 s64, s92, 253952
    ds_read_b128 v[120:123], v13 offset:63488
    v_mfma_f32_16x16x32_bf16 v[40:43], a[16:19], v[184:187], v[40:43]
    ds_read_b128 v[124:127], v13 offset:64512
    v_mfma_f32_16x16x32_bf16 v[40:43], a[8:11], v[180:183], v[40:43]
    buffer_store_dwordx4 v[240:243], v1, s[32:35], s64 offen offset:0 sc1
    v_mfma_f32_16x16x32_bf16 v[40:43], a[0:3], v[176:179], v[40:43]
    v_mfma_f32_16x16x32_bf16 v[40:43], a[184:187], v[172:175], v[40:43]
    v_mfma_f32_16x16x32_bf16 v[40:43], a[176:179], v[168:171], v[40:43]
    buffer_store_dwordx4 v[244:247], v1, s[32:35], s64 offen offset:1024 sc1
    v_mfma_f32_16x16x32_bf16 v[40:43], a[168:171], v[164:167], v[40:43]
    v_mfma_f32_16x16x32_bf16 v[40:43], a[160:163], v[160:163], v[40:43]
    s_waitcnt lgkmcnt(0)
    v_mfma_f32_16x16x32_bf16 v[32:35], a[32:35], v[64:67], v[32:35]
    s_waitcnt vmcnt(14)
    v_mfma_f32_16x16x32_bf16 v[32:35], a[40:43], v[68:71], v[32:35]
    s_barrier
    v_mfma_f32_16x16x32_bf16 v[32:35], a[48:51], v[72:75], v[32:35]
    ds_read_b128 v[128:131], v20 offset:0
    v_mfma_f32_16x16x32_bf16 v[32:35], a[56:59], v[76:79], v[32:35]
    ds_read_b128 v[132:135], v20 offset:1024
    v_mfma_f32_16x16x32_bf16 v[32:35], a[64:67], v[80:83], v[32:35]
    ds_read_b128 v[136:139], v20 offset:2048
    v_mfma_f32_16x16x32_bf16 v[32:35], a[72:75], v[84:87], v[32:35]
    v_mfma_f32_16x16x32_bf16 v[32:35], a[80:83], v[88:91], v[32:35]
    ds_read_b128 v[140:143], v20 offset:3072
    v_mfma_f32_16x16x32_bf16 v[32:35], a[88:91], v[92:95], v[32:35]
    ds_read_b128 v[144:147], v20 offset:4096
    v_mfma_f32_16x16x32_bf16 v[36:39], a[92:95], v[92:95], v[36:39]
    ds_read_b128 v[148:151], v20 offset:5120
    v_mfma_f32_16x16x32_bf16 v[36:39], a[84:87], v[88:91], v[36:39]
    ds_read_b128 v[152:155], v20 offset:6144
    v_mfma_f32_16x16x32_bf16 v[36:39], a[76:79], v[84:87], v[36:39]
    ds_read_b128 v[156:159], v20 offset:7168
    v_mfma_f32_16x16x32_bf16 v[36:39], a[68:71], v[80:83], v[36:39]
    v_mfma_f32_16x16x32_bf16 v[36:39], a[60:63], v[76:79], v[36:39]
    ds_read_b128 v[160:163], v20 offset:8192
    v_mfma_f32_16x16x32_bf16 v[36:39], a[52:55], v[72:75], v[36:39]
    ds_read_b128 v[164:167], v20 offset:9216
    v_mfma_f32_16x16x32_bf16 v[36:39], a[44:47], v[68:71], v[36:39]
    ds_read_b128 v[168:171], v20 offset:10240
    v_mfma_f32_16x16x32_bf16 v[36:39], a[36:39], v[64:67], v[36:39]
    ds_read_b128 v[172:175], v20 offset:11264
    v_mfma_f32_16x16x32_bf16 v[44:47], a[36:39], v[96:99], v[44:47]
    ds_read_b128 v[176:179], v20 offset:12288
    v_mfma_f32_16x16x32_bf16 v[44:47], a[44:47], v[100:103], v[44:47]
    v_mfma_f32_16x16x32_bf16 v[44:47], a[52:55], v[104:107], v[44:47]
    ds_read_b128 v[180:183], v20 offset:13312
    v_mfma_f32_16x16x32_bf16 v[44:47], a[60:63], v[108:111], v[44:47]
    ds_read_b128 v[184:187], v20 offset:14336
    v_mfma_f32_16x16x32_bf16 v[44:47], a[68:71], v[112:115], v[44:47]
    ds_read_b128 v[188:191], v20 offset:15360
    v_mfma_f32_16x16x32_bf16 v[44:47], a[76:79], v[116:119], v[44:47]
    v_mfma_f32_16x16x32_bf16 v[44:47], a[84:87], v[120:123], v[44:47]
    v_mfma_f32_16x16x32_bf16 v[44:47], a[92:95], v[124:127], v[44:47]
    v_mfma_f32_16x16x32_bf16 v[40:43], a[88:91], v[124:127], v[40:43]
    v_mfma_f32_16x16x32_bf16 v[40:43], a[80:83], v[120:123], v[40:43]
    v_mfma_f32_16x16x32_bf16 v[40:43], a[72:75], v[116:119], v[40:43]
    v_mfma_f32_16x16x32_bf16 v[40:43], a[64:67], v[112:115], v[40:43]
    v_mfma_f32_16x16x32_bf16 v[40:43], a[56:59], v[108:111], v[40:43]
    v_mfma_f32_16x16x32_bf16 v[40:43], a[48:51], v[104:107], v[40:43]
    v_mfma_f32_16x16x32_bf16 v[40:43], a[40:43], v[100:103], v[40:43]
    v_mfma_f32_16x16x32_bf16 v[40:43], a[32:35], v[96:99], v[40:43]
    s_waitcnt lgkmcnt(0)
    v_mfma_f32_16x16x32_bf16 v[32:35], a[96:99], v[128:131], v[32:35]
    s_waitcnt vmcnt(10)
    v_mfma_f32_16x16x32_bf16 v[32:35], a[104:107], v[132:135], v[32:35]
    s_barrier
    v_mfma_f32_16x16x32_bf16 v[32:35], a[112:115], v[136:139], v[32:35]
    s_add_u32 m0, s60, 16384
    ds_read_b128 v[64:67], v20 offset:16384
    v_mfma_f32_16x16x32_bf16 v[32:35], a[120:123], v[140:143], v[32:35]
    s_add_u32 s62, s42, s17
    ds_read_b128 v[68:71], v20 offset:17408
    v_mfma_f32_16x16x32_bf16 v[32:35], a[128:131], v[144:147], v[32:35]
    buffer_load_dwordx4 v1, s[28:31], s62 offen offset:0 sc1 lds
    v_mfma_f32_16x16x32_bf16 v[32:35], a[136:139], v[148:151], v[32:35]
    ds_read_b128 v[72:75], v20 offset:18432
    v_mfma_f32_16x16x32_bf16 v[32:35], a[144:147], v[152:155], v[32:35]
    buffer_load_dwordx4 v1, s[28:31], s62 offen offset:1024 sc1 lds
    v_mfma_f32_16x16x32_bf16 v[32:35], a[152:155], v[156:159], v[32:35]
    ds_read_b128 v[76:79], v20 offset:19456
    v_mfma_f32_16x16x32_bf16 v[36:39], a[156:159], v[156:159], v[36:39]
    ds_read_b128 v[80:83], v20 offset:20480
    v_mfma_f32_16x16x32_bf16 v[36:39], a[148:151], v[152:155], v[36:39]
    ds_read_b128 v[84:87], v20 offset:21504
    v_mfma_f32_16x16x32_bf16 v[36:39], a[140:143], v[148:151], v[36:39]
    buffer_load_dwordx4 v1, s[28:31], s62 offen offset:2048 sc1 lds
    v_mfma_f32_16x16x32_bf16 v[36:39], a[132:135], v[144:147], v[36:39]
    ds_read_b128 v[88:91], v20 offset:22528
    v_mfma_f32_16x16x32_bf16 v[36:39], a[124:127], v[140:143], v[36:39]
    ds_read_b128 v[92:95], v20 offset:23552
    v_mfma_f32_16x16x32_bf16 v[36:39], a[116:119], v[136:139], v[36:39]
    ds_read_b128 v[96:99], v20 offset:24576
    v_mfma_f32_16x16x32_bf16 v[36:39], a[108:111], v[132:135], v[36:39]
    buffer_load_dwordx4 v1, s[28:31], s62 offen offset:3072 sc1 lds
    v_mfma_f32_16x16x32_bf16 v[36:39], a[100:103], v[128:131], v[36:39]
    s_add_u32 m0, s60, 32768
    ds_read_b128 v[100:103], v20 offset:25600
    v_mfma_f32_16x16x32_bf16 v[44:47], a[100:103], v[160:163], v[44:47]
    s_add_u32 s62, s42, s18
    ds_read_b128 v[104:107], v20 offset:26624
    v_mfma_f32_16x16x32_bf16 v[44:47], a[108:111], v[164:167], v[44:47]
    buffer_load_dwordx4 v1, s[28:31], s62 offen offset:0 sc1 lds
    v_mfma_f32_16x16x32_bf16 v[44:47], a[116:119], v[168:171], v[44:47]
    ds_read_b128 v[108:111], v20 offset:27648
    v_mfma_f32_16x16x32_bf16 v[44:47], a[124:127], v[172:175], v[44:47]
    ds_read_b128 v[112:115], v20 offset:28672
    v_mfma_f32_16x16x32_bf16 v[44:47], a[132:135], v[176:179], v[44:47]
    ds_read_b128 v[116:119], v20 offset:29696
    v_mfma_f32_16x16x32_bf16 v[44:47], a[140:143], v[180:183], v[44:47]
    buffer_load_dwordx4 v1, s[28:31], s62 offen offset:1024 sc1 lds
    v_mfma_f32_16x16x32_bf16 v[44:47], a[148:151], v[184:187], v[44:47]
    ds_read_b128 v[120:123], v20 offset:30720
    v_mfma_f32_16x16x32_bf16 v[44:47], a[156:159], v[188:191], v[44:47]
    ds_read_b128 v[124:127], v20 offset:31744
    v_mfma_f32_16x16x32_bf16 v[40:43], a[152:155], v[188:191], v[40:43]
    v_mfma_f32_16x16x32_bf16 v[40:43], a[144:147], v[184:187], v[40:43]
    buffer_load_dwordx4 v1, s[28:31], s62 offen offset:2048 sc1 lds
    v_mfma_f32_16x16x32_bf16 v[40:43], a[136:139], v[180:183], v[40:43]
    v_mfma_f32_16x16x32_bf16 v[40:43], a[128:131], v[176:179], v[40:43]
    v_mfma_f32_16x16x32_bf16 v[40:43], a[120:123], v[172:175], v[40:43]
    v_mfma_f32_16x16x32_bf16 v[40:43], a[112:115], v[168:171], v[40:43]
    buffer_load_dwordx4 v1, s[28:31], s62 offen offset:3072 sc1 lds
    v_mfma_f32_16x16x32_bf16 v[40:43], a[104:107], v[164:167], v[40:43]
    v_mfma_f32_16x16x32_bf16 v[40:43], a[96:99], v[160:163], v[40:43]
    s_waitcnt lgkmcnt(0)
    v_mfma_f32_16x16x32_bf16 v[32:35], a[192:195], v[64:67], v[32:35]
    s_waitcnt vmcnt(14)
    v_mfma_f32_16x16x32_bf16 v[32:35], a[200:203], v[68:71], v[32:35]
    s_barrier
    v_mfma_f32_16x16x32_bf16 v[32:35], a[208:211], v[72:75], v[32:35]
    s_add_u32 m0, s60, 49152
    ds_read_b128 v[128:131], v12 offset:0
    v_mfma_f32_16x16x32_bf16 v[32:35], a[216:219], v[76:79], v[32:35]
    s_add_u32 s62, s42, s19
    ds_read_b128 v[132:135], v12 offset:1024
    v_mfma_f32_16x16x32_bf16 v[32:35], a[224:227], v[80:83], v[32:35]
    buffer_load_dwordx4 v1, s[28:31], s62 offen offset:0 sc1 lds
    v_mfma_f32_16x16x32_bf16 v[32:35], a[232:235], v[84:87], v[32:35]
    ds_read_b128 v[136:139], v12 offset:2048
    v_mfma_f32_16x16x32_bf16 v[32:35], a[240:243], v[88:91], v[32:35]
    ds_read_b128 v[140:143], v12 offset:3072
    v_mfma_f32_16x16x32_bf16 v[32:35], a[248:251], v[92:95], v[32:35]
    buffer_load_dwordx4 v1, s[28:31], s62 offen offset:1024 sc1 lds
    v_mfma_f32_16x16x32_bf16 v[36:39], a[252:255], v[92:95], v[36:39]
    ds_read_b128 v[144:147], v12 offset:4096
    v_mfma_f32_16x16x32_bf16 v[36:39], a[244:247], v[88:91], v[36:39]
    ds_read_b128 v[148:151], v12 offset:5120
    v_mfma_f32_16x16x32_bf16 v[36:39], a[236:239], v[84:87], v[36:39]
    ds_read_b128 v[152:155], v12 offset:6144
    v_mfma_f32_16x16x32_bf16 v[36:39], a[228:231], v[80:83], v[36:39]
    buffer_load_dwordx4 v1, s[28:31], s62 offen offset:2048 sc1 lds
    v_mfma_f32_16x16x32_bf16 v[36:39], a[220:223], v[76:79], v[36:39]
    ds_read_b128 v[156:159], v12 offset:7168
    v_mfma_f32_16x16x32_bf16 v[36:39], a[212:215], v[72:75], v[36:39]
    ds_read_b128 v[160:163], v12 offset:8192
    v_mfma_f32_16x16x32_bf16 v[36:39], a[204:207], v[68:71], v[36:39]
    ds_read_b128 v[164:167], v12 offset:9216
    v_mfma_f32_16x16x32_bf16 v[36:39], a[196:199], v[64:67], v[36:39]
    buffer_load_dwordx4 v1, s[28:31], s62 offen offset:3072 sc1 lds
    v_mfma_f32_16x16x32_bf16 v[44:47], a[196:199], v[96:99], v[44:47]
    ds_read_b128 v[168:171], v12 offset:10240
    v_mfma_f32_16x16x32_bf16 v[44:47], a[204:207], v[100:103], v[44:47]
    ds_read_b128 v[172:175], v12 offset:11264
    v_mfma_f32_16x16x32_bf16 v[44:47], a[212:215], v[104:107], v[44:47]
    ds_read_b128 v[176:179], v12 offset:12288
    v_mfma_f32_16x16x32_bf16 v[44:47], a[220:223], v[108:111], v[44:47]
    ds_read_b128 v[180:183], v12 offset:13312
    v_mfma_f32_16x16x32_bf16 v[44:47], a[228:231], v[112:115], v[44:47]
    ds_read_b128 v[184:187], v12 offset:14336
    v_mfma_f32_16x16x32_bf16 v[44:47], a[236:239], v[116:119], v[44:47]
    ds_read_b128 v[188:191], v12 offset:15360
    v_mfma_f32_16x16x32_bf16 v[44:47], a[244:247], v[120:123], v[44:47]
    v_mfma_f32_16x16x32_bf16 v[44:47], a[252:255], v[124:127], v[44:47]
    v_mfma_f32_16x16x32_bf16 v[40:43], a[248:251], v[124:127], v[40:43]
    v_mfma_f32_16x16x32_bf16 v[40:43], a[240:243], v[120:123], v[40:43]
    v_mfma_f32_16x16x32_bf16 v[40:43], a[232:235], v[116:119], v[40:43]
    v_mfma_f32_16x16x32_bf16 v[40:43], a[224:227], v[112:115], v[40:43]
    v_mfma_f32_16x16x32_bf16 v[40:43], a[216:219], v[108:111], v[40:43]
    v_mfma_f32_16x16x32_bf16 v[40:43], a[208:211], v[104:107], v[40:43]
    v_mfma_f32_16x16x32_bf16 v[40:43], a[200:203], v[100:103], v[40:43]
    v_mfma_f32_16x16x32_bf16 v[40:43], a[192:195], v[96:99], v[40:43]
    s_waitcnt lgkmcnt(0)
    v_mfma_f32_16x16x32_bf16 v[48:51], a[160:163], v[128:131], 0
    s_waitcnt vmcnt(8)
    v_mfma_f32_16x16x32_bf16 v[48:51], a[168:171], v[132:135], v[48:51]
    s_barrier
    v_mfma_f32_16x16x32_bf16 v[48:51], a[176:179], v[136:139], v[48:51]
    s_add_u32 m0, s60, 65536
    ds_read_b128 v[64:67], v12 offset:16384
    ds_read_b128 v[68:71], v12 offset:17408
    v_cvt_pk_bf16_f32 v216, v32, v33
    v_mfma_f32_16x16x32_bf16 v[48:51], a[184:187], v[140:143], v[48:51]
    s_add_u32 s62, s43, s16
    ds_read_b128 v[72:75], v12 offset:18432
    v_cvt_pk_bf16_f32 v217, v34, v35
    v_cvt_pk_bf16_f32 v218, v36, v37
    v_mfma_f32_16x16x32_bf16 v[48:51], a[0:3], v[144:147], v[48:51]
    buffer_load_dwordx4 v1, s[28:31], s62 offen offset:0 sc1 lds
    v_cvt_pk_bf16_f32 v219, v38, v39
    v_mfma_f32_16x16x32_bf16 v[48:51], a[8:11], v[148:151], v[48:51]
    buffer_load_dwordx4 v1, s[28:31], s62 offen offset:1024 sc1 lds
    v_cvt_pk_bf16_f32 v220, v40, v41
    v_mfma_f32_16x16x32_bf16 v[48:51], a[16:19], v[152:155], v[48:51]
    ds_read_b128 v[76:79], v12 offset:19456
    v_cvt_pk_bf16_f32 v221, v42, v43
    v_cvt_pk_bf16_f32 v222, v44, v45
    v_mfma_f32_16x16x32_bf16 v[48:51], a[24:27], v[156:159], v[48:51]
    buffer_load_dwordx4 v1, s[28:31], s62 offen offset:2048 sc1 lds
    v_cvt_pk_bf16_f32 v223, v46, v47
    v_mfma_f32_16x16x32_bf16 v[52:55], a[28:31], v[156:159], 0
    ds_read_b128 v[80:83], v12 offset:20480
    v_min_u32 v216, -2, v216
    v_min_u32 v217, -2, v217
    v_mfma_f32_16x16x32_bf16 v[52:55], a[20:23], v[152:155], v[52:55]
    ds_read_b128 v[84:87], v12 offset:21504
    v_min_u32 v218, -2, v218
    v_min_u32 v219, -2, v219
    v_mfma_f32_16x16x32_bf16 v[52:55], a[12:15], v[148:151], v[52:55]
    buffer_load_dwordx4 v1, s[28:31], s62 offen offset:3072 sc1 lds
    v_min_u32 v220, -2, v220
    v_mfma_f32_16x16x32_bf16 v[52:55], a[4:7], v[144:147], v[52:55]
    s_add_u32 s64, s92, 40960
    ds_read_b128 v[88:91], v12 offset:22528
    v_min_u32 v221, -2, v221
    v_min_u32 v222, -2, v222
    v_mfma_f32_16x16x32_bf16 v[52:55], a[188:191], v[140:143], v[52:55]
    buffer_load_dwordx4 v[208:211], v1, s[32:35], s64 offen offset:0 sc1
    v_min_u32 v223, -2, v223
    v_mfma_f32_16x16x32_bf16 v[52:55], a[180:183], v[136:139], v[52:55]
    ds_read_b128 v[92:95], v12 offset:23552
    v_mfma_f32_16x16x32_bf16 v[52:55], a[172:175], v[132:135], v[52:55]
    buffer_load_dwordx4 v[212:215], v1, s[32:35], s64 offen offset:1024 sc1
    v_mfma_f32_16x16x32_bf16 v[52:55], a[164:167], v[128:131], v[52:55]
    s_add_u32 s64, s92, 49152
    ds_read_b128 v[96:99], v12 offset:24576
    v_mfma_f32_16x16x32_bf16 v[60:63], a[164:167], v[160:163], 0
    ds_read_b128 v[100:103], v12 offset:25600
    v_mfma_f32_16x16x32_bf16 v[60:63], a[172:175], v[164:167], v[60:63]
    buffer_load_dwordx4 v[224:227], v1, s[32:35], s64 offen offset:0 sc1
    v_mfma_f32_16x16x32_bf16 v[60:63], a[180:183], v[168:171], v[60:63]
    ds_read_b128 v[104:107], v12 offset:26624
    v_mfma_f32_16x16x32_bf16 v[60:63], a[188:191], v[172:175], v[60:63]
    buffer_load_dwordx4 v[228:231], v1, s[32:35], s64 offen offset:1024 sc1
    v_mfma_f32_16x16x32_bf16 v[60:63], a[4:7], v[176:179], v[60:63]
    s_add_u32 s64, s92, 57344
    ds_read_b128 v[108:111], v12 offset:27648
    v_mfma_f32_16x16x32_bf16 v[60:63], a[12:15], v[180:183], v[60:63]
    buffer_load_dwordx4 v[240:243], v1, s[32:35], s64 offen offset:0 sc1
    v_mfma_f32_16x16x32_bf16 v[60:63], a[20:23], v[184:187], v[60:63]
    ds_read_b128 v[112:115], v12 offset:28672
    v_mfma_f32_16x16x32_bf16 v[60:63], a[28:31], v[188:191], v[60:63]
    ds_read_b128 v[116:119], v12 offset:29696
    v_mfma_f32_16x16x32_bf16 v[56:59], a[24:27], v[188:191], 0
    buffer_load_dwordx4 v[244:247], v1, s[32:35], s64 offen offset:1024 sc1
    v_mfma_f32_16x16x32_bf16 v[56:59], a[16:19], v[184:187], v[56:59]
    s_xor_b32 s64, s92, 73728
    ds_read_b128 v[120:123], v12 offset:30720
    v_mfma_f32_16x16x32_bf16 v[56:59], a[8:11], v[180:183], v[56:59]
    buffer_store_dwordx4 v[216:219], v1, s[32:35], s64 offen offset:0 sc1
    v_mfma_f32_16x16x32_bf16 v[56:59], a[0:3], v[176:179], v[56:59]
    ds_read_b128 v[124:127], v12 offset:31744
    v_mfma_f32_16x16x32_bf16 v[56:59], a[184:187], v[172:175], v[56:59]
    v_mfma_f32_16x16x32_bf16 v[56:59], a[176:179], v[168:171], v[56:59]
    buffer_store_dwordx4 v[220:223], v1, s[32:35], s64 offen offset:1024 sc1
    v_mfma_f32_16x16x32_bf16 v[56:59], a[168:171], v[164:167], v[56:59]
    v_mfma_f32_16x16x32_bf16 v[56:59], a[160:163], v[160:163], v[56:59]
    s_waitcnt lgkmcnt(0)
    v_mfma_f32_16x16x32_bf16 v[48:51], a[32:35], v[64:67], v[48:51]
    s_waitcnt vmcnt(16)
    v_and_b32 v10, 15, v0
    v_bfe_u32 v11, v0, 4, 2
    v_mfma_f32_16x16x32_bf16 v[48:51], a[40:43], v[68:71], v[48:51]
    s_barrier
    v_and_b32 v18, 7, v0
    v_xor_b32 v11, v11, v18
    v_mfma_f32_16x16x32_bf16 v[48:51], a[48:51], v[72:75], v[48:51]
    ds_read_b128 v[128:131], v12 offset:32768
    v_lshlrev_b32 v10, 7, v10
    v_mfma_f32_16x16x32_bf16 v[48:51], a[56:59], v[76:79], v[48:51]
    ds_read_b128 v[132:135], v12 offset:33792
    v_lshl_add_u32 v10, v11, 4, v10
    v_mfma_f32_16x16x32_bf16 v[48:51], a[64:67], v[80:83], v[48:51]
    ds_read_b128 v[136:139], v12 offset:34816
    v_add_u32 v10, s60, v10
    v_mfma_f32_16x16x32_bf16 v[48:51], a[72:75], v[84:87], v[48:51]
    v_xor_b32 v11, 64, v10
    v_and_b32 v18, 3, v0
    v_mfma_f32_16x16x32_bf16 v[48:51], a[80:83], v[88:91], v[48:51]
    ds_read_b128 v[140:143], v12 offset:35840
    v_lshlrev_b32 v18, 1, v18
    v_mfma_f32_16x16x32_bf16 v[48:51], a[88:91], v[92:95], v[48:51]
    ds_read_b128 v[144:147], v12 offset:36864
    v_bfe_u32 v19, v0, 2, 3
    v_mfma_f32_16x16x32_bf16 v[52:55], a[92:95], v[92:95], v[52:55]
    ds_read_b128 v[148:151], v12 offset:37888
    v_xor_b32 v18, v18, v19
    v_mfma_f32_16x16x32_bf16 v[52:55], a[84:87], v[88:91], v[52:55]
    ds_read_b128 v[152:155], v12 offset:38912
    v_bfe_u32 v19, v0, 2, 4
    v_mfma_f32_16x16x32_bf16 v[52:55], a[76:79], v[84:87], v[52:55]
    ds_read_b128 v[156:159], v12 offset:39936
    v_lshlrev_b32 v19, 7, v19
    v_mfma_f32_16x16x32_bf16 v[52:55], a[68:71], v[80:83], v[52:55]
    v_lshl_add_u32 v18, v18, 4, v19
    v_add_u32 v18, s60, v18
    v_mfma_f32_16x16x32_bf16 v[52:55], a[60:63], v[76:79], v[52:55]
    ds_read_b128 v[160:163], v12 offset:40960
    v_xor_b32 v19, 16, v18
    v_mfma_f32_16x16x32_bf16 v[52:55], a[52:55], v[72:75], v[52:55]
    ds_read_b128 v[164:167], v12 offset:41984
    v_mfma_f32_16x16x32_bf16 v[52:55], a[44:47], v[68:71], v[52:55]
    ds_read_b128 v[168:171], v12 offset:43008
    v_mfma_f32_16x16x32_bf16 v[52:55], a[36:39], v[64:67], v[52:55]
    ds_read_b128 v[172:175], v12 offset:44032
    v_mfma_f32_16x16x32_bf16 v[60:63], a[36:39], v[96:99], v[60:63]
    ds_read_b128 v[176:179], v12 offset:45056
    v_mfma_f32_16x16x32_bf16 v[60:63], a[44:47], v[100:103], v[60:63]
    v_mfma_f32_16x16x32_bf16 v[60:63], a[52:55], v[104:107], v[60:63]
    ds_read_b128 v[180:183], v12 offset:46080
    v_mfma_f32_16x16x32_bf16 v[60:63], a[60:63], v[108:111], v[60:63]
    ds_read_b128 v[184:187], v12 offset:47104
    v_mfma_f32_16x16x32_bf16 v[60:63], a[68:71], v[112:115], v[60:63]
    ds_read_b128 v[188:191], v12 offset:48128
    v_mfma_f32_16x16x32_bf16 v[60:63], a[76:79], v[116:119], v[60:63]
    v_mfma_f32_16x16x32_bf16 v[60:63], a[84:87], v[120:123], v[60:63]
    v_mfma_f32_16x16x32_bf16 v[60:63], a[92:95], v[124:127], v[60:63]
    v_mfma_f32_16x16x32_bf16 v[56:59], a[88:91], v[124:127], v[56:59]
    v_mfma_f32_16x16x32_bf16 v[56:59], a[80:83], v[120:123], v[56:59]
    v_mfma_f32_16x16x32_bf16 v[56:59], a[72:75], v[116:119], v[56:59]
    v_mfma_f32_16x16x32_bf16 v[56:59], a[64:67], v[112:115], v[56:59]
    v_mfma_f32_16x16x32_bf16 v[56:59], a[56:59], v[108:111], v[56:59]
    v_mfma_f32_16x16x32_bf16 v[56:59], a[48:51], v[104:107], v[56:59]
    v_mfma_f32_16x16x32_bf16 v[56:59], a[40:43], v[100:103], v[56:59]
    v_mfma_f32_16x16x32_bf16 v[56:59], a[32:35], v[96:99], v[56:59]
    s_waitcnt lgkmcnt(0)
    v_mfma_f32_16x16x32_bf16 v[48:51], a[96:99], v[128:131], v[48:51]
    s_waitcnt vmcnt(12)
    v_mfma_f32_16x16x32_bf16 v[48:51], a[104:107], v[132:135], v[48:51]
    s_barrier
    v_mfma_f32_16x16x32_bf16 v[48:51], a[112:115], v[136:139], v[48:51]
    s_add_u32 m0, s60, 81920
    ds_read_b128 v[64:67], v12 offset:49152
    v_mfma_f32_16x16x32_bf16 v[48:51], a[120:123], v[140:143], v[48:51]
    s_add_u32 s62, s43, s17
    ds_read_b128 v[68:71], v12 offset:50176
    v_mfma_f32_16x16x32_bf16 v[48:51], a[128:131], v[144:147], v[48:51]
    buffer_load_dwordx4 v1, s[28:31], s62 offen offset:0 sc1 lds
    v_mfma_f32_16x16x32_bf16 v[48:51], a[136:139], v[148:151], v[48:51]
    ds_read_b128 v[72:75], v12 offset:51200
    v_mfma_f32_16x16x32_bf16 v[48:51], a[144:147], v[152:155], v[48:51]
    buffer_load_dwordx4 v1, s[28:31], s62 offen offset:1024 sc1 lds
    v_mfma_f32_16x16x32_bf16 v[48:51], a[152:155], v[156:159], v[48:51]
    ds_read_b128 v[76:79], v12 offset:52224
    v_mfma_f32_16x16x32_bf16 v[52:55], a[156:159], v[156:159], v[52:55]
    ds_read_b128 v[80:83], v12 offset:53248
    v_mfma_f32_16x16x32_bf16 v[52:55], a[148:151], v[152:155], v[52:55]
    ds_read_b128 v[84:87], v12 offset:54272
    v_mfma_f32_16x16x32_bf16 v[52:55], a[140:143], v[148:151], v[52:55]
    buffer_load_dwordx4 v1, s[28:31], s62 offen offset:2048 sc1 lds
    v_mfma_f32_16x16x32_bf16 v[52:55], a[132:135], v[144:147], v[52:55]
    ds_read_b128 v[88:91], v12 offset:55296
    v_mfma_f32_16x16x32_bf16 v[52:55], a[124:127], v[140:143], v[52:55]
    ds_read_b128 v[92:95], v12 offset:56320
    v_mfma_f32_16x16x32_bf16 v[52:55], a[116:119], v[136:139], v[52:55]
    ds_read_b128 v[96:99], v12 offset:57344
    v_mfma_f32_16x16x32_bf16 v[52:55], a[108:111], v[132:135], v[52:55]
    buffer_load_dwordx4 v1, s[28:31], s62 offen offset:3072 sc1 lds
    v_mfma_f32_16x16x32_bf16 v[52:55], a[100:103], v[128:131], v[52:55]
    s_add_u32 m0, s60, 98304
    ds_read_b128 v[100:103], v12 offset:58368
    v_mfma_f32_16x16x32_bf16 v[60:63], a[100:103], v[160:163], v[60:63]
    s_add_u32 s62, s43, s18
    ds_read_b128 v[104:107], v12 offset:59392
    v_mfma_f32_16x16x32_bf16 v[60:63], a[108:111], v[164:167], v[60:63]
    buffer_load_dwordx4 v1, s[28:31], s62 offen offset:0 sc1 lds
    v_mfma_f32_16x16x32_bf16 v[60:63], a[116:119], v[168:171], v[60:63]
    ds_read_b128 v[108:111], v12 offset:60416
    v_mfma_f32_16x16x32_bf16 v[60:63], a[124:127], v[172:175], v[60:63]
    ds_read_b128 v[112:115], v12 offset:61440
    v_mfma_f32_16x16x32_bf16 v[60:63], a[132:135], v[176:179], v[60:63]
    ds_read_b128 v[116:119], v12 offset:62464
    v_mfma_f32_16x16x32_bf16 v[60:63], a[140:143], v[180:183], v[60:63]
    buffer_load_dwordx4 v1, s[28:31], s62 offen offset:1024 sc1 lds
    v_mfma_f32_16x16x32_bf16 v[60:63], a[148:151], v[184:187], v[60:63]
    ds_read_b128 v[120:123], v12 offset:63488
    v_mfma_f32_16x16x32_bf16 v[60:63], a[156:159], v[188:191], v[60:63]
    ds_read_b128 v[124:127], v12 offset:64512
    v_mfma_f32_16x16x32_bf16 v[56:59], a[152:155], v[188:191], v[56:59]
    v_mfma_f32_16x16x32_bf16 v[56:59], a[144:147], v[184:187], v[56:59]
    buffer_load_dwordx4 v1, s[28:31], s62 offen offset:2048 sc1 lds
    v_mfma_f32_16x16x32_bf16 v[56:59], a[136:139], v[180:183], v[56:59]
    v_mfma_f32_16x16x32_bf16 v[56:59], a[128:131], v[176:179], v[56:59]
    v_mfma_f32_16x16x32_bf16 v[56:59], a[120:123], v[172:175], v[56:59]
    v_mfma_f32_16x16x32_bf16 v[56:59], a[112:115], v[168:171], v[56:59]
    buffer_load_dwordx4 v1, s[28:31], s62 offen offset:3072 sc1 lds
    v_mfma_f32_16x16x32_bf16 v[56:59], a[104:107], v[164:167], v[56:59]
    v_mfma_f32_16x16x32_bf16 v[56:59], a[96:99], v[160:163], v[56:59]
    s_waitcnt lgkmcnt(0)
    v_mfma_f32_16x16x32_bf16 v[48:51], a[192:195], v[64:67], v[48:51]
    s_waitcnt vmcnt(10)
    v_max3_u32 v28, v208, v209, v210
    v_max3_u32 v29, v211, v212, v213
    v_mfma_f32_16x16x32_bf16 v[48:51], a[200:203], v[68:71], v[48:51]
    s_barrier
    v_max3_u32 v29, v29, v214, v215
    v_max3_u32 v28, v28, v224, v225
    v_mfma_f32_16x16x32_bf16 v[48:51], a[208:211], v[72:75], v[48:51]
    s_add_u32 m0, s60, 114688
    ds_read_b128 v[128:131], v13 offset:0
    v_max3_u32 v29, v29, v226, v227
    v_mfma_f32_16x16x32_bf16 v[48:51], a[216:219], v[76:79], v[48:51]
    s_add_u32 s62, s43, s19
    ds_read_b128 v[132:135], v13 offset:1024
    v_max3_u32 v28, v28, v228, v229
    v_mfma_f32_16x16x32_bf16 v[48:51], a[224:227], v[80:83], v[48:51]
    buffer_load_dwordx4 v1, s[28:31], s62 offen offset:0 sc1 lds
    v_mfma_f32_16x16x32_bf16 v[48:51], a[232:235], v[84:87], v[48:51]
    ds_read_b128 v[136:139], v13 offset:2048
    v_max3_u32 v29, v29, v230, v231
    v_mfma_f32_16x16x32_bf16 v[48:51], a[240:243], v[88:91], v[48:51]
    ds_read_b128 v[140:143], v13 offset:3072
    v_max3_u32 v28, v28, v240, v241
    v_mfma_f32_16x16x32_bf16 v[48:51], a[248:251], v[92:95], v[48:51]
    buffer_load_dwordx4 v1, s[28:31], s62 offen offset:1024 sc1 lds
    v_mfma_f32_16x16x32_bf16 v[52:55], a[252:255], v[92:95], v[52:55]
    ds_read_b128 v[144:147], v13 offset:4096
    v_max3_u32 v29, v29, v242, v243
    v_mfma_f32_16x16x32_bf16 v[52:55], a[244:247], v[88:91], v[52:55]
    ds_read_b128 v[148:151], v13 offset:5120
    v_max3_u32 v28, v28, v244, v245
    v_mfma_f32_16x16x32_bf16 v[52:55], a[236:239], v[84:87], v[52:55]
    ds_read_b128 v[152:155], v13 offset:6144
    v_max3_u32 v29, v29, v246, v247
    v_mfma_f32_16x16x32_bf16 v[52:55], a[228:231], v[80:83], v[52:55]
    buffer_load_dwordx4 v1, s[28:31], s62 offen offset:2048 sc1 lds
    v_mfma_f32_16x16x32_bf16 v[52:55], a[220:223], v[76:79], v[52:55]
    ds_read_b128 v[156:159], v13 offset:7168
    v_max_u32 v28, v28, v29
    v_mfma_f32_16x16x32_bf16 v[52:55], a[212:215], v[72:75], v[52:55]
    ds_read_b128 v[160:163], v13 offset:8192
    v_cmp_eq_u32 vcc, -1, v28
    s_nop 0
    s_cmp_eq_u64 vcc, 0
    s_cbranch_scc0 L_spin_g
L_back_g:
    v_mfma_f32_16x16x32_bf16 v[52:55], a[204:207], v[68:71], v[52:55]
    ds_read_b128 v[164:167], v13 offset:9216
    v_lshlrev_b32 v2, 16, v208
    v_mfma_f32_16x16x32_bf16 v[52:55], a[196:199], v[64:67], v[52:55]
    buffer_load_dwordx4 v1, s[28:31], s62 offen offset:3072 sc1 lds
    v_mfma_f32_16x16x32_bf16 v[60:63], a[196:199], v[96:99], v[60:63]
    ds_read_b128 v[168:171], v13 offset:10240
    v_and_b32 v3, 0xffff0000, v208
    v_mfma_f32_16x16x32_bf16 v[60:63], a[204:207], v[100:103], v[60:63]
    ds_read_b128 v[172:175], v13 offset:11264
    v_lshlrev_b32 v4, 16, v209
    v_mfma_f32_16x16x32_bf16 v[60:63], a[212:215], v[104:107], v[60:63]
    ds_read_b128 v[176:179], v13 offset:12288
    v_and_b32 v5, 0xffff0000, v209
    v_mfma_f32_16x16x32_bf16 v[60:63], a[220:223], v[108:111], v[60:63]
    ds_read_b128 v[180:183], v13 offset:13312
    v_lshlrev_b32 v6, 16, v210
    v_mfma_f32_16x16x32_bf16 v[60:63], a[228:231], v[112:115], v[60:63]
    ds_read_b128 v[184:187], v13 offset:14336
    v_and_b32 v7, 0xffff0000, v210
    v_mfma_f32_16x16x32_bf16 v[60:63], a[236:239], v[116:119], v[60:63]
    ds_read_b128 v[188:191], v13 offset:15360
    v_lshlrev_b32 v8, 16, v211
    v_mfma_f32_16x16x32_bf16 v[60:63], a[244:247], v[120:123], v[60:63]
    v_and_b32 v9, 0xffff0000, v211
    v_add_f32 v192, v192, v2
    v_mfma_f32_16x16x32_bf16 v[60:63], a[252:255], v[124:127], v[60:63]
    v_add_f32 v193, v193, v3
    v_add_f32 v194, v194, v4
    v_mfma_f32_16x16x32_bf16 v[56:59], a[248:251], v[124:127], v[56:59]
    v_add_f32 v195, v195, v5
    v_add_f32 v196, v196, v6
    v_mfma_f32_16x16x32_bf16 v[56:59], a[240:243], v[120:123], v[56:59]
    v_add_f32 v197, v197, v7
    v_add_f32 v198, v198, v8
    v_mfma_f32_16x16x32_bf16 v[56:59], a[232:235], v[116:119], v[56:59]
    v_add_f32 v199, v199, v9
    v_lshlrev_b32 v2, 16, v212
    v_mfma_f32_16x16x32_bf16 v[56:59], a[224:227], v[112:115], v[56:59]
    v_and_b32 v3, 0xffff0000, v212
    v_lshlrev_b32 v4, 16, v213
    v_mfma_f32_16x16x32_bf16 v[56:59], a[216:219], v[108:111], v[56:59]
    v_and_b32 v5, 0xffff0000, v213
    v_lshlrev_b32 v6, 16, v214
    v_mfma_f32_16x16x32_bf16 v[56:59], a[208:211], v[104:107], v[56:59]
    v_and_b32 v7, 0xffff0000, v214
    v_lshlrev_b32 v8, 16, v215
    v_mfma_f32_16x16x32_bf16 v[56:59], a[200:203], v[100:103], v[56:59]
    v_and_b32 v9, 0xffff0000, v215
    v_add_f32 v200, v200, v2
    v_mfma_f32_16x16x32_bf16 v[56:59], a[192:195], v[96:99], v[56:59]
    s_waitcnt lgkmcnt(0)
    v_add_f32 v201, v201, v3
    v_add_f32 v202, v202, v4
    v_mfma_f32_16x16x32_bf16 v[32:35], a[160:163], v[128:131], 0
    s_waitcnt vmcnt(8)
    v_add_f32 v203, v203, v5
    v_add_f32 v204, v204, v6
    v_mfma_f32_16x16x32_bf16 v[32:35], a[168:171], v[132:135], v[32:35]
    s_barrier
    v_add_f32 v205, v205, v7
    v_add_f32 v206, v206, v8
    v_mfma_f32_16x16x32_bf16 v[32:35], a[176:179], v[136:139], v[32:35]
    s_add_u32 m0, s60, 131072
    ds_read_b128 v[64:67], v13 offset:16384
    v_cvt_pk_bf16_f32 v232, v48, v49
    v_mfma_f32_16x16x32_bf16 v[32:35], a[184:187], v[140:143], v[32:35]
    s_add_u32 s62, s40, s16
    ds_read_b128 v[68:71], v13 offset:17408
    v_cvt_pk_bf16_f32 v233, v50, v51
    v_mfma_f32_16x16x32_bf16 v[32:35], a[0:3], v[144:147], v[32:35]
    buffer_load_dwordx4 v1, s[28:31], s62 offen offset:0 sc1 lds
    v_mfma_f32_16x16x32_bf16 v[32:35], a[8:11], v[148:151], v[32:35]
    ds_read_b128 v[72:75], v13 offset:18432
    v_cvt_pk_bf16_f32 v234, v52, v53
    v_mfma_f32_16x16x32_bf16 v[32:35], a[16:19], v[152:155], v[32:35]
    buffer_load_dwordx4 v1, s[28:31], s62 offen offset:1024 sc1 lds
    v_mfma_f32_16x16x32_bf16 v[32:35], a[24:27], v[156:159], v[32:35]
    ds_read_b128 v[76:79], v13 offset:19456
    v_cvt_pk_bf16_f32 v235, v54, v55
    v_mfma_f32_16x16x32_bf16 v[36:39], a[28:31], v[156:159], 0
    ds_read_b128 v[80:83], v13 offset:20480
    v_cvt_pk_bf16_f32 v236, v56, v57
    v_mfma_f32_16x16x32_bf16 v[36:39], a[20:23], v[152:155], v[36:39]
    ds_read_b128 v[84:87], v13 offset:21504
    v_cvt_pk_bf16_f32 v237, v58, v59
    v_mfma_f32_16x16x32_bf16 v[36:39], a[12:15], v[148:151], v[36:39]
    buffer_load_dwordx4 v1, s[28:31], s62 offen offset:2048 sc1 lds
    v_mfma_f32_16x16x32_bf16 v[36:39], a[4:7], v[144:147], v[36:39]
    ds_read_b128 v[88:91], v13 offset:22528
    v_cvt_pk_bf16_f32 v238, v60, v61
    v_mfma_f32_16x16x32_bf16 v[36:39], a[188:191], v[140:143], v[36:39]
    ds_read_b128 v[92:95], v13 offset:23552
    v_cvt_pk_bf16_f32 v239, v62, v63
    v_mfma_f32_16x16x32_bf16 v[36:39], a[180:183], v[136:139], v[36:39]
    ds_read_b128 v[96:99], v13 offset:24576
    v_min_u32 v232, -2, v232
    v_mfma_f32_16x16x32_bf16 v[36:39], a[172:175], v[132:135], v[36:39]
    buffer_load_dwordx4 v1, s[28:31], s62 offen offset:3072 sc1 lds
    v_mfma_f32_16x16x32_bf16 v[36:39], a[164:167], v[128:131], v[36:39]
    s_add_u32 s64, s92, 8192
    ds_read_b128 v[100:103], v13 offset:25600
    v_min_u32 v233, -2, v233
    v_mfma_f32_16x16x32_bf16 v[44:47], a[164:167], v[160:163], 0
    ds_read_b128 v[104:107], v13 offset:26624
    v_min_u32 v234, -2, v234
    v_mfma_f32_16x16x32_bf16 v[44:47], a[172:175], v[164:167], v[44:47]
    buffer_load_dwordx4 v[216:219], v1, s[32:35], s64 offen offset:0 sc1
    v_mfma_f32_16x16x32_bf16 v[44:47], a[180:183], v[168:171], v[44:47]
    ds_read_b128 v[108:111], v13 offset:27648
    v_min_u32 v235, -2, v235
    v_mfma_f32_16x16x32_bf16 v[44:47], a[188:191], v[172:175], v[44:47]
    ds_read_b128 v[112:115], v13 offset:28672
    v_min_u32 v236, -2, v236
    v_mfma_f32_16x16x32_bf16 v[44:47], a[4:7], v[176:179], v[44:47]
    ds_read_b128 v[116:119], v13 offset:29696
    v_min_u32 v237, -2, v237
    v_mfma_f32_16x16x32_bf16 v[44:47], a[12:15], v[180:183], v[44:47]
    buffer_load_dwordx4 v[220:223], v1, s[32:35], s64 offen offset:1024 sc1
    v_mfma_f32_16x16x32_bf16 v[44:47], a[20:23], v[184:187], v[44:47]
    ds_read_b128 v[120:123], v13 offset:30720
    v_min_u32 v238, -2, v238
    v_mfma_f32_16x16x32_bf16 v[44:47], a[28:31], v[188:191], v[44:47]
    s_xor_b32 s64, s92, 147456
    ds_read_b128 v[124:127], v13 offset:31744
    v_min_u32 v239, -2, v239
    v_mfma_f32_16x16x32_bf16 v[40:43], a[24:27], v[188:191], 0
    v_add_f32 v207, v207, v9
    v_lshlrev_b32 v2, 16, v224
    v_mfma_f32_16x16x32_bf16 v[40:43], a[16:19], v[184:187], v[40:43]
    buffer_store_dwordx4 v[232:235], v1, s[32:35], s64 offen offset:0 sc1
    v_mfma_f32_16x16x32_bf16 v[40:43], a[8:11], v[180:183], v[40:43]
    v_and_b32 v3, 0xffff0000, v224
    v_lshlrev_b32 v4, 16, v225
    v_mfma_f32_16x16x32_bf16 v[40:43], a[0:3], v[176:179], v[40:43]
    v_and_b32 v5, 0xffff0000, v225
    v_lshlrev_b32 v6, 16, v226
    v_mfma_f32_16x16x32_bf16 v[40:43], a[184:187], v[172:175], v[40:43]
    v_and_b32 v7, 0xffff0000, v226
    v_lshlrev_b32 v8, 16, v227
    v_mfma_f32_16x16x32_bf16 v[40:43], a[176:179], v[168:171], v[40:43]
    buffer_store_dwordx4 v[236:239], v1, s[32:35], s64 offen offset:1024 sc1
    v_mfma_f32_16x16x32_bf16 v[40:43], a[168:171], v[164:167], v[40:43]
    v_and_b32 v9, 0xffff0000, v227
    v_add_f32 v192, v192, v2
    v_mfma_f32_16x16x32_bf16 v[40:43], a[160:163], v[160:163], v[40:43]
    s_waitcnt lgkmcnt(0)
    v_add_f32 v193, v193, v3
    v_add_f32 v194, v194, v4
    v_mfma_f32_16x16x32_bf16 v[32:35], a[32:35], v[64:67], v[32:35]
    s_waitcnt vmcnt(12)
    v_add_f32 v195, v195, v5
    v_add_f32 v196, v196, v6
    v_mfma_f32_16x16x32_bf16 v[32:35], a[40:43], v[68:71], v[32:35]
    s_barrier
    v_add_f32 v197, v197, v7
    v_add_f32 v198, v198, v8
    v_mfma_f32_16x16x32_bf16 v[32:35], a[48:51], v[72:75], v[32:35]
    ds_read_b128 v[128:131], v13 offset:32768
    v_add_f32 v199, v199, v9
    v_mfma_f32_16x16x32_bf16 v[32:35], a[56:59], v[76:79], v[32:35]
    ds_read_b128 v[132:135], v13 offset:33792
    v_lshlrev_b32 v2, 16, v228
    v_mfma_f32_16x16x32_bf16 v[32:35], a[64:67], v[80:83], v[32:35]
    ds_read_b128 v[136:139], v13 offset:34816
    v_and_b32 v3, 0xffff0000, v228
    v_mfma_f32_16x16x32_bf16 v[32:35], a[72:75], v[84:87], v[32:35]
    v_lshlrev_b32 v4, 16, v229
    v_and_b32 v5, 0xffff0000, v229
    v_mfma_f32_16x16x32_bf16 v[32:35], a[80:83], v[88:91], v[32:35]
    ds_read_b128 v[140:143], v13 offset:35840
    v_lshlrev_b32 v6, 16, v230
    v_mfma_f32_16x16x32_bf16 v[32:35], a[88:91], v[92:95], v[32:35]
    ds_read_b128 v[144:147], v13 offset:36864
    v_and_b32 v7, 0xffff0000, v230
    v_mfma_f32_16x16x32_bf16 v[36:39], a[92:95], v[92:95], v[36:39]
    ds_read_b128 v[148:151], v13 offset:37888
    v_lshlrev_b32 v8, 16, v231
    v_mfma_f32_16x16x32_bf16 v[36:39], a[84:87], v[88:91], v[36:39]
    ds_read_b128 v[152:155], v13 offset:38912
    v_and_b32 v9, 0xffff0000, v231
    v_mfma_f32_16x16x32_bf16 v[36:39], a[76:79], v[84:87], v[36:39]
    ds_read_b128 v[156:159], v13 offset:39936
    v_add_f32 v200, v200, v2
    v_mfma_f32_16x16x32_bf16 v[36:39], a[68:71], v[80:83], v[36:39]
    v_add_f32 v201, v201, v3
    v_add_f32 v202, v202, v4
    v_mfma_f32_16x16x32_bf16 v[36:39], a[60:63], v[76:79], v[36:39]
    ds_read_b128 v[160:163], v13 offset:40960
    v_add_f32 v203, v203, v5
    v_mfma_f32_16x16x32_bf16 v[36:39], a[52:55], v[72:75], v[36:39]
    ds_read_b128 v[164:167], v13 offset:41984
    v_add_f32 v204, v204, v6
    v_mfma_f32_16x16x32_bf16 v[36:39], a[44:47], v[68:71], v[36:39]
    ds_read_b128 v[168:171], v13 offset:43008
    v_add_f32 v205, v205, v7
    v_mfma_f32_16x16x32_bf16 v[36:39], a[36:39], v[64:67], v[36:39]
    ds_read_b128 v[172:175], v13 offset:44032
    v_add_f32 v206, v206, v8
    v_mfma_f32_16x16x32_bf16 v[44:47], a[36:39], v[96:99], v[44:47]
    ds_read_b128 v[176:179], v13 offset:45056
    v_add_f32 v207, v207, v9
    v_mfma_f32_16x16x32_bf16 v[44:47], a[44:47], v[100:103], v[44:47]
    v_lshlrev_b32 v2, 16, v240
    v_and_b32 v3, 0xffff0000, v240
    v_mfma_f32_16x16x32_bf16 v[44:47], a[52:55], v[104:107], v[44:47]
    ds_read_b128 v[180:183], v13 offset:46080
    v_lshlrev_b32 v4, 16, v241
    v_mfma_f32_16x16x32_bf16 v[44:47], a[60:63], v[108:111], v[44:47]
    ds_read_b128 v[184:187], v13 offset:47104
    v_and_b32 v5, 0xffff0000, v241
    v_mfma_f32_16x16x32_bf16 v[44:47], a[68:71], v[112:115], v[44:47]
    ds_read_b128 v[188:191], v13 offset:48128
    v_lshlrev_b32 v6, 16, v242
    v_mfma_f32_16x16x32_bf16 v[44:47], a[76:79], v[116:119], v[44:47]
    v_and_b32 v7, 0xffff0000, v242
    v_lshlrev_b32 v8, 16, v243
    v_mfma_f32_16x16x32_bf16 v[44:47], a[84:87], v[120:123], v[44:47]
    v_and_b32 v9, 0xffff0000, v243
    v_add_f32 v192, v192, v2
    v_mfma_f32_16x16x32_bf16 v[44:47], a[92:95], v[124:127], v[44:47]
    v_add_f32 v193, v193, v3
    v_add_f32 v194, v194, v4
    v_mfma_f32_16x16x32_bf16 v[40:43], a[88:91], v[124:127], v[40:43]
    v_add_f32 v195, v195, v5
    v_add_f32 v196, v196, v6
    v_mfma_f32_16x16x32_bf16 v[40:43], a[80:83], v[120:123], v[40:43]
    v_add_f32 v197, v197, v7
    v_add_f32 v198, v198, v8
    v_mfma_f32_16x16x32_bf16 v[40:43], a[72:75], v[116:119], v[40:43]
    v_add_f32 v199, v199, v9
    v_lshlrev_b32 v2, 16, v244
    v_mfma_f32_16x16x32_bf16 v[40:43], a[64:67], v[112:115], v[40:43]
    v_and_b32 v3, 0xffff0000, v244
    v_lshlrev_b32 v4, 16, v245
    v_mfma_f32_16x16x32_bf16 v[40:43], a[56:59], v[108:111], v[40:43]
    v_and_b32 v5, 0xffff0000, v245
    v_lshlrev_b32 v6, 16, v246
    v_mfma_f32_16x16x32_bf16 v[40:43], a[48:51], v[104:107], v[40:43]
    v_and_b32 v7, 0xffff0000, v246
    v_lshlrev_b32 v8, 16, v247
    v_mfma_f32_16x16x32_bf16 v[40:43], a[40:43], v[100:103], v[40:43]
    v_and_b32 v9, 0xffff0000, v247
    v_add_f32 v200, v200, v2
    v_mfma_f32_16x16x32_bf16 v[40:43], a[32:35], v[96:99], v[40:43]
    s_waitcnt lgkmcnt(0)
    v_add_f32 v201, v201, v3
    v_add_f32 v202, v202, v4
    v_mfma_f32_16x16x32_bf16 v[32:35], a[96:99], v[128:131], v[32:35]
    s_waitcnt vmcnt(8)
    v_add_f32 v203, v203, v5
    v_add_f32 v204, v204, v6
    v_mfma_f32_16x16x32_bf16 v[32:35], a[104:107], v[132:135], v[32:35]
    s_barrier
    v_add_f32 v205, v205, v7
    v_add_f32 v206, v206, v8
    v_mfma_f32_16x16x32_bf16 v[32:35], a[112:115], v[136:139], v[32:35]
    s_add_u32 m0, s60, 147456
    ds_read_b128 v[64:67], v13 offset:49152
    v_add_f32 v207, v207, v9
    v_mfma_f32_16x16x32_bf16 v[32:35], a[120:123], v[140:143], v[32:35]
    s_add_u32 s62, s40, s17
    ds_read_b128 v[68:71], v13 offset:50176
    v_mul_f32 v2, 0xbfb8aa3b, v192
    v_mfma_f32_16x16x32_bf16 v[32:35], a[128:131], v[144:147], v[32:35]
    buffer_load_dwordx4 v1, s[28:31], s62 offen offset:0 sc1 lds
    v_mfma_f32_16x16x32_bf16 v[32:35], a[136:139], v[148:151], v[32:35]
    ds_read_b128 v[72:75], v13 offset:51200
    v_mul_f32 v3, 0xbfb8aa3b, v193
    v_mfma_f32_16x16x32_bf16 v[32:35], a[144:147], v[152:155], v[32:35]
    buffer_load_dwordx4 v1, s[28:31], s62 offen offset:1024 sc1 lds
    v_mfma_f32_16x16x32_bf16 v[32:35], a[152:155], v[156:159], v[32:35]
    ds_read_b128 v[76:79], v13 offset:52224
    v_mul_f32 v4, 0xbfb8aa3b, v194
    v_mfma_f32_16x16x32_bf16 v[36:39], a[156:159], v[156:159], v[36:39]
    ds_read_b128 v[80:83], v13 offset:53248
    v_mul_f32 v5, 0xbfb8aa3b, v195
    v_mfma_f32_16x16x32_bf16 v[36:39], a[148:151], v[152:155], v[36:39]
    ds_read_b128 v[84:87], v13 offset:54272
    v_mul_f32 v6, 0xbfb8aa3b, v196
    v_mfma_f32_16x16x32_bf16 v[36:39], a[140:143], v[148:151], v[36:39]
    buffer_load_dwordx4 v1, s[28:31], s62 offen offset:2048 sc1 lds
    v_mfma_f32_16x16x32_bf16 v[36:39], a[132:135], v[144:147], v[36:39]
    ds_read_b128 v[88:91], v13 offset:55296
    v_mul_f32 v7, 0xbfb8aa3b, v197
    v_mfma_f32_16x16x32_bf16 v[36:39], a[124:127], v[140:143], v[36:39]
    ds_read_b128 v[92:95], v13 offset:56320
    v_mul_f32 v8, 0xbfb8aa3b, v198
    v_mfma_f32_16x16x32_bf16 v[36:39], a[116:119], v[136:139], v[36:39]
    ds_read_b128 v[96:99], v13 offset:57344
    v_mul_f32 v9, 0xbfb8aa3b, v199
    v_mfma_f32_16x16x32_bf16 v[36:39], a[108:111], v[132:135], v[36:39]
    buffer_load_dwordx4 v1, s[28:31], s62 offen offset:3072 sc1 lds
    v_mfma_f32_16x16x32_bf16 v[36:39], a[100:103], v[128:131], v[36:39]
    s_add_u32 m0, s60, 0
    ds_read_b128 v[100:103], v13 offset:58368
    v_mfma_f32_16x16x32_bf16 v[44:47], a[100:103], v[160:163], v[44:47]
    s_add_u32 s62, s40, s18
    ds_read_b128 v[104:107], v13 offset:59392
    v_mfma_f32_16x16x32_bf16 v[44:47], a[108:111], v[164:167], v[44:47]
    buffer_load_dwordx4 v1, s[28:31], s62 offen offset:0 sc1 lds
    v_mfma_f32_16x16x32_bf16 v[44:47], a[116:119], v[168:171], v[44:47]
    ds_read_b128 v[108:111], v13 offset:60416
    v_mfma_f32_16x16x32_bf16 v[44:47], a[124:127], v[172:175], v[44:47]
    ds_read_b128 v[112:115], v13 offset:61440
    v_mfma_f32_16x16x32_bf16 v[44:47], a[132:135], v[176:179], v[44:47]
    ds_read_b128 v[116:119], v13 offset:62464
    v_mfma_f32_16x16x32_bf16 v[44:47], a[140:143], v[180:183], v[44:47]
    buffer_load_dwordx4 v1, s[28:31], s62 offen offset:1024 sc1 lds
    v_mfma_f32_16x16x32_bf16 v[44:47], a[148:151], v[184:187], v[44:47]
    ds_read_b128 v[120:123], v13 offset:63488
    v_mfma_f32_16x16x32_bf16 v[44:47], a[156:159], v[188:191], v[44:47]
    ds_read_b128 v[124:127], v13 offset:64512
    v_mfma_f32_16x16x32_bf16 v[40:43], a[152:155], v[188:191], v[40:43]
    v_exp_f32 v2, v2
    v_mfma_f32_16x16x32_bf16 v[40:43], a[144:147], v[184:187], v[40:43]
    buffer_load_dwordx4 v1, s[28:31], s62 offen offset:2048 sc1 lds
    v_mfma_f32_16x16x32_bf16 v[40:43], a[136:139], v[180:183], v[40:43]
    v_exp_f32 v3, v3
    v_mfma_f32_16x16x32_bf16 v[40:43], a[128:131], v[176:179], v[40:43]
    v_exp_f32 v4, v4
    v_mfma_f32_16x16x32_bf16 v[40:43], a[120:123], v[172:175], v[40:43]
    v_exp_f32 v5, v5
    v_mfma_f32_16x16x32_bf16 v[40:43], a[112:115], v[168:171], v[40:43]
    buffer_load_dwordx4 v1, s[28:31], s62 offen offset:3072 sc1 lds
    v_mfma_f32_16x16x32_bf16 v[40:43], a[104:107], v[164:167], v[40:43]
    v_exp_f32 v6, v6
    v_mfma_f32_16x16x32_bf16 v[40:43], a[96:99], v[160:163], v[40:43]
    s_waitcnt lgkmcnt(0)
    v_exp_f32 v7, v7
    v_mfma_f32_16x16x32_bf16 v[32:35], a[192:195], v[64:67], v[32:35]
    s_waitcnt vmcnt(10)
    v_max3_u32 v28, v216, v217, v218
    v_max3_u32 v29, v219, v220, v221
    v_mfma_f32_16x16x32_bf16 v[32:35], a[200:203], v[68:71], v[32:35]
    s_barrier
    v_max3_u32 v29, v29, v222, v223
    v_max_u32 v28, v28, v29
    v_mfma_f32_16x16x32_bf16 v[32:35], a[208:211], v[72:75], v[32:35]
    s_add_u32 m0, s60, 16384
    ds_read_b128 v[128:131], v20 offset:0
    v_cmp_eq_u32 vcc, -1, v28
    s_nop 0
    s_cmp_eq_u64 vcc, 0
    s_cbranch_scc0 L_spin_s1
L_back_s1:
    v_mfma_f32_16x16x32_bf16 v[32:35], a[216:219], v[76:79], v[32:35]
    s_add_u32 s62, s40, s19
    ds_read_b128 v[132:135], v20 offset:1024
    v_lshlrev_b32 v48, 16, v216
    v_mfma_f32_16x16x32_bf16 v[32:35], a[224:227], v[80:83], v[32:35]
    buffer_load_dwordx4 v1, s[28:31], s62 offen offset:0 sc1 lds
    v_mfma_f32_16x16x32_bf16 v[32:35], a[232:235], v[84:87], v[32:35]
    ds_read_b128 v[136:139], v20 offset:2048
    v_and_b32 v49, 0xffff0000, v216
    v_mfma_f32_16x16x32_bf16 v[32:35], a[240:243], v[88:91], v[32:35]
    ds_read_b128 v[140:143], v20 offset:3072
    v_lshlrev_b32 v50, 16, v217
    v_mfma_f32_16x16x32_bf16 v[32:35], a[248:251], v[92:95], v[32:35]
    buffer_load_dwordx4 v1, s[28:31], s62 offen offset:1024 sc1 lds
    v_mfma_f32_16x16x32_bf16 v[36:39], a[252:255], v[92:95], v[36:39]
    ds_read_b128 v[144:147], v20 offset:4096
    v_and_b32 v51, 0xffff0000, v217
    v_mfma_f32_16x16x32_bf16 v[36:39], a[244:247], v[88:91], v[36:39]
    ds_read_b128 v[148:151], v20 offset:5120
    v_lshlrev_b32 v52, 16, v218
    v_mfma_f32_16x16x32_bf16 v[36:39], a[236:239], v[84:87], v[36:39]
    ds_read_b128 v[152:155], v20 offset:6144
    v_and_b32 v53, 0xffff0000, v218
    v_mfma_f32_16x16x32_bf16 v[36:39], a[228:231], v[80:83], v[36:39]
    buffer_load_dwordx4 v1, s[28:31], s62 offen offset:2048 sc1 lds
    v_mfma_f32_16x16x32_bf16 v[36:39], a[220:223], v[76:79], v[36:39]
    ds_read_b128 v[156:159], v20 offset:7168
    v_lshlrev_b32 v54, 16, v219
    v_mfma_f32_16x16x32_bf16 v[36:39], a[212:215], v[72:75], v[36:39]
    ds_read_b128 v[160:163], v20 offset:8192
    v_and_b32 v55, 0xffff0000, v219
    v_mfma_f32_16x16x32_bf16 v[36:39], a[204:207], v[68:71], v[36:39]
    ds_read_b128 v[164:167], v20 offset:9216
    v_lshlrev_b32 v56, 16, v220
    v_mfma_f32_16x16x32_bf16 v[36:39], a[196:199], v[64:67], v[36:39]
    buffer_load_dwordx4 v1, s[28:31], s62 offen offset:3072 sc1 lds
    v_mfma_f32_16x16x32_bf16 v[44:47], a[196:199], v[96:99], v[44:47]
    ds_read_b128 v[168:171], v20 offset:10240
    v_and_b32 v57, 0xffff0000, v220
    v_mfma_f32_16x16x32_bf16 v[44:47], a[204:207], v[100:103], v[44:47]
    ds_read_b128 v[172:175], v20 offset:11264
    v_lshlrev_b32 v58, 16, v221
    v_mfma_f32_16x16x32_bf16 v[44:47], a[212:215], v[104:107], v[44:47]
    ds_read_b128 v[176:179], v20 offset:12288
    v_and_b32 v59, 0xffff0000, v221
    v_mfma_f32_16x16x32_bf16 v[44:47], a[220:223], v[108:111], v[44:47]
    ds_read_b128 v[180:183], v20 offset:13312
    v_lshlrev_b32 v60, 16, v222
    v_mfma_f32_16x16x32_bf16 v[44:47], a[228:231], v[112:115], v[44:47]
    ds_read_b128 v[184:187], v20 offset:14336
    v_and_b32 v61, 0xffff0000, v222
    v_mfma_f32_16x16x32_bf16 v[44:47], a[236:239], v[116:119], v[44:47]
    ds_read_b128 v[188:191], v20 offset:15360
    v_lshlrev_b32 v62, 16, v223
    v_mfma_f32_16x16x32_bf16 v[44:47], a[244:247], v[120:123], v[44:47]
    v_and_b32 v63, 0xffff0000, v223
    v_add_f32 v2, 1.0, v2
    v_mfma_f32_16x16x32_bf16 v[44:47], a[252:255], v[124:127], v[44:47]
    v_exp_f32 v8, v8
    v_mfma_f32_16x16x32_bf16 v[40:43], a[248:251], v[124:127], v[40:43]
    v_exp_f32 v9, v9
    v_mfma_f32_16x16x32_bf16 v[40:43], a[240:243], v[120:123], v[40:43]
    v_rcp_f32 v2, v2
    v_mfma_f32_16x16x32_bf16 v[40:43], a[232:235], v[116:119], v[40:43]
    v_add_f32 v3, 1.0, v3
    v_add_f32 v4, 1.0, v4
    v_mfma_f32_16x16x32_bf16 v[40:43], a[224:227], v[112:115], v[40:43]
    v_rcp_f32 v3, v3
    v_mfma_f32_16x16x32_bf16 v[40:43], a[216:219], v[108:111], v[40:43]
    v_rcp_f32 v4, v4
    v_mfma_f32_16x16x32_bf16 v[40:43], a[208:211], v[104:107], v[40:43]
    v_add_f32 v5, 1.0, v5
    v_add_f32 v6, 1.0, v6
    v_mfma_f32_16x16x32_bf16 v[40:43], a[200:203], v[100:103], v[40:43]
    v_rcp_f32 v5, v5
    v_mfma_f32_16x16x32_bf16 v[40:43], a[192:195], v[96:99], v[40:43]
    s_waitcnt lgkmcnt(0)
    v_rcp_f32 v6, v6
    v_mfma_f32_16x16x32_bf16 v[48:51], a[160:163], v[128:131], v[48:51]
    s_waitcnt vmcnt(8)
    v_add_f32 v7, 1.0, v7
    v_add_f32 v8, 1.0, v8
    v_mfma_f32_16x16x32_bf16 v[48:51], a[168:171], v[132:135], v[48:51]
    s_barrier
    v_rcp_f32 v7, v7
    v_mfma_f32_16x16x32_bf16 v[48:51], a[176:179], v[136:139], v[48:51]
    ds_read_b128 v[64:67], v20 offset:16384
    v_cvt_pk_bf16_f32 v248, v32, v33
    v_cvt_pk_bf16_f32 v249, v34, v35
    v_mfma_f32_16x16x32_bf16 v[48:51], a[184:187], v[140:143], v[48:51]
    ds_read_b128 v[68:71], v20 offset:17408
    v_cvt_pk_bf16_f32 v250, v36, v37
    v_cvt_pk_bf16_f32 v251, v38, v39
    v_mfma_f32_16x16x32_bf16 v[48:51], a[0:3], v[144:147], v[48:51]
    ds_read_b128 v[72:75], v20 offset:18432
    v_cvt_pk_bf16_f32 v252, v40, v41
    v_cvt_pk_bf16_f32 v253, v42, v43
    v_mfma_f32_16x16x32_bf16 v[48:51], a[8:11], v[148:151], v[48:51]
    ds_read_b128 v[76:79], v20 offset:19456
    v_cvt_pk_bf16_f32 v254, v44, v45
    v_cvt_pk_bf16_f32 v255, v46, v47
    v_mfma_f32_16x16x32_bf16 v[48:51], a[16:19], v[152:155], v[48:51]
    ds_read_b128 v[80:83], v20 offset:20480
    v_min_u32 v248, -2, v248
    v_min_u32 v249, -2, v249
    v_mfma_f32_16x16x32_bf16 v[48:51], a[24:27], v[156:159], v[48:51]
    ds_read_b128 v[84:87], v20 offset:21504
    v_min_u32 v250, -2, v250
    v_min_u32 v251, -2, v251
    v_mfma_f32_16x16x32_bf16 v[52:55], a[28:31], v[156:159], v[52:55]
    ds_read_b128 v[88:91], v20 offset:22528
    v_min_u32 v252, -2, v252
    v_min_u32 v253, -2, v253
    v_mfma_f32_16x16x32_bf16 v[52:55], a[20:23], v[152:155], v[52:55]
    ds_read_b128 v[92:95], v20 offset:23552
    v_min_u32 v254, -2, v254
    v_min_u32 v255, -2, v255
    v_mfma_f32_16x16x32_bf16 v[52:55], a[12:15], v[148:151], v[52:55]
    s_xor_b32 s64, s92, 221184
    ds_read_b128 v[96:99], v20 offset:24576
    v_add_f32 v9, 1.0, v9
    v_mfma_f32_16x16x32_bf16 v[52:55], a[4:7], v[144:147], v[52:55]
    ds_read_b128 v[100:103], v20 offset:25600
    v_mul_f32 v192, v192, v2
    v_mfma_f32_16x16x32_bf16 v[52:55], a[188:191], v[140:143], v[52:55]
    buffer_store_dwordx4 v[248:251], v1, s[32:35], s64 offen offset:0 sc1
    v_mfma_f32_16x16x32_bf16 v[52:55], a[180:183], v[136:139], v[52:55]
    ds_read_b128 v[104:107], v20 offset:26624
    v_mul_f32 v193, v193, v3
    v_mfma_f32_16x16x32_bf16 v[52:55], a[172:175], v[132:135], v[52:55]
    ds_read_b128 v[108:111], v20 offset:27648
    v_mul_f32 v194, v194, v4
    v_mfma_f32_16x16x32_bf16 v[52:55], a[164:167], v[128:131], v[52:55]
    buffer_store_dwordx4 v[252:255], v1, s[32:35], s64 offen offset:1024 sc1
    v_mfma_f32_16x16x32_bf16 v[60:63], a[164:167], v[160:163], v[60:63]
    ds_read_b128 v[112:115], v20 offset:28672
    v_mul_f32 v195, v195, v5
    v_mfma_f32_16x16x32_bf16 v[60:63], a[172:175], v[164:167], v[60:63]
    ds_read_b128 v[116:119], v20 offset:29696
    v_mul_f32 v196, v196, v6
    v_mfma_f32_16x16x32_bf16 v[60:63], a[180:183], v[168:171], v[60:63]
    buffer_load_dwordx4 v[208:211], v27, s[4:7], s15 offen
    v_mfma_f32_16x16x32_bf16 v[60:63], a[188:191], v[172:175], v[60:63]
    ds_read_b128 v[120:123], v20 offset:30720
    v_mul_f32 v197, v197, v7
    v_mfma_f32_16x16x32_bf16 v[60:63], a[4:7], v[176:179], v[60:63]
    ds_read_b128 v[124:127], v20 offset:31744
    v_mul_f32 v2, 0xbfb8aa3b, v200
    v_mfma_f32_16x16x32_bf16 v[60:63], a[12:15], v[180:183], v[60:63]
    v_rcp_f32 v8, v8
    v_mfma_f32_16x16x32_bf16 v[60:63], a[20:23], v[184:187], v[60:63]
    buffer_load_dwordx4 v[212:215], v27, s[4:7], s71 offen
    v_mfma_f32_16x16x32_bf16 v[60:63], a[28:31], v[188:191], v[60:63]
    s_add_u32 s64, s92, 16384
    v_rcp_f32 v9, v9
    v_mfma_f32_16x16x32_bf16 v[56:59], a[24:27], v[188:191], v[56:59]
    v_exp_f32 v2, v2
    v_mfma_f32_16x16x32_bf16 v[56:59], a[16:19], v[184:187], v[56:59]
    buffer_load_dwordx4 v[232:235], v1, s[32:35], s64 offen offset:0 sc1
    v_mfma_f32_16x16x32_bf16 v[56:59], a[8:11], v[180:183], v[56:59]
    v_mul_f32 v198, v198, v8
    v_mul_f32 v199, v199, v9
    v_mfma_f32_16x16x32_bf16 v[56:59], a[0:3], v[176:179], v[56:59]
    v_mul_f32 v3, 0xbfb8aa3b, v201
    v_mul_f32 v4, 0xbfb8aa3b, v202
    v_mfma_f32_16x16x32_bf16 v[56:59], a[184:187], v[172:175], v[56:59]
    v_exp_f32 v3, v3
    v_mfma_f32_16x16x32_bf16 v[56:59], a[176:179], v[168:171], v[56:59]
    buffer_load_dwordx4 v[236:239], v1, s[32:35], s64 offen offset:1024 sc1
    v_mfma_f32_16x16x32_bf16 v[56:59], a[168:171], v[164:167], v[56:59]
    v_exp_f32 v4, v4
    v_mfma_f32_16x16x32_bf16 v[56:59], a[160:163], v[160:163], v[56:59]
    s_waitcnt lgkmcnt(0)
    v_mul_f32 v5, 0xbfb8aa3b, v203
    v_mul_f32 v6, 0xbfb8aa3b, v204
    v_mfma_f32_16x16x32_bf16 v[48:51], a[32:35], v[64:67], v[48:51]
    s_waitcnt vmcnt(10)
    v_exp_f32 v5, v5
    v_mfma_f32_16x16x32_bf16 v[48:51], a[40:43], v[68:71], v[48:51]
    s_barrier
    v_exp_f32 v6, v6
    v_mfma_f32_16x16x32_bf16 v[48:51], a[48:51], v[72:75], v[48:51]
    ds_read_b128 v[128:131], v12 offset:0
    v_mul_f32 v7, 0xbfb8aa3b, v205
    v_mfma_f32_16x16x32_bf16 v[48:51], a[56:59], v[76:79], v[48:51]
    ds_read_b128 v[132:135], v12 offset:1024
    v_mul_f32 v8, 0xbfb8aa3b, v206
    v_mfma_f32_16x16x32_bf16 v[48:51], a[64:67], v[80:83], v[48:51]
    ds_read_b128 v[136:139], v12 offset:2048
    v_mul_f32 v9, 0xbfb8aa3b, v207
    v_mfma_f32_16x16x32_bf16 v[48:51], a[72:75], v[84:87], v[48:51]
    v_exp_f32 v7, v7
    v_mfma_f32_16x16x32_bf16 v[48:51], a[80:83], v[88:91], v[48:51]
    ds_read_b128 v[140:143], v12 offset:3072
    v_add_f32 v2, 1.0, v2
    v_mfma_f32_16x16x32_bf16 v[48:51], a[88:91], v[92:95], v[48:51]
    ds_read_b128 v[144:147], v12 offset:4096
    v_add_f32 v3, 1.0, v3
    v_mfma_f32_16x16x32_bf16 v[52:55], a[92:95], v[92:95], v[52:55]
    ds_read_b128 v[148:151], v12 offset:5120
    v_add_f32 v4, 1.0, v4
    v_mfma_f32_16x16x32_bf16 v[52:55], a[84:87], v[88:91], v[52:55]
    ds_read_b128 v[152:155], v12 offset:6144
    v_add_f32 v5, 1.0, v5
    v_mfma_f32_16x16x32_bf16 v[52:55], a[76:79], v[84:87], v[52:55]
    ds_read_b128 v[156:159], v12 offset:7168
    v_add_f32 v6, 1.0, v6
    v_mfma_f32_16x16x32_bf16 v[52:55], a[68:71], v[80:83], v[52:55]
    v_exp_f32 v8, v8
    v_mfma_f32_16x16x32_bf16 v[52:55], a[60:63], v[76:79], v[52:55]
    ds_read_b128 v[160:163], v12 offset:8192
    v_add_f32 v7, 1.0, v7
    v_mfma_f32_16x16x32_bf16 v[52:55], a[52:55], v[72:75], v[52:55]
    ds_read_b128 v[164:167], v12 offset:9216
    v_add_f32 v8, 1.0, v8
    v_mfma_f32_16x16x32_bf16 v[52:55], a[44:47], v[68:71], v[52:55]
    ds_read_b128 v[168:171], v12 offset:10240
    v_mfma_f32_16x16x32_bf16 v[52:55], a[36:39], v[64:67], v[52:55]
    ds_read_b128 v[172:175], v12 offset:11264
    v_mfma_f32_16x16x32_bf16 v[60:63], a[36:39], v[96:99], v[60:63]
    ds_read_b128 v[176:179], v12 offset:12288
    v_mfma_f32_16x16x32_bf16 v[60:63], a[44:47], v[100:103], v[60:63]
    v_exp_f32 v9, v9
    v_mfma_f32_16x16x32_bf16 v[60:63], a[52:55], v[104:107], v[60:63]
    ds_read_b128 v[180:183], v12 offset:13312
    v_add_f32 v9, 1.0, v9
    v_mfma_f32_16x16x32_bf16 v[60:63], a[60:63], v[108:111], v[60:63]
    ds_read_b128 v[184:187], v12 offset:14336
    v_mfma_f32_16x16x32_bf16 v[60:63], a[68:71], v[112:115], v[60:63]
    ds_read_b128 v[188:191], v12 offset:15360
    v_mfma_f32_16x16x32_bf16 v[60:63], a[76:79], v[116:119], v[60:63]
    v_rcp_f32 v2, v2
    v_mfma_f32_16x16x32_bf16 v[60:63], a[84:87], v[120:123], v[60:63]
    v_rcp_f32 v3, v3
    v_mfma_f32_16x16x32_bf16 v[60:63], a[92:95], v[124:127], v[60:63]
    v_rcp_f32 v4, v4
    v_mfma_f32_16x16x32_bf16 v[56:59], a[88:91], v[124:127], v[56:59]
    v_rcp_f32 v5, v5
    v_mfma_f32_16x16x32_bf16 v[56:59], a[80:83], v[120:123], v[56:59]
    v_rcp_f32 v6, v6
    v_mfma_f32_16x16x32_bf16 v[56:59], a[72:75], v[116:119], v[56:59]
    v_rcp_f32 v7, v7
    v_mfma_f32_16x16x32_bf16 v[56:59], a[64:67], v[112:115], v[56:59]
    v_rcp_f32 v8, v8
    v_mfma_f32_16x16x32_bf16 v[56:59], a[56:59], v[108:111], v[56:59]
    v_rcp_f32 v9, v9
    v_mfma_f32_16x16x32_bf16 v[56:59], a[48:51], v[104:107], v[56:59]
    v_mul_f32 v200, v200, v2
    v_mul_f32 v201, v201, v3
    v_mfma_f32_16x16x32_bf16 v[56:59], a[40:43], v[100:103], v[56:59]
    v_mul_f32 v202, v202, v4
    v_mul_f32 v203, v203, v5
    v_mfma_f32_16x16x32_bf16 v[56:59], a[32:35], v[96:99], v[56:59]
    s_waitcnt lgkmcnt(0)
    v_mul_f32 v204, v204, v6
    v_mul_f32 v205, v205, v7
    v_mfma_f32_16x16x32_bf16 v[48:51], a[96:99], v[128:131], v[48:51]
    s_waitcnt vmcnt(6)
    v_mul_f32 v206, v206, v8
    v_mul_f32 v207, v207, v9
    v_mfma_f32_16x16x32_bf16 v[48:51], a[104:107], v[132:135], v[48:51]
    s_barrier
    v_mfma_f32_16x16x32_bf16 v[48:51], a[112:115], v[136:139], v[48:51]
    s_add_u32 s64, s92, 24576
    ds_read_b128 v[64:67], v12 offset:16384
    v_mfma_f32_16x16x32_bf16 v[48:51], a[120:123], v[140:143], v[48:51]
    buffer_load_dwordx4 v[248:251], v1, s[32:35], s64 offen offset:0 sc1
    v_mfma_f32_16x16x32_bf16 v[48:51], a[128:131], v[144:147], v[48:51]
    ds_read_b128 v[68:71], v12 offset:17408
    v_mfma_f32_16x16x32_bf16 v[48:51], a[136:139], v[148:151], v[48:51]
    ds_read_b128 v[72:75], v12 offset:18432
    v_mfma_f32_16x16x32_bf16 v[48:51], a[144:147], v[152:155], v[48:51]
    ds_read_b128 v[76:79], v12 offset:19456
    v_mfma_f32_16x16x32_bf16 v[48:51], a[152:155], v[156:159], v[48:51]
    buffer_load_dwordx4 v[252:255], v1, s[32:35], s64 offen offset:1024 sc1
    v_mfma_f32_16x16x32_bf16 v[52:55], a[156:159], v[156:159], v[52:55]
    ds_read_b128 v[80:83], v12 offset:20480
    v_mfma_f32_16x16x32_bf16 v[52:55], a[148:151], v[152:155], v[52:55]
    ds_read_b128 v[84:87], v12 offset:21504
    v_mfma_f32_16x16x32_bf16 v[52:55], a[140:143], v[148:151], v[52:55]
    ds_read_b128 v[88:91], v12 offset:22528
    v_mfma_f32_16x16x32_bf16 v[52:55], a[132:135], v[144:147], v[52:55]
    ds_read_b128 v[92:95], v12 offset:23552
    v_mfma_f32_16x16x32_bf16 v[52:55], a[124:127], v[140:143], v[52:55]
    v_mfma_f32_16x16x32_bf16 v[52:55], a[116:119], v[136:139], v[52:55]
    ds_read_b128 v[96:99], v12 offset:24576
    v_mfma_f32_16x16x32_bf16 v[52:55], a[108:111], v[132:135], v[52:55]
    ds_read_b128 v[100:103], v12 offset:25600
    v_mfma_f32_16x16x32_bf16 v[52:55], a[100:103], v[128:131], v[52:55]
    ds_read_b128 v[104:107], v12 offset:26624
    v_mfma_f32_16x16x32_bf16 v[60:63], a[100:103], v[160:163], v[60:63]
    ds_read_b128 v[108:111], v12 offset:27648
    v_mfma_f32_16x16x32_bf16 v[60:63], a[108:111], v[164:167], v[60:63]
    ds_read_b128 v[112:115], v12 offset:28672
    v_mfma_f32_16x16x32_bf16 v[60:63], a[116:119], v[168:171], v[60:63]
    ds_read_b128 v[116:119], v12 offset:29696
    v_mfma_f32_16x16x32_bf16 v[60:63], a[124:127], v[172:175], v[60:63]
    ds_read_b128 v[120:123], v12 offset:30720
    v_mfma_f32_16x16x32_bf16 v[60:63], a[132:135], v[176:179], v[60:63]
    s_waitcnt vmcnt(2)
    ds_read_b128 v[124:127], v12 offset:31744
    v_max3_u32 v28, v232, v233, v234
    v_mfma_f32_16x16x32_bf16 v[60:63], a[140:143], v[180:183], v[60:63]
    v_max3_u32 v29, v235, v236, v237
    v_max3_u32 v29, v29, v238, v239
    v_mfma_f32_16x16x32_bf16 v[60:63], a[148:151], v[184:187], v[60:63]
    v_max_u32 v28, v28, v29
    v_mfma_f32_16x16x32_bf16 v[60:63], a[156:159], v[188:191], v[60:63]
    v_cmp_eq_u32 vcc, -1, v28
    s_nop 0
    s_cmp_eq_u64 vcc, 0
    s_cbranch_scc0 L_spin_s2
L_back_s2:
    v_mfma_f32_16x16x32_bf16 v[56:59], a[152:155], v[188:191], v[56:59]
    v_lshlrev_b32 v224, 16, v232
    v_and_b32 v225, 0xffff0000, v232
    v_mfma_f32_16x16x32_bf16 v[56:59], a[144:147], v[184:187], v[56:59]
    v_lshlrev_b32 v226, 16, v233
    v_and_b32 v227, 0xffff0000, v233
    v_mfma_f32_16x16x32_bf16 v[56:59], a[136:139], v[180:183], v[56:59]
    v_lshlrev_b32 v228, 16, v234
    v_and_b32 v229, 0xffff0000, v234
    v_mfma_f32_16x16x32_bf16 v[56:59], a[128:131], v[176:179], v[56:59]
    v_lshlrev_b32 v230, 16, v235
    v_and_b32 v231, 0xffff0000, v235
    v_mfma_f32_16x16x32_bf16 v[56:59], a[120:123], v[172:175], v[56:59]
    v_lshlrev_b32 v240, 16, v236
    v_and_b32 v241, 0xffff0000, v236
    v_mfma_f32_16x16x32_bf16 v[56:59], a[112:115], v[168:171], v[56:59]
    v_lshlrev_b32 v242, 16, v237
    v_and_b32 v243, 0xffff0000, v237
    v_mfma_f32_16x16x32_bf16 v[56:59], a[104:107], v[164:167], v[56:59]
    v_lshlrev_b32 v244, 16, v238
    v_and_b32 v245, 0xffff0000, v238
    v_mfma_f32_16x16x32_bf16 v[56:59], a[96:99], v[160:163], v[56:59]
    s_waitcnt lgkmcnt(0)
    v_lshlrev_b32 v246, 16, v239
    v_and_b32 v247, 0xffff0000, v239
    v_mfma_f32_16x16x32_bf16 v[48:51], a[192:195], v[64:67], v[48:51]
    v_lshlrev_b32 v128, 16, v208
    v_and_b32 v129, 0xffff0000, v208
    v_mfma_f32_16x16x32_bf16 v[48:51], a[200:203], v[68:71], v[48:51]
    v_lshlrev_b32 v130, 16, v209
    v_and_b32 v131, 0xffff0000, v209
    v_mfma_f32_16x16x32_bf16 v[48:51], a[208:211], v[72:75], v[48:51]
    v_lshlrev_b32 v132, 16, v210
    v_and_b32 v133, 0xffff0000, v210
    v_mfma_f32_16x16x32_bf16 v[48:51], a[216:219], v[76:79], v[48:51]
    v_lshlrev_b32 v134, 16, v211
    v_and_b32 v135, 0xffff0000, v211
    v_mfma_f32_16x16x32_bf16 v[48:51], a[224:227], v[80:83], v[48:51]
    v_mfma_f32_16x16x32_bf16 v[48:51], a[232:235], v[84:87], v[48:51]
    v_mfma_f32_16x16x32_bf16 v[48:51], a[240:243], v[88:91], v[48:51]
    v_mfma_f32_16x16x32_bf16 v[48:51], a[248:251], v[92:95], v[48:51]
    v_mfma_f32_16x16x32_bf16 v[52:55], a[252:255], v[92:95], v[52:55]
    v_mfma_f32_16x16x32_bf16 v[52:55], a[244:247], v[88:91], v[52:55]
    v_mfma_f32_16x16x32_bf16 v[52:55], a[236:239], v[84:87], v[52:55]
    s_waitcnt vmcnt(0)
    v_max3_u32 v28, v248, v249, v250
    v_max3_u32 v29, v251, v252, v253
    v_mfma_f32_16x16x32_bf16 v[52:55], a[228:231], v[80:83], v[52:55]
    v_max3_u32 v29, v29, v254, v255
    v_max_u32 v28, v28, v29
    v_mfma_f32_16x16x32_bf16 v[52:55], a[220:223], v[76:79], v[52:55]
    v_cmp_eq_u32 vcc, -1, v28
    s_nop 0
    s_cmp_eq_u64 vcc, 0
    s_cbranch_scc0 L_spin_s3
L_back_s3:
    v_mfma_f32_16x16x32_bf16 v[52:55], a[212:215], v[72:75], v[52:55]
    v_lshlrev_b32 v160, 16, v248
    v_and_b32 v161, 0xffff0000, v248
    v_mfma_f32_16x16x32_bf16 v[52:55], a[204:207], v[68:71], v[52:55]
    v_lshlrev_b32 v162, 16, v249
    v_and_b32 v163, 0xffff0000, v249
    v_mfma_f32_16x16x32_bf16 v[52:55], a[196:199], v[64:67], v[52:55]
    v_lshlrev_b32 v164, 16, v250
    v_and_b32 v165, 0xffff0000, v250
    v_mfma_f32_16x16x32_bf16 v[60:63], a[196:199], v[96:99], v[60:63]
    v_lshlrev_b32 v166, 16, v251
    v_and_b32 v167, 0xffff0000, v251
    v_mfma_f32_16x16x32_bf16 v[60:63], a[204:207], v[100:103], v[60:63]
    v_add_f32 v224, v224, v160
    v_add_f32 v225, v225, v161
    v_mfma_f32_16x16x32_bf16 v[60:63], a[212:215], v[104:107], v[60:63]
    v_add_f32 v226, v226, v162
    v_add_f32 v227, v227, v163
    v_mfma_f32_16x16x32_bf16 v[60:63], a[220:223], v[108:111], v[60:63]
    v_add_f32 v228, v228, v164
    v_add_f32 v229, v229, v165
    v_mfma_f32_16x16x32_bf16 v[60:63], a[228:231], v[112:115], v[60:63]
    v_add_f32 v230, v230, v166
    v_add_f32 v231, v231, v167
    v_mfma_f32_16x16x32_bf16 v[60:63], a[236:239], v[116:119], v[60:63]
    v_add_f32 v48, v48, v224
    v_add_f32 v49, v49, v225
    v_mfma_f32_16x16x32_bf16 v[60:63], a[244:247], v[120:123], v[60:63]
    v_add_f32 v50, v50, v226
    v_add_f32 v51, v51, v227
    v_mfma_f32_16x16x32_bf16 v[60:63], a[252:255], v[124:127], v[60:63]
    v_add_f32 v52, v52, v228
    v_add_f32 v53, v53, v229
    v_mfma_f32_16x16x32_bf16 v[56:59], a[248:251], v[124:127], v[56:59]
    v_add_f32 v54, v54, v230
    v_add_f32 v55, v55, v231
    v_mfma_f32_16x16x32_bf16 v[56:59], a[240:243], v[120:123], v[56:59]
    v_mul_f32 v48, v48, v192
    v_mul_f32 v49, v49, v193
    v_mfma_f32_16x16x32_bf16 v[56:59], a[232:235], v[116:119], v[56:59]
    v_mul_f32 v50, v50, v194
    v_mul_f32 v51, v51, v195
    v_mfma_f32_16x16x32_bf16 v[56:59], a[224:227], v[112:115], v[56:59]
    v_mul_f32 v52, v52, v196
    v_mul_f32 v53, v53, v197
    v_mfma_f32_16x16x32_bf16 v[56:59], a[216:219], v[108:111], v[56:59]
    v_mul_f32 v54, v54, v198
    v_mul_f32 v55, v55, v199
    v_mfma_f32_16x16x32_bf16 v[56:59], a[208:211], v[104:107], v[56:59]
    ds_write_b128 v10, v[48:51]
    v_mfma_f32_16x16x32_bf16 v[56:59], a[200:203], v[100:103], v[56:59]
    ds_write_b128 v11, v[52:55]
    v_mfma_f32_16x16x32_bf16 v[56:59], a[192:195], v[96:99], v[56:59]
    ds_read_b128 v[144:147], v18
    ds_read_b128 v[148:151], v19
    v_lshlrev_b32 v168, 16, v252
    v_and_b32 v169, 0xffff0000, v252
    v_lshlrev_b32 v170, 16, v253
    v_and_b32 v171, 0xffff0000, v253
    v_lshlrev_b32 v172, 16, v254
    v_and_b32 v173, 0xffff0000, v254
    v_lshlrev_b32 v174, 16, v255
    v_and_b32 v175, 0xffff0000, v255
    v_add_f32 v240, v240, v168
    v_add_f32 v241, v241, v169
    v_add_f32 v242, v242, v170
    v_add_f32 v243, v243, v171
    v_add_f32 v244, v244, v172
    v_add_f32 v245, v245, v173
    v_add_f32 v246, v246, v174
    v_add_f32 v247, v247, v175
    v_pk_add_f32 v[56:57], v[56:57], v[240:241]
    v_pk_add_f32 v[58:59], v[58:59], v[242:243]
    v_pk_add_f32 v[60:61], v[60:61], v[244:245]
    v_pk_add_f32 v[62:63], v[62:63], v[246:247]
    v_pk_mul_f32 v[56:57], v[56:57], v[200:201]
    v_pk_mul_f32 v[58:59], v[58:59], v[202:203]
    v_pk_mul_f32 v[60:61], v[60:61], v[204:205]
    v_pk_mul_f32 v[62:63], v[62:63], v[206:207]
    ds_write_b128 v10, v[56:59] offset:2048
    ds_write_b128 v11, v[60:63] offset:2048
    ds_read_b128 v[152:155], v18 offset:2048
    ds_read_b128 v[156:159], v19 offset:2048
    s_waitcnt lgkmcnt(4)
    v_pk_add_f32 v[128:129], v[128:129], v[144:145]
    v_pk_add_f32 v[130:131], v[130:131], v[146:147]
    v_pk_add_f32 v[132:133], v[132:133], v[148:149]
    v_pk_add_f32 v[134:135], v[134:135], v[150:151]
    v_cvt_pk_bf16_f32 v176, v128, v129
    v_cvt_pk_bf16_f32 v177, v130, v131
    v_cvt_pk_bf16_f32 v178, v132, v133
    v_cvt_pk_bf16_f32 v179, v134, v135
    buffer_store_dwordx4 v[176:179], v27, s[52:55], s15 offen
    v_lshlrev_b32 v136, 16, v212
    v_and_b32 v137, 0xffff0000, v212
    v_lshlrev_b32 v138, 16, v213
    v_and_b32 v139, 0xffff0000, v213
    v_lshlrev_b32 v140, 16, v214
    v_and_b32 v141, 0xffff0000, v214
    v_lshlrev_b32 v142, 16, v215
    v_and_b32 v143, 0xffff0000, v215
    s_waitcnt lgkmcnt(0)
    v_pk_add_f32 v[136:137], v[136:137], v[152:153]
    v_pk_add_f32 v[138:139], v[138:139], v[154:155]
    v_pk_add_f32 v[140:141], v[140:141], v[156:157]
    v_pk_add_f32 v[142:143], v[142:143], v[158:159]
    v_cvt_pk_bf16_f32 v180, v136, v137
    v_cvt_pk_bf16_f32 v181, v138, v139
    v_cvt_pk_bf16_f32 v182, v140, v141
    v_cvt_pk_bf16_f32 v183, v142, v143
    buffer_store_dwordx4 v[180:183], v27, s[52:55], s71 offen
L_end:
    s_endpgm
L_spin_s3:
    s_mov_b32 s3, 0x200000
L_spin2_s3:
    s_sleep 2
    s_add_u32 s65, s92, 24576
    buffer_load_dwordx4 v[248:251], v1, s[32:35], s65 offen offset:0 sc1
    buffer_load_dwordx4 v[252:255], v1, s[32:35], s65 offen offset:1024 sc1
    s_waitcnt vmcnt(0)
    s_sub_u32 s3, s3, 1
    s_cmp_eq_u32 s3, 0
    s_cbranch_scc1 L_back_s3
    v_max3_u32 v28, v248, v249, v250
    v_max3_u32 v29, v251, v252, v253
    v_max3_u32 v29, v29, v254, v255
    v_max_u32 v28, v28, v29
    v_cmp_eq_u32 vcc, -1, v28
    s_nop 0
    s_cmp_eq_u64 vcc, 0
    s_cbranch_scc0 L_spin2_s3
    s_branch L_back_s3
L_spin_s2:
    s_mov_b32 s3, 0x200000
L_spin2_s2:
    s_sleep 2
    s_add_u32 s65, s92, 16384
    buffer_load_dwordx4 v[232:235], v1, s[32:35], s65 offen offset:0 sc1
    buffer_load_dwordx4 v[236:239], v1, s[32:35], s65 offen offset:1024 sc1
    s_waitcnt vmcnt(0)
    s_sub_u32 s3, s3, 1
    s_cmp_eq_u32 s3, 0
    s_cbranch_scc1 L_back_s2
    v_max3_u32 v28, v232, v233, v234
    v_max3_u32 v29, v235, v236, v237
    v_max3_u32 v29, v29, v238, v239
    v_max_u32 v28, v28, v29
    v_cmp_eq_u32 vcc, -1, v28
    s_nop 0
    s_cmp_eq_u64 vcc, 0
    s_cbranch_scc0 L_spin2_s2
    s_branch L_back_s2
L_spin_s1:
    s_mov_b32 s3, 0x200000
L_spin2_s1:
    s_sleep 2
    s_add_u32 s65, s92, 8192
    buffer_load_dwordx4 v[216:219], v1, s[32:35], s65 offen offset:0 sc1
    buffer_load_dwordx4 v[220:223], v1, s[32:35], s65 offen offset:1024 sc1
    s_waitcnt vmcnt(0)
    s_sub_u32 s3, s3, 1
    s_cmp_eq_u32 s3, 0
    s_cbranch_scc1 L_back_s1
    v_max3_u32 v28, v216, v217, v218
    v_max3_u32 v29, v219, v220, v221
    v_max3_u32 v29, v29, v222, v223
    v_max_u32 v28, v28, v29
    v_cmp_eq_u32 vcc, -1, v28
    s_nop 0
    s_cmp_eq_u64 vcc, 0
    s_cbranch_scc0 L_spin2_s1
    s_branch L_back_s1
L_spin_g:
    s_mov_b32 s3, 0x200000
L_spin2_g:
    s_sleep 2
    s_add_u32 s65, s92, 40960
    buffer_load_dwordx4 v[208:211], v1, s[32:35], s65 offen offset:0 sc1
    buffer_load_dwordx4 v[212:215], v1, s[32:35], s65 offen offset:1024 sc1
    s_add_u32 s65, s92, 49152
    buffer_load_dwordx4 v[224:227], v1, s[32:35], s65 offen offset:0 sc1
    buffer_load_dwordx4 v[228:231], v1, s[32:35], s65 offen offset:1024 sc1
    s_add_u32 s65, s92, 57344
    buffer_load_dwordx4 v[240:243], v1, s[32:35], s65 offen offset:0 sc1
    buffer_load_dwordx4 v[244:247], v1, s[32:35], s65 offen offset:1024 sc1
    s_waitcnt vmcnt(0)
    s_sub_u32 s3, s3, 1
    s_cmp_eq_u32 s3, 0
    s_cbranch_scc1 L_back_g
    v_max3_u32 v28, v208, v209, v210
    v_max3_u32 v29, v211, v212, v213
    v_max3_u32 v29, v29, v214, v215
    v_max3_u32 v28, v28, v224, v225
    v_max3_u32 v29, v29, v226, v227
    v_max3_u32 v28, v28, v228, v229
    v_max3_u32 v29, v29, v230, v231
    v_max3_u32 v28, v28, v240, v241
    v_max3_u32 v29, v29, v242, v243
    v_max3_u32 v28, v28, v244, v245
    v_max3_u32 v29, v29, v246, v247
    v_max_u32 v28, v28, v29
    v_cmp_eq_u32 vcc, -1, v28
    s_nop 0
    s_cmp_eq_u64 vcc, 0
    s_cbranch_scc0 L_spin2_g
    s_branch L_back_g
L_spin_o:
    s_mov_b32 s3, 0x200000
L_spin2_o:
    s_sleep 2
    buffer_load_dword v29, v23, s[36:39], 0 offen sc1
    s_waitcnt vmcnt(0)
    s_sub_u32 s3, s3, 1
    s_cmp_eq_u32 s3, 0
    s_cbranch_scc1 L_back_o
    v_cmp_eq_u32 vcc, 0, v29
    s_nop 0
    s_cmp_eq_u64 vcc, 0
    s_cbranch_scc0 L_spin2_o
    s_branch L_back_o
L_spin_h:
    s_mov_b32 s3, 0x200000
L_spin2_h:
    s_sleep 2
    buffer_load_dword v29, v23, s[36:39], 0 offen sc1
    s_waitcnt vmcnt(0)
    s_sub_u32 s3, s3, 1
    s_cmp_eq_u32 s3, 0
    s_cbranch_scc1 L_back_h
    v_cmp_gt_u32 vcc, v31, v29
    s_nop 0
    s_cmp_eq_u64 vcc, 0
    s_cbranch_scc0 L_spin2_h
    s_branch L_back_h
L_spin_stS:
    s_mov_b32 s3, 0x200000
L_spin2_stS:
    s_sleep 2
    buffer_load_dword v50, v51, s[40:43], 0 offen sc1
    s_waitcnt vmcnt(0)
    s_sub_u32 s3, s3, 1
    s_cmp_eq_u32 s3, 0
    s_cbranch_scc1 L_back_stS
    v_cmp_gt_u32 vcc, 32, v50
    s_nop 0
    s_cmp_eq_u64 vcc, 0
    s_cbranch_scc0 L_spin2_stS
    s_branch L_back_stS
L_spin_stF:
    s_mov_b32 s3, 0x200000
L_spin2_stF:
    s_sleep 2
    buffer_load_dword v50, v51, s[40:43], 0 offen sc1
    s_waitcnt vmcnt(0)
    s_sub_u32 s3, s3, 1
    s_cmp_eq_u32 s3, 0
    s_cbranch_scc1 L_back_stF
    v_cmp_gt_u32 vcc, 32, v50
    s_nop 0
    s_cmp_eq_u64 vcc, 0
    s_cbranch_scc0 L_spin2_stF
    s_branch L_back_stF
L_proj_F:
    s_waitcnt vmcnt(8)
    ds_read_b128 a[0:3], v40 offset:0
    ds_read_b128 a[4:7], v41 offset:0
    ds_read_b128 a[8:11], v42 offset:0
    ds_read_b128 a[12:15], v43 offset:0
    ds_read_b128 a[16:19], v40 offset:4096
    ds_read_b128 a[20:23], v41 offset:4096
    ds_read_b128 a[24:27], v42 offset:4096
    ds_read_b128 a[28:31], v43 offset:4096
    ds_read_b128 a[32:35], v40 offset:8192
    ds_read_b128 a[36:39], v41 offset:8192
    ds_read_b128 a[40:43], v42 offset:8192
    ds_read_b128 a[44:47], v43 offset:8192
    ds_read_b128 a[48:51], v40 offset:12288
    ds_read_b128 a[52:55], v41 offset:12288
    ds_read_b128 a[56:59], v42 offset:12288
    ds_read_b128 a[60:63], v43 offset:12288
    buffer_load_dword a252, v22, s[8:11], 0 offen
    s_lshl_b32 s65, s64, 11
    buffer_load_dwordx4 v[72:75], v58, s[4:7], s65 offen offset:0
    buffer_load_dwordx4 v[76:79], v58, s[4:7], s65 offen offset:512
    buffer_store_dword v55, v53, s[36:39], 0 offen sc1
    s_waitcnt vmcnt(4)
    s_barrier
    ds_read_b64_tr_b16 a[212:213], v28 offset:32768
    ds_read_b64_tr_b16 a[214:215], v28 offset:33280
    ds_read_b64_tr_b16 a[216:217], v28 offset:36864
    ds_read_b64_tr_b16 a[218:219], v28 offset:37376
    ds_read_b64_tr_b16 a[220:221], v28 offset:40960
    ds_read_b64_tr_b16 a[222:223], v28 offset:41472
    ds_read_b64_tr_b16 a[224:225], v28 offset:45056
    ds_read_b64_tr_b16 a[226:227], v28 offset:45568
    s_waitcnt lgkmcnt(0)
    v_mfma_f32_16x16x32_bf16 v[128:131], a[212:215], a[0:3], 0
    ds_read_b64_tr_b16 a[228:229], v28 offset:49152
    v_mfma_f32_16x16x32_bf16 v[128:131], a[216:219], a[4:7], v[128:131]
    ds_read_b64_tr_b16 a[230:231], v28 offset:49664
    v_mfma_f32_16x16x32_bf16 v[128:131], a[220:223], a[8:11], v[128:131]
    ds_read_b64_tr_b16 a[232:233], v28 offset:53248
    v_mfma_f32_16x16x32_bf16 v[128:131], a[224:227], a[12:15], v[128:131]
    v_mfma_f32_16x16x32_bf16 v[132:135], a[224:227], a[28:31], 0
    ds_read_b64_tr_b16 a[234:235], v28 offset:53760
    v_mfma_f32_16x16x32_bf16 v[132:135], a[220:223], a[24:27], v[132:135]
    ds_read_b64_tr_b16 a[236:237], v28 offset:57344
    v_mfma_f32_16x16x32_bf16 v[132:135], a[216:219], a[20:23], v[132:135]
    ds_read_b64_tr_b16 a[238:239], v28 offset:57856
    v_mfma_f32_16x16x32_bf16 v[132:135], a[212:215], a[16:19], v[132:135]
    v_mfma_f32_16x16x32_bf16 v[136:139], a[212:215], a[32:35], 0
    ds_read_b64_tr_b16 a[240:241], v28 offset:61440
    v_mfma_f32_16x16x32_bf16 v[136:139], a[216:219], a[36:39], v[136:139]
    ds_read_b64_tr_b16 a[242:243], v28 offset:61952
    v_mfma_f32_16x16x32_bf16 v[136:139], a[220:223], a[40:43], v[136:139]
    v_mfma_f32_16x16x32_bf16 v[136:139], a[224:227], a[44:47], v[136:139]
    s_add_u32 m0, s59, 65536
    v_mfma_f32_16x16x32_bf16 v[140:143], a[224:227], a[60:63], 0
    s_add_u32 s65, s67, 0
    v_mfma_f32_16x16x32_bf16 v[140:143], a[220:223], a[56:59], v[140:143]
    buffer_load_dwordx4 v32, s[8:11], s65 offen offset:0 lds
    v_mfma_f32_16x16x32_bf16 v[140:143], a[216:219], a[52:55], v[140:143]
    v_mfma_f32_16x16x32_bf16 v[140:143], a[212:215], a[48:51], v[140:143]
    v_smfmac_f32_16x16x64_bf16 a[192:195], a[208:211], a[212:219], v20
    v_smfmac_f32_16x16x64_bf16 a[192:195], a[208:211], a[220:227], v20
    s_waitcnt lgkmcnt(0)
    buffer_load_dwordx4 v33, s[8:11], s65 offen offset:1024 lds
    v_mfma_f32_16x16x32_bf16 v[192:195], a[228:231], a[0:3], 0
    ds_read_b64_tr_b16 a[212:213], v29 offset:32768
    v_mfma_f32_16x16x32_bf16 v[192:195], a[232:235], a[4:7], v[192:195]
    ds_read_b64_tr_b16 a[214:215], v29 offset:33280
    v_mfma_f32_16x16x32_bf16 v[192:195], a[236:239], a[8:11], v[192:195]
    ds_read_b64_tr_b16 a[216:217], v29 offset:36864
    v_mfma_f32_16x16x32_bf16 v[192:195], a[240:243], a[12:15], v[192:195]
    buffer_load_dwordx4 v34, s[8:11], s65 offen offset:2048 lds
    v_mfma_f32_16x16x32_bf16 v[196:199], a[240:243], a[28:31], 0
    ds_read_b64_tr_b16 a[218:219], v29 offset:37376
    v_mfma_f32_16x16x32_bf16 v[196:199], a[236:239], a[24:27], v[196:199]
    ds_read_b64_tr_b16 a[220:221], v29 offset:40960
    v_mfma_f32_16x16x32_bf16 v[196:199], a[232:235], a[20:23], v[196:199]
    ds_read_b64_tr_b16 a[222:223], v29 offset:41472
    v_mfma_f32_16x16x32_bf16 v[196:199], a[228:231], a[16:19], v[196:199]
    buffer_load_dwordx4 v35, s[8:11], s65 offen offset:3072 lds
    v_mfma_f32_16x16x32_bf16 v[200:203], a[228:231], a[32:35], 0
    ds_read_b64_tr_b16 a[224:225], v29 offset:45056
    v_mfma_f32_16x16x32_bf16 v[200:203], a[232:235], a[36:39], v[200:203]
    s_add_u32 m0, s59, 69632
    ds_read_b64_tr_b16 a[226:227], v29 offset:45568
    v_mfma_f32_16x16x32_bf16 v[200:203], a[236:239], a[40:43], v[200:203]
    s_add_u32 s65, s67, 131072
    v_mfma_f32_16x16x32_bf16 v[200:203], a[240:243], a[44:47], v[200:203]
    v_mfma_f32_16x16x32_bf16 v[204:207], a[240:243], a[60:63], 0
    buffer_load_dwordx4 v32, s[8:11], s65 offen offset:0 lds
    v_mfma_f32_16x16x32_bf16 v[204:207], a[236:239], a[56:59], v[204:207]
    v_mfma_f32_16x16x32_bf16 v[204:207], a[232:235], a[52:55], v[204:207]
    v_mfma_f32_16x16x32_bf16 v[204:207], a[228:231], a[48:51], v[204:207]
    buffer_load_dwordx4 v33, s[8:11], s65 offen offset:1024 lds
    v_smfmac_f32_16x16x64_bf16 a[196:199], a[208:211], a[228:235], v20
    v_smfmac_f32_16x16x64_bf16 a[196:199], a[208:211], a[236:243], v20
    s_waitcnt lgkmcnt(0)
    v_mfma_f32_16x16x32_bf16 v[144:147], a[212:215], a[0:3], 0
    ds_read_b64_tr_b16 a[228:229], v29 offset:49152
    v_mfma_f32_16x16x32_bf16 v[144:147], a[216:219], a[4:7], v[144:147]
    ds_read_b64_tr_b16 a[230:231], v29 offset:49664
    v_mfma_f32_16x16x32_bf16 v[144:147], a[220:223], a[8:11], v[144:147]
    ds_read_b64_tr_b16 a[232:233], v29 offset:53248
    v_mfma_f32_16x16x32_bf16 v[144:147], a[224:227], a[12:15], v[144:147]
    buffer_load_dwordx4 v34, s[8:11], s65 offen offset:2048 lds
    v_mfma_f32_16x16x32_bf16 v[148:151], a[224:227], a[28:31], 0
    ds_read_b64_tr_b16 a[234:235], v29 offset:53760
    v_mfma_f32_16x16x32_bf16 v[148:151], a[220:223], a[24:27], v[148:151]
    ds_read_b64_tr_b16 a[236:237], v29 offset:57344
    v_mfma_f32_16x16x32_bf16 v[148:151], a[216:219], a[20:23], v[148:151]
    ds_read_b64_tr_b16 a[238:239], v29 offset:57856
    v_mfma_f32_16x16x32_bf16 v[148:151], a[212:215], a[16:19], v[148:151]
    buffer_load_dwordx4 v35, s[8:11], s65 offen offset:3072 lds
    v_mfma_f32_16x16x32_bf16 v[152:155], a[212:215], a[32:35], 0
    ds_read_b64_tr_b16 a[240:241], v29 offset:61440
    v_mfma_f32_16x16x32_bf16 v[152:155], a[216:219], a[36:39], v[152:155]
    s_xor_b32 m0, s100, 0
    ds_read_b64_tr_b16 a[242:243], v29 offset:61952
    v_mfma_f32_16x16x32_bf16 v[152:155], a[220:223], a[40:43], v[152:155]
    s_xor_b32 s65, s101, 256
    v_mfma_f32_16x16x32_bf16 v[152:155], a[224:227], a[44:47], v[152:155]
    v_mfma_f32_16x16x32_bf16 v[156:159], a[224:227], a[60:63], 0
    buffer_load_dwordx4 v44, s[4:7], s65 offen offset:0 lds
    v_mfma_f32_16x16x32_bf16 v[156:159], a[220:223], a[56:59], v[156:159]
    v_mfma_f32_16x16x32_bf16 v[156:159], a[216:219], a[52:55], v[156:159]
    v_mfma_f32_16x16x32_bf16 v[156:159], a[212:215], a[48:51], v[156:159]
    s_waitcnt lgkmcnt(0)
    buffer_load_dwordx4 v45, s[4:7], s65 offen offset:1024 lds
    v_mfma_f32_16x16x32_bf16 v[208:211], a[228:231], a[0:3], 0
    ds_read_b64_tr_b16 a[212:213], v30 offset:32768
    v_mfma_f32_16x16x32_bf16 v[208:211], a[232:235], a[4:7], v[208:211]
    ds_read_b64_tr_b16 a[214:215], v30 offset:33280
    v_mfma_f32_16x16x32_bf16 v[208:211], a[236:239], a[8:11], v[208:211]
    ds_read_b64_tr_b16 a[216:217], v30 offset:36864
    v_mfma_f32_16x16x32_bf16 v[208:211], a[240:243], a[12:15], v[208:211]
    buffer_load_dwordx4 v46, s[4:7], s65 offen offset:2048 lds
    v_mfma_f32_16x16x32_bf16 v[212:215], a[240:243], a[28:31], 0
    ds_read_b64_tr_b16 a[218:219], v30 offset:37376
    v_mfma_f32_16x16x32_bf16 v[212:215], a[236:239], a[24:27], v[212:215]
    ds_read_b64_tr_b16 a[220:221], v30 offset:40960
    v_mfma_f32_16x16x32_bf16 v[212:215], a[232:235], a[20:23], v[212:215]
    ds_read_b64_tr_b16 a[222:223], v30 offset:41472
    v_mfma_f32_16x16x32_bf16 v[212:215], a[228:231], a[16:19], v[212:215]
    v_mfma_f32_16x16x32_bf16 v[216:219], a[228:231], a[32:35], 0
    ds_read_b64_tr_b16 a[224:225], v30 offset:45056
    v_mfma_f32_16x16x32_bf16 v[216:219], a[232:235], a[36:39], v[216:219]
    ds_read_b64_tr_b16 a[226:227], v30 offset:45568
    v_mfma_f32_16x16x32_bf16 v[216:219], a[236:239], a[40:43], v[216:219]
    buffer_load_dwordx4 v47, s[4:7], s65 offen offset:3072 lds
    v_mfma_f32_16x16x32_bf16 v[216:219], a[240:243], a[44:47], v[216:219]
    s_mov_b32 s65, 458752
    v_mfma_f32_16x16x32_bf16 v[220:223], a[240:243], a[60:63], 0
    v_mfma_f32_16x16x32_bf16 v[220:223], a[236:239], a[56:59], v[220:223]
    buffer_load_dword a252, v23, s[12:15], s65 offen
    v_mfma_f32_16x16x32_bf16 v[220:223], a[232:235], a[52:55], v[220:223]
    v_mfma_f32_16x16x32_bf16 v[220:223], a[228:231], a[48:51], v[220:223]
    s_waitcnt lgkmcnt(0)
    v_mfma_f32_16x16x32_bf16 v[160:163], a[212:215], a[0:3], 0
    ds_read_b64_tr_b16 a[228:229], v30 offset:49152
    v_mfma_f32_16x16x32_bf16 v[160:163], a[216:219], a[4:7], v[160:163]
    ds_read_b64_tr_b16 a[230:231], v30 offset:49664
    v_mfma_f32_16x16x32_bf16 v[160:163], a[220:223], a[8:11], v[160:163]
    ds_read_b64_tr_b16 a[232:233], v30 offset:53248
    v_mfma_f32_16x16x32_bf16 v[160:163], a[224:227], a[12:15], v[160:163]
    buffer_load_dword a252, v23, s[16:19], s65 offen
    v_mfma_f32_16x16x32_bf16 v[164:167], a[224:227], a[28:31], 0
    s_waitcnt vmcnt(15)
    ds_read_b64_tr_b16 a[234:235], v30 offset:53760
    v_lshlrev_b32 v88, 16, v72
    v_mfma_f32_16x16x32_bf16 v[164:167], a[220:223], a[24:27], v[164:167]
    ds_read_b64_tr_b16 a[236:237], v30 offset:57344
    v_and_b32 v89, 0xffff0000, v72
    v_mfma_f32_16x16x32_bf16 v[164:167], a[216:219], a[20:23], v[164:167]
    ds_read_b64_tr_b16 a[238:239], v30 offset:57856
    v_lshlrev_b32 v90, 16, v73
    v_mfma_f32_16x16x32_bf16 v[164:167], a[212:215], a[16:19], v[164:167]
    v_and_b32 v91, 0xffff0000, v73
    v_lshlrev_b32 v92, 16, v74
    v_mfma_f32_16x16x32_bf16 v[168:171], a[212:215], a[32:35], 0
    ds_read_b64_tr_b16 a[240:241], v30 offset:61440
    v_and_b32 v93, 0xffff0000, v74
    v_mfma_f32_16x16x32_bf16 v[168:171], a[216:219], a[36:39], v[168:171]
    ds_read_b64_tr_b16 a[242:243], v30 offset:61952
    v_lshlrev_b32 v94, 16, v75
    v_mfma_f32_16x16x32_bf16 v[168:171], a[220:223], a[40:43], v[168:171]
    v_and_b32 v95, 0xffff0000, v75
    v_lshlrev_b32 v104, 16, v76
    v_mfma_f32_16x16x32_bf16 v[168:171], a[224:227], a[44:47], v[168:171]
    v_and_b32 v105, 0xffff0000, v76
    v_lshlrev_b32 v106, 16, v77
    v_mfma_f32_16x16x32_bf16 v[172:175], a[224:227], a[60:63], 0
    v_and_b32 v107, 0xffff0000, v77
    v_lshlrev_b32 v108, 16, v78
    v_mfma_f32_16x16x32_bf16 v[172:175], a[220:223], a[56:59], v[172:175]
    v_and_b32 v109, 0xffff0000, v78
    v_lshlrev_b32 v110, 16, v79
    v_mfma_f32_16x16x32_bf16 v[172:175], a[216:219], a[52:55], v[172:175]
    v_and_b32 v111, 0xffff0000, v79
    v_add_f32 v120, v89, v88
    v_mfma_f32_16x16x32_bf16 v[172:175], a[212:215], a[48:51], v[172:175]
    s_waitcnt lgkmcnt(0)
    v_add_f32 v121, v105, v104
    v_add_f32 v120, v90, v120
    v_mfma_f32_16x16x32_bf16 v[224:227], a[228:231], a[0:3], 0
    ds_read_b64_tr_b16 a[212:213], v31 offset:32768
    v_add_f32 v121, v106, v121
    v_mfma_f32_16x16x32_bf16 v[224:227], a[232:235], a[4:7], v[224:227]
    ds_read_b64_tr_b16 a[214:215], v31 offset:33280
    v_add_f32 v120, v91, v120
    v_mfma_f32_16x16x32_bf16 v[224:227], a[236:239], a[8:11], v[224:227]
    ds_read_b64_tr_b16 a[216:217], v31 offset:36864
    v_add_f32 v121, v107, v121
    v_mfma_f32_16x16x32_bf16 v[224:227], a[240:243], a[12:15], v[224:227]
    v_add_f32 v120, v92, v120
    v_add_f32 v121, v108, v121
    v_mfma_f32_16x16x32_bf16 v[228:231], a[240:243], a[28:31], 0
    ds_read_b64_tr_b16 a[218:219], v31 offset:37376
    v_add_f32 v120, v93, v120
    v_mfma_f32_16x16x32_bf16 v[228:231], a[236:239], a[24:27], v[228:231]
    ds_read_b64_tr_b16 a[220:221], v31 offset:40960
    v_add_f32 v121, v109, v121
    v_mfma_f32_16x16x32_bf16 v[228:231], a[232:235], a[20:23], v[228:231]
    ds_read_b64_tr_b16 a[222:223], v31 offset:41472
    v_add_f32 v120, v94, v120
    v_mfma_f32_16x16x32_bf16 v[228:231], a[228:231], a[16:19], v[228:231]
    v_add_f32 v121, v110, v121
    v_add_f32 v120, v95, v120
    v_mfma_f32_16x16x32_bf16 v[232:235], a[228:231], a[32:35], 0
    ds_read_b64_tr_b16 a[224:225], v31 offset:45056
    v_add_f32 v121, v111, v121
    v_mfma_f32_16x16x32_bf16 v[232:235], a[232:235], a[36:39], v[232:235]
    ds_read_b64_tr_b16 a[226:227], v31 offset:45568
    v_add_f32 v120, v120, v121
    v_mfma_f32_16x16x32_bf16 v[232:235], a[236:239], a[40:43], v[232:235]
    v_mfma_f32_16x16x32_bf16 v[232:235], a[240:243], a[44:47], v[232:235]
    v_add_f32_dpp v120, v120, v120 row_ror:8 row_mask:0xf bank_mask:0xf
    v_mfma_f32_16x16x32_bf16 v[236:239], a[240:243], a[60:63], 0
    v_mfma_f32_16x16x32_bf16 v[236:239], a[236:239], a[56:59], v[236:239]
    s_xor_b32 m0, s100, 4096
    v_add_f32_dpp v120, v120, v120 row_ror:4 row_mask:0xf bank_mask:0xf
    v_mfma_f32_16x16x32_bf16 v[236:239], a[232:235], a[52:55], v[236:239]
    s_xor_b32 s65, s101, 16640
    v_mfma_f32_16x16x32_bf16 v[236:239], a[228:231], a[48:51], v[236:239]
    s_waitcnt lgkmcnt(0)
    buffer_load_dwordx4 v44, s[4:7], s65 offen offset:0 lds
    v_mfma_f32_16x16x32_bf16 v[176:179], a[212:215], a[0:3], 0
    ds_read_b64_tr_b16 a[228:229], v31 offset:49152
    v_add_f32_dpp v120, v120, v120 row_ror:2 row_mask:0xf bank_mask:0xf
    v_mfma_f32_16x16x32_bf16 v[176:179], a[216:219], a[4:7], v[176:179]
    ds_read_b64_tr_b16 a[230:231], v31 offset:49664
    v_mfma_f32_16x16x32_bf16 v[176:179], a[220:223], a[8:11], v[176:179]
    ds_read_b64_tr_b16 a[232:233], v31 offset:53248
    v_add_f32_dpp v120, v120, v120 row_ror:1 row_mask:0xf bank_mask:0xf
    v_mfma_f32_16x16x32_bf16 v[176:179], a[224:227], a[12:15], v[176:179]
    buffer_load_dwordx4 v45, s[4:7], s65 offen offset:1024 lds
    v_mfma_f32_16x16x32_bf16 v[180:183], a[224:227], a[28:31], 0
    ds_read_b64_tr_b16 a[234:235], v31 offset:53760
    v_mov_b32 v121, v120
    v_mfma_f32_16x16x32_bf16 v[180:183], a[220:223], a[24:27], v[180:183]
    ds_read_b64_tr_b16 a[236:237], v31 offset:57344
    v_mfma_f32_16x16x32_bf16 v[180:183], a[216:219], a[20:23], v[180:183]
    ds_read_b64_tr_b16 a[238:239], v31 offset:57856
    v_permlane16_swap_b32 v121, v120
    v_mfma_f32_16x16x32_bf16 v[180:183], a[212:215], a[16:19], v[180:183]
    buffer_load_dwordx4 v46, s[4:7], s65 offen offset:2048 lds
    v_mfma_f32_16x16x32_bf16 v[184:187], a[212:215], a[32:35], 0
    ds_read_b64_tr_b16 a[240:241], v31 offset:61440
    v_add_f32 v120, v120, v121
    v_mfma_f32_16x16x32_bf16 v[184:187], a[216:219], a[36:39], v[184:187]
    ds_read_b64_tr_b16 a[242:243], v31 offset:61952
    v_mul_f32 v122, 0x3b000000, v120
    v_mfma_f32_16x16x32_bf16 v[184:187], a[220:223], a[40:43], v[184:187]
    v_sub_f32 v88, v88, v122
    v_sub_f32 v89, v89, v122
    v_mfma_f32_16x16x32_bf16 v[184:187], a[224:227], a[44:47], v[184:187]
    v_sub_f32 v90, v90, v122
    v_sub_f32 v91, v91, v122
    v_mfma_f32_16x16x32_bf16 v[188:191], a[224:227], a[60:63], 0
    buffer_load_dwordx4 v47, s[4:7], s65 offen offset:3072 lds
    v_mfma_f32_16x16x32_bf16 v[188:191], a[220:223], a[56:59], v[188:191]
    s_xor_b32 m0, s100, 8192
    v_sub_f32 v92, v92, v122
    v_sub_f32 v93, v93, v122
    v_mfma_f32_16x16x32_bf16 v[188:191], a[216:219], a[52:55], v[188:191]
    s_xor_b32 s65, s101, 33024
    v_sub_f32 v94, v94, v122
    v_sub_f32 v95, v95, v122
    v_mfma_f32_16x16x32_bf16 v[188:191], a[212:215], a[48:51], v[188:191]
    s_waitcnt lgkmcnt(0)
    v_sub_f32 v104, v104, v122
    v_sub_f32 v105, v105, v122
    v_mfma_f32_16x16x32_bf16 v[240:243], a[228:231], a[0:3], 0
    s_waitcnt vmcnt(10)
    buffer_load_dwordx4 v44, s[4:7], s65 offen offset:0 lds
    v_mfma_f32_16x16x32_bf16 v[240:243], a[232:235], a[4:7], v[240:243]
    s_barrier
    v_sub_f32 v106, v106, v122
    v_sub_f32 v107, v107, v122
    v_mfma_f32_16x16x32_bf16 v[240:243], a[236:239], a[8:11], v[240:243]
    ds_read_b64_tr_b16 a[212:213], v24 offset:0
    v_sub_f32 v108, v108, v122
    v_mfma_f32_16x16x32_bf16 v[240:243], a[240:243], a[12:15], v[240:243]
    ds_read_b64_tr_b16 a[214:215], v24 offset:1024
    v_sub_f32 v109, v109, v122
    v_mfma_f32_16x16x32_bf16 v[244:247], a[240:243], a[28:31], 0
    ds_read_b64_tr_b16 a[216:217], v24 offset:8192
    v_sub_f32 v110, v110, v122
    v_mfma_f32_16x16x32_bf16 v[244:247], a[236:239], a[24:27], v[244:247]
    ds_read_b64_tr_b16 a[218:219], v24 offset:9216
    buffer_load_dwordx4 v45, s[4:7], s65 offen offset:1024 lds
    v_mfma_f32_16x16x32_bf16 v[244:247], a[232:235], a[20:23], v[244:247]
    ds_read_b64_tr_b16 a[220:221], v24 offset:16384
    v_sub_f32 v111, v111, v122
    v_mfma_f32_16x16x32_bf16 v[244:247], a[228:231], a[16:19], v[244:247]
    ds_read_b64_tr_b16 a[222:223], v24 offset:17408
    v_mul_f32 v120, v88, v88
    v_mfma_f32_16x16x32_bf16 v[248:251], a[228:231], a[32:35], 0
    ds_read_b64_tr_b16 a[224:225], v24 offset:24576
    v_mul_f32 v121, v104, v104
    v_mfma_f32_16x16x32_bf16 v[248:251], a[232:235], a[36:39], v[248:251]
    ds_read_b64_tr_b16 a[226:227], v24 offset:25600
    v_fmac_f32 v120, v89, v89
    v_mfma_f32_16x16x32_bf16 v[248:251], a[236:239], a[40:43], v[248:251]
    buffer_load_dwordx4 v46, s[4:7], s65 offen offset:2048 lds
    v_mfma_f32_16x16x32_bf16 v[248:251], a[240:243], a[44:47], v[248:251]
    v_fmac_f32 v121, v105, v105
    v_fmac_f32 v120, v90, v90
    v_mfma_f32_16x16x32_bf16 v[252:255], a[240:243], a[60:63], 0
    v_fmac_f32 v121, v106, v106
    v_fmac_f32 v120, v91, v91
    v_mfma_f32_16x16x32_bf16 v[252:255], a[236:239], a[56:59], v[252:255]
    buffer_load_dwordx4 v47, s[4:7], s65 offen offset:3072 lds
    v_mfma_f32_16x16x32_bf16 v[252:255], a[232:235], a[52:55], v[252:255]
    v_fmac_f32 v121, v107, v107
    v_fmac_f32 v120, v92, v92
    v_mfma_f32_16x16x32_bf16 v[252:255], a[228:231], a[48:51], v[252:255]
    s_waitcnt lgkmcnt(0)
    v_fmac_f32 v121, v108, v108
    v_fmac_f32 v120, v93, v93
    v_mfma_f32_16x16x32_bf16 v[64:67], a[212:215], a[0:3], 0
    s_xor_b32 m0, s100, 12288
    ds_read_b64_tr_b16 a[228:229], v24 offset:8
    v_fmac_f32 v121, v109, v109
    v_mfma_f32_16x16x32_bf16 v[64:67], a[216:219], a[4:7], v[64:67]
    s_xor_b32 s65, s101, 49408
    ds_read_b64_tr_b16 a[230:231], v24 offset:1032
    v_fmac_f32 v120, v94, v94
    v_mfma_f32_16x16x32_bf16 v[64:67], a[220:223], a[8:11], v[64:67]
    ds_read_b64_tr_b16 a[232:233], v24 offset:8200
    v_fmac_f32 v121, v110, v110
    v_mfma_f32_16x16x32_bf16 v[64:67], a[224:227], a[12:15], v[64:67]
    buffer_load_dwordx4 v44, s[4:7], s65 offen offset:0 lds
    v_mfma_f32_16x16x32_bf16 v[80:83], a[224:227], a[28:31], 0
    ds_read_b64_tr_b16 a[234:235], v24 offset:9224
    v_fmac_f32 v120, v95, v95
    v_mfma_f32_16x16x32_bf16 v[80:83], a[220:223], a[24:27], v[80:83]
    ds_read_b64_tr_b16 a[236:237], v24 offset:16392
    v_fmac_f32 v121, v111, v111
    v_mfma_f32_16x16x32_bf16 v[80:83], a[216:219], a[20:23], v[80:83]
    ds_read_b64_tr_b16 a[238:239], v24 offset:17416
    v_add_f32 v120, v120, v121
    v_mfma_f32_16x16x32_bf16 v[80:83], a[212:215], a[16:19], v[80:83]
    buffer_load_dwordx4 v45, s[4:7], s65 offen offset:1024 lds
    v_mfma_f32_16x16x32_bf16 v[96:99], a[212:215], a[32:35], 0
    ds_read_b64_tr_b16 a[240:241], v24 offset:24584
    v_add_f32_dpp v120, v120, v120 row_ror:8 row_mask:0xf bank_mask:0xf
    v_mfma_f32_16x16x32_bf16 v[96:99], a[216:219], a[36:39], v[96:99]
    ds_read_b64_tr_b16 a[242:243], v24 offset:25608
    v_cvt_pk_bf16_f32 v122, v122, v122
    v_mfma_f32_16x16x32_bf16 v[96:99], a[220:223], a[40:43], v[96:99]
    v_add_f32_dpp v120, v120, v120 row_ror:4 row_mask:0xf bank_mask:0xf
    v_and_b32 v122, 0xffff0000, v122
    v_mfma_f32_16x16x32_bf16 v[96:99], a[224:227], a[44:47], v[96:99]
    buffer_load_dwordx4 v46, s[4:7], s65 offen offset:2048 lds
    v_mfma_f32_16x16x32_bf16 v[112:115], a[224:227], a[60:63], 0
    v_add_f32_dpp v120, v120, v120 row_ror:2 row_mask:0xf bank_mask:0xf
    v_mfma_f32_16x16x32_bf16 v[112:115], a[220:223], a[56:59], v[112:115]
    v_mfma_f32_16x16x32_bf16 v[112:115], a[216:219], a[52:55], v[112:115]
    v_add_f32_dpp v120, v120, v120 row_ror:1 row_mask:0xf bank_mask:0xf
    v_mov_b32 v121, v120
    v_mfma_f32_16x16x32_bf16 v[112:115], a[212:215], a[48:51], v[112:115]
    buffer_load_dwordx4 v47, s[4:7], s65 offen offset:3072 lds
    v_smfmac_f32_16x16x64_bf16 a[200:203], a[208:211], a[212:219], v20
    s_add_u32 m0, s60, 98304
    v_permlane16_swap_b32 v121, v120
    v_smfmac_f32_16x16x64_bf16 a[200:203], a[208:211], a[220:227], v20
    s_waitcnt lgkmcnt(0)
    v_add_f32 v120, v120, v121
    v_mfma_f32_16x16x32_bf16 a[128:131], a[228:231], a[0:3], 0
    s_add_u32 s65, s68, 458752
    ds_read_b64_tr_b16 a[212:213], v25 offset:0
    v_mul_f32 v123, 0x3b000000, v120
    v_mfma_f32_16x16x32_bf16 a[128:131], a[232:235], a[4:7], a[128:131]
    ds_read_b64_tr_b16 a[214:215], v25 offset:1024
    v_cvt_pk_bf16_f32 v123, v123, v123
    v_mfma_f32_16x16x32_bf16 a[128:131], a[236:239], a[8:11], a[128:131]
    ds_read_b64_tr_b16 a[216:217], v25 offset:8192
    v_and_b32 v123, 0xffff0000, v123
    v_mfma_f32_16x16x32_bf16 a[128:131], a[240:243], a[12:15], a[128:131]
    buffer_load_dwordx4 v36, s[12:15], s65 offen offset:0 lds
    v_mfma_f32_16x16x32_bf16 a[144:147], a[240:243], a[28:31], 0
    ds_read_b64_tr_b16 a[218:219], v25 offset:9216
    v_add_f32 v123, 0x3727c5ac, v123
    v_mfma_f32_16x16x32_bf16 a[144:147], a[236:239], a[24:27], a[144:147]
    ds_read_b64_tr_b16 a[220:221], v25 offset:16384
    v_cvt_pk_bf16_f32 v123, v123, v123
    v_mfma_f32_16x16x32_bf16 a[144:147], a[232:235], a[20:23], a[144:147]
    ds_read_b64_tr_b16 a[222:223], v25 offset:17408
    v_and_b32 v123, 0xffff0000, v123
    v_mfma_f32_16x16x32_bf16 a[144:147], a[228:231], a[16:19], a[144:147]
    buffer_load_dwordx4 v37, s[12:15], s65 offen offset:1024 lds
    v_mfma_f32_16x16x32_bf16 a[160:163], a[228:231], a[32:35], 0
    ds_read_b64_tr_b16 a[224:225], v25 offset:24576
    v_mfma_f32_16x16x32_bf16 a[160:163], a[232:235], a[36:39], a[160:163]
    ds_read_b64_tr_b16 a[226:227], v25 offset:25600
    v_mfma_f32_16x16x32_bf16 a[160:163], a[236:239], a[40:43], a[160:163]
    buffer_load_dwordx4 v38, s[12:15], s65 offen offset:2048 lds
    v_mfma_f32_16x16x32_bf16 a[160:163], a[240:243], a[44:47], a[160:163]
    v_sqrt_f32 v123, v123
    v_mfma_f32_16x16x32_bf16 a[176:179], a[240:243], a[60:63], 0
    v_cvt_pk_bf16_f32 v123, v123, v123
    v_and_b32 v123, 0xffff0000, v123
    v_mfma_f32_16x16x32_bf16 a[176:179], a[236:239], a[56:59], a[176:179]
    v_mul_f32 v123, v123, v123
    v_mfma_f32_16x16x32_bf16 a[176:179], a[232:235], a[52:55], a[176:179]
    buffer_store_dwordx2 v[122:123], v57, s[36:39], 0 offen sc1
    v_mfma_f32_16x16x32_bf16 a[176:179], a[228:231], a[48:51], a[176:179]
    buffer_load_dwordx4 v39, s[12:15], s65 offen offset:3072 lds
    v_smfmac_f32_16x16x64_bf16 a[204:207], a[208:211], a[228:235], v20
    s_add_u32 m0, s60, 114688
    v_smfmac_f32_16x16x64_bf16 a[204:207], a[208:211], a[236:243], v20
    s_waitcnt lgkmcnt(0)
    v_mfma_f32_16x16x32_bf16 v[68:71], a[212:215], a[0:3], 0
    s_add_u32 s65, s68, 458752
    ds_read_b64_tr_b16 a[228:229], v25 offset:8
    v_mfma_f32_16x16x32_bf16 v[68:71], a[216:219], a[4:7], v[68:71]
    ds_read_b64_tr_b16 a[230:231], v25 offset:1032
    v_mfma_f32_16x16x32_bf16 v[68:71], a[220:223], a[8:11], v[68:71]
    ds_read_b64_tr_b16 a[232:233], v25 offset:8200
    v_mfma_f32_16x16x32_bf16 v[68:71], a[224:227], a[12:15], v[68:71]
    buffer_load_dwordx4 v36, s[16:19], s65 offen offset:0 lds
    v_mfma_f32_16x16x32_bf16 v[84:87], a[224:227], a[28:31], 0
    ds_read_b64_tr_b16 a[234:235], v25 offset:9224
    v_mfma_f32_16x16x32_bf16 v[84:87], a[220:223], a[24:27], v[84:87]
    ds_read_b64_tr_b16 a[236:237], v25 offset:16392
    v_mfma_f32_16x16x32_bf16 v[84:87], a[216:219], a[20:23], v[84:87]
    ds_read_b64_tr_b16 a[238:239], v25 offset:17416
    v_mfma_f32_16x16x32_bf16 v[84:87], a[212:215], a[16:19], v[84:87]
    buffer_load_dwordx4 v37, s[16:19], s65 offen offset:1024 lds
    v_mfma_f32_16x16x32_bf16 v[100:103], a[212:215], a[32:35], 0
    ds_read_b64_tr_b16 a[240:241], v25 offset:24584
    v_mfma_f32_16x16x32_bf16 v[100:103], a[216:219], a[36:39], v[100:103]
    ds_read_b64_tr_b16 a[242:243], v25 offset:25608
    v_mfma_f32_16x16x32_bf16 v[100:103], a[220:223], a[40:43], v[100:103]
    buffer_load_dwordx4 v38, s[16:19], s65 offen offset:2048 lds
    v_mfma_f32_16x16x32_bf16 v[100:103], a[224:227], a[44:47], v[100:103]
    v_mfma_f32_16x16x32_bf16 v[116:119], a[224:227], a[60:63], 0
    v_mfma_f32_16x16x32_bf16 v[116:119], a[220:223], a[56:59], v[116:119]
    v_mfma_f32_16x16x32_bf16 v[116:119], a[216:219], a[52:55], v[116:119]
    buffer_load_dwordx4 v39, s[16:19], s65 offen offset:3072 lds
    v_mfma_f32_16x16x32_bf16 v[116:119], a[212:215], a[48:51], v[116:119]
    s_waitcnt lgkmcnt(0)
    v_mfma_f32_16x16x32_bf16 a[132:135], a[228:231], a[0:3], 0
    ds_read_b64_tr_b16 a[212:213], v26 offset:0
    v_mfma_f32_16x16x32_bf16 a[132:135], a[232:235], a[4:7], a[132:135]
    s_mov_b32 s65, 1048576
    ds_read_b64_tr_b16 a[214:215], v26 offset:1024
    v_mfma_f32_16x16x32_bf16 a[132:135], a[236:239], a[8:11], a[132:135]
    ds_read_b64_tr_b16 a[216:217], v26 offset:8192
    v_mfma_f32_16x16x32_bf16 a[132:135], a[240:243], a[12:15], a[132:135]
    buffer_load_dword a252, v22, s[8:11], s65 offen
    v_mfma_f32_16x16x32_bf16 a[148:151], a[240:243], a[28:31], 0
    ds_read_b64_tr_b16 a[218:219], v26 offset:9216
    v_mfma_f32_16x16x32_bf16 a[148:151], a[236:239], a[24:27], a[148:151]
    ds_read_b64_tr_b16 a[220:221], v26 offset:16384
    v_mfma_f32_16x16x32_bf16 a[148:151], a[232:235], a[20:23], a[148:151]
    ds_read_b64_tr_b16 a[222:223], v26 offset:17408
    v_mfma_f32_16x16x32_bf16 a[148:151], a[228:231], a[16:19], a[148:151]
    s_waitcnt vmcnt(10)
    ds_read_b128 a[64:67], v40 offset:0
    ds_read_b128 a[68:71], v41 offset:0
    v_mfma_f32_16x16x32_bf16 a[164:167], a[228:231], a[32:35], 0
    ds_read_b64_tr_b16 a[224:225], v26 offset:24576
    v_mfma_f32_16x16x32_bf16 a[164:167], a[232:235], a[36:39], a[164:167]
    ds_read_b64_tr_b16 a[226:227], v26 offset:25600
    v_mfma_f32_16x16x32_bf16 a[164:167], a[236:239], a[40:43], a[164:167]
    ds_read_b128 a[72:75], v42 offset:0
    v_mfma_f32_16x16x32_bf16 a[164:167], a[240:243], a[44:47], a[164:167]
    ds_read_b128 a[76:79], v43 offset:0
    v_mfma_f32_16x16x32_bf16 a[180:183], a[240:243], a[60:63], 0
    ds_read_b128 a[80:83], v40 offset:4096
    v_mfma_f32_16x16x32_bf16 a[180:183], a[236:239], a[56:59], a[180:183]
    ds_read_b128 a[84:87], v41 offset:4096
    v_mfma_f32_16x16x32_bf16 a[180:183], a[232:235], a[52:55], a[180:183]
    ds_read_b128 a[88:91], v42 offset:4096
    v_mfma_f32_16x16x32_bf16 a[180:183], a[228:231], a[48:51], a[180:183]
    s_waitcnt lgkmcnt(5)
    ds_read_b128 a[92:95], v43 offset:4096
    v_mfma_f32_16x16x32_bf16 v[72:75], a[212:215], a[0:3], 0
    ds_read_b64_tr_b16 a[228:229], v26 offset:8
    v_mfma_f32_16x16x32_bf16 v[72:75], a[216:219], a[4:7], v[72:75]
    ds_read_b64_tr_b16 a[230:231], v26 offset:1032
    v_mfma_f32_16x16x32_bf16 v[72:75], a[220:223], a[8:11], v[72:75]
    ds_read_b64_tr_b16 a[232:233], v26 offset:8200
    v_mfma_f32_16x16x32_bf16 v[72:75], a[224:227], a[12:15], v[72:75]
    ds_read_b128 a[96:99], v40 offset:8192
    v_mfma_f32_16x16x32_bf16 v[88:91], a[224:227], a[28:31], 0
    ds_read_b64_tr_b16 a[234:235], v26 offset:9224
    v_mfma_f32_16x16x32_bf16 v[88:91], a[220:223], a[24:27], v[88:91]
    ds_read_b64_tr_b16 a[236:237], v26 offset:16392
    v_mfma_f32_16x16x32_bf16 v[88:91], a[216:219], a[20:23], v[88:91]
    ds_read_b64_tr_b16 a[238:239], v26 offset:17416
    v_mfma_f32_16x16x32_bf16 v[88:91], a[212:215], a[16:19], v[88:91]
    ds_read_b128 a[100:103], v41 offset:8192
    v_mfma_f32_16x16x32_bf16 v[104:107], a[212:215], a[32:35], 0
    ds_read_b64_tr_b16 a[240:241], v26 offset:24584
    v_mfma_f32_16x16x32_bf16 v[104:107], a[216:219], a[36:39], v[104:107]
    ds_read_b64_tr_b16 a[242:243], v26 offset:25608
    v_mfma_f32_16x16x32_bf16 v[104:107], a[220:223], a[40:43], v[104:107]
    ds_read_b128 a[104:107], v42 offset:8192
    v_mfma_f32_16x16x32_bf16 v[104:107], a[224:227], a[44:47], v[104:107]
    ds_read_b128 a[108:111], v43 offset:8192
    v_mfma_f32_16x16x32_bf16 v[120:123], a[224:227], a[60:63], 0
    ds_read_b128 a[112:115], v40 offset:12288
    v_mfma_f32_16x16x32_bf16 v[120:123], a[220:223], a[56:59], v[120:123]
    ds_read_b128 a[116:119], v41 offset:12288
    v_mfma_f32_16x16x32_bf16 v[120:123], a[216:219], a[52:55], v[120:123]
    ds_read_b128 a[120:123], v42 offset:12288
    v_mfma_f32_16x16x32_bf16 v[120:123], a[212:215], a[48:51], v[120:123]
    s_waitcnt lgkmcnt(5)
    ds_read_b128 a[124:127], v43 offset:12288
    v_mfma_f32_16x16x32_bf16 a[136:139], a[228:231], a[0:3], 0
    ds_read_b64_tr_b16 a[212:213], v27 offset:0
    v_mfma_f32_16x16x32_bf16 a[136:139], a[232:235], a[4:7], a[136:139]
    ds_read_b64_tr_b16 a[214:215], v27 offset:1024
    v_mfma_f32_16x16x32_bf16 a[136:139], a[236:239], a[8:11], a[136:139]
    ds_read_b64_tr_b16 a[216:217], v27 offset:8192
    v_mfma_f32_16x16x32_bf16 a[136:139], a[240:243], a[12:15], a[136:139]
    v_mfma_f32_16x16x32_bf16 a[152:155], a[240:243], a[28:31], 0
    s_waitcnt lgkmcnt(3)
    ds_read_b64_tr_b16 a[218:219], v27 offset:9216
    v_mfma_f32_16x16x32_bf16 a[152:155], a[236:239], a[24:27], a[152:155]
    ds_read_b64_tr_b16 a[220:221], v27 offset:16384
    v_mfma_f32_16x16x32_bf16 a[152:155], a[232:235], a[20:23], a[152:155]
    s_xor_b32 m0, s100, 0
    ds_read_b64_tr_b16 a[222:223], v27 offset:17408
    v_mfma_f32_16x16x32_bf16 a[152:155], a[228:231], a[16:19], a[152:155]
    s_xor_b32 s65, s101, 512
    v_mfma_f32_16x16x32_bf16 a[168:171], a[228:231], a[32:35], 0
    ds_read_b64_tr_b16 a[224:225], v27 offset:24576
    v_mfma_f32_16x16x32_bf16 a[168:171], a[232:235], a[36:39], a[168:171]
    ds_read_b64_tr_b16 a[226:227], v27 offset:25600
    v_mfma_f32_16x16x32_bf16 a[168:171], a[236:239], a[40:43], a[168:171]
    buffer_load_dwordx4 v44, s[4:7], s65 offen offset:0 lds
    v_mfma_f32_16x16x32_bf16 a[168:171], a[240:243], a[44:47], a[168:171]
    v_mfma_f32_16x16x32_bf16 a[184:187], a[240:243], a[60:63], 0
    buffer_load_dwordx4 v45, s[4:7], s65 offen offset:1024 lds
    v_mfma_f32_16x16x32_bf16 a[184:187], a[236:239], a[56:59], a[184:187]
    v_mfma_f32_16x16x32_bf16 a[184:187], a[232:235], a[52:55], a[184:187]
    v_mfma_f32_16x16x32_bf16 a[184:187], a[228:231], a[48:51], a[184:187]
    s_waitcnt lgkmcnt(0)
    buffer_load_dwordx4 v46, s[4:7], s65 offen offset:2048 lds
    v_mfma_f32_16x16x32_bf16 v[76:79], a[212:215], a[0:3], 0
    ds_read_b64_tr_b16 a[228:229], v27 offset:8
    v_mfma_f32_16x16x32_bf16 v[76:79], a[216:219], a[4:7], v[76:79]
    ds_read_b64_tr_b16 a[230:231], v27 offset:1032
    v_mfma_f32_16x16x32_bf16 v[76:79], a[220:223], a[8:11], v[76:79]
    ds_read_b64_tr_b16 a[232:233], v27 offset:8200
    v_mfma_f32_16x16x32_bf16 v[76:79], a[224:227], a[12:15], v[76:79]
    v_mfma_f32_16x16x32_bf16 v[92:95], a[224:227], a[28:31], 0
    ds_read_b64_tr_b16 a[234:235], v27 offset:9224
    v_mfma_f32_16x16x32_bf16 v[92:95], a[220:223], a[24:27], v[92:95]
    ds_read_b64_tr_b16 a[236:237], v27 offset:16392
    v_mfma_f32_16x16x32_bf16 v[92:95], a[216:219], a[20:23], v[92:95]
    ds_read_b64_tr_b16 a[238:239], v27 offset:17416
    v_mfma_f32_16x16x32_bf16 v[92:95], a[212:215], a[16:19], v[92:95]
    buffer_load_dwordx4 v47, s[4:7], s65 offen offset:3072 lds
    v_mfma_f32_16x16x32_bf16 v[108:111], a[212:215], a[32:35], 0
    s_mov_b32 s65, 917504
    ds_read_b64_tr_b16 a[240:241], v27 offset:24584
    v_mfma_f32_16x16x32_bf16 v[108:111], a[216:219], a[36:39], v[108:111]
    ds_read_b64_tr_b16 a[242:243], v27 offset:25608
    v_mfma_f32_16x16x32_bf16 v[108:111], a[220:223], a[40:43], v[108:111]
    buffer_load_dword a252, v23, s[12:15], s65 offen
    v_mfma_f32_16x16x32_bf16 v[108:111], a[224:227], a[44:47], v[108:111]
    v_mfma_f32_16x16x32_bf16 v[124:127], a[224:227], a[60:63], 0
    v_mfma_f32_16x16x32_bf16 v[124:127], a[220:223], a[56:59], v[124:127]
    v_mfma_f32_16x16x32_bf16 v[124:127], a[216:219], a[52:55], v[124:127]
    buffer_load_dword a252, v23, s[16:19], s65 offen
    v_mfma_f32_16x16x32_bf16 v[124:127], a[212:215], a[48:51], v[124:127]
    s_waitcnt lgkmcnt(0)
    v_mfma_f32_16x16x32_bf16 a[140:143], a[228:231], a[0:3], 0
    s_waitcnt vmcnt(7)
    v_mfma_f32_16x16x32_bf16 a[140:143], a[232:235], a[4:7], a[140:143]
    s_barrier
    v_mfma_f32_16x16x32_bf16 a[140:143], a[236:239], a[8:11], a[140:143]
    ds_read_b64_tr_b16 a[212:213], v28 offset:0
    v_mfma_f32_16x16x32_bf16 a[140:143], a[240:243], a[12:15], a[140:143]
    ds_read_b64_tr_b16 a[214:215], v28 offset:512
    v_mfma_f32_16x16x32_bf16 a[156:159], a[240:243], a[28:31], 0
    ds_read_b64_tr_b16 a[216:217], v28 offset:4096
    v_mfma_f32_16x16x32_bf16 a[156:159], a[236:239], a[24:27], a[156:159]
    ds_read_b64_tr_b16 a[218:219], v28 offset:4608
    v_mfma_f32_16x16x32_bf16 a[156:159], a[232:235], a[20:23], a[156:159]
    ds_read_b64_tr_b16 a[220:221], v28 offset:8192
    buffer_atomic_add v49, v48, s[40:43], 0 offen
    v_mfma_f32_16x16x32_bf16 a[156:159], a[228:231], a[16:19], a[156:159]
    s_add_u32 m0, s59, 131072
    ds_read_b64_tr_b16 a[222:223], v28 offset:8704
    v_mfma_f32_16x16x32_bf16 a[172:175], a[228:231], a[32:35], 0
    s_add_u32 s65, s67, 1048576
    ds_read_b64_tr_b16 a[224:225], v28 offset:12288
    v_mfma_f32_16x16x32_bf16 a[172:175], a[232:235], a[36:39], a[172:175]
    ds_read_b64_tr_b16 a[226:227], v28 offset:12800
    v_mfma_f32_16x16x32_bf16 a[172:175], a[236:239], a[40:43], a[172:175]
    buffer_load_dwordx4 v32, s[8:11], s65 offen offset:0 lds
    v_mfma_f32_16x16x32_bf16 a[172:175], a[240:243], a[44:47], a[172:175]
    v_mfma_f32_16x16x32_bf16 a[188:191], a[240:243], a[60:63], 0
    v_mfma_f32_16x16x32_bf16 a[188:191], a[236:239], a[56:59], a[188:191]
    v_mfma_f32_16x16x32_bf16 a[188:191], a[232:235], a[52:55], a[188:191]
    buffer_load_dwordx4 v33, s[8:11], s65 offen offset:1024 lds
    v_mfma_f32_16x16x32_bf16 a[188:191], a[228:231], a[48:51], a[188:191]
    s_waitcnt lgkmcnt(0)
    v_mfma_f32_16x16x32_bf16 v[128:131], a[212:215], a[64:67], v[128:131]
    ds_read_b64_tr_b16 a[228:229], v28 offset:16384
    v_mfma_f32_16x16x32_bf16 v[128:131], a[216:219], a[68:71], v[128:131]
    ds_read_b64_tr_b16 a[230:231], v28 offset:16896
    v_mfma_f32_16x16x32_bf16 v[128:131], a[220:223], a[72:75], v[128:131]
    ds_read_b64_tr_b16 a[232:233], v28 offset:20480
    v_mfma_f32_16x16x32_bf16 v[128:131], a[224:227], a[76:79], v[128:131]
    buffer_load_dwordx4 v34, s[8:11], s65 offen offset:2048 lds
    v_mfma_f32_16x16x32_bf16 v[132:135], a[224:227], a[92:95], v[132:135]
    ds_read_b64_tr_b16 a[234:235], v28 offset:20992
    v_mfma_f32_16x16x32_bf16 v[132:135], a[220:223], a[88:91], v[132:135]
    ds_read_b64_tr_b16 a[236:237], v28 offset:24576
    v_mfma_f32_16x16x32_bf16 v[132:135], a[216:219], a[84:87], v[132:135]
    ds_read_b64_tr_b16 a[238:239], v28 offset:25088
    v_mfma_f32_16x16x32_bf16 v[132:135], a[212:215], a[80:83], v[132:135]
    buffer_load_dwordx4 v35, s[8:11], s65 offen offset:3072 lds
    v_mfma_f32_16x16x32_bf16 v[136:139], a[212:215], a[96:99], v[136:139]
    s_add_u32 m0, s59, 135168
    ds_read_b64_tr_b16 a[240:241], v28 offset:28672
    v_mfma_f32_16x16x32_bf16 v[136:139], a[216:219], a[100:103], v[136:139]
    s_add_u32 s65, s67, 1179648
    ds_read_b64_tr_b16 a[242:243], v28 offset:29184
    v_mfma_f32_16x16x32_bf16 v[136:139], a[220:223], a[104:107], v[136:139]
    v_mfma_f32_16x16x32_bf16 v[136:139], a[224:227], a[108:111], v[136:139]
    buffer_load_dwordx4 v32, s[8:11], s65 offen offset:0 lds
    v_mfma_f32_16x16x32_bf16 v[140:143], a[224:227], a[124:127], v[140:143]
    v_mfma_f32_16x16x32_bf16 v[140:143], a[220:223], a[120:123], v[140:143]
    v_mfma_f32_16x16x32_bf16 v[140:143], a[216:219], a[116:119], v[140:143]
    v_mfma_f32_16x16x32_bf16 v[140:143], a[212:215], a[112:115], v[140:143]
    buffer_load_dwordx4 v33, s[8:11], s65 offen offset:1024 lds
    v_smfmac_f32_16x16x64_bf16 a[192:195], a[208:211], a[212:219], v20
    v_smfmac_f32_16x16x64_bf16 a[192:195], a[208:211], a[220:227], v20
    s_waitcnt lgkmcnt(0)
    v_mfma_f32_16x16x32_bf16 v[192:195], a[228:231], a[64:67], v[192:195]
    ds_read_b64_tr_b16 a[212:213], v29 offset:0
    v_mfma_f32_16x16x32_bf16 v[192:195], a[232:235], a[68:71], v[192:195]
    ds_read_b64_tr_b16 a[214:215], v29 offset:512
    v_mfma_f32_16x16x32_bf16 v[192:195], a[236:239], a[72:75], v[192:195]
    ds_read_b64_tr_b16 a[216:217], v29 offset:4096
    v_mfma_f32_16x16x32_bf16 v[192:195], a[240:243], a[76:79], v[192:195]
    buffer_load_dwordx4 v34, s[8:11], s65 offen offset:2048 lds
    v_mfma_f32_16x16x32_bf16 v[196:199], a[240:243], a[92:95], v[196:199]
    ds_read_b64_tr_b16 a[218:219], v29 offset:4608
    v_mfma_f32_16x16x32_bf16 v[196:199], a[236:239], a[88:91], v[196:199]
    ds_read_b64_tr_b16 a[220:221], v29 offset:8192
    v_mfma_f32_16x16x32_bf16 v[196:199], a[232:235], a[84:87], v[196:199]
    ds_read_b64_tr_b16 a[222:223], v29 offset:8704
    v_mfma_f32_16x16x32_bf16 v[196:199], a[228:231], a[80:83], v[196:199]
    buffer_load_dwordx4 v35, s[8:11], s65 offen offset:3072 lds
    v_mfma_f32_16x16x32_bf16 v[200:203], a[228:231], a[96:99], v[200:203]
    ds_read_b64_tr_b16 a[224:225], v29 offset:12288
    v_mfma_f32_16x16x32_bf16 v[200:203], a[232:235], a[100:103], v[200:203]
    ds_read_b64_tr_b16 a[226:227], v29 offset:12800
    v_mfma_f32_16x16x32_bf16 v[200:203], a[236:239], a[104:107], v[200:203]
    v_mfma_f32_16x16x32_bf16 v[200:203], a[240:243], a[108:111], v[200:203]
    v_mfma_f32_16x16x32_bf16 v[204:207], a[240:243], a[124:127], v[204:207]
    v_mfma_f32_16x16x32_bf16 v[204:207], a[236:239], a[120:123], v[204:207]
    s_xor_b32 m0, s100, 4096
    v_mfma_f32_16x16x32_bf16 v[204:207], a[232:235], a[116:119], v[204:207]
    s_xor_b32 s65, s101, 16896
    v_mfma_f32_16x16x32_bf16 v[204:207], a[228:231], a[112:115], v[204:207]
    buffer_load_dwordx4 v44, s[4:7], s65 offen offset:0 lds
    v_smfmac_f32_16x16x64_bf16 a[196:199], a[208:211], a[228:235], v20
    v_smfmac_f32_16x16x64_bf16 a[196:199], a[208:211], a[236:243], v20
    s_waitcnt lgkmcnt(0)
    v_mfma_f32_16x16x32_bf16 v[144:147], a[212:215], a[64:67], v[144:147]
    ds_read_b64_tr_b16 a[228:229], v29 offset:16384
    v_mfma_f32_16x16x32_bf16 v[144:147], a[216:219], a[68:71], v[144:147]
    ds_read_b64_tr_b16 a[230:231], v29 offset:16896
    v_mfma_f32_16x16x32_bf16 v[144:147], a[220:223], a[72:75], v[144:147]
    ds_read_b64_tr_b16 a[232:233], v29 offset:20480
    v_mfma_f32_16x16x32_bf16 v[144:147], a[224:227], a[76:79], v[144:147]
    buffer_load_dwordx4 v45, s[4:7], s65 offen offset:1024 lds
    v_mfma_f32_16x16x32_bf16 v[148:151], a[224:227], a[92:95], v[148:151]
    ds_read_b64_tr_b16 a[234:235], v29 offset:20992
    v_mfma_f32_16x16x32_bf16 v[148:151], a[220:223], a[88:91], v[148:151]
    ds_read_b64_tr_b16 a[236:237], v29 offset:24576
    v_mfma_f32_16x16x32_bf16 v[148:151], a[216:219], a[84:87], v[148:151]
    ds_read_b64_tr_b16 a[238:239], v29 offset:25088
    v_mfma_f32_16x16x32_bf16 v[148:151], a[212:215], a[80:83], v[148:151]
    buffer_load_dwordx4 v46, s[4:7], s65 offen offset:2048 lds
    v_mfma_f32_16x16x32_bf16 v[152:155], a[212:215], a[96:99], v[152:155]
    ds_read_b64_tr_b16 a[240:241], v29 offset:28672
    v_mfma_f32_16x16x32_bf16 v[152:155], a[216:219], a[100:103], v[152:155]
    ds_read_b64_tr_b16 a[242:243], v29 offset:29184
    v_mfma_f32_16x16x32_bf16 v[152:155], a[220:223], a[104:107], v[152:155]
    buffer_load_dwordx4 v47, s[4:7], s65 offen offset:3072 lds
    v_mfma_f32_16x16x32_bf16 v[152:155], a[224:227], a[108:111], v[152:155]
    s_xor_b32 m0, s100, 8192
    v_mfma_f32_16x16x32_bf16 v[156:159], a[224:227], a[124:127], v[156:159]
    s_xor_b32 s65, s101, 33280
    v_mfma_f32_16x16x32_bf16 v[156:159], a[220:223], a[120:123], v[156:159]
    v_mfma_f32_16x16x32_bf16 v[156:159], a[216:219], a[116:119], v[156:159]
    buffer_load_dwordx4 v44, s[4:7], s65 offen offset:0 lds
    v_mfma_f32_16x16x32_bf16 v[156:159], a[212:215], a[112:115], v[156:159]
    s_waitcnt lgkmcnt(0)
    v_mfma_f32_16x16x32_bf16 v[208:211], a[228:231], a[64:67], v[208:211]
    ds_read_b64_tr_b16 a[212:213], v30 offset:0
    v_mfma_f32_16x16x32_bf16 v[208:211], a[232:235], a[68:71], v[208:211]
    ds_read_b64_tr_b16 a[214:215], v30 offset:512
    v_mfma_f32_16x16x32_bf16 v[208:211], a[236:239], a[72:75], v[208:211]
    ds_read_b64_tr_b16 a[216:217], v30 offset:4096
    v_mfma_f32_16x16x32_bf16 v[208:211], a[240:243], a[76:79], v[208:211]
    buffer_load_dwordx4 v45, s[4:7], s65 offen offset:1024 lds
    v_mfma_f32_16x16x32_bf16 v[212:215], a[240:243], a[92:95], v[212:215]
    ds_read_b64_tr_b16 a[218:219], v30 offset:4608
    v_mfma_f32_16x16x32_bf16 v[212:215], a[236:239], a[88:91], v[212:215]
    ds_read_b64_tr_b16 a[220:221], v30 offset:8192
    v_mfma_f32_16x16x32_bf16 v[212:215], a[232:235], a[84:87], v[212:215]
    ds_read_b64_tr_b16 a[222:223], v30 offset:8704
    v_mfma_f32_16x16x32_bf16 v[212:215], a[228:231], a[80:83], v[212:215]
    buffer_load_dwordx4 v46, s[4:7], s65 offen offset:2048 lds
    v_mfma_f32_16x16x32_bf16 v[216:219], a[228:231], a[96:99], v[216:219]
    ds_read_b64_tr_b16 a[224:225], v30 offset:12288
    v_mfma_f32_16x16x32_bf16 v[216:219], a[232:235], a[100:103], v[216:219]
    ds_read_b64_tr_b16 a[226:227], v30 offset:12800
    v_mfma_f32_16x16x32_bf16 v[216:219], a[236:239], a[104:107], v[216:219]
    v_mfma_f32_16x16x32_bf16 v[216:219], a[240:243], a[108:111], v[216:219]
    buffer_load_dwordx4 v47, s[4:7], s65 offen offset:3072 lds
    v_mfma_f32_16x16x32_bf16 v[220:223], a[240:243], a[124:127], v[220:223]
    s_xor_b32 m0, s100, 12288
    v_mfma_f32_16x16x32_bf16 v[220:223], a[236:239], a[120:123], v[220:223]
    s_xor_b32 s65, s101, 49664
    v_mfma_f32_16x16x32_bf16 v[220:223], a[232:235], a[116:119], v[220:223]
    v_mfma_f32_16x16x32_bf16 v[220:223], a[228:231], a[112:115], v[220:223]
    s_waitcnt lgkmcnt(0)
    buffer_load_dwordx4 v44, s[4:7], s65 offen offset:0 lds
    v_mfma_f32_16x16x32_bf16 v[160:163], a[212:215], a[64:67], v[160:163]
    ds_read_b64_tr_b16 a[228:229], v30 offset:16384
    v_mfma_f32_16x16x32_bf16 v[160:163], a[216:219], a[68:71], v[160:163]
    ds_read_b64_tr_b16 a[230:231], v30 offset:16896
    v_mfma_f32_16x16x32_bf16 v[160:163], a[220:223], a[72:75], v[160:163]
    ds_read_b64_tr_b16 a[232:233], v30 offset:20480
    v_mfma_f32_16x16x32_bf16 v[160:163], a[224:227], a[76:79], v[160:163]
    buffer_load_dwordx4 v45, s[4:7], s65 offen offset:1024 lds
    v_mfma_f32_16x16x32_bf16 v[164:167], a[224:227], a[92:95], v[164:167]
    ds_read_b64_tr_b16 a[234:235], v30 offset:20992
    v_mfma_f32_16x16x32_bf16 v[164:167], a[220:223], a[88:91], v[164:167]
    ds_read_b64_tr_b16 a[236:237], v30 offset:24576
    v_mfma_f32_16x16x32_bf16 v[164:167], a[216:219], a[84:87], v[164:167]
    ds_read_b64_tr_b16 a[238:239], v30 offset:25088
    v_mfma_f32_16x16x32_bf16 v[164:167], a[212:215], a[80:83], v[164:167]
    buffer_load_dwordx4 v46, s[4:7], s65 offen offset:2048 lds
    v_mfma_f32_16x16x32_bf16 v[168:171], a[212:215], a[96:99], v[168:171]
    ds_read_b64_tr_b16 a[240:241], v30 offset:28672
    v_mfma_f32_16x16x32_bf16 v[168:171], a[216:219], a[100:103], v[168:171]
    ds_read_b64_tr_b16 a[242:243], v30 offset:29184
    v_mfma_f32_16x16x32_bf16 v[168:171], a[220:223], a[104:107], v[168:171]
    v_mfma_f32_16x16x32_bf16 v[168:171], a[224:227], a[108:111], v[168:171]
    v_mfma_f32_16x16x32_bf16 v[172:175], a[224:227], a[124:127], v[172:175]
    v_mfma_f32_16x16x32_bf16 v[172:175], a[220:223], a[120:123], v[172:175]
    buffer_load_dwordx4 v47, s[4:7], s65 offen offset:3072 lds
    v_mfma_f32_16x16x32_bf16 v[172:175], a[216:219], a[116:119], v[172:175]
    s_add_u32 m0, s60, 65536
    v_mfma_f32_16x16x32_bf16 v[172:175], a[212:215], a[112:115], v[172:175]
    s_waitcnt lgkmcnt(0)
    v_mfma_f32_16x16x32_bf16 v[224:227], a[228:231], a[64:67], v[224:227]
    s_add_u32 s65, s68, 917504
    ds_read_b64_tr_b16 a[212:213], v31 offset:0
    v_mfma_f32_16x16x32_bf16 v[224:227], a[232:235], a[68:71], v[224:227]
    ds_read_b64_tr_b16 a[214:215], v31 offset:512
    v_mfma_f32_16x16x32_bf16 v[224:227], a[236:239], a[72:75], v[224:227]
    ds_read_b64_tr_b16 a[216:217], v31 offset:4096
    v_mfma_f32_16x16x32_bf16 v[224:227], a[240:243], a[76:79], v[224:227]
    buffer_load_dwordx4 v36, s[12:15], s65 offen offset:0 lds
    v_mfma_f32_16x16x32_bf16 v[228:231], a[240:243], a[92:95], v[228:231]
    ds_read_b64_tr_b16 a[218:219], v31 offset:4608
    v_mfma_f32_16x16x32_bf16 v[228:231], a[236:239], a[88:91], v[228:231]
    ds_read_b64_tr_b16 a[220:221], v31 offset:8192
    v_mfma_f32_16x16x32_bf16 v[228:231], a[232:235], a[84:87], v[228:231]
    ds_read_b64_tr_b16 a[222:223], v31 offset:8704
    v_mfma_f32_16x16x32_bf16 v[228:231], a[228:231], a[80:83], v[228:231]
    buffer_load_dwordx4 v37, s[12:15], s65 offen offset:1024 lds
    v_mfma_f32_16x16x32_bf16 v[232:235], a[228:231], a[96:99], v[232:235]
    ds_read_b64_tr_b16 a[224:225], v31 offset:12288
    v_mfma_f32_16x16x32_bf16 v[232:235], a[232:235], a[100:103], v[232:235]
    ds_read_b64_tr_b16 a[226:227], v31 offset:12800
    v_mfma_f32_16x16x32_bf16 v[232:235], a[236:239], a[104:107], v[232:235]
    buffer_load_dwordx4 v38, s[12:15], s65 offen offset:2048 lds
    v_mfma_f32_16x16x32_bf16 v[232:235], a[240:243], a[108:111], v[232:235]
    v_mfma_f32_16x16x32_bf16 v[236:239], a[240:243], a[124:127], v[236:239]
    v_mfma_f32_16x16x32_bf16 v[236:239], a[236:239], a[120:123], v[236:239]
    v_mfma_f32_16x16x32_bf16 v[236:239], a[232:235], a[116:119], v[236:239]
    buffer_load_dwordx4 v39, s[12:15], s65 offen offset:3072 lds
    v_mfma_f32_16x16x32_bf16 v[236:239], a[228:231], a[112:115], v[236:239]
    s_waitcnt lgkmcnt(0)
    v_mfma_f32_16x16x32_bf16 v[176:179], a[212:215], a[64:67], v[176:179]
    s_add_u32 m0, s60, 81920
    ds_read_b64_tr_b16 a[228:229], v31 offset:16384
    v_mfma_f32_16x16x32_bf16 v[176:179], a[216:219], a[68:71], v[176:179]
    s_add_u32 s65, s68, 917504
    ds_read_b64_tr_b16 a[230:231], v31 offset:16896
    v_mfma_f32_16x16x32_bf16 v[176:179], a[220:223], a[72:75], v[176:179]
    ds_read_b64_tr_b16 a[232:233], v31 offset:20480
    v_mfma_f32_16x16x32_bf16 v[176:179], a[224:227], a[76:79], v[176:179]
    buffer_load_dwordx4 v36, s[16:19], s65 offen offset:0 lds
    v_mfma_f32_16x16x32_bf16 v[180:183], a[224:227], a[92:95], v[180:183]
    ds_read_b64_tr_b16 a[234:235], v31 offset:20992
    v_mfma_f32_16x16x32_bf16 v[180:183], a[220:223], a[88:91], v[180:183]
    ds_read_b64_tr_b16 a[236:237], v31 offset:24576
    v_mfma_f32_16x16x32_bf16 v[180:183], a[216:219], a[84:87], v[180:183]
    ds_read_b64_tr_b16 a[238:239], v31 offset:25088
    v_mfma_f32_16x16x32_bf16 v[180:183], a[212:215], a[80:83], v[180:183]
    buffer_load_dwordx4 v37, s[16:19], s65 offen offset:1024 lds
    v_mfma_f32_16x16x32_bf16 v[184:187], a[212:215], a[96:99], v[184:187]
    ds_read_b64_tr_b16 a[240:241], v31 offset:28672
    v_mfma_f32_16x16x32_bf16 v[184:187], a[216:219], a[100:103], v[184:187]
    ds_read_b64_tr_b16 a[242:243], v31 offset:29184
    v_mfma_f32_16x16x32_bf16 v[184:187], a[220:223], a[104:107], v[184:187]
    v_mfma_f32_16x16x32_bf16 v[184:187], a[224:227], a[108:111], v[184:187]
    buffer_load_dwordx4 v38, s[16:19], s65 offen offset:2048 lds
    v_mfma_f32_16x16x32_bf16 v[188:191], a[224:227], a[124:127], v[188:191]
    v_mfma_f32_16x16x32_bf16 v[188:191], a[220:223], a[120:123], v[188:191]
    v_mfma_f32_16x16x32_bf16 v[188:191], a[216:219], a[116:119], v[188:191]
    v_mfma_f32_16x16x32_bf16 v[188:191], a[212:215], a[112:115], v[188:191]
    s_waitcnt lgkmcnt(0)
    buffer_load_dwordx4 v39, s[16:19], s65 offen offset:3072 lds
    v_mfma_f32_16x16x32_bf16 v[240:243], a[228:231], a[64:67], v[240:243]
    s_waitcnt vmcnt(20)
    v_add_u32 v24, 65536, v24
    v_add_u32 v25, 65536, v25
    v_mfma_f32_16x16x32_bf16 v[240:243], a[232:235], a[68:71], v[240:243]
    s_barrier
    v_add_u32 v26, 65536, v26
    v_add_u32 v27, 65536, v27
    v_mfma_f32_16x16x32_bf16 v[240:243], a[236:239], a[72:75], v[240:243]
    s_mov_b32 s65, 1376256
    ds_read_b64_tr_b16 a[212:213], v24 offset:0
    v_mfma_f32_16x16x32_bf16 v[240:243], a[240:243], a[76:79], v[240:243]
    ds_read_b64_tr_b16 a[214:215], v24 offset:1024
    v_mfma_f32_16x16x32_bf16 v[244:247], a[240:243], a[92:95], v[244:247]
    ds_read_b64_tr_b16 a[216:217], v24 offset:8192
    buffer_load_dword a252, v23, s[12:15], s65 offen
    v_mfma_f32_16x16x32_bf16 v[244:247], a[236:239], a[88:91], v[244:247]
    ds_read_b64_tr_b16 a[218:219], v24 offset:9216
    v_mfma_f32_16x16x32_bf16 v[244:247], a[232:235], a[84:87], v[244:247]
    ds_read_b64_tr_b16 a[220:221], v24 offset:16384
    v_mfma_f32_16x16x32_bf16 v[244:247], a[228:231], a[80:83], v[244:247]
    ds_read_b64_tr_b16 a[222:223], v24 offset:17408
    v_mfma_f32_16x16x32_bf16 v[248:251], a[228:231], a[96:99], v[248:251]
    ds_read_b64_tr_b16 a[224:225], v24 offset:24576
    v_mfma_f32_16x16x32_bf16 v[248:251], a[232:235], a[100:103], v[248:251]
    ds_read_b64_tr_b16 a[226:227], v24 offset:25600
    v_mfma_f32_16x16x32_bf16 v[248:251], a[236:239], a[104:107], v[248:251]
    buffer_load_dword a252, v23, s[16:19], s65 offen
    v_mfma_f32_16x16x32_bf16 v[248:251], a[240:243], a[108:111], v[248:251]
    s_mov_b32 s65, 2097152
    v_mfma_f32_16x16x32_bf16 v[252:255], a[240:243], a[124:127], v[252:255]
    v_mfma_f32_16x16x32_bf16 v[252:255], a[236:239], a[120:123], v[252:255]
    buffer_load_dword a252, v22, s[8:11], s65 offen
    v_mfma_f32_16x16x32_bf16 v[252:255], a[232:235], a[116:119], v[252:255]
    v_mfma_f32_16x16x32_bf16 v[252:255], a[228:231], a[112:115], v[252:255]
    s_waitcnt lgkmcnt(0)
    v_mfma_f32_16x16x32_bf16 v[64:67], a[212:215], a[64:67], v[64:67]
    ds_read_b64_tr_b16 a[228:229], v24 offset:8
    v_mfma_f32_16x16x32_bf16 v[64:67], a[216:219], a[68:71], v[64:67]
    ds_read_b64_tr_b16 a[230:231], v24 offset:1032
    v_mfma_f32_16x16x32_bf16 v[64:67], a[220:223], a[72:75], v[64:67]
    ds_read_b64_tr_b16 a[232:233], v24 offset:8200
    v_mfma_f32_16x16x32_bf16 v[64:67], a[224:227], a[76:79], v[64:67]
    v_mfma_f32_16x16x32_bf16 v[80:83], a[224:227], a[92:95], v[80:83]
    ds_read_b64_tr_b16 a[234:235], v24 offset:9224
    v_mfma_f32_16x16x32_bf16 v[80:83], a[220:223], a[88:91], v[80:83]
    ds_read_b64_tr_b16 a[236:237], v24 offset:16392
    v_mfma_f32_16x16x32_bf16 v[80:83], a[216:219], a[84:87], v[80:83]
    s_waitcnt vmcnt(11)
    ds_read_b64_tr_b16 a[238:239], v24 offset:17416
    v_mfma_f32_16x16x32_bf16 v[80:83], a[212:215], a[80:83], v[80:83]
    ds_read_b128 a[0:3], v40 offset:0
    v_mfma_f32_16x16x32_bf16 v[96:99], a[212:215], a[96:99], v[96:99]
    ds_read_b64_tr_b16 a[240:241], v24 offset:24584
    v_mfma_f32_16x16x32_bf16 v[96:99], a[216:219], a[100:103], v[96:99]
    ds_read_b64_tr_b16 a[242:243], v24 offset:25608
    v_mfma_f32_16x16x32_bf16 v[96:99], a[220:223], a[104:107], v[96:99]
    ds_read_b128 a[4:7], v41 offset:0
    v_mfma_f32_16x16x32_bf16 v[96:99], a[224:227], a[108:111], v[96:99]
    ds_read_b128 a[8:11], v42 offset:0
    v_mfma_f32_16x16x32_bf16 v[112:115], a[224:227], a[124:127], v[112:115]
    ds_read_b128 a[12:15], v43 offset:0
    v_mfma_f32_16x16x32_bf16 v[112:115], a[220:223], a[120:123], v[112:115]
    ds_read_b128 a[16:19], v40 offset:4096
    v_mfma_f32_16x16x32_bf16 v[112:115], a[216:219], a[116:119], v[112:115]
    ds_read_b128 a[20:23], v41 offset:4096
    v_mfma_f32_16x16x32_bf16 v[112:115], a[212:215], a[112:115], v[112:115]
    ds_read_b128 a[24:27], v42 offset:4096
    v_smfmac_f32_16x16x64_bf16 a[200:203], a[208:211], a[212:219], v20
    ds_read_b128 a[28:31], v43 offset:4096
    v_smfmac_f32_16x16x64_bf16 a[200:203], a[208:211], a[220:227], v20
    s_waitcnt lgkmcnt(7)
    v_mfma_f32_16x16x32_bf16 a[128:131], a[228:231], a[64:67], a[128:131]
    ds_read_b64_tr_b16 a[212:213], v25 offset:0
    v_mfma_f32_16x16x32_bf16 a[128:131], a[232:235], a[68:71], a[128:131]
    ds_read_b64_tr_b16 a[214:215], v25 offset:1024
    v_mfma_f32_16x16x32_bf16 a[128:131], a[236:239], a[72:75], a[128:131]
    ds_read_b64_tr_b16 a[216:217], v25 offset:8192
    v_mfma_f32_16x16x32_bf16 a[128:131], a[240:243], a[76:79], a[128:131]
    ds_read_b128 a[32:35], v40 offset:8192
    v_mfma_f32_16x16x32_bf16 a[144:147], a[240:243], a[92:95], a[144:147]
    ds_read_b64_tr_b16 a[218:219], v25 offset:9216
    v_mfma_f32_16x16x32_bf16 a[144:147], a[236:239], a[88:91], a[144:147]
    ds_read_b64_tr_b16 a[220:221], v25 offset:16384
    v_mfma_f32_16x16x32_bf16 a[144:147], a[232:235], a[84:87], a[144:147]
    ds_read_b64_tr_b16 a[222:223], v25 offset:17408
    v_mfma_f32_16x16x32_bf16 a[144:147], a[228:231], a[80:83], a[144:147]
    ds_read_b128 a[36:39], v41 offset:8192
    v_mfma_f32_16x16x32_bf16 a[160:163], a[228:231], a[96:99], a[160:163]
    ds_read_b64_tr_b16 a[224:225], v25 offset:24576
    v_mfma_f32_16x16x32_bf16 a[160:163], a[232:235], a[100:103], a[160:163]
    ds_read_b64_tr_b16 a[226:227], v25 offset:25600
    v_mfma_f32_16x16x32_bf16 a[160:163], a[236:239], a[104:107], a[160:163]
    ds_read_b128 a[40:43], v42 offset:8192
    v_mfma_f32_16x16x32_bf16 a[160:163], a[240:243], a[108:111], a[160:163]
    ds_read_b128 a[44:47], v43 offset:8192
    v_mfma_f32_16x16x32_bf16 a[176:179], a[240:243], a[124:127], a[176:179]
    ds_read_b128 a[48:51], v40 offset:12288
    v_mfma_f32_16x16x32_bf16 a[176:179], a[236:239], a[120:123], a[176:179]
    ds_read_b128 a[52:55], v41 offset:12288
    v_mfma_f32_16x16x32_bf16 a[176:179], a[232:235], a[116:119], a[176:179]
    ds_read_b128 a[56:59], v42 offset:12288
    v_mfma_f32_16x16x32_bf16 a[176:179], a[228:231], a[112:115], a[176:179]
    ds_read_b128 a[60:63], v43 offset:12288
    v_smfmac_f32_16x16x64_bf16 a[204:207], a[208:211], a[228:235], v20
    v_smfmac_f32_16x16x64_bf16 a[204:207], a[208:211], a[236:243], v20
    s_waitcnt lgkmcnt(6)
    v_mfma_f32_16x16x32_bf16 v[68:71], a[212:215], a[64:67], v[68:71]
    ds_read_b64_tr_b16 a[228:229], v25 offset:8
    v_mfma_f32_16x16x32_bf16 v[68:71], a[216:219], a[68:71], v[68:71]
    ds_read_b64_tr_b16 a[230:231], v25 offset:1032
    v_mfma_f32_16x16x32_bf16 v[68:71], a[220:223], a[72:75], v[68:71]
    s_waitcnt lgkmcnt(2)
    ds_read_b64_tr_b16 a[232:233], v25 offset:8200
    v_mfma_f32_16x16x32_bf16 v[68:71], a[224:227], a[76:79], v[68:71]
    v_mfma_f32_16x16x32_bf16 v[84:87], a[224:227], a[92:95], v[84:87]
    s_xor_b32 m0, s100, 0
    ds_read_b64_tr_b16 a[234:235], v25 offset:9224
    v_mfma_f32_16x16x32_bf16 v[84:87], a[220:223], a[88:91], v[84:87]
    s_xor_b32 s65, s101, 768
    ds_read_b64_tr_b16 a[236:237], v25 offset:16392
    v_mfma_f32_16x16x32_bf16 v[84:87], a[216:219], a[84:87], v[84:87]
    ds_read_b64_tr_b16 a[238:239], v25 offset:17416
    v_mfma_f32_16x16x32_bf16 v[84:87], a[212:215], a[80:83], v[84:87]
    buffer_load_dwordx4 v44, s[4:7], s65 offen offset:0 lds
    v_mfma_f32_16x16x32_bf16 v[100:103], a[212:215], a[96:99], v[100:103]
    ds_read_b64_tr_b16 a[240:241], v25 offset:24584
    v_mfma_f32_16x16x32_bf16 v[100:103], a[216:219], a[100:103], v[100:103]
    ds_read_b64_tr_b16 a[242:243], v25 offset:25608
    v_mfma_f32_16x16x32_bf16 v[100:103], a[220:223], a[104:107], v[100:103]
    buffer_load_dwordx4 v45, s[4:7], s65 offen offset:1024 lds
    v_mfma_f32_16x16x32_bf16 v[100:103], a[224:227], a[108:111], v[100:103]
    v_mfma_f32_16x16x32_bf16 v[116:119], a[224:227], a[124:127], v[116:119]
    v_mfma_f32_16x16x32_bf16 v[116:119], a[220:223], a[120:123], v[116:119]
    v_mfma_f32_16x16x32_bf16 v[116:119], a[216:219], a[116:119], v[116:119]
    buffer_load_dwordx4 v46, s[4:7], s65 offen offset:2048 lds
    v_mfma_f32_16x16x32_bf16 v[116:119], a[212:215], a[112:115], v[116:119]
    s_waitcnt lgkmcnt(0)
    v_mfma_f32_16x16x32_bf16 a[132:135], a[228:231], a[64:67], a[132:135]
    ds_read_b64_tr_b16 a[212:213], v26 offset:0
    v_mfma_f32_16x16x32_bf16 a[132:135], a[232:235], a[68:71], a[132:135]
    ds_read_b64_tr_b16 a[214:215], v26 offset:1024
    v_mfma_f32_16x16x32_bf16 a[132:135], a[236:239], a[72:75], a[132:135]
    ds_read_b64_tr_b16 a[216:217], v26 offset:8192
    v_mfma_f32_16x16x32_bf16 a[132:135], a[240:243], a[76:79], a[132:135]
    buffer_load_dwordx4 v47, s[4:7], s65 offen offset:3072 lds
    v_mfma_f32_16x16x32_bf16 a[148:151], a[240:243], a[92:95], a[148:151]
    ds_read_b64_tr_b16 a[218:219], v26 offset:9216
    v_mfma_f32_16x16x32_bf16 a[148:151], a[236:239], a[88:91], a[148:151]
    s_mov_b32 s65, 3145728
    ds_read_b64_tr_b16 a[220:221], v26 offset:16384
    v_mfma_f32_16x16x32_bf16 a[148:151], a[232:235], a[84:87], a[148:151]
    ds_read_b64_tr_b16 a[222:223], v26 offset:17408
    v_mfma_f32_16x16x32_bf16 a[148:151], a[228:231], a[80:83], a[148:151]
    buffer_load_dword a252, v22, s[8:11], s65 offen
    v_mfma_f32_16x16x32_bf16 a[164:167], a[228:231], a[96:99], a[164:167]
    ds_read_b64_tr_b16 a[224:225], v26 offset:24576
    v_mfma_f32_16x16x32_bf16 a[164:167], a[232:235], a[100:103], a[164:167]
    ds_read_b64_tr_b16 a[226:227], v26 offset:25600
    v_mfma_f32_16x16x32_bf16 a[164:167], a[236:239], a[104:107], a[164:167]
    v_mfma_f32_16x16x32_bf16 a[164:167], a[240:243], a[108:111], a[164:167]
    v_mfma_f32_16x16x32_bf16 a[180:183], a[240:243], a[124:127], a[180:183]
    global_load_dword a252, v[60:61], off
    v_mfma_f32_16x16x32_bf16 a[180:183], a[236:239], a[120:123], a[180:183]
    v_mfma_f32_16x16x32_bf16 a[180:183], a[232:235], a[116:119], a[180:183]
    v_mfma_f32_16x16x32_bf16 a[180:183], a[228:231], a[112:115], a[180:183]
    s_waitcnt lgkmcnt(0)
    v_mfma_f32_16x16x32_bf16 v[72:75], a[212:215], a[64:67], v[72:75]
    ds_read_b64_tr_b16 a[228:229], v26 offset:8
    v_mfma_f32_16x16x32_bf16 v[72:75], a[216:219], a[68:71], v[72:75]
    ds_read_b64_tr_b16 a[230:231], v26 offset:1032
    v_mfma_f32_16x16x32_bf16 v[72:75], a[220:223], a[72:75], v[72:75]
    ds_read_b64_tr_b16 a[232:233], v26 offset:8200
    v_mfma_f32_16x16x32_bf16 v[72:75], a[224:227], a[76:79], v[72:75]
    v_mfma_f32_16x16x32_bf16 v[88:91], a[224:227], a[92:95], v[88:91]
    ds_read_b64_tr_b16 a[234:235], v26 offset:9224
    v_mfma_f32_16x16x32_bf16 v[88:91], a[220:223], a[88:91], v[88:91]
    ds_read_b64_tr_b16 a[236:237], v26 offset:16392
    v_mfma_f32_16x16x32_bf16 v[88:91], a[216:219], a[84:87], v[88:91]
    ds_read_b64_tr_b16 a[238:239], v26 offset:17416
    v_mfma_f32_16x16x32_bf16 v[88:91], a[212:215], a[80:83], v[88:91]
    v_mfma_f32_16x16x32_bf16 v[104:107], a[212:215], a[96:99], v[104:107]
    ds_read_b64_tr_b16 a[240:241], v26 offset:24584
    v_mfma_f32_16x16x32_bf16 v[104:107], a[216:219], a[100:103], v[104:107]
    ds_read_b64_tr_b16 a[242:243], v26 offset:25608
    v_mfma_f32_16x16x32_bf16 v[104:107], a[220:223], a[104:107], v[104:107]
    v_mfma_f32_16x16x32_bf16 v[104:107], a[224:227], a[108:111], v[104:107]
    v_mfma_f32_16x16x32_bf16 v[120:123], a[224:227], a[124:127], v[120:123]
    v_mfma_f32_16x16x32_bf16 v[120:123], a[220:223], a[120:123], v[120:123]
    v_mfma_f32_16x16x32_bf16 v[120:123], a[216:219], a[116:119], v[120:123]
    v_mfma_f32_16x16x32_bf16 v[120:123], a[212:215], a[112:115], v[120:123]
    s_waitcnt lgkmcnt(0)
    v_mfma_f32_16x16x32_bf16 a[136:139], a[228:231], a[64:67], a[136:139]
    ds_read_b64_tr_b16 a[212:213], v27 offset:0
    v_mfma_f32_16x16x32_bf16 a[136:139], a[232:235], a[68:71], a[136:139]
    ds_read_b64_tr_b16 a[214:215], v27 offset:1024
    v_mfma_f32_16x16x32_bf16 a[136:139], a[236:239], a[72:75], a[136:139]
    ds_read_b64_tr_b16 a[216:217], v27 offset:8192
    v_mfma_f32_16x16x32_bf16 a[136:139], a[240:243], a[76:79], a[136:139]
    v_mfma_f32_16x16x32_bf16 a[152:155], a[240:243], a[92:95], a[152:155]
    ds_read_b64_tr_b16 a[218:219], v27 offset:9216
    v_mfma_f32_16x16x32_bf16 a[152:155], a[236:239], a[88:91], a[152:155]
    ds_read_b64_tr_b16 a[220:221], v27 offset:16384
    v_mfma_f32_16x16x32_bf16 a[152:155], a[232:235], a[84:87], a[152:155]
    s_xor_b32 m0, s100, 4096
    ds_read_b64_tr_b16 a[222:223], v27 offset:17408
    v_mfma_f32_16x16x32_bf16 a[152:155], a[228:231], a[80:83], a[152:155]
    s_xor_b32 s65, s101, 17152
    v_mfma_f32_16x16x32_bf16 a[168:171], a[228:231], a[96:99], a[168:171]
    ds_read_b64_tr_b16 a[224:225], v27 offset:24576
    v_mfma_f32_16x16x32_bf16 a[168:171], a[232:235], a[100:103], a[168:171]
    ds_read_b64_tr_b16 a[226:227], v27 offset:25600
    v_mfma_f32_16x16x32_bf16 a[168:171], a[236:239], a[104:107], a[168:171]
    buffer_load_dwordx4 v44, s[4:7], s65 offen offset:0 lds
    v_mfma_f32_16x16x32_bf16 a[168:171], a[240:243], a[108:111], a[168:171]
    v_mfma_f32_16x16x32_bf16 a[184:187], a[240:243], a[124:127], a[184:187]
    buffer_load_dwordx4 v45, s[4:7], s65 offen offset:1024 lds
    v_mfma_f32_16x16x32_bf16 a[184:187], a[236:239], a[120:123], a[184:187]
    v_mfma_f32_16x16x32_bf16 a[184:187], a[232:235], a[116:119], a[184:187]
    v_mfma_f32_16x16x32_bf16 a[184:187], a[228:231], a[112:115], a[184:187]
    s_waitcnt lgkmcnt(0)
    buffer_load_dwordx4 v46, s[4:7], s65 offen offset:2048 lds
    v_mfma_f32_16x16x32_bf16 v[76:79], a[212:215], a[64:67], v[76:79]
    ds_read_b64_tr_b16 a[228:229], v27 offset:8
    v_mfma_f32_16x16x32_bf16 v[76:79], a[216:219], a[68:71], v[76:79]
    ds_read_b64_tr_b16 a[230:231], v27 offset:1032
    v_mfma_f32_16x16x32_bf16 v[76:79], a[220:223], a[72:75], v[76:79]
    ds_read_b64_tr_b16 a[232:233], v27 offset:8200
    v_mfma_f32_16x16x32_bf16 v[76:79], a[224:227], a[76:79], v[76:79]
    v_mfma_f32_16x16x32_bf16 v[92:95], a[224:227], a[92:95], v[92:95]
    ds_read_b64_tr_b16 a[234:235], v27 offset:9224
    v_mfma_f32_16x16x32_bf16 v[92:95], a[220:223], a[88:91], v[92:95]
    ds_read_b64_tr_b16 a[236:237], v27 offset:16392
    v_mfma_f32_16x16x32_bf16 v[92:95], a[216:219], a[84:87], v[92:95]
    ds_read_b64_tr_b16 a[238:239], v27 offset:17416
    v_mfma_f32_16x16x32_bf16 v[92:95], a[212:215], a[80:83], v[92:95]
    buffer_load_dwordx4 v47, s[4:7], s65 offen offset:3072 lds
    v_mfma_f32_16x16x32_bf16 v[108:111], a[212:215], a[96:99], v[108:111]
    s_xor_b32 m0, s100, 8192
    ds_read_b64_tr_b16 a[240:241], v27 offset:24584
    v_mfma_f32_16x16x32_bf16 v[108:111], a[216:219], a[100:103], v[108:111]
    s_xor_b32 s65, s101, 33536
    ds_read_b64_tr_b16 a[242:243], v27 offset:25608
    v_mfma_f32_16x16x32_bf16 v[108:111], a[220:223], a[104:107], v[108:111]
    buffer_load_dwordx4 v44, s[4:7], s65 offen offset:0 lds
    v_mfma_f32_16x16x32_bf16 v[108:111], a[224:227], a[108:111], v[108:111]
    v_mfma_f32_16x16x32_bf16 v[124:127], a[224:227], a[124:127], v[124:127]
    v_mfma_f32_16x16x32_bf16 v[124:127], a[220:223], a[120:123], v[124:127]
    buffer_load_dwordx4 v45, s[4:7], s65 offen offset:1024 lds
    v_mfma_f32_16x16x32_bf16 v[124:127], a[216:219], a[116:119], v[124:127]
    v_mfma_f32_16x16x32_bf16 v[124:127], a[212:215], a[112:115], v[124:127]
    s_waitcnt lgkmcnt(0)
    v_mfma_f32_16x16x32_bf16 a[140:143], a[228:231], a[64:67], a[140:143]
    s_waitcnt vmcnt(15)
    v_add_u32 v28, 4294934528, v28
    v_add_u32 v29, 4294934528, v29
    v_mfma_f32_16x16x32_bf16 a[140:143], a[232:235], a[68:71], a[140:143]
    s_barrier
    v_add_u32 v30, 4294934528, v30
    v_add_u32 v31, 4294934528, v31
    v_mfma_f32_16x16x32_bf16 a[140:143], a[236:239], a[72:75], a[140:143]
    ds_read_b64_tr_b16 a[212:213], v28 offset:0
    buffer_load_dwordx4 v46, s[4:7], s65 offen offset:2048 lds
    v_mfma_f32_16x16x32_bf16 a[140:143], a[240:243], a[76:79], a[140:143]
    ds_read_b64_tr_b16 a[214:215], v28 offset:512
    v_mfma_f32_16x16x32_bf16 a[156:159], a[240:243], a[92:95], a[156:159]
    ds_read_b64_tr_b16 a[216:217], v28 offset:4096
    v_mfma_f32_16x16x32_bf16 a[156:159], a[236:239], a[88:91], a[156:159]
    ds_read_b64_tr_b16 a[218:219], v28 offset:4608
    v_mfma_f32_16x16x32_bf16 a[156:159], a[232:235], a[84:87], a[156:159]
    ds_read_b64_tr_b16 a[220:221], v28 offset:8192
    buffer_load_dwordx4 v47, s[4:7], s65 offen offset:3072 lds
    v_mfma_f32_16x16x32_bf16 a[156:159], a[228:231], a[80:83], a[156:159]
    s_xor_b32 m0, s100, 12288
    ds_read_b64_tr_b16 a[222:223], v28 offset:8704
    v_mfma_f32_16x16x32_bf16 a[172:175], a[228:231], a[96:99], a[172:175]
    s_xor_b32 s65, s101, 49920
    ds_read_b64_tr_b16 a[224:225], v28 offset:12288
    v_mfma_f32_16x16x32_bf16 a[172:175], a[232:235], a[100:103], a[172:175]
    ds_read_b64_tr_b16 a[226:227], v28 offset:12800
    v_mfma_f32_16x16x32_bf16 a[172:175], a[236:239], a[104:107], a[172:175]
    buffer_load_dwordx4 v44, s[4:7], s65 offen offset:0 lds
    v_mfma_f32_16x16x32_bf16 a[172:175], a[240:243], a[108:111], a[172:175]
    v_mfma_f32_16x16x32_bf16 a[188:191], a[240:243], a[124:127], a[188:191]
    v_mfma_f32_16x16x32_bf16 a[188:191], a[236:239], a[120:123], a[188:191]
    v_mfma_f32_16x16x32_bf16 a[188:191], a[232:235], a[116:119], a[188:191]
    v_mfma_f32_16x16x32_bf16 a[188:191], a[228:231], a[112:115], a[188:191]
    s_waitcnt lgkmcnt(0)
    buffer_load_dwordx4 v45, s[4:7], s65 offen offset:1024 lds
    v_mfma_f32_16x16x32_bf16 v[128:131], a[212:215], a[0:3], v[128:131]
    ds_read_b64_tr_b16 a[228:229], v28 offset:16384
    v_mfma_f32_16x16x32_bf16 v[128:131], a[216:219], a[4:7], v[128:131]
    ds_read_b64_tr_b16 a[230:231], v28 offset:16896
    v_mfma_f32_16x16x32_bf16 v[128:131], a[220:223], a[8:11], v[128:131]
    ds_read_b64_tr_b16 a[232:233], v28 offset:20480
    v_mfma_f32_16x16x32_bf16 v[128:131], a[224:227], a[12:15], v[128:131]
    buffer_load_dwordx4 v46, s[4:7], s65 offen offset:2048 lds
    v_mfma_f32_16x16x32_bf16 v[132:135], a[224:227], a[28:31], v[132:135]
    ds_read_b64_tr_b16 a[234:235], v28 offset:20992
    v_mfma_f32_16x16x32_bf16 v[132:135], a[220:223], a[24:27], v[132:135]
    ds_read_b64_tr_b16 a[236:237], v28 offset:24576
    v_mfma_f32_16x16x32_bf16 v[132:135], a[216:219], a[20:23], v[132:135]
    ds_read_b64_tr_b16 a[238:239], v28 offset:25088
    v_mfma_f32_16x16x32_bf16 v[132:135], a[212:215], a[16:19], v[132:135]
    buffer_load_dwordx4 v47, s[4:7], s65 offen offset:3072 lds
    v_mfma_f32_16x16x32_bf16 v[136:139], a[212:215], a[32:35], v[136:139]
    ds_read_b64_tr_b16 a[240:241], v28 offset:28672
    v_mfma_f32_16x16x32_bf16 v[136:139], a[216:219], a[36:39], v[136:139]
    s_add_u32 m0, s60, 98304
    ds_read_b64_tr_b16 a[242:243], v28 offset:29184
    v_mfma_f32_16x16x32_bf16 v[136:139], a[220:223], a[40:43], v[136:139]
    s_add_u32 s65, s68, 1376256
    v_mfma_f32_16x16x32_bf16 v[136:139], a[224:227], a[44:47], v[136:139]
    v_mfma_f32_16x16x32_bf16 v[140:143], a[224:227], a[60:63], v[140:143]
    buffer_load_dwordx4 v36, s[12:15], s65 offen offset:0 lds
    v_mfma_f32_16x16x32_bf16 v[140:143], a[220:223], a[56:59], v[140:143]
    v_mfma_f32_16x16x32_bf16 v[140:143], a[216:219], a[52:55], v[140:143]
    v_mfma_f32_16x16x32_bf16 v[140:143], a[212:215], a[48:51], v[140:143]
    buffer_load_dwordx4 v37, s[12:15], s65 offen offset:1024 lds
    v_smfmac_f32_16x16x64_bf16 a[192:195], a[208:211], a[212:219], v20
    v_smfmac_f32_16x16x64_bf16 a[192:195], a[208:211], a[220:227], v20
    s_waitcnt lgkmcnt(0)
    v_mfma_f32_16x16x32_bf16 v[192:195], a[228:231], a[0:3], v[192:195]
    ds_read_b64_tr_b16 a[212:213], v29 offset:0
    v_mfma_f32_16x16x32_bf16 v[192:195], a[232:235], a[4:7], v[192:195]
    ds_read_b64_tr_b16 a[214:215], v29 offset:512
    v_mfma_f32_16x16x32_bf16 v[192:195], a[236:239], a[8:11], v[192:195]
    ds_read_b64_tr_b16 a[216:217], v29 offset:4096
    v_mfma_f32_16x16x32_bf16 v[192:195], a[240:243], a[12:15], v[192:195]
    buffer_load_dwordx4 v38, s[12:15], s65 offen offset:2048 lds
    v_mfma_f32_16x16x32_bf16 v[196:199], a[240:243], a[28:31], v[196:199]
    ds_read_b64_tr_b16 a[218:219], v29 offset:4608
    v_mfma_f32_16x16x32_bf16 v[196:199], a[236:239], a[24:27], v[196:199]
    ds_read_b64_tr_b16 a[220:221], v29 offset:8192
    v_mfma_f32_16x16x32_bf16 v[196:199], a[232:235], a[20:23], v[196:199]
    ds_read_b64_tr_b16 a[222:223], v29 offset:8704
    v_mfma_f32_16x16x32_bf16 v[196:199], a[228:231], a[16:19], v[196:199]
    buffer_load_dwordx4 v39, s[12:15], s65 offen offset:3072 lds
    v_mfma_f32_16x16x32_bf16 v[200:203], a[228:231], a[32:35], v[200:203]
    s_add_u32 m0, s60, 114688
    ds_read_b64_tr_b16 a[224:225], v29 offset:12288
    v_mfma_f32_16x16x32_bf16 v[200:203], a[232:235], a[36:39], v[200:203]
    s_add_u32 s65, s68, 1376256
    ds_read_b64_tr_b16 a[226:227], v29 offset:12800
    v_mfma_f32_16x16x32_bf16 v[200:203], a[236:239], a[40:43], v[200:203]
    v_mfma_f32_16x16x32_bf16 v[200:203], a[240:243], a[44:47], v[200:203]
    buffer_load_dwordx4 v36, s[16:19], s65 offen offset:0 lds
    v_mfma_f32_16x16x32_bf16 v[204:207], a[240:243], a[60:63], v[204:207]
    v_mfma_f32_16x16x32_bf16 v[204:207], a[236:239], a[56:59], v[204:207]
    v_mfma_f32_16x16x32_bf16 v[204:207], a[232:235], a[52:55], v[204:207]
    v_mfma_f32_16x16x32_bf16 v[204:207], a[228:231], a[48:51], v[204:207]
    buffer_load_dwordx4 v37, s[16:19], s65 offen offset:1024 lds
    v_smfmac_f32_16x16x64_bf16 a[196:199], a[208:211], a[228:235], v20
    v_smfmac_f32_16x16x64_bf16 a[196:199], a[208:211], a[236:243], v20
    s_waitcnt lgkmcnt(0)
    v_mfma_f32_16x16x32_bf16 v[144:147], a[212:215], a[0:3], v[144:147]
    ds_read_b64_tr_b16 a[228:229], v29 offset:16384
    v_mfma_f32_16x16x32_bf16 v[144:147], a[216:219], a[4:7], v[144:147]
    ds_read_b64_tr_b16 a[230:231], v29 offset:16896
    v_mfma_f32_16x16x32_bf16 v[144:147], a[220:223], a[8:11], v[144:147]
    ds_read_b64_tr_b16 a[232:233], v29 offset:20480
    v_mfma_f32_16x16x32_bf16 v[144:147], a[224:227], a[12:15], v[144:147]
    buffer_load_dwordx4 v38, s[16:19], s65 offen offset:2048 lds
    v_mfma_f32_16x16x32_bf16 v[148:151], a[224:227], a[28:31], v[148:151]
    ds_read_b64_tr_b16 a[234:235], v29 offset:20992
    v_mfma_f32_16x16x32_bf16 v[148:151], a[220:223], a[24:27], v[148:151]
    ds_read_b64_tr_b16 a[236:237], v29 offset:24576
    v_mfma_f32_16x16x32_bf16 v[148:151], a[216:219], a[20:23], v[148:151]
    ds_read_b64_tr_b16 a[238:239], v29 offset:25088
    v_mfma_f32_16x16x32_bf16 v[148:151], a[212:215], a[16:19], v[148:151]
    buffer_load_dwordx4 v39, s[16:19], s65 offen offset:3072 lds
    v_mfma_f32_16x16x32_bf16 v[152:155], a[212:215], a[32:35], v[152:155]
    ds_read_b64_tr_b16 a[240:241], v29 offset:28672
    v_mfma_f32_16x16x32_bf16 v[152:155], a[216:219], a[36:39], v[152:155]
    ds_read_b64_tr_b16 a[242:243], v29 offset:29184
    v_mfma_f32_16x16x32_bf16 v[152:155], a[220:223], a[40:43], v[152:155]
    v_mfma_f32_16x16x32_bf16 v[152:155], a[224:227], a[44:47], v[152:155]
    v_mfma_f32_16x16x32_bf16 v[156:159], a[224:227], a[60:63], v[156:159]
    v_mfma_f32_16x16x32_bf16 v[156:159], a[220:223], a[56:59], v[156:159]
    v_mfma_f32_16x16x32_bf16 v[156:159], a[216:219], a[52:55], v[156:159]
    v_mfma_f32_16x16x32_bf16 v[156:159], a[212:215], a[48:51], v[156:159]
    s_waitcnt lgkmcnt(0)
    v_mfma_f32_16x16x32_bf16 v[208:211], a[228:231], a[0:3], v[208:211]
    ds_read_b64_tr_b16 a[212:213], v30 offset:0
    v_mfma_f32_16x16x32_bf16 v[208:211], a[232:235], a[4:7], v[208:211]
    ds_read_b64_tr_b16 a[214:215], v30 offset:512
    v_mfma_f32_16x16x32_bf16 v[208:211], a[236:239], a[8:11], v[208:211]
    ds_read_b64_tr_b16 a[216:217], v30 offset:4096
    v_mfma_f32_16x16x32_bf16 v[208:211], a[240:243], a[12:15], v[208:211]
    v_mfma_f32_16x16x32_bf16 v[212:215], a[240:243], a[28:31], v[212:215]
    ds_read_b64_tr_b16 a[218:219], v30 offset:4608
    v_mfma_f32_16x16x32_bf16 v[212:215], a[236:239], a[24:27], v[212:215]
    ds_read_b64_tr_b16 a[220:221], v30 offset:8192
    v_mfma_f32_16x16x32_bf16 v[212:215], a[232:235], a[20:23], v[212:215]
    ds_read_b64_tr_b16 a[222:223], v30 offset:8704
    v_mfma_f32_16x16x32_bf16 v[212:215], a[228:231], a[16:19], v[212:215]
    v_mfma_f32_16x16x32_bf16 v[216:219], a[228:231], a[32:35], v[216:219]
    ds_read_b64_tr_b16 a[224:225], v30 offset:12288
    v_mfma_f32_16x16x32_bf16 v[216:219], a[232:235], a[36:39], v[216:219]
    ds_read_b64_tr_b16 a[226:227], v30 offset:12800
    v_mfma_f32_16x16x32_bf16 v[216:219], a[236:239], a[40:43], v[216:219]
    v_mfma_f32_16x16x32_bf16 v[216:219], a[240:243], a[44:47], v[216:219]
    v_mfma_f32_16x16x32_bf16 v[220:223], a[240:243], a[60:63], v[220:223]
    s_add_u32 m0, s59, 131072
    v_mfma_f32_16x16x32_bf16 v[220:223], a[236:239], a[56:59], v[220:223]
    s_add_u32 s65, s67, 2097152
    v_mfma_f32_16x16x32_bf16 v[220:223], a[232:235], a[52:55], v[220:223]
    buffer_load_dwordx4 v32, s[8:11], s65 offen offset:0 lds
    v_mfma_f32_16x16x32_bf16 v[220:223], a[228:231], a[48:51], v[220:223]
    s_waitcnt lgkmcnt(0)
    v_mfma_f32_16x16x32_bf16 v[160:163], a[212:215], a[0:3], v[160:163]
    ds_read_b64_tr_b16 a[228:229], v30 offset:16384
    v_mfma_f32_16x16x32_bf16 v[160:163], a[216:219], a[4:7], v[160:163]
    ds_read_b64_tr_b16 a[230:231], v30 offset:16896
    v_mfma_f32_16x16x32_bf16 v[160:163], a[220:223], a[8:11], v[160:163]
    ds_read_b64_tr_b16 a[232:233], v30 offset:20480
    v_mfma_f32_16x16x32_bf16 v[160:163], a[224:227], a[12:15], v[160:163]
    buffer_load_dwordx4 v33, s[8:11], s65 offen offset:1024 lds
    v_mfma_f32_16x16x32_bf16 v[164:167], a[224:227], a[28:31], v[164:167]
    ds_read_b64_tr_b16 a[234:235], v30 offset:20992
    v_mfma_f32_16x16x32_bf16 v[164:167], a[220:223], a[24:27], v[164:167]
    ds_read_b64_tr_b16 a[236:237], v30 offset:24576
    v_mfma_f32_16x16x32_bf16 v[164:167], a[216:219], a[20:23], v[164:167]
    ds_read_b64_tr_b16 a[238:239], v30 offset:25088
    v_mfma_f32_16x16x32_bf16 v[164:167], a[212:215], a[16:19], v[164:167]
    buffer_load_dwordx4 v34, s[8:11], s65 offen offset:2048 lds
    v_mfma_f32_16x16x32_bf16 v[168:171], a[212:215], a[32:35], v[168:171]
    ds_read_b64_tr_b16 a[240:241], v30 offset:28672
    v_mfma_f32_16x16x32_bf16 v[168:171], a[216:219], a[36:39], v[168:171]
    ds_read_b64_tr_b16 a[242:243], v30 offset:29184
    v_mfma_f32_16x16x32_bf16 v[168:171], a[220:223], a[40:43], v[168:171]
    buffer_load_dwordx4 v35, s[8:11], s65 offen offset:3072 lds
    v_mfma_f32_16x16x32_bf16 v[168:171], a[224:227], a[44:47], v[168:171]
    s_waitcnt vmcnt(12)
    ds_read_b128 a[64:67], v40 offset:0
    ds_read_b128 a[68:71], v41 offset:0
    v_mfma_f32_16x16x32_bf16 v[172:175], a[224:227], a[60:63], v[172:175]
    s_add_u32 m0, s59, 135168
    ds_read_b128 a[72:75], v42 offset:0
    ds_read_b128 a[76:79], v43 offset:0
    v_mfma_f32_16x16x32_bf16 v[172:175], a[220:223], a[56:59], v[172:175]
    s_add_u32 s65, s67, 2228224
    ds_read_b128 a[80:83], v40 offset:4096
    ds_read_b128 a[84:87], v41 offset:4096
    v_mfma_f32_16x16x32_bf16 v[172:175], a[216:219], a[52:55], v[172:175]
    ds_read_b128 a[88:91], v42 offset:4096
    ds_read_b128 a[92:95], v43 offset:4096
    v_mfma_f32_16x16x32_bf16 v[172:175], a[212:215], a[48:51], v[172:175]
    s_waitcnt lgkmcnt(8)
    buffer_load_dwordx4 v32, s[8:11], s65 offen offset:0 lds
    v_mfma_f32_16x16x32_bf16 v[224:227], a[228:231], a[0:3], v[224:227]
    ds_read_b64_tr_b16 a[212:213], v31 offset:0
    v_mfma_f32_16x16x32_bf16 v[224:227], a[232:235], a[4:7], v[224:227]
    ds_read_b64_tr_b16 a[214:215], v31 offset:512
    v_mfma_f32_16x16x32_bf16 v[224:227], a[236:239], a[8:11], v[224:227]
    ds_read_b64_tr_b16 a[216:217], v31 offset:4096
    v_mfma_f32_16x16x32_bf16 v[224:227], a[240:243], a[12:15], v[224:227]
    buffer_load_dwordx4 v33, s[8:11], s65 offen offset:1024 lds
    v_mfma_f32_16x16x32_bf16 v[228:231], a[240:243], a[28:31], v[228:231]
    ds_read_b64_tr_b16 a[218:219], v31 offset:4608
    v_mfma_f32_16x16x32_bf16 v[228:231], a[236:239], a[24:27], v[228:231]
    ds_read_b64_tr_b16 a[220:221], v31 offset:8192
    v_mfma_f32_16x16x32_bf16 v[228:231], a[232:235], a[20:23], v[228:231]
    ds_read_b64_tr_b16 a[222:223], v31 offset:8704
    v_mfma_f32_16x16x32_bf16 v[228:231], a[228:231], a[16:19], v[228:231]
    buffer_load_dwordx4 v34, s[8:11], s65 offen offset:2048 lds
    v_mfma_f32_16x16x32_bf16 v[232:235], a[228:231], a[32:35], v[232:235]
    ds_read_b64_tr_b16 a[224:225], v31 offset:12288
    v_mfma_f32_16x16x32_bf16 v[232:235], a[232:235], a[36:39], v[232:235]
    ds_read_b64_tr_b16 a[226:227], v31 offset:12800
    v_mfma_f32_16x16x32_bf16 v[232:235], a[236:239], a[40:43], v[232:235]
    ds_read_b128 a[96:99], v40 offset:8192
    v_mfma_f32_16x16x32_bf16 v[232:235], a[240:243], a[44:47], v[232:235]
    ds_read_b128 a[100:103], v41 offset:8192
    v_mfma_f32_16x16x32_bf16 v[236:239], a[240:243], a[60:63], v[236:239]
    buffer_load_dwordx4 v35, s[8:11], s65 offen offset:3072 lds
    v_mfma_f32_16x16x32_bf16 v[236:239], a[236:239], a[56:59], v[236:239]
    ds_read_b128 a[104:107], v42 offset:8192
    v_mfma_f32_16x16x32_bf16 v[236:239], a[232:235], a[52:55], v[236:239]
    ds_read_b128 a[108:111], v43 offset:8192
    v_mfma_f32_16x16x32_bf16 v[236:239], a[228:231], a[48:51], v[236:239]
    s_waitcnt lgkmcnt(4)
    ds_read_b128 a[112:115], v40 offset:12288
    v_mfma_f32_16x16x32_bf16 v[176:179], a[212:215], a[0:3], v[176:179]
    ds_read_b64_tr_b16 a[228:229], v31 offset:16384
    v_mfma_f32_16x16x32_bf16 v[176:179], a[216:219], a[4:7], v[176:179]
    ds_read_b64_tr_b16 a[230:231], v31 offset:16896
    v_mfma_f32_16x16x32_bf16 v[176:179], a[220:223], a[8:11], v[176:179]
    ds_read_b64_tr_b16 a[232:233], v31 offset:20480
    v_mfma_f32_16x16x32_bf16 v[176:179], a[224:227], a[12:15], v[176:179]
    ds_read_b128 a[116:119], v41 offset:12288
    v_mfma_f32_16x16x32_bf16 v[180:183], a[224:227], a[28:31], v[180:183]
    ds_read_b64_tr_b16 a[234:235], v31 offset:20992
    v_mfma_f32_16x16x32_bf16 v[180:183], a[220:223], a[24:27], v[180:183]
    ds_read_b64_tr_b16 a[236:237], v31 offset:24576
    v_mfma_f32_16x16x32_bf16 v[180:183], a[216:219], a[20:23], v[180:183]
    ds_read_b64_tr_b16 a[238:239], v31 offset:25088
    v_mfma_f32_16x16x32_bf16 v[180:183], a[212:215], a[16:19], v[180:183]
    ds_read_b128 a[120:123], v42 offset:12288
    v_mfma_f32_16x16x32_bf16 v[184:187], a[212:215], a[32:35], v[184:187]
    ds_read_b64_tr_b16 a[240:241], v31 offset:28672
    v_mfma_f32_16x16x32_bf16 v[184:187], a[216:219], a[36:39], v[184:187]
    ds_read_b64_tr_b16 a[242:243], v31 offset:29184
    v_mfma_f32_16x16x32_bf16 v[184:187], a[220:223], a[40:43], v[184:187]
    ds_read_b128 a[124:127], v43 offset:12288
    v_mfma_f32_16x16x32_bf16 v[184:187], a[224:227], a[44:47], v[184:187]
    v_mfma_f32_16x16x32_bf16 v[188:191], a[224:227], a[60:63], v[188:191]
    v_mfma_f32_16x16x32_bf16 v[188:191], a[220:223], a[56:59], v[188:191]
    v_mfma_f32_16x16x32_bf16 v[188:191], a[216:219], a[52:55], v[188:191]
    v_mfma_f32_16x16x32_bf16 v[188:191], a[212:215], a[48:51], v[188:191]
    s_waitcnt lgkmcnt(1)
    v_mfma_f32_16x16x32_bf16 v[240:243], a[228:231], a[0:3], v[240:243]
    s_waitcnt vmcnt(8) lgkmcnt(0)
    v_mfma_f32_16x16x32_bf16 v[240:243], a[232:235], a[4:7], v[240:243]
    s_barrier
    v_mfma_f32_16x16x32_bf16 v[240:243], a[236:239], a[8:11], v[240:243]
    ds_read_b64_tr_b16 a[212:213], v28 offset:32768
    buffer_load_dword v50, v51, s[40:43], 0 offen sc1
    v_mfma_f32_16x16x32_bf16 v[240:243], a[240:243], a[12:15], v[240:243]
    ds_read_b64_tr_b16 a[214:215], v28 offset:33280
    v_mfma_f32_16x16x32_bf16 v[244:247], a[240:243], a[28:31], v[244:247]
    ds_read_b64_tr_b16 a[216:217], v28 offset:36864
    v_mfma_f32_16x16x32_bf16 v[244:247], a[236:239], a[24:27], v[244:247]
    ds_read_b64_tr_b16 a[218:219], v28 offset:37376
    v_mfma_f32_16x16x32_bf16 v[244:247], a[232:235], a[20:23], v[244:247]
    ds_read_b64_tr_b16 a[220:221], v28 offset:40960
    v_mfma_f32_16x16x32_bf16 v[244:247], a[228:231], a[16:19], v[244:247]
    ds_read_b64_tr_b16 a[222:223], v28 offset:41472
    v_mfma_f32_16x16x32_bf16 v[248:251], a[228:231], a[32:35], v[248:251]
    ds_read_b64_tr_b16 a[224:225], v28 offset:45056
    v_mfma_f32_16x16x32_bf16 v[248:251], a[232:235], a[36:39], v[248:251]
    ds_read_b64_tr_b16 a[226:227], v28 offset:45568
    v_mfma_f32_16x16x32_bf16 v[248:251], a[236:239], a[40:43], v[248:251]
    v_mfma_f32_16x16x32_bf16 v[248:251], a[240:243], a[44:47], v[248:251]
    v_mfma_f32_16x16x32_bf16 v[252:255], a[240:243], a[60:63], v[252:255]
    v_mfma_f32_16x16x32_bf16 v[252:255], a[236:239], a[56:59], v[252:255]
    v_mfma_f32_16x16x32_bf16 v[252:255], a[232:235], a[52:55], v[252:255]
    v_mfma_f32_16x16x32_bf16 v[252:255], a[228:231], a[48:51], v[252:255]
    s_waitcnt lgkmcnt(0)
    v_mfma_f32_16x16x32_bf16 v[128:131], a[212:215], a[64:67], v[128:131]
    ds_read_b64_tr_b16 a[228:229], v28 offset:49152
    v_mfma_f32_16x16x32_bf16 v[128:131], a[216:219], a[68:71], v[128:131]
    s_add_u32 m0, s59, 65536
    ds_read_b64_tr_b16 a[230:231], v28 offset:49664
    v_mfma_f32_16x16x32_bf16 v[128:131], a[220:223], a[72:75], v[128:131]
    s_add_u32 s65, s67, 3145728
    ds_read_b64_tr_b16 a[232:233], v28 offset:53248
    v_mfma_f32_16x16x32_bf16 v[128:131], a[224:227], a[76:79], v[128:131]
    buffer_load_dwordx4 v32, s[8:11], s65 offen offset:0 lds
    v_mfma_f32_16x16x32_bf16 v[132:135], a[224:227], a[92:95], v[132:135]
    ds_read_b64_tr_b16 a[234:235], v28 offset:53760
    v_mfma_f32_16x16x32_bf16 v[132:135], a[220:223], a[88:91], v[132:135]
    ds_read_b64_tr_b16 a[236:237], v28 offset:57344
    v_mfma_f32_16x16x32_bf16 v[132:135], a[216:219], a[84:87], v[132:135]
    ds_read_b64_tr_b16 a[238:239], v28 offset:57856
    v_mfma_f32_16x16x32_bf16 v[132:135], a[212:215], a[80:83], v[132:135]
    buffer_load_dwordx4 v33, s[8:11], s65 offen offset:1024 lds
    v_mfma_f32_16x16x32_bf16 v[136:139], a[212:215], a[96:99], v[136:139]
    ds_read_b64_tr_b16 a[240:241], v28 offset:61440
    v_mfma_f32_16x16x32_bf16 v[136:139], a[216:219], a[100:103], v[136:139]
    ds_read_b64_tr_b16 a[242:243], v28 offset:61952
    v_mfma_f32_16x16x32_bf16 v[136:139], a[220:223], a[104:107], v[136:139]
    v_mfma_f32_16x16x32_bf16 v[136:139], a[224:227], a[108:111], v[136:139]
    v_mfma_f32_16x16x32_bf16 v[140:143], a[224:227], a[124:127], v[140:143]
    v_mfma_f32_16x16x32_bf16 v[140:143], a[220:223], a[120:123], v[140:143]
    buffer_load_dwordx4 v34, s[8:11], s65 offen offset:2048 lds
    v_mfma_f32_16x16x32_bf16 v[140:143], a[216:219], a[116:119], v[140:143]
    v_mfma_f32_16x16x32_bf16 v[140:143], a[212:215], a[112:115], v[140:143]
    v_smfmac_f32_16x16x64_bf16 a[192:195], a[208:211], a[212:219], v20
    v_smfmac_f32_16x16x64_bf16 a[192:195], a[208:211], a[220:227], v20
    s_waitcnt lgkmcnt(0)
    v_mfma_f32_16x16x32_bf16 v[192:195], a[228:231], a[64:67], v[192:195]
    ds_read_b64_tr_b16 a[212:213], v29 offset:32768
    buffer_load_dwordx4 v35, s[8:11], s65 offen offset:3072 lds
    v_mfma_f32_16x16x32_bf16 v[192:195], a[232:235], a[68:71], v[192:195]
    ds_read_b64_tr_b16 a[214:215], v29 offset:33280
    v_mfma_f32_16x16x32_bf16 v[192:195], a[236:239], a[72:75], v[192:195]
    s_add_u32 m0, s59, 69632
    ds_read_b64_tr_b16 a[216:217], v29 offset:36864
    v_mfma_f32_16x16x32_bf16 v[192:195], a[240:243], a[76:79], v[192:195]
    s_add_u32 s65, s67, 3276800
    v_mfma_f32_16x16x32_bf16 v[196:199], a[240:243], a[92:95], v[196:199]
    ds_read_b64_tr_b16 a[218:219], v29 offset:37376
    v_mfma_f32_16x16x32_bf16 v[196:199], a[236:239], a[88:91], v[196:199]
    ds_read_b64_tr_b16 a[220:221], v29 offset:40960
    v_mfma_f32_16x16x32_bf16 v[196:199], a[232:235], a[84:87], v[196:199]
    ds_read_b64_tr_b16 a[222:223], v29 offset:41472
    v_mfma_f32_16x16x32_bf16 v[196:199], a[228:231], a[80:83], v[196:199]
    buffer_load_dwordx4 v32, s[8:11], s65 offen offset:0 lds
    v_mfma_f32_16x16x32_bf16 v[200:203], a[228:231], a[96:99], v[200:203]
    ds_read_b64_tr_b16 a[224:225], v29 offset:45056
    v_mfma_f32_16x16x32_bf16 v[200:203], a[232:235], a[100:103], v[200:203]
    ds_read_b64_tr_b16 a[226:227], v29 offset:45568
    v_mfma_f32_16x16x32_bf16 v[200:203], a[236:239], a[104:107], v[200:203]
    buffer_load_dwordx4 v33, s[8:11], s65 offen offset:1024 lds
    v_mfma_f32_16x16x32_bf16 v[200:203], a[240:243], a[108:111], v[200:203]
    v_mfma_f32_16x16x32_bf16 v[204:207], a[240:243], a[124:127], v[204:207]
    v_mfma_f32_16x16x32_bf16 v[204:207], a[236:239], a[120:123], v[204:207]
    v_mfma_f32_16x16x32_bf16 v[204:207], a[232:235], a[116:119], v[204:207]
    v_mfma_f32_16x16x32_bf16 v[204:207], a[228:231], a[112:115], v[204:207]
    buffer_load_dwordx4 v34, s[8:11], s65 offen offset:2048 lds
    v_smfmac_f32_16x16x64_bf16 a[196:199], a[208:211], a[228:235], v20
    v_smfmac_f32_16x16x64_bf16 a[196:199], a[208:211], a[236:243], v20
    s_waitcnt lgkmcnt(0)
    v_mfma_f32_16x16x32_bf16 v[144:147], a[212:215], a[64:67], v[144:147]
    ds_read_b64_tr_b16 a[228:229], v29 offset:49152
    v_mfma_f32_16x16x32_bf16 v[144:147], a[216:219], a[68:71], v[144:147]
    ds_read_b64_tr_b16 a[230:231], v29 offset:49664
    v_mfma_f32_16x16x32_bf16 v[144:147], a[220:223], a[72:75], v[144:147]
    ds_read_b64_tr_b16 a[232:233], v29 offset:53248
    v_mfma_f32_16x16x32_bf16 v[144:147], a[224:227], a[76:79], v[144:147]
    buffer_load_dwordx4 v35, s[8:11], s65 offen offset:3072 lds
    v_mfma_f32_16x16x32_bf16 v[148:151], a[224:227], a[92:95], v[148:151]
    ds_read_b64_tr_b16 a[234:235], v29 offset:53760
    v_mfma_f32_16x16x32_bf16 v[148:151], a[220:223], a[88:91], v[148:151]
    ds_read_b64_tr_b16 a[236:237], v29 offset:57344
    v_mfma_f32_16x16x32_bf16 v[148:151], a[216:219], a[84:87], v[148:151]
    ds_read_b64_tr_b16 a[238:239], v29 offset:57856
    v_mfma_f32_16x16x32_bf16 v[148:151], a[212:215], a[80:83], v[148:151]
    s_waitcnt vmcnt(8)
    v_cmp_gt_u32 vcc, 32, v50
    s_nop 0
    s_cmp_eq_u64 vcc, 0
    s_cbranch_scc0 L_spin_stF
L_back_stF:
    v_mfma_f32_16x16x32_bf16 v[152:155], a[212:215], a[96:99], v[152:155]
    ds_read_b64_tr_b16 a[240:241], v29 offset:61440
    v_mfma_f32_16x16x32_bf16 v[152:155], a[216:219], a[100:103], v[152:155]
    ds_read_b64_tr_b16 a[242:243], v29 offset:61952
    v_mfma_f32_16x16x32_bf16 v[152:155], a[220:223], a[104:107], v[152:155]
    buffer_load_dwordx2 v[56:57], v52, s[36:39], 0 offen offset:0 sc1
    v_mfma_f32_16x16x32_bf16 v[152:155], a[224:227], a[108:111], v[152:155]
    v_mfma_f32_16x16x32_bf16 v[156:159], a[224:227], a[124:127], v[156:159]
    v_mfma_f32_16x16x32_bf16 v[156:159], a[220:223], a[120:123], v[156:159]
    buffer_load_dwordx2 v[58:59], v52, s[36:39], 0 offen offset:128 sc1
    v_mfma_f32_16x16x32_bf16 v[156:159], a[216:219], a[116:119], v[156:159]
    v_mfma_f32_16x16x32_bf16 v[156:159], a[212:215], a[112:115], v[156:159]
    s_waitcnt lgkmcnt(0)
    buffer_load_dwordx2 v[60:61], v52, s[36:39], 0 offen offset:256 sc1
    v_mfma_f32_16x16x32_bf16 v[208:211], a[228:231], a[64:67], v[208:211]
    ds_read_b64_tr_b16 a[212:213], v30 offset:32768
    v_accvgpr_read_b32 v22, a192
    v_mfma_f32_16x16x32_bf16 v[208:211], a[232:235], a[68:71], v[208:211]
    ds_read_b64_tr_b16 a[214:215], v30 offset:33280
    v_accvgpr_read_b32 v23, a193
    v_mfma_f32_16x16x32_bf16 v[208:211], a[236:239], a[72:75], v[208:211]
    ds_read_b64_tr_b16 a[216:217], v30 offset:36864
    v_add_f32 v22, v22, v23
    v_mfma_f32_16x16x32_bf16 v[208:211], a[240:243], a[76:79], v[208:211]
    buffer_load_dwordx2 v[62:63], v52, s[36:39], 0 offen offset:384 sc1
    v_mfma_f32_16x16x32_bf16 v[212:215], a[240:243], a[92:95], v[212:215]
    ds_read_b64_tr_b16 a[218:219], v30 offset:37376
    v_mfma_f32_16x16x32_bf16 v[212:215], a[236:239], a[88:91], v[212:215]
    s_add_u32 m0, s59, 0
    ds_read_b64_tr_b16 a[220:221], v30 offset:40960
    v_mfma_f32_16x16x32_bf16 v[212:215], a[232:235], a[84:87], v[212:215]
    ds_read_b64_tr_b16 a[222:223], v30 offset:41472
    v_mfma_f32_16x16x32_bf16 v[212:215], a[228:231], a[80:83], v[212:215]
    buffer_load_dwordx4 v14, s[20:23], s62 offen offset:0 lds
    v_mfma_f32_16x16x32_bf16 v[216:219], a[228:231], a[96:99], v[216:219]
    ds_read_b64_tr_b16 a[224:225], v30 offset:45056
    v_mfma_f32_16x16x32_bf16 v[216:219], a[232:235], a[100:103], v[216:219]
    ds_read_b64_tr_b16 a[226:227], v30 offset:45568
    v_mfma_f32_16x16x32_bf16 v[216:219], a[236:239], a[104:107], v[216:219]
    ds_write_b32 v21, v22 offset:0
    v_accvgpr_read_b32 v22, a196
    v_mfma_f32_16x16x32_bf16 v[216:219], a[240:243], a[108:111], v[216:219]
    v_accvgpr_read_b32 v23, a197
    v_add_f32 v22, v22, v23
    v_mfma_f32_16x16x32_bf16 v[220:223], a[240:243], a[124:127], v[220:223]
    ds_write_b32 v21, v22 offset:64
    v_mfma_f32_16x16x32_bf16 v[220:223], a[236:239], a[120:123], v[220:223]
    v_mfma_f32_16x16x32_bf16 v[220:223], a[232:235], a[116:119], v[220:223]
    v_mfma_f32_16x16x32_bf16 v[220:223], a[228:231], a[112:115], v[220:223]
    s_waitcnt lgkmcnt(2)
    buffer_load_dwordx4 v15, s[20:23], s62 offen offset:1024 lds
    v_mfma_f32_16x16x32_bf16 v[160:163], a[212:215], a[64:67], v[160:163]
    ds_read_b64_tr_b16 a[228:229], v30 offset:49152
    v_mfma_f32_16x16x32_bf16 v[160:163], a[216:219], a[68:71], v[160:163]
    ds_read_b64_tr_b16 a[230:231], v30 offset:49664
    v_mfma_f32_16x16x32_bf16 v[160:163], a[220:223], a[72:75], v[160:163]
    ds_read_b64_tr_b16 a[232:233], v30 offset:53248
    v_mfma_f32_16x16x32_bf16 v[160:163], a[224:227], a[76:79], v[160:163]
    v_mfma_f32_16x16x32_bf16 v[164:167], a[224:227], a[92:95], v[164:167]
    ds_read_b64_tr_b16 a[234:235], v30 offset:53760
    v_mfma_f32_16x16x32_bf16 v[164:167], a[220:223], a[88:91], v[164:167]
    ds_read_b64_tr_b16 a[236:237], v30 offset:57344
    v_mfma_f32_16x16x32_bf16 v[164:167], a[216:219], a[84:87], v[164:167]
    ds_read_b64_tr_b16 a[238:239], v30 offset:57856
    v_add_u32 v21, 98304, v21
    v_mfma_f32_16x16x32_bf16 v[164:167], a[212:215], a[80:83], v[164:167]
    v_mfma_f32_16x16x32_bf16 v[168:171], a[212:215], a[96:99], v[168:171]
    ds_read_b64_tr_b16 a[240:241], v30 offset:61440
    v_mfma_f32_16x16x32_bf16 v[168:171], a[216:219], a[100:103], v[168:171]
    ds_read_b64_tr_b16 a[242:243], v30 offset:61952
    v_mfma_f32_16x16x32_bf16 v[168:171], a[220:223], a[104:107], v[168:171]
    buffer_load_dwordx4 v16, s[20:23], s62 offen offset:2048 lds
    v_mfma_f32_16x16x32_bf16 v[168:171], a[224:227], a[108:111], v[168:171]
    v_mfma_f32_16x16x32_bf16 v[172:175], a[224:227], a[124:127], v[172:175]
    v_mfma_f32_16x16x32_bf16 v[172:175], a[220:223], a[120:123], v[172:175]
    v_mfma_f32_16x16x32_bf16 v[172:175], a[216:219], a[116:119], v[172:175]
    v_mfma_f32_16x16x32_bf16 v[172:175], a[212:215], a[112:115], v[172:175]
    s_waitcnt lgkmcnt(0)
    v_mfma_f32_16x16x32_bf16 v[224:227], a[228:231], a[64:67], v[224:227]
    ds_read_b64_tr_b16 a[212:213], v31 offset:32768
    v_mfma_f32_16x16x32_bf16 v[224:227], a[232:235], a[68:71], v[224:227]
    ds_read_b64_tr_b16 a[214:215], v31 offset:33280
    v_mfma_f32_16x16x32_bf16 v[224:227], a[236:239], a[72:75], v[224:227]
    ds_read_b64_tr_b16 a[216:217], v31 offset:36864
    v_mfma_f32_16x16x32_bf16 v[224:227], a[240:243], a[76:79], v[224:227]
    buffer_load_dwordx4 v17, s[20:23], s62 offen offset:3072 lds
    v_mfma_f32_16x16x32_bf16 v[228:231], a[240:243], a[92:95], v[228:231]
    s_add_u32 s62, s62, 4096
    ds_read_b64_tr_b16 a[218:219], v31 offset:37376
    v_mfma_f32_16x16x32_bf16 v[228:231], a[236:239], a[88:91], v[228:231]
    ds_read_b64_tr_b16 a[220:221], v31 offset:40960
    v_mfma_f32_16x16x32_bf16 v[228:231], a[232:235], a[84:87], v[228:231]
    ds_read_b64_tr_b16 a[222:223], v31 offset:41472
    v_mfma_f32_16x16x32_bf16 v[228:231], a[228:231], a[80:83], v[228:231]
    v_mfma_f32_16x16x32_bf16 v[232:235], a[228:231], a[96:99], v[232:235]
    ds_read_b64_tr_b16 a[224:225], v31 offset:45056
    v_mfma_f32_16x16x32_bf16 v[232:235], a[232:235], a[100:103], v[232:235]
    ds_read_b64_tr_b16 a[226:227], v31 offset:45568
    v_mfma_f32_16x16x32_bf16 v[232:235], a[236:239], a[104:107], v[232:235]
    v_mfma_f32_16x16x32_bf16 v[232:235], a[240:243], a[108:111], v[232:235]
    v_mfma_f32_16x16x32_bf16 v[236:239], a[240:243], a[124:127], v[236:239]
    s_add_u32 m0, s59, 4096
    v_mfma_f32_16x16x32_bf16 v[236:239], a[236:239], a[120:123], v[236:239]
    v_mfma_f32_16x16x32_bf16 v[236:239], a[232:235], a[116:119], v[236:239]
    buffer_load_dwordx4 v14, s[20:23], s62 offen offset:0 lds
    v_mfma_f32_16x16x32_bf16 v[236:239], a[228:231], a[112:115], v[236:239]
    s_waitcnt lgkmcnt(0)
    v_mfma_f32_16x16x32_bf16 v[176:179], a[212:215], a[64:67], v[176:179]
    ds_read_b64_tr_b16 a[228:229], v31 offset:49152
    v_mfma_f32_16x16x32_bf16 v[176:179], a[216:219], a[68:71], v[176:179]
    ds_read_b64_tr_b16 a[230:231], v31 offset:49664
    v_mfma_f32_16x16x32_bf16 v[176:179], a[220:223], a[72:75], v[176:179]
    ds_read_b64_tr_b16 a[232:233], v31 offset:53248
    v_mfma_f32_16x16x32_bf16 v[176:179], a[224:227], a[76:79], v[176:179]
    v_mfma_f32_16x16x32_bf16 v[180:183], a[224:227], a[92:95], v[180:183]
    ds_read_b64_tr_b16 a[234:235], v31 offset:53760
    v_mfma_f32_16x16x32_bf16 v[180:183], a[220:223], a[88:91], v[180:183]
    ds_read_b64_tr_b16 a[236:237], v31 offset:57344
    v_mfma_f32_16x16x32_bf16 v[180:183], a[216:219], a[84:87], v[180:183]
    s_waitcnt vmcnt(5)
    ds_read_b64_tr_b16 a[238:239], v31 offset:57856
    v_mfma_f32_16x16x32_bf16 v[180:183], a[212:215], a[80:83], v[180:183]
    buffer_load_dwordx4 v15, s[20:23], s62 offen offset:1024 lds
    v_mfma_f32_16x16x32_bf16 v[184:187], a[212:215], a[96:99], v[184:187]
    ds_read_b64_tr_b16 a[240:241], v31 offset:61440
    v_mfma_f32_16x16x32_bf16 v[184:187], a[216:219], a[100:103], v[184:187]
    ds_read_b64_tr_b16 a[242:243], v31 offset:61952
    v_mfma_f32_16x16x32_bf16 v[184:187], a[220:223], a[104:107], v[184:187]
    v_rsq_f32 v36, v57
    v_mfma_f32_16x16x32_bf16 v[184:187], a[224:227], a[108:111], v[184:187]
    v_rsq_f32 v37, v59
    v_mfma_f32_16x16x32_bf16 v[188:191], a[224:227], a[124:127], v[188:191]
    v_rsq_f32 v38, v61
    v_mfma_f32_16x16x32_bf16 v[188:191], a[220:223], a[120:123], v[188:191]
    v_rsq_f32 v39, v63
    v_mfma_f32_16x16x32_bf16 v[188:191], a[216:219], a[116:119], v[188:191]
    v_sub_f32 v32, 0, v56
    v_mov_b32 v44, v57
    v_mfma_f32_16x16x32_bf16 v[188:191], a[212:215], a[112:115], v[188:191]
    s_waitcnt lgkmcnt(0)
    v_sub_f32 v33, 0, v58
    v_mov_b32 v45, v59
    v_mfma_f32_16x16x32_bf16 v[240:243], a[228:231], a[64:67], v[240:243]
    s_waitcnt vmcnt(19) lgkmcnt(15)
    v_sub_f32 v34, 0, v60
    v_mov_b32 v46, v61
    v_mfma_f32_16x16x32_bf16 v[240:243], a[232:235], a[68:71], v[240:243]
    s_barrier
    buffer_load_dwordx4 v16, s[20:23], s62 offen offset:2048 lds
    v_mfma_f32_16x16x32_bf16 v[240:243], a[236:239], a[72:75], v[240:243]
    ds_read_b64_tr_b16 a[212:213], v24 offset:0
    v_sub_f32 v35, 0, v62
    v_mfma_f32_16x16x32_bf16 v[240:243], a[240:243], a[76:79], v[240:243]
    ds_read_b64_tr_b16 a[214:215], v24 offset:1024
    v_mov_b32 v47, v63
    v_mfma_f32_16x16x32_bf16 v[244:247], a[240:243], a[92:95], v[244:247]
    ds_read_b64_tr_b16 a[216:217], v24 offset:8192
    v_mul_f32 v40, 0xbfb8aa3b, v36
    v_mfma_f32_16x16x32_bf16 v[244:247], a[236:239], a[88:91], v[244:247]
    ds_read_b64_tr_b16 a[218:219], v24 offset:9216
    v_mul_f32 v36, 0x3e0293ee, v36
    v_mfma_f32_16x16x32_bf16 v[244:247], a[232:235], a[84:87], v[244:247]
    ds_read_b64_tr_b16 a[220:221], v24 offset:16384
    v_mul_f32 v41, 0xbfb8aa3b, v37
    v_mfma_f32_16x16x32_bf16 v[244:247], a[228:231], a[80:83], v[244:247]
    ds_read_b64_tr_b16 a[222:223], v24 offset:17408
    v_mul_f32 v37, 0x3e0293ee, v37
    v_mfma_f32_16x16x32_bf16 v[248:251], a[228:231], a[96:99], v[248:251]
    ds_read_b64_tr_b16 a[224:225], v24 offset:24576
    v_mul_f32 v42, 0xbfb8aa3b, v38
    v_mfma_f32_16x16x32_bf16 v[248:251], a[232:235], a[100:103], v[248:251]
    ds_read_b64_tr_b16 a[226:227], v24 offset:25600
    v_mul_f32 v38, 0x3e0293ee, v38
    v_mfma_f32_16x16x32_bf16 v[248:251], a[236:239], a[104:107], v[248:251]
    v_mul_f32 v43, 0xbfb8aa3b, v39
    v_mul_f32 v39, 0x3e0293ee, v39
    v_mfma_f32_16x16x32_bf16 v[248:251], a[240:243], a[108:111], v[248:251]
    v_mfma_f32_16x16x32_bf16 v[252:255], a[240:243], a[124:127], v[252:255]
    buffer_load_dwordx4 v17, s[20:23], s62 offen offset:3072 lds
    v_mfma_f32_16x16x32_bf16 v[252:255], a[236:239], a[120:123], v[252:255]
    s_add_u32 s62, s62, 28672
    v_mfma_f32_16x16x32_bf16 v[252:255], a[232:235], a[116:119], v[252:255]
    v_mfma_f32_16x16x32_bf16 v[252:255], a[228:231], a[112:115], v[252:255]
    s_waitcnt lgkmcnt(0)
    v_mfma_f32_16x16x32_bf16 v[64:67], a[212:215], a[0:3], v[64:67]
    ds_read_b64_tr_b16 a[228:229], v24 offset:8
    v_mfma_f32_16x16x32_bf16 v[64:67], a[216:219], a[4:7], v[64:67]
    ds_read_b64_tr_b16 a[230:231], v24 offset:1032
    v_mfma_f32_16x16x32_bf16 v[64:67], a[220:223], a[8:11], v[64:67]
    ds_read_b64_tr_b16 a[232:233], v24 offset:8200
    v_xor_b32 v28, 0, v54
    v_mfma_f32_16x16x32_bf16 v[64:67], a[224:227], a[12:15], v[64:67]
    v_xor_b32 v29, 128, v54
    v_xor_b32 v30, 256, v54
    v_mfma_f32_16x16x32_bf16 v[80:83], a[224:227], a[28:31], v[80:83]
    ds_read_b64_tr_b16 a[234:235], v24 offset:9224
    v_xor_b32 v31, 384, v54
    v_mfma_f32_16x16x32_bf16 v[80:83], a[220:223], a[24:27], v[80:83]
    ds_read_b64_tr_b16 a[236:237], v24 offset:16392
    v_mfma_f32_16x16x32_bf16 v[80:83], a[216:219], a[20:23], v[80:83]
    ds_read_b64_tr_b16 a[238:239], v24 offset:17416
    v_mfma_f32_16x16x32_bf16 v[80:83], a[212:215], a[16:19], v[80:83]
    ds_read_b128 v[48:51], v28 offset:0
    v_mfma_f32_16x16x32_bf16 v[96:99], a[212:215], a[32:35], v[96:99]
    ds_read_b64_tr_b16 a[240:241], v24 offset:24584
    v_mfma_f32_16x16x32_bf16 v[96:99], a[216:219], a[36:39], v[96:99]
    ds_read_b64_tr_b16 a[242:243], v24 offset:25608
    v_mfma_f32_16x16x32_bf16 v[96:99], a[220:223], a[40:43], v[96:99]
    ds_read_b128 v[52:55], v28 offset:64
    v_mfma_f32_16x16x32_bf16 v[96:99], a[224:227], a[44:47], v[96:99]
    ds_read_b128 v[56:59], v29 offset:0
    v_mfma_f32_16x16x32_bf16 v[112:115], a[224:227], a[60:63], v[112:115]
    ds_read_b128 v[60:63], v29 offset:64
    v_mfma_f32_16x16x32_bf16 v[112:115], a[220:223], a[56:59], v[112:115]
    v_mfma_f32_16x16x32_bf16 v[112:115], a[216:219], a[52:55], v[112:115]
    v_mfma_f32_16x16x32_bf16 v[112:115], a[212:215], a[48:51], v[112:115]
    v_smfmac_f32_16x16x64_bf16 a[200:203], a[208:211], a[212:219], v20
    s_waitcnt lgkmcnt(2)
    v_fmac_f32 v128, v48, v32
    v_smfmac_f32_16x16x64_bf16 a[200:203], a[208:211], a[220:227], v20
    s_waitcnt lgkmcnt(3)
    v_fmac_f32 v129, v49, v32
    v_mfma_f32_16x16x32_bf16 a[128:131], a[228:231], a[0:3], a[128:131]
    s_waitcnt lgkmcnt(0)
    ds_read_b64_tr_b16 a[212:213], v25 offset:0
    v_fmac_f32 v130, v50, v32
    v_mfma_f32_16x16x32_bf16 a[128:131], a[232:235], a[4:7], a[128:131]
    ds_read_b64_tr_b16 a[214:215], v25 offset:1024
    v_fmac_f32 v131, v51, v32
    v_mfma_f32_16x16x32_bf16 a[128:131], a[236:239], a[8:11], a[128:131]
    ds_read_b64_tr_b16 a[216:217], v25 offset:8192
    v_fmac_f32 v132, v48, v33
    v_mfma_f32_16x16x32_bf16 a[128:131], a[240:243], a[12:15], a[128:131]
    v_fmac_f32 v133, v49, v33
    v_fmac_f32 v134, v50, v33
    v_mfma_f32_16x16x32_bf16 a[144:147], a[240:243], a[28:31], a[144:147]
    ds_read_b64_tr_b16 a[218:219], v25 offset:9216
    v_fmac_f32 v135, v51, v33
    v_mfma_f32_16x16x32_bf16 a[144:147], a[236:239], a[24:27], a[144:147]
    ds_read_b64_tr_b16 a[220:221], v25 offset:16384
    v_fmac_f32 v136, v48, v34
    v_mfma_f32_16x16x32_bf16 a[144:147], a[232:235], a[20:23], a[144:147]
    ds_read_b64_tr_b16 a[222:223], v25 offset:17408
    v_fmac_f32 v137, v49, v34
    v_mfma_f32_16x16x32_bf16 a[144:147], a[228:231], a[16:19], a[144:147]
    v_fmac_f32 v138, v50, v34
    v_fmac_f32 v139, v51, v34
    v_mfma_f32_16x16x32_bf16 a[160:163], a[228:231], a[32:35], a[160:163]
    ds_read_b64_tr_b16 a[224:225], v25 offset:24576
    v_fmac_f32 v140, v48, v35
    v_mfma_f32_16x16x32_bf16 a[160:163], a[232:235], a[36:39], a[160:163]
    ds_read_b64_tr_b16 a[226:227], v25 offset:25600
    v_fmac_f32 v141, v49, v35
    v_mfma_f32_16x16x32_bf16 a[160:163], a[236:239], a[40:43], a[160:163]
    v_fmac_f32 v142, v50, v35
    v_fmac_f32 v143, v51, v35
    v_mfma_f32_16x16x32_bf16 a[160:163], a[240:243], a[44:47], a[160:163]
    v_fmac_f32 v192, v52, v32
    v_fmac_f32 v193, v53, v32
    v_mfma_f32_16x16x32_bf16 a[176:179], a[240:243], a[60:63], a[176:179]
    v_fmac_f32 v194, v54, v32
    v_fmac_f32 v195, v55, v32
    v_mfma_f32_16x16x32_bf16 a[176:179], a[236:239], a[56:59], a[176:179]
    v_fmac_f32 v196, v52, v33
    v_fmac_f32 v197, v53, v33
    v_mfma_f32_16x16x32_bf16 a[176:179], a[232:235], a[52:55], a[176:179]
    v_fmac_f32 v198, v54, v33
    v_fmac_f32 v199, v55, v33
    v_mfma_f32_16x16x32_bf16 a[176:179], a[228:231], a[48:51], a[176:179]
    v_fmac_f32 v200, v52, v34
    v_fmac_f32 v201, v53, v34
    v_smfmac_f32_16x16x64_bf16 a[204:207], a[208:211], a[228:235], v20
    v_fmac_f32 v202, v54, v34
    v_smfmac_f32_16x16x64_bf16 a[204:207], a[208:211], a[236:243], v20
    s_waitcnt lgkmcnt(0)
    v_fmac_f32 v203, v55, v34
    v_mfma_f32_16x16x32_bf16 v[68:71], a[212:215], a[0:3], v[68:71]
    ds_read_b64_tr_b16 a[228:229], v25 offset:8
    v_fmac_f32 v204, v52, v35
    v_mfma_f32_16x16x32_bf16 v[68:71], a[216:219], a[4:7], v[68:71]
    s_add_u32 m0, s59, 98304
    ds_read_b64_tr_b16 a[230:231], v25 offset:1032
    v_fmac_f32 v205, v53, v35
    v_mfma_f32_16x16x32_bf16 v[68:71], a[220:223], a[8:11], v[68:71]
    ds_read_b64_tr_b16 a[232:233], v25 offset:8200
    v_fmac_f32 v206, v54, v35
    v_mfma_f32_16x16x32_bf16 v[68:71], a[224:227], a[12:15], v[68:71]
    buffer_load_dwordx4 v18, s[24:27], s63 offen offset:0 lds
    v_mfma_f32_16x16x32_bf16 v[84:87], a[224:227], a[28:31], v[84:87]
    ds_read_b64_tr_b16 a[234:235], v25 offset:9224
    v_fmac_f32 v207, v55, v35
    v_mfma_f32_16x16x32_bf16 v[84:87], a[220:223], a[24:27], v[84:87]
    ds_read_b64_tr_b16 a[236:237], v25 offset:16392
    v_fmac_f32 v144, v56, v32
    v_mfma_f32_16x16x32_bf16 v[84:87], a[216:219], a[20:23], v[84:87]
    ds_read_b64_tr_b16 a[238:239], v25 offset:17416
    v_fmac_f32 v145, v57, v32
    v_mfma_f32_16x16x32_bf16 v[84:87], a[212:215], a[16:19], v[84:87]
    ds_read_b128 v[48:51], v30 offset:0
    v_fmac_f32 v146, v58, v32
    v_mfma_f32_16x16x32_bf16 v[100:103], a[212:215], a[32:35], v[100:103]
    ds_read_b64_tr_b16 a[240:241], v25 offset:24584
    v_fmac_f32 v147, v59, v32
    v_mfma_f32_16x16x32_bf16 v[100:103], a[216:219], a[36:39], v[100:103]
    ds_read_b64_tr_b16 a[242:243], v25 offset:25608
    v_fmac_f32 v148, v56, v33
    v_mfma_f32_16x16x32_bf16 v[100:103], a[220:223], a[40:43], v[100:103]
    ds_read_b128 v[52:55], v30 offset:64
    v_fmac_f32 v149, v57, v33
    v_mfma_f32_16x16x32_bf16 v[100:103], a[224:227], a[44:47], v[100:103]
    v_fmac_f32 v150, v58, v33
    v_fmac_f32 v151, v59, v33
    v_mfma_f32_16x16x32_bf16 v[116:119], a[224:227], a[60:63], v[116:119]
    v_fmac_f32 v152, v56, v34
    v_fmac_f32 v153, v57, v34
    v_mfma_f32_16x16x32_bf16 v[116:119], a[220:223], a[56:59], v[116:119]
    v_fmac_f32 v154, v58, v34
    v_fmac_f32 v155, v59, v34
    v_mfma_f32_16x16x32_bf16 v[116:119], a[216:219], a[52:55], v[116:119]
    buffer_load_dwordx4 v19, s[24:27], s63 offen offset:1024 lds
    v_mfma_f32_16x16x32_bf16 v[116:119], a[212:215], a[48:51], v[116:119]
    s_waitcnt lgkmcnt(1)
    v_fmac_f32 v156, v56, v35
    v_fmac_f32 v157, v57, v35
    v_mfma_f32_16x16x32_bf16 a[132:135], a[228:231], a[0:3], a[132:135]
    s_waitcnt lgkmcnt(0)
    ds_read_b64_tr_b16 a[212:213], v26 offset:0
    v_fmac_f32 v158, v58, v35
    v_mfma_f32_16x16x32_bf16 a[132:135], a[232:235], a[4:7], a[132:135]
    ds_read_b64_tr_b16 a[214:215], v26 offset:1024
    v_fmac_f32 v159, v59, v35
    v_mfma_f32_16x16x32_bf16 a[132:135], a[236:239], a[8:11], a[132:135]
    ds_read_b64_tr_b16 a[216:217], v26 offset:8192
    v_fmac_f32 v208, v60, v32
    v_mfma_f32_16x16x32_bf16 a[132:135], a[240:243], a[12:15], a[132:135]
    v_fmac_f32 v209, v61, v32
    v_fmac_f32 v210, v62, v32
    v_mfma_f32_16x16x32_bf16 a[148:151], a[240:243], a[28:31], a[148:151]
    ds_read_b64_tr_b16 a[218:219], v26 offset:9216
    v_fmac_f32 v211, v63, v32
    v_mfma_f32_16x16x32_bf16 a[148:151], a[236:239], a[24:27], a[148:151]
    ds_read_b64_tr_b16 a[220:221], v26 offset:16384
    v_fmac_f32 v212, v60, v33
    v_mfma_f32_16x16x32_bf16 a[148:151], a[232:235], a[20:23], a[148:151]
    ds_read_b64_tr_b16 a[222:223], v26 offset:17408
    v_fmac_f32 v213, v61, v33
    v_mfma_f32_16x16x32_bf16 a[148:151], a[228:231], a[16:19], a[148:151]
    v_fmac_f32 v214, v62, v33
    v_fmac_f32 v215, v63, v33
    v_mfma_f32_16x16x32_bf16 a[164:167], a[228:231], a[32:35], a[164:167]
    ds_read_b64_tr_b16 a[224:225], v26 offset:24576
    v_fmac_f32 v216, v60, v34
    v_mfma_f32_16x16x32_bf16 a[164:167], a[232:235], a[36:39], a[164:167]
    ds_read_b64_tr_b16 a[226:227], v26 offset:25600
    v_fmac_f32 v217, v61, v34
    v_mfma_f32_16x16x32_bf16 a[164:167], a[236:239], a[40:43], a[164:167]
    buffer_load_dwordx4 v18, s[24:27], s63 offen offset:2048 lds
    v_mfma_f32_16x16x32_bf16 a[164:167], a[240:243], a[44:47], a[164:167]
    v_fmac_f32 v218, v62, v34
    v_fmac_f32 v219, v63, v34
    v_mfma_f32_16x16x32_bf16 a[180:183], a[240:243], a[60:63], a[180:183]
    v_fmac_f32 v220, v60, v35
    v_fmac_f32 v221, v61, v35
    v_mfma_f32_16x16x32_bf16 a[180:183], a[236:239], a[56:59], a[180:183]
    v_fmac_f32 v222, v62, v35
    v_fmac_f32 v223, v63, v35
    v_mfma_f32_16x16x32_bf16 a[180:183], a[232:235], a[52:55], a[180:183]
    s_add_u32 s64, s92, s69
    ds_read_b128 v[56:59], v31 offset:0
    v_fmac_f32 v160, v48, v32
    v_mfma_f32_16x16x32_bf16 a[180:183], a[228:231], a[48:51], a[180:183]
    s_waitcnt lgkmcnt(1)
    ds_read_b128 v[60:63], v31 offset:64
    v_fmac_f32 v161, v49, v32
    v_mfma_f32_16x16x32_bf16 v[72:75], a[212:215], a[0:3], v[72:75]
    s_and_b32 s66, s58, 2
    ds_read_b64_tr_b16 a[228:229], v26 offset:8
    v_fmac_f32 v162, v50, v32
    v_mfma_f32_16x16x32_bf16 v[72:75], a[216:219], a[4:7], v[72:75]
    s_lshl_b32 s66, s66, 9
    ds_read_b64_tr_b16 a[230:231], v26 offset:1032
    v_fmac_f32 v163, v51, v32
    v_mfma_f32_16x16x32_bf16 v[72:75], a[220:223], a[8:11], v[72:75]
    ds_read_b64_tr_b16 a[232:233], v26 offset:8200
    v_fmac_f32 v164, v48, v33
    v_mfma_f32_16x16x32_bf16 v[72:75], a[224:227], a[12:15], v[72:75]
    buffer_load_dwordx4 v19, s[24:27], s63 offen offset:3072 lds
    v_mfma_f32_16x16x32_bf16 v[88:91], a[224:227], a[28:31], v[88:91]
    s_add_u32 s63, s63, 4096
    ds_read_b64_tr_b16 a[234:235], v26 offset:9224
    v_fmac_f32 v165, v49, v33
    v_mfma_f32_16x16x32_bf16 v[88:91], a[220:223], a[24:27], v[88:91]
    s_waitcnt lgkmcnt(4)
    ds_read_b64_tr_b16 a[236:237], v26 offset:16392
    v_fmac_f32 v166, v50, v33
    v_mfma_f32_16x16x32_bf16 v[88:91], a[216:219], a[20:23], v[88:91]
    ds_read_b64_tr_b16 a[238:239], v26 offset:17416
    v_fmac_f32 v167, v51, v33
    v_mfma_f32_16x16x32_bf16 v[88:91], a[212:215], a[16:19], v[88:91]
    v_fmac_f32 v168, v48, v34
    v_fmac_f32 v169, v49, v34
    v_mfma_f32_16x16x32_bf16 v[104:107], a[212:215], a[32:35], v[104:107]
    ds_read_b64_tr_b16 a[240:241], v26 offset:24584
    v_fmac_f32 v170, v50, v34
    v_mfma_f32_16x16x32_bf16 v[104:107], a[216:219], a[36:39], v[104:107]
    ds_read_b64_tr_b16 a[242:243], v26 offset:25608
    v_fmac_f32 v171, v51, v34
    v_mfma_f32_16x16x32_bf16 v[104:107], a[220:223], a[40:43], v[104:107]
    v_fmac_f32 v172, v48, v35
    v_fmac_f32 v173, v49, v35
    v_mfma_f32_16x16x32_bf16 v[104:107], a[224:227], a[44:47], v[104:107]
    v_fmac_f32 v174, v50, v35
    v_fmac_f32 v175, v51, v35
    v_mfma_f32_16x16x32_bf16 v[120:123], a[224:227], a[60:63], v[120:123]
    v_fmac_f32 v224, v52, v32
    v_fmac_f32 v225, v53, v32
    v_mfma_f32_16x16x32_bf16 v[120:123], a[220:223], a[56:59], v[120:123]
    v_fmac_f32 v226, v54, v32
    v_fmac_f32 v227, v55, v32
    v_mfma_f32_16x16x32_bf16 v[120:123], a[216:219], a[52:55], v[120:123]
    s_add_u32 m0, s59, 102400
    v_fmac_f32 v228, v52, v33
    v_fmac_f32 v229, v53, v33
    v_mfma_f32_16x16x32_bf16 v[120:123], a[212:215], a[48:51], v[120:123]
    s_waitcnt lgkmcnt(0)
    buffer_load_dwordx4 v18, s[24:27], s63 offen offset:0 lds
    v_mfma_f32_16x16x32_bf16 a[136:139], a[228:231], a[0:3], a[136:139]
    ds_read_b64_tr_b16 a[212:213], v27 offset:0
    v_fmac_f32 v230, v54, v33
    v_mfma_f32_16x16x32_bf16 a[136:139], a[232:235], a[4:7], a[136:139]
    ds_read_b64_tr_b16 a[214:215], v27 offset:1024
    v_fmac_f32 v231, v55, v33
    v_mfma_f32_16x16x32_bf16 a[136:139], a[236:239], a[8:11], a[136:139]
    ds_read_b64_tr_b16 a[216:217], v27 offset:8192
    v_fmac_f32 v232, v52, v34
    v_mfma_f32_16x16x32_bf16 a[136:139], a[240:243], a[12:15], a[136:139]
    v_fmac_f32 v233, v53, v34
    v_fmac_f32 v234, v54, v34
    v_mfma_f32_16x16x32_bf16 a[152:155], a[240:243], a[28:31], a[152:155]
    ds_read_b64_tr_b16 a[218:219], v27 offset:9216
    v_fmac_f32 v235, v55, v34
    v_mfma_f32_16x16x32_bf16 a[152:155], a[236:239], a[24:27], a[152:155]
    ds_read_b64_tr_b16 a[220:221], v27 offset:16384
    v_fmac_f32 v236, v52, v35
    v_mfma_f32_16x16x32_bf16 a[152:155], a[232:235], a[20:23], a[152:155]
    ds_read_b64_tr_b16 a[222:223], v27 offset:17408
    v_fmac_f32 v237, v53, v35
    v_mfma_f32_16x16x32_bf16 a[152:155], a[228:231], a[16:19], a[152:155]
    v_fmac_f32 v238, v54, v35
    v_fmac_f32 v239, v55, v35
    v_mfma_f32_16x16x32_bf16 a[168:171], a[228:231], a[32:35], a[168:171]
    ds_read_b64_tr_b16 a[224:225], v27 offset:24576
    v_fmac_f32 v176, v56, v32
    v_mfma_f32_16x16x32_bf16 a[168:171], a[232:235], a[36:39], a[168:171]
    ds_read_b64_tr_b16 a[226:227], v27 offset:25600
    v_fmac_f32 v177, v57, v32
    v_mfma_f32_16x16x32_bf16 a[168:171], a[236:239], a[40:43], a[168:171]
    v_fmac_f32 v178, v58, v32
    v_fmac_f32 v179, v59, v32
    v_mfma_f32_16x16x32_bf16 a[168:171], a[240:243], a[44:47], a[168:171]
    buffer_load_dwordx4 v19, s[24:27], s63 offen offset:1024 lds
    v_mfma_f32_16x16x32_bf16 a[184:187], a[240:243], a[60:63], a[184:187]
    v_fmac_f32 v180, v56, v33
    v_fmac_f32 v181, v57, v33
    v_mfma_f32_16x16x32_bf16 a[184:187], a[236:239], a[56:59], a[184:187]
    v_fmac_f32 v182, v58, v33
    v_fmac_f32 v183, v59, v33
    v_mfma_f32_16x16x32_bf16 a[184:187], a[232:235], a[52:55], a[184:187]
    v_fmac_f32 v184, v56, v34
    v_fmac_f32 v185, v57, v34
    v_mfma_f32_16x16x32_bf16 a[184:187], a[228:231], a[48:51], a[184:187]
    s_waitcnt lgkmcnt(0)
    v_fmac_f32 v186, v58, v34
    v_fmac_f32 v187, v59, v34
    v_mfma_f32_16x16x32_bf16 v[76:79], a[212:215], a[0:3], v[76:79]
    ds_read_b64_tr_b16 a[228:229], v27 offset:8
    v_fmac_f32 v188, v56, v35
    v_mfma_f32_16x16x32_bf16 v[76:79], a[216:219], a[4:7], v[76:79]
    ds_read_b64_tr_b16 a[230:231], v27 offset:1032
    v_fmac_f32 v189, v57, v35
    v_mfma_f32_16x16x32_bf16 v[76:79], a[220:223], a[8:11], v[76:79]
    ds_read_b64_tr_b16 a[232:233], v27 offset:8200
    v_fmac_f32 v190, v58, v35
    v_mfma_f32_16x16x32_bf16 v[76:79], a[224:227], a[12:15], v[76:79]
    v_fmac_f32 v191, v59, v35
    v_fmac_f32 v240, v60, v32
    v_mfma_f32_16x16x32_bf16 v[92:95], a[224:227], a[28:31], v[92:95]
    ds_read_b64_tr_b16 a[234:235], v27 offset:9224
    v_fmac_f32 v241, v61, v32
    v_mfma_f32_16x16x32_bf16 v[92:95], a[220:223], a[24:27], v[92:95]
    ds_read_b64_tr_b16 a[236:237], v27 offset:16392
    v_fmac_f32 v242, v62, v32
    v_mfma_f32_16x16x32_bf16 v[92:95], a[216:219], a[20:23], v[92:95]
    ds_read_b64_tr_b16 a[238:239], v27 offset:17416
    v_fmac_f32 v243, v63, v32
    v_mfma_f32_16x16x32_bf16 v[92:95], a[212:215], a[16:19], v[92:95]
    buffer_load_dwordx4 v18, s[24:27], s63 offen offset:2048 lds
    v_mfma_f32_16x16x32_bf16 v[108:111], a[212:215], a[32:35], v[108:111]
    ds_read_b64_tr_b16 a[240:241], v27 offset:24584
    v_fmac_f32 v244, v60, v33
    v_mfma_f32_16x16x32_bf16 v[108:111], a[216:219], a[36:39], v[108:111]
    ds_read_b64_tr_b16 a[242:243], v27 offset:25608
    v_fmac_f32 v245, v61, v33
    v_mfma_f32_16x16x32_bf16 v[108:111], a[220:223], a[40:43], v[108:111]
    v_fmac_f32 v246, v62, v33
    v_fmac_f32 v247, v63, v33
    v_mfma_f32_16x16x32_bf16 v[108:111], a[224:227], a[44:47], v[108:111]
    v_fmac_f32 v248, v60, v34
    v_fmac_f32 v249, v61, v34
    v_mfma_f32_16x16x32_bf16 v[124:127], a[224:227], a[60:63], v[124:127]
    v_fmac_f32 v250, v62, v34
    v_fmac_f32 v251, v63, v34
    v_mfma_f32_16x16x32_bf16 v[124:127], a[220:223], a[56:59], v[124:127]
    v_fmac_f32 v252, v60, v35
    v_fmac_f32 v253, v61, v35
    v_mfma_f32_16x16x32_bf16 v[124:127], a[216:219], a[52:55], v[124:127]
    v_fmac_f32 v254, v62, v35
    v_fmac_f32 v255, v63, v35
    v_mfma_f32_16x16x32_bf16 v[124:127], a[212:215], a[48:51], v[124:127]
    s_waitcnt lgkmcnt(0)
    v_add_u32 v30, 98304, v28
    v_add_u32 v28, s66, v1
    v_mfma_f32_16x16x32_bf16 a[140:143], a[228:231], a[0:3], a[140:143]
    s_waitcnt vmcnt(19)
    v_add_u32 v24, 4294901760, v24
    v_add_u32 v25, 4294901760, v25
    v_mfma_f32_16x16x32_bf16 a[140:143], a[232:235], a[4:7], a[140:143]
    s_barrier
    v_add_u32 v26, 4294901760, v26
    v_add_u32 v27, 4294901760, v27
    v_mfma_f32_16x16x32_bf16 a[140:143], a[236:239], a[8:11], a[140:143]
    ds_read_b64_tr_b16 a[212:213], v24 offset:0
    buffer_load_dwordx4 v19, s[24:27], s63 offen offset:3072 lds
    v_mfma_f32_16x16x32_bf16 a[140:143], a[240:243], a[12:15], a[140:143]
    s_add_u32 s63, s63, 28672
    ds_read_b64_tr_b16 a[214:215], v24 offset:1024
    v_xor_b32 v29, 0x400, v28
    v_mfma_f32_16x16x32_bf16 a[156:159], a[240:243], a[28:31], a[156:159]
    ds_read_b64_tr_b16 a[216:217], v24 offset:8192
    v_mul_f32 v192, v192, v128
    v_mfma_f32_16x16x32_bf16 a[156:159], a[236:239], a[24:27], a[156:159]
    ds_read_b64_tr_b16 a[218:219], v24 offset:9216
    v_mul_f32 v128, v40, v128
    v_mfma_f32_16x16x32_bf16 a[156:159], a[232:235], a[20:23], a[156:159]
    ds_read_b64_tr_b16 a[220:221], v24 offset:16384
    v_mul_f32 v193, v193, v129
    v_mfma_f32_16x16x32_bf16 a[156:159], a[228:231], a[16:19], a[156:159]
    ds_read_b64_tr_b16 a[222:223], v24 offset:17408
    v_mul_f32 v129, v40, v129
    v_mfma_f32_16x16x32_bf16 a[172:175], a[228:231], a[32:35], a[172:175]
    ds_read_b64_tr_b16 a[224:225], v24 offset:24576
    v_mul_f32 v194, v194, v130
    v_mfma_f32_16x16x32_bf16 a[172:175], a[232:235], a[36:39], a[172:175]
    ds_read_b64_tr_b16 a[226:227], v24 offset:25600
    v_mul_f32 v130, v40, v130
    v_mfma_f32_16x16x32_bf16 a[172:175], a[236:239], a[40:43], a[172:175]
    v_exp_f32 v128, v128
    v_mfma_f32_16x16x32_bf16 a[172:175], a[240:243], a[44:47], a[172:175]
    v_exp_f32 v129, v129
    v_mfma_f32_16x16x32_bf16 a[188:191], a[240:243], a[60:63], a[188:191]
    v_exp_f32 v130, v130
    v_mfma_f32_16x16x32_bf16 a[188:191], a[236:239], a[56:59], a[188:191]
    v_mul_f32 v195, v195, v131
    v_mul_f32 v131, v40, v131
    v_mfma_f32_16x16x32_bf16 a[188:191], a[232:235], a[52:55], a[188:191]
    v_exp_f32 v131, v131
    v_mfma_f32_16x16x32_bf16 a[188:191], a[228:231], a[48:51], a[188:191]
    s_waitcnt lgkmcnt(0)
    v_mul_f32 v208, v208, v144
    v_mul_f32 v144, v40, v144
    v_mfma_f32_16x16x32_bf16 v[64:67], a[212:215], a[64:67], v[64:67]
    ds_read_b64_tr_b16 a[228:229], v24 offset:8
    v_mul_f32 v209, v209, v145
    v_mfma_f32_16x16x32_bf16 v[64:67], a[216:219], a[68:71], v[64:67]
    ds_read_b64_tr_b16 a[230:231], v24 offset:1032
    v_mul_f32 v145, v40, v145
    v_mfma_f32_16x16x32_bf16 v[64:67], a[220:223], a[72:75], v[64:67]
    ds_read_b64_tr_b16 a[232:233], v24 offset:8200
    v_mul_f32 v210, v210, v146
    v_mfma_f32_16x16x32_bf16 v[64:67], a[224:227], a[76:79], v[64:67]
    v_exp_f32 v144, v144
    v_mfma_f32_16x16x32_bf16 v[80:83], a[224:227], a[92:95], v[80:83]
    ds_read_b64_tr_b16 a[234:235], v24 offset:9224
    v_mul_f32 v146, v40, v146
    v_mfma_f32_16x16x32_bf16 v[80:83], a[220:223], a[88:91], v[80:83]
    ds_read_b64_tr_b16 a[236:237], v24 offset:16392
    v_mul_f32 v211, v211, v147
    v_mfma_f32_16x16x32_bf16 v[80:83], a[216:219], a[84:87], v[80:83]
    ds_read_b64_tr_b16 a[238:239], v24 offset:17416
    v_mul_f32 v147, v40, v147
    v_mfma_f32_16x16x32_bf16 v[80:83], a[212:215], a[80:83], v[80:83]
    v_exp_f32 v145, v145
    v_mfma_f32_16x16x32_bf16 v[96:99], a[212:215], a[96:99], v[96:99]
    ds_read_b64_tr_b16 a[240:241], v24 offset:24584
    v_fma_f32 v128, v128, v44, v44
    v_mfma_f32_16x16x32_bf16 v[96:99], a[216:219], a[100:103], v[96:99]
    ds_read_b64_tr_b16 a[242:243], v24 offset:25608
    v_fma_f32 v129, v129, v44, v44
    v_mfma_f32_16x16x32_bf16 v[96:99], a[220:223], a[104:107], v[96:99]
    v_exp_f32 v146, v146
    v_mfma_f32_16x16x32_bf16 v[96:99], a[224:227], a[108:111], v[96:99]
    v_exp_f32 v147, v147
    v_mfma_f32_16x16x32_bf16 v[112:115], a[224:227], a[124:127], v[112:115]
    v_rcp_f32 v128, v128
    v_mfma_f32_16x16x32_bf16 v[112:115], a[220:223], a[120:123], v[112:115]
    v_rcp_f32 v129, v129
    v_mfma_f32_16x16x32_bf16 v[112:115], a[216:219], a[116:119], v[112:115]
    v_fma_f32 v130, v130, v44, v44
    v_fma_f32 v131, v131, v44, v44
    v_mfma_f32_16x16x32_bf16 v[112:115], a[212:215], a[112:115], v[112:115]
    v_rcp_f32 v130, v130
    v_smfmac_f32_16x16x64_bf16 a[200:203], a[208:211], a[212:219], v20
    v_fma_f32 v144, v144, v44, v44
    v_smfmac_f32_16x16x64_bf16 a[200:203], a[208:211], a[220:227], v20
    s_waitcnt lgkmcnt(0)
    v_fma_f32 v145, v145, v44, v44
    v_mfma_f32_16x16x32_bf16 a[128:131], a[228:231], a[64:67], a[128:131]
    ds_read_b64_tr_b16 a[212:213], v25 offset:0
    v_fma_f32 v146, v146, v44, v44
    v_mfma_f32_16x16x32_bf16 a[128:131], a[232:235], a[68:71], a[128:131]
    ds_read_b64_tr_b16 a[214:215], v25 offset:1024
    v_fma_f32 v147, v147, v44, v44
    v_mfma_f32_16x16x32_bf16 a[128:131], a[236:239], a[72:75], a[128:131]
    ds_read_b64_tr_b16 a[216:217], v25 offset:8192
    v_mul_f32 v128, v128, v192
    v_mfma_f32_16x16x32_bf16 a[128:131], a[240:243], a[76:79], a[128:131]
    v_rcp_f32 v131, v131
    v_mfma_f32_16x16x32_bf16 a[144:147], a[240:243], a[92:95], a[144:147]
    ds_read_b64_tr_b16 a[218:219], v25 offset:9216
    v_mul_f32 v129, v129, v193
    v_mfma_f32_16x16x32_bf16 a[144:147], a[236:239], a[88:91], a[144:147]
    ds_read_b64_tr_b16 a[220:221], v25 offset:16384
    v_mul_f32 v130, v130, v194
    v_mfma_f32_16x16x32_bf16 a[144:147], a[232:235], a[84:87], a[144:147]
    ds_read_b64_tr_b16 a[222:223], v25 offset:17408
    v_mul_f32 v131, v131, v195
    v_mfma_f32_16x16x32_bf16 a[144:147], a[228:231], a[80:83], a[144:147]
    v_rcp_f32 v144, v144
    v_mfma_f32_16x16x32_bf16 a[160:163], a[228:231], a[96:99], a[160:163]
    ds_read_b64_tr_b16 a[224:225], v25 offset:24576
    v_mul_f32 v144, v144, v208
    v_mfma_f32_16x16x32_bf16 a[160:163], a[232:235], a[100:103], a[160:163]
    ds_read_b64_tr_b16 a[226:227], v25 offset:25600
    v_cvt_pk_bf16_f32 v128, v128, v129
    v_mfma_f32_16x16x32_bf16 a[160:163], a[236:239], a[104:107], a[160:163]
    v_rcp_f32 v145, v145
    v_mfma_f32_16x16x32_bf16 a[160:163], a[240:243], a[108:111], a[160:163]
    v_rcp_f32 v146, v146
    v_mfma_f32_16x16x32_bf16 a[176:179], a[240:243], a[124:127], a[176:179]
    v_rcp_f32 v147, v147
    v_mfma_f32_16x16x32_bf16 a[176:179], a[236:239], a[120:123], a[176:179]
    v_mul_f32 v145, v145, v209
    v_mul_f32 v146, v146, v210
    v_mfma_f32_16x16x32_bf16 a[176:179], a[232:235], a[116:119], a[176:179]
    v_mul_f32 v147, v147, v211
    v_cvt_pk_bf16_f32 v129, v130, v131
    v_mfma_f32_16x16x32_bf16 a[176:179], a[228:231], a[112:115], a[176:179]
    v_cvt_pk_bf16_f32 v130, v144, v145
    v_cvt_pk_bf16_f32 v131, v146, v147
    v_smfmac_f32_16x16x64_bf16 a[204:207], a[208:211], a[228:235], v20
    v_mul_f32 v224, v224, v160
    v_smfmac_f32_16x16x64_bf16 a[204:207], a[208:211], a[236:243], v20
    s_waitcnt lgkmcnt(0)
    v_mul_f32 v160, v40, v160
    v_mfma_f32_16x16x32_bf16 v[68:71], a[212:215], a[64:67], v[68:71]
    ds_read_b64_tr_b16 a[228:229], v25 offset:8
    v_mul_f32 v225, v225, v161
    v_mfma_f32_16x16x32_bf16 v[68:71], a[216:219], a[68:71], v[68:71]
    s_add_u32 m0, s59, 32768
    ds_read_b64_tr_b16 a[230:231], v25 offset:1032
    v_mul_f32 v161, v40, v161
    v_mfma_f32_16x16x32_bf16 v[68:71], a[220:223], a[72:75], v[68:71]
    ds_read_b64_tr_b16 a[232:233], v25 offset:8200
    v_mul_f32 v226, v226, v162
    v_mfma_f32_16x16x32_bf16 v[68:71], a[224:227], a[76:79], v[68:71]
    buffer_load_dwordx4 v14, s[20:23], s62 offen offset:0 lds
    v_mfma_f32_16x16x32_bf16 v[84:87], a[224:227], a[92:95], v[84:87]
    ds_read_b64_tr_b16 a[234:235], v25 offset:9224
    v_mul_f32 v162, v40, v162
    v_mfma_f32_16x16x32_bf16 v[84:87], a[220:223], a[88:91], v[84:87]
    ds_read_b64_tr_b16 a[236:237], v25 offset:16392
    v_mul_f32 v227, v227, v163
    v_mfma_f32_16x16x32_bf16 v[84:87], a[216:219], a[84:87], v[84:87]
    ds_read_b64_tr_b16 a[238:239], v25 offset:17416
    v_mul_f32 v163, v40, v163
    v_mfma_f32_16x16x32_bf16 v[84:87], a[212:215], a[80:83], v[84:87]
    buffer_store_dwordx4 v[128:131], v28, s[28:31], s64 offen sc1
    v_mfma_f32_16x16x32_bf16 v[100:103], a[212:215], a[96:99], v[100:103]
    ds_read_b64_tr_b16 a[240:241], v25 offset:24584
    v_mul_f32 v240, v240, v176
    v_mfma_f32_16x16x32_bf16 v[100:103], a[216:219], a[100:103], v[100:103]
    ds_read_b64_tr_b16 a[242:243], v25 offset:25608
    v_mul_f32 v176, v40, v176
    v_mfma_f32_16x16x32_bf16 v[100:103], a[220:223], a[104:107], v[100:103]
    v_exp_f32 v160, v160
    v_mfma_f32_16x16x32_bf16 v[100:103], a[224:227], a[108:111], v[100:103]
    v_exp_f32 v161, v161
    v_mfma_f32_16x16x32_bf16 v[116:119], a[224:227], a[124:127], v[116:119]
    v_exp_f32 v162, v162
    v_mfma_f32_16x16x32_bf16 v[116:119], a[220:223], a[120:123], v[116:119]
    v_exp_f32 v163, v163
    v_mfma_f32_16x16x32_bf16 v[116:119], a[216:219], a[116:119], v[116:119]
    buffer_load_dwordx4 v15, s[20:23], s62 offen offset:1024 lds
    v_mfma_f32_16x16x32_bf16 v[116:119], a[212:215], a[112:115], v[116:119]
    s_waitcnt lgkmcnt(0)
    v_exp_f32 v176, v176
    v_mfma_f32_16x16x32_bf16 a[132:135], a[228:231], a[64:67], a[132:135]
    ds_read_b64_tr_b16 a[212:213], v26 offset:0
    v_accvgpr_read_b32 v22, a200
    v_mfma_f32_16x16x32_bf16 a[132:135], a[232:235], a[68:71], a[132:135]
    ds_read_b64_tr_b16 a[214:215], v26 offset:1024
    v_accvgpr_read_b32 v23, a201
    v_mfma_f32_16x16x32_bf16 a[132:135], a[236:239], a[72:75], a[132:135]
    ds_read_b64_tr_b16 a[216:217], v26 offset:8192
    v_add_f32 v22, v22, v23
    v_mfma_f32_16x16x32_bf16 a[132:135], a[240:243], a[76:79], a[132:135]
    ds_write_b32 v21, v22 offset:0
    v_accvgpr_read_b32 v22, a204
    v_mfma_f32_16x16x32_bf16 a[148:151], a[240:243], a[92:95], a[148:151]
    ds_read_b64_tr_b16 a[218:219], v26 offset:9216
    v_accvgpr_read_b32 v23, a205
    v_mfma_f32_16x16x32_bf16 a[148:151], a[236:239], a[88:91], a[148:151]
    ds_read_b64_tr_b16 a[220:221], v26 offset:16384
    v_add_f32 v22, v22, v23
    v_mfma_f32_16x16x32_bf16 a[148:151], a[232:235], a[84:87], a[148:151]
    ds_read_b64_tr_b16 a[222:223], v26 offset:17408
    v_mul_f32 v241, v241, v177
    v_mfma_f32_16x16x32_bf16 a[148:151], a[228:231], a[80:83], a[148:151]
    ds_write_b32 v21, v22 offset:64
    v_mul_f32 v177, v40, v177
    v_mfma_f32_16x16x32_bf16 a[164:167], a[228:231], a[96:99], a[164:167]
    ds_read_b64_tr_b16 a[224:225], v26 offset:24576
    v_mul_f32 v242, v242, v178
    v_mfma_f32_16x16x32_bf16 a[164:167], a[232:235], a[100:103], a[164:167]
    ds_read_b64_tr_b16 a[226:227], v26 offset:25600
    v_mul_f32 v178, v40, v178
    v_mfma_f32_16x16x32_bf16 a[164:167], a[236:239], a[104:107], a[164:167]
    buffer_load_dwordx4 v16, s[20:23], s62 offen offset:2048 lds
    v_mfma_f32_16x16x32_bf16 a[164:167], a[240:243], a[108:111], a[164:167]
    v_exp_f32 v177, v177
    v_mfma_f32_16x16x32_bf16 a[180:183], a[240:243], a[124:127], a[180:183]
    v_exp_f32 v178, v178
    v_mfma_f32_16x16x32_bf16 a[180:183], a[236:239], a[120:123], a[180:183]
    v_mul_f32 v243, v243, v179
    v_mul_f32 v179, v40, v179
    v_mfma_f32_16x16x32_bf16 a[180:183], a[232:235], a[116:119], a[180:183]
    v_exp_f32 v179, v179
    v_mfma_f32_16x16x32_bf16 a[180:183], a[228:231], a[112:115], a[180:183]
    s_waitcnt lgkmcnt(0)
    v_fma_f32 v160, v160, v44, v44
    v_fma_f32 v161, v161, v44, v44
    v_mfma_f32_16x16x32_bf16 v[72:75], a[212:215], a[64:67], v[72:75]
    ds_read_b64_tr_b16 a[228:229], v26 offset:8
    v_fma_f32 v162, v162, v44, v44
    v_mfma_f32_16x16x32_bf16 v[72:75], a[216:219], a[68:71], v[72:75]
    ds_read_b64_tr_b16 a[230:231], v26 offset:1032
    v_fma_f32 v163, v163, v44, v44
    v_mfma_f32_16x16x32_bf16 v[72:75], a[220:223], a[72:75], v[72:75]
    ds_read_b64_tr_b16 a[232:233], v26 offset:8200
    v_fma_f32 v176, v176, v44, v44
    v_mfma_f32_16x16x32_bf16 v[72:75], a[224:227], a[76:79], v[72:75]
    buffer_load_dwordx4 v17, s[20:23], s62 offen offset:3072 lds
    v_mfma_f32_16x16x32_bf16 v[88:91], a[224:227], a[92:95], v[88:91]
    s_add_u32 s62, s62, 4096
    ds_read_b64_tr_b16 a[234:235], v26 offset:9224
    v_fma_f32 v177, v177, v44, v44
    v_mfma_f32_16x16x32_bf16 v[88:91], a[220:223], a[88:91], v[88:91]
    ds_read_b64_tr_b16 a[236:237], v26 offset:16392
    v_fma_f32 v178, v178, v44, v44
    v_mfma_f32_16x16x32_bf16 v[88:91], a[216:219], a[84:87], v[88:91]
    ds_read_b64_tr_b16 a[238:239], v26 offset:17416
    v_fma_f32 v179, v179, v44, v44
    v_mfma_f32_16x16x32_bf16 v[88:91], a[212:215], a[80:83], v[88:91]
    v_rcp_f32 v160, v160
    v_mfma_f32_16x16x32_bf16 v[104:107], a[212:215], a[96:99], v[104:107]
    ds_read_b64_tr_b16 a[240:241], v26 offset:24584
    v_mul_f32 v160, v160, v224
    v_mfma_f32_16x16x32_bf16 v[104:107], a[216:219], a[100:103], v[104:107]
    ds_read_b64_tr_b16 a[242:243], v26 offset:25608
    v_mul_f32 v196, v196, v132
    v_mfma_f32_16x16x32_bf16 v[104:107], a[220:223], a[104:107], v[104:107]
    v_rcp_f32 v161, v161
    v_mfma_f32_16x16x32_bf16 v[104:107], a[224:227], a[108:111], v[104:107]
    v_rcp_f32 v162, v162
    v_mfma_f32_16x16x32_bf16 v[120:123], a[224:227], a[124:127], v[120:123]
    v_rcp_f32 v163, v163
    v_mfma_f32_16x16x32_bf16 v[120:123], a[220:223], a[120:123], v[120:123]
    v_rcp_f32 v176, v176
    v_mfma_f32_16x16x32_bf16 v[120:123], a[216:219], a[116:119], v[120:123]
    s_add_u32 m0, s59, 36864
    v_rcp_f32 v177, v177
    v_mfma_f32_16x16x32_bf16 v[120:123], a[212:215], a[112:115], v[120:123]
    s_waitcnt lgkmcnt(0)
    buffer_load_dwordx4 v14, s[20:23], s62 offen offset:0 lds
    v_mfma_f32_16x16x32_bf16 a[136:139], a[228:231], a[64:67], a[136:139]
    ds_read_b64_tr_b16 a[212:213], v27 offset:0
    v_mul_f32 v161, v161, v225
    v_mfma_f32_16x16x32_bf16 a[136:139], a[232:235], a[68:71], a[136:139]
    ds_read_b64_tr_b16 a[214:215], v27 offset:1024
    v_mul_f32 v162, v162, v226
    v_mfma_f32_16x16x32_bf16 a[136:139], a[236:239], a[72:75], a[136:139]
    ds_read_b64_tr_b16 a[216:217], v27 offset:8192
    v_mul_f32 v163, v163, v227
    v_mfma_f32_16x16x32_bf16 a[136:139], a[240:243], a[76:79], a[136:139]
    v_rcp_f32 v178, v178
    v_mfma_f32_16x16x32_bf16 a[152:155], a[240:243], a[92:95], a[152:155]
    ds_read_b64_tr_b16 a[218:219], v27 offset:9216
    v_mul_f32 v176, v176, v240
    v_mfma_f32_16x16x32_bf16 a[152:155], a[236:239], a[88:91], a[152:155]
    ds_read_b64_tr_b16 a[220:221], v27 offset:16384
    v_mul_f32 v177, v177, v241
    v_mfma_f32_16x16x32_bf16 a[152:155], a[232:235], a[84:87], a[152:155]
    ds_read_b64_tr_b16 a[222:223], v27 offset:17408
    v_mul_f32 v178, v178, v242
    v_mfma_f32_16x16x32_bf16 a[152:155], a[228:231], a[80:83], a[152:155]
    v_rcp_f32 v179, v179
    v_mfma_f32_16x16x32_bf16 a[168:171], a[228:231], a[96:99], a[168:171]
    ds_read_b64_tr_b16 a[224:225], v27 offset:24576
    v_mul_f32 v179, v179, v243
    v_mfma_f32_16x16x32_bf16 a[168:171], a[232:235], a[100:103], a[168:171]
    ds_read_b64_tr_b16 a[226:227], v27 offset:25600
    v_cvt_pk_bf16_f32 v160, v160, v161
    v_mfma_f32_16x16x32_bf16 a[168:171], a[236:239], a[104:107], a[168:171]
    v_cvt_pk_bf16_f32 v161, v162, v163
    v_cvt_pk_bf16_f32 v162, v176, v177
    v_mfma_f32_16x16x32_bf16 a[168:171], a[240:243], a[108:111], a[168:171]
    buffer_load_dwordx4 v15, s[20:23], s62 offen offset:1024 lds
    v_mfma_f32_16x16x32_bf16 a[184:187], a[240:243], a[124:127], a[184:187]
    v_cvt_pk_bf16_f32 v163, v178, v179
    v_mul_f32 v132, v41, v132
    v_mfma_f32_16x16x32_bf16 a[184:187], a[236:239], a[120:123], a[184:187]
    buffer_store_dwordx4 v[160:163], v29, s[28:31], s64 offen sc1
    v_mfma_f32_16x16x32_bf16 a[184:187], a[232:235], a[116:119], a[184:187]
    s_add_u32 s64, s64, 188416
    v_exp_f32 v132, v132
    v_mfma_f32_16x16x32_bf16 a[184:187], a[228:231], a[112:115], a[184:187]
    s_waitcnt lgkmcnt(0)
    v_mul_f32 v197, v197, v133
    v_mul_f32 v133, v41, v133
    v_mfma_f32_16x16x32_bf16 v[76:79], a[212:215], a[64:67], v[76:79]
    ds_read_b64_tr_b16 a[228:229], v27 offset:8
    v_mul_f32 v198, v198, v134
    v_mfma_f32_16x16x32_bf16 v[76:79], a[216:219], a[68:71], v[76:79]
    ds_read_b64_tr_b16 a[230:231], v27 offset:1032
    v_mul_f32 v134, v41, v134
    v_mfma_f32_16x16x32_bf16 v[76:79], a[220:223], a[72:75], v[76:79]
    ds_read_b64_tr_b16 a[232:233], v27 offset:8200
    v_mul_f32 v199, v199, v135
    v_mfma_f32_16x16x32_bf16 v[76:79], a[224:227], a[76:79], v[76:79]
    v_exp_f32 v133, v133
    v_mfma_f32_16x16x32_bf16 v[92:95], a[224:227], a[92:95], v[92:95]
    ds_read_b64_tr_b16 a[234:235], v27 offset:9224
    v_mul_f32 v135, v41, v135
    v_mfma_f32_16x16x32_bf16 v[92:95], a[220:223], a[88:91], v[92:95]
    ds_read_b64_tr_b16 a[236:237], v27 offset:16392
    v_mul_f32 v212, v212, v148
    v_mfma_f32_16x16x32_bf16 v[92:95], a[216:219], a[84:87], v[92:95]
    ds_read_b64_tr_b16 a[238:239], v27 offset:17416
    v_mul_f32 v148, v41, v148
    v_mfma_f32_16x16x32_bf16 v[92:95], a[212:215], a[80:83], v[92:95]
    buffer_load_dwordx4 v16, s[20:23], s62 offen offset:2048 lds
    v_mfma_f32_16x16x32_bf16 v[108:111], a[212:215], a[96:99], v[108:111]
    ds_read_b64_tr_b16 a[240:241], v27 offset:24584
    v_mul_f32 v213, v213, v149
    v_mfma_f32_16x16x32_bf16 v[108:111], a[216:219], a[100:103], v[108:111]
    ds_read_b64_tr_b16 a[242:243], v27 offset:25608
    v_mul_f32 v149, v41, v149
    v_mfma_f32_16x16x32_bf16 v[108:111], a[220:223], a[104:107], v[108:111]
    v_exp_f32 v134, v134
    v_mfma_f32_16x16x32_bf16 v[108:111], a[224:227], a[108:111], v[108:111]
    v_exp_f32 v135, v135
    v_mfma_f32_16x16x32_bf16 v[124:127], a[224:227], a[124:127], v[124:127]
    v_exp_f32 v148, v148
    v_mfma_f32_16x16x32_bf16 v[124:127], a[220:223], a[120:123], v[124:127]
    v_exp_f32 v149, v149
    v_mfma_f32_16x16x32_bf16 v[124:127], a[216:219], a[116:119], v[124:127]
    v_mul_f32 v214, v214, v150
    v_mul_f32 v150, v41, v150
    v_mfma_f32_16x16x32_bf16 v[124:127], a[212:215], a[112:115], v[124:127]
    s_waitcnt lgkmcnt(0)
    v_exp_f32 v150, v150
    v_mfma_f32_16x16x32_bf16 a[140:143], a[228:231], a[64:67], a[140:143]
    s_waitcnt vmcnt(17) lgkmcnt(15)
    v_mul_f32 v215, v215, v151
    v_mul_f32 v151, v41, v151
    v_mfma_f32_16x16x32_bf16 a[140:143], a[232:235], a[68:71], a[140:143]
    s_barrier
    buffer_load_dwordx4 v17, s[20:23], s62 offen offset:3072 lds
    v_mfma_f32_16x16x32_bf16 a[140:143], a[236:239], a[72:75], a[140:143]
    s_add_u32 s62, s62, 28672
    ds_read_b128 a[212:215], v2 offset:0
    v_fma_f32 v132, v132, v45, v45
    v_mfma_f32_16x16x32_bf16 a[140:143], a[240:243], a[76:79], a[140:143]
    ds_read_b128 a[216:219], v3 offset:0
    v_fma_f32 v133, v133, v45, v45
    v_mfma_f32_16x16x32_bf16 a[156:159], a[240:243], a[92:95], a[156:159]
    ds_read_b128 a[220:223], v4 offset:0
    v_fma_f32 v134, v134, v45, v45
    v_mfma_f32_16x16x32_bf16 a[156:159], a[236:239], a[88:91], a[156:159]
    ds_read_b128 a[224:227], v5 offset:0
    v_fma_f32 v135, v135, v45, v45
    v_mfma_f32_16x16x32_bf16 a[156:159], a[232:235], a[84:87], a[156:159]
    v_exp_f32 v151, v151
    v_mfma_f32_16x16x32_bf16 a[156:159], a[228:231], a[80:83], a[156:159]
    v_rcp_f32 v132, v132
    v_mfma_f32_16x16x32_bf16 a[172:175], a[228:231], a[96:99], a[172:175]
    v_rcp_f32 v133, v133
    v_mfma_f32_16x16x32_bf16 a[172:175], a[232:235], a[100:103], a[172:175]
    v_rcp_f32 v134, v134
    v_mfma_f32_16x16x32_bf16 a[172:175], a[236:239], a[104:107], a[172:175]
    v_rcp_f32 v135, v135
    v_mfma_f32_16x16x32_bf16 a[172:175], a[240:243], a[108:111], a[172:175]
    v_fma_f32 v148, v148, v45, v45
    v_fma_f32 v149, v149, v45, v45
    v_mfma_f32_16x16x32_bf16 a[188:191], a[240:243], a[124:127], a[188:191]
    v_rcp_f32 v148, v148
    v_mfma_f32_16x16x32_bf16 a[188:191], a[236:239], a[120:123], a[188:191]
    v_rcp_f32 v149, v149
    v_mfma_f32_16x16x32_bf16 a[188:191], a[232:235], a[116:119], a[188:191]
    v_fma_f32 v150, v150, v45, v45
    v_fma_f32 v151, v151, v45, v45
    v_mfma_f32_16x16x32_bf16 a[188:191], a[228:231], a[112:115], a[188:191]
    v_rcp_f32 v150, v150
    v_xor_b32 v24, 0, v30
    v_xor_b32 v25, 128, v30
    v_xor_b32 v26, 256, v30
    v_xor_b32 v27, 384, v30
    ds_read_b128 v[48:51], v24 offset:0
    ds_read_b128 v[52:55], v24 offset:64
    ds_read_b128 v[56:59], v25 offset:0
    ds_read_b128 v[60:63], v25 offset:64
    v_mul_f32 v132, v132, v196
    v_mul_f32 v133, v133, v197
    v_mul_f32 v134, v134, v198
    v_mul_f32 v135, v135, v199
    v_mul_f32 v148, v148, v212
    v_rcp_f32 v151, v151
    v_mul_f32 v149, v149, v213
    v_mul_f32 v150, v150, v214
    v_mul_f32 v151, v151, v215
    v_cvt_pk_bf16_f32 v132, v132, v133
    v_cvt_pk_bf16_f32 v133, v134, v135
    v_cvt_pk_bf16_f32 v134, v148, v149
    v_cvt_pk_bf16_f32 v135, v150, v151
    buffer_store_dwordx4 v[132:135], v28, s[28:31], s64 offen sc1
    s_waitcnt lgkmcnt(2)
    v_accvgpr_read_b32 v192, a128
    v_accvgpr_read_b32 v193, a129
    v_accvgpr_read_b32 v194, a130
    v_accvgpr_read_b32 v195, a131
    v_pk_fma_f32 v[64:65], v[48:49], v[32:33], v[64:65] op_sel:[0,0,0] op_sel_hi:[1,0,1]
    v_pk_fma_f32 v[66:67], v[50:51], v[32:33], v[66:67] op_sel:[0,0,0] op_sel_hi:[1,0,1]
    v_pk_fma_f32 v[192:193], v[52:53], v[32:33], v[192:193] op_sel:[0,0,0] op_sel_hi:[1,0,1]
    v_pk_fma_f32 v[194:195], v[54:55], v[32:33], v[194:195] op_sel:[0,0,0] op_sel_hi:[1,0,1]
    v_pk_mul_f32 v[64:65], v[64:65], v[36:37] op_sel:[0,0] op_sel_hi:[1,0]
    v_pk_mul_f32 v[66:67], v[66:67], v[36:37] op_sel:[0,0] op_sel_hi:[1,0]
    v_pk_mul_f32 v[192:193], v[192:193], v[36:37] op_sel:[0,0] op_sel_hi:[1,0]
    v_pk_mul_f32 v[194:195], v[194:195], v[36:37] op_sel:[0,0] op_sel_hi:[1,0]
    v_cvt_pk_bf16_f32 v64, v64, v65
    v_cvt_pk_bf16_f32 v65, v66, v67
    v_cvt_pk_bf16_f32 v66, v192, v193
    v_cvt_pk_bf16_f32 v67, v194, v195
    v_accvgpr_read_b32 v208, a144
    v_accvgpr_read_b32 v209, a145
    v_accvgpr_read_b32 v210, a146
    v_accvgpr_read_b32 v211, a147
    v_pk_fma_f32 v[80:81], v[48:49], v[32:33], v[80:81] op_sel:[0,1,0] op_sel_hi:[1,1,1]
    v_pk_fma_f32 v[82:83], v[50:51], v[32:33], v[82:83] op_sel:[0,1,0] op_sel_hi:[1,1,1]
    v_pk_fma_f32 v[208:209], v[52:53], v[32:33], v[208:209] op_sel:[0,1,0] op_sel_hi:[1,1,1]
    v_pk_fma_f32 v[210:211], v[54:55], v[32:33], v[210:211] op_sel:[0,1,0] op_sel_hi:[1,1,1]
    v_pk_mul_f32 v[80:81], v[80:81], v[36:37] op_sel:[0,1] op_sel_hi:[1,1]
    v_pk_mul_f32 v[82:83], v[82:83], v[36:37] op_sel:[0,1] op_sel_hi:[1,1]
    v_pk_mul_f32 v[208:209], v[208:209], v[36:37] op_sel:[0,1] op_sel_hi:[1,1]
    v_pk_mul_f32 v[210:211], v[210:211], v[36:37] op_sel:[0,1] op_sel_hi:[1,1]
    v_cvt_pk_bf16_f32 v80, v80, v81
    v_cvt_pk_bf16_f32 v81, v82, v83
    v_cvt_pk_bf16_f32 v82, v208, v209
    v_cvt_pk_bf16_f32 v83, v210, v211
    v_accvgpr_read_b32 v192, a160
    v_accvgpr_read_b32 v193, a161
    v_accvgpr_read_b32 v194, a162
    v_accvgpr_read_b32 v195, a163
    v_pk_fma_f32 v[96:97], v[48:49], v[34:35], v[96:97] op_sel:[0,0,0] op_sel_hi:[1,0,1]
    v_pk_fma_f32 v[98:99], v[50:51], v[34:35], v[98:99] op_sel:[0,0,0] op_sel_hi:[1,0,1]
    v_pk_fma_f32 v[192:193], v[52:53], v[34:35], v[192:193] op_sel:[0,0,0] op_sel_hi:[1,0,1]
    v_pk_fma_f32 v[194:195], v[54:55], v[34:35], v[194:195] op_sel:[0,0,0] op_sel_hi:[1,0,1]
    v_pk_mul_f32 v[96:97], v[96:97], v[38:39] op_sel:[0,0] op_sel_hi:[1,0]
    v_pk_mul_f32 v[98:99], v[98:99], v[38:39] op_sel:[0,0] op_sel_hi:[1,0]
    v_pk_mul_f32 v[192:193], v[192:193], v[38:39] op_sel:[0,0] op_sel_hi:[1,0]
    v_pk_mul_f32 v[194:195], v[194:195], v[38:39] op_sel:[0,0] op_sel_hi:[1,0]
    v_cvt_pk_bf16_f32 v96, v96, v97
    v_cvt_pk_bf16_f32 v97, v98, v99
    v_cvt_pk_bf16_f32 v98, v192, v193
    v_cvt_pk_bf16_f32 v99, v194, v195
    v_accvgpr_read_b32 v208, a176
    v_accvgpr_read_b32 v209, a177
    v_accvgpr_read_b32 v210, a178
    v_accvgpr_read_b32 v211, a179
    v_pk_fma_f32 v[112:113], v[48:49], v[34:35], v[112:113] op_sel:[0,1,0] op_sel_hi:[1,1,1]
    v_pk_fma_f32 v[114:115], v[50:51], v[34:35], v[114:115] op_sel:[0,1,0] op_sel_hi:[1,1,1]
    v_pk_fma_f32 v[208:209], v[52:53], v[34:35], v[208:209] op_sel:[0,1,0] op_sel_hi:[1,1,1]
    v_pk_fma_f32 v[210:211], v[54:55], v[34:35], v[210:211] op_sel:[0,1,0] op_sel_hi:[1,1,1]
    v_pk_mul_f32 v[112:113], v[112:113], v[38:39] op_sel:[0,1] op_sel_hi:[1,1]
    v_pk_mul_f32 v[114:115], v[114:115], v[38:39] op_sel:[0,1] op_sel_hi:[1,1]
    v_pk_mul_f32 v[208:209], v[208:209], v[38:39] op_sel:[0,1] op_sel_hi:[1,1]
    v_pk_mul_f32 v[210:211], v[210:211], v[38:39] op_sel:[0,1] op_sel_hi:[1,1]
    v_cvt_pk_bf16_f32 v112, v112, v113
    v_cvt_pk_bf16_f32 v113, v114, v115
    v_cvt_pk_bf16_f32 v114, v208, v209
    v_cvt_pk_bf16_f32 v115, v210, v211
    ds_read_b128 v[48:51], v26 offset:0
    ds_read_b128 v[52:55], v26 offset:64
    s_waitcnt lgkmcnt(2)
    v_accvgpr_read_b32 v192, a132
    v_accvgpr_read_b32 v193, a133
    v_accvgpr_read_b32 v194, a134
    v_accvgpr_read_b32 v195, a135
    v_pk_fma_f32 v[68:69], v[56:57], v[32:33], v[68:69] op_sel:[0,0,0] op_sel_hi:[1,0,1]
    v_pk_fma_f32 v[70:71], v[58:59], v[32:33], v[70:71] op_sel:[0,0,0] op_sel_hi:[1,0,1]
    v_pk_fma_f32 v[192:193], v[60:61], v[32:33], v[192:193] op_sel:[0,0,0] op_sel_hi:[1,0,1]
    v_pk_fma_f32 v[194:195], v[62:63], v[32:33], v[194:195] op_sel:[0,0,0] op_sel_hi:[1,0,1]
    v_pk_mul_f32 v[68:69], v[68:69], v[36:37] op_sel:[0,0] op_sel_hi:[1,0]
    v_pk_mul_f32 v[70:71], v[70:71], v[36:37] op_sel:[0,0] op_sel_hi:[1,0]
    v_pk_mul_f32 v[192:193], v[192:193], v[36:37] op_sel:[0,0] op_sel_hi:[1,0]
    v_pk_mul_f32 v[194:195], v[194:195], v[36:37] op_sel:[0,0] op_sel_hi:[1,0]
    v_cvt_pk_bf16_f32 v68, v68, v69
    v_cvt_pk_bf16_f32 v69, v70, v71
    v_cvt_pk_bf16_f32 v70, v192, v193
    v_cvt_pk_bf16_f32 v71, v194, v195
    v_accvgpr_read_b32 v208, a148
    v_accvgpr_read_b32 v209, a149
    v_accvgpr_read_b32 v210, a150
    v_accvgpr_read_b32 v211, a151
    v_pk_fma_f32 v[84:85], v[56:57], v[32:33], v[84:85] op_sel:[0,1,0] op_sel_hi:[1,1,1]
    v_pk_fma_f32 v[86:87], v[58:59], v[32:33], v[86:87] op_sel:[0,1,0] op_sel_hi:[1,1,1]
    v_pk_fma_f32 v[208:209], v[60:61], v[32:33], v[208:209] op_sel:[0,1,0] op_sel_hi:[1,1,1]
    v_pk_fma_f32 v[210:211], v[62:63], v[32:33], v[210:211] op_sel:[0,1,0] op_sel_hi:[1,1,1]
    v_pk_mul_f32 v[84:85], v[84:85], v[36:37] op_sel:[0,1] op_sel_hi:[1,1]
    v_pk_mul_f32 v[86:87], v[86:87], v[36:37] op_sel:[0,1] op_sel_hi:[1,1]
    v_pk_mul_f32 v[208:209], v[208:209], v[36:37] op_sel:[0,1] op_sel_hi:[1,1]
    v_pk_mul_f32 v[210:211], v[210:211], v[36:37] op_sel:[0,1] op_sel_hi:[1,1]
    v_cvt_pk_bf16_f32 v84, v84, v85
    v_cvt_pk_bf16_f32 v85, v86, v87
    v_cvt_pk_bf16_f32 v86, v208, v209
    v_cvt_pk_bf16_f32 v87, v210, v211
    v_accvgpr_read_b32 v192, a164
    v_accvgpr_read_b32 v193, a165
    v_accvgpr_read_b32 v194, a166
    v_accvgpr_read_b32 v195, a167
    v_pk_fma_f32 v[100:101], v[56:57], v[34:35], v[100:101] op_sel:[0,0,0] op_sel_hi:[1,0,1]
    v_pk_fma_f32 v[102:103], v[58:59], v[34:35], v[102:103] op_sel:[0,0,0] op_sel_hi:[1,0,1]
    v_pk_fma_f32 v[192:193], v[60:61], v[34:35], v[192:193] op_sel:[0,0,0] op_sel_hi:[1,0,1]
    v_pk_fma_f32 v[194:195], v[62:63], v[34:35], v[194:195] op_sel:[0,0,0] op_sel_hi:[1,0,1]
    v_pk_mul_f32 v[100:101], v[100:101], v[38:39] op_sel:[0,0] op_sel_hi:[1,0]
    v_pk_mul_f32 v[102:103], v[102:103], v[38:39] op_sel:[0,0] op_sel_hi:[1,0]
    v_pk_mul_f32 v[192:193], v[192:193], v[38:39] op_sel:[0,0] op_sel_hi:[1,0]
    v_pk_mul_f32 v[194:195], v[194:195], v[38:39] op_sel:[0,0] op_sel_hi:[1,0]
    v_cvt_pk_bf16_f32 v100, v100, v101
    v_cvt_pk_bf16_f32 v101, v102, v103
    v_cvt_pk_bf16_f32 v102, v192, v193
    v_cvt_pk_bf16_f32 v103, v194, v195
    v_accvgpr_read_b32 v208, a180
    v_accvgpr_read_b32 v209, a181
    v_accvgpr_read_b32 v210, a182
    v_accvgpr_read_b32 v211, a183
    v_pk_fma_f32 v[116:117], v[56:57], v[34:35], v[116:117] op_sel:[0,1,0] op_sel_hi:[1,1,1]
    v_pk_fma_f32 v[118:119], v[58:59], v[34:35], v[118:119] op_sel:[0,1,0] op_sel_hi:[1,1,1]
    v_pk_fma_f32 v[208:209], v[60:61], v[34:35], v[208:209] op_sel:[0,1,0] op_sel_hi:[1,1,1]
    v_pk_fma_f32 v[210:211], v[62:63], v[34:35], v[210:211] op_sel:[0,1,0] op_sel_hi:[1,1,1]
    v_pk_mul_f32 v[116:117], v[116:117], v[38:39] op_sel:[0,1] op_sel_hi:[1,1]
    v_pk_mul_f32 v[118:119], v[118:119], v[38:39] op_sel:[0,1] op_sel_hi:[1,1]
    v_pk_mul_f32 v[208:209], v[208:209], v[38:39] op_sel:[0,1] op_sel_hi:[1,1]
    v_pk_mul_f32 v[210:211], v[210:211], v[38:39] op_sel:[0,1] op_sel_hi:[1,1]
    v_cvt_pk_bf16_f32 v116, v116, v117
    v_cvt_pk_bf16_f32 v117, v118, v119
    v_cvt_pk_bf16_f32 v118, v208, v209
    v_cvt_pk_bf16_f32 v119, v210, v211
    ds_read_b128 v[56:59], v27 offset:0
    ds_read_b128 v[60:63], v27 offset:64
    s_waitcnt lgkmcnt(2)
    v_accvgpr_read_b32 v192, a136
    v_accvgpr_read_b32 v193, a137
    v_accvgpr_read_b32 v194, a138
    v_accvgpr_read_b32 v195, a139
    v_pk_fma_f32 v[72:73], v[48:49], v[32:33], v[72:73] op_sel:[0,0,0] op_sel_hi:[1,0,1]
    v_pk_fma_f32 v[74:75], v[50:51], v[32:33], v[74:75] op_sel:[0,0,0] op_sel_hi:[1,0,1]
    v_pk_fma_f32 v[192:193], v[52:53], v[32:33], v[192:193] op_sel:[0,0,0] op_sel_hi:[1,0,1]
    v_pk_fma_f32 v[194:195], v[54:55], v[32:33], v[194:195] op_sel:[0,0,0] op_sel_hi:[1,0,1]
    v_pk_mul_f32 v[72:73], v[72:73], v[36:37] op_sel:[0,0] op_sel_hi:[1,0]
    v_pk_mul_f32 v[74:75], v[74:75], v[36:37] op_sel:[0,0] op_sel_hi:[1,0]
    v_pk_mul_f32 v[192:193], v[192:193], v[36:37] op_sel:[0,0] op_sel_hi:[1,0]
    v_pk_mul_f32 v[194:195], v[194:195], v[36:37] op_sel:[0,0] op_sel_hi:[1,0]
    v_cvt_pk_bf16_f32 v72, v72, v73
    v_cvt_pk_bf16_f32 v73, v74, v75
    v_cvt_pk_bf16_f32 v74, v192, v193
    v_cvt_pk_bf16_f32 v75, v194, v195
    v_accvgpr_read_b32 v208, a152
    v_accvgpr_read_b32 v209, a153
    v_accvgpr_read_b32 v210, a154
    v_accvgpr_read_b32 v211, a155
    v_pk_fma_f32 v[88:89], v[48:49], v[32:33], v[88:89] op_sel:[0,1,0] op_sel_hi:[1,1,1]
    v_pk_fma_f32 v[90:91], v[50:51], v[32:33], v[90:91] op_sel:[0,1,0] op_sel_hi:[1,1,1]
    v_pk_fma_f32 v[208:209], v[52:53], v[32:33], v[208:209] op_sel:[0,1,0] op_sel_hi:[1,1,1]
    v_pk_fma_f32 v[210:211], v[54:55], v[32:33], v[210:211] op_sel:[0,1,0] op_sel_hi:[1,1,1]
    v_pk_mul_f32 v[88:89], v[88:89], v[36:37] op_sel:[0,1] op_sel_hi:[1,1]
    v_pk_mul_f32 v[90:91], v[90:91], v[36:37] op_sel:[0,1] op_sel_hi:[1,1]
    v_pk_mul_f32 v[208:209], v[208:209], v[36:37] op_sel:[0,1] op_sel_hi:[1,1]
    v_pk_mul_f32 v[210:211], v[210:211], v[36:37] op_sel:[0,1] op_sel_hi:[1,1]
    v_cvt_pk_bf16_f32 v88, v88, v89
    v_cvt_pk_bf16_f32 v89, v90, v91
    v_cvt_pk_bf16_f32 v90, v208, v209
    v_cvt_pk_bf16_f32 v91, v210, v211
    v_accvgpr_read_b32 v192, a168
    v_accvgpr_read_b32 v193, a169
    v_accvgpr_read_b32 v194, a170
    v_accvgpr_read_b32 v195, a171
    v_pk_fma_f32 v[104:105], v[48:49], v[34:35], v[104:105] op_sel:[0,0,0] op_sel_hi:[1,0,1]
    v_pk_fma_f32 v[106:107], v[50:51], v[34:35], v[106:107] op_sel:[0,0,0] op_sel_hi:[1,0,1]
    v_pk_fma_f32 v[192:193], v[52:53], v[34:35], v[192:193] op_sel:[0,0,0] op_sel_hi:[1,0,1]
    v_pk_fma_f32 v[194:195], v[54:55], v[34:35], v[194:195] op_sel:[0,0,0] op_sel_hi:[1,0,1]
    v_pk_mul_f32 v[104:105], v[104:105], v[38:39] op_sel:[0,0] op_sel_hi:[1,0]
    v_pk_mul_f32 v[106:107], v[106:107], v[38:39] op_sel:[0,0] op_sel_hi:[1,0]
    v_pk_mul_f32 v[192:193], v[192:193], v[38:39] op_sel:[0,0] op_sel_hi:[1,0]
    v_pk_mul_f32 v[194:195], v[194:195], v[38:39] op_sel:[0,0] op_sel_hi:[1,0]
    v_cvt_pk_bf16_f32 v104, v104, v105
    v_cvt_pk_bf16_f32 v105, v106, v107
    v_cvt_pk_bf16_f32 v106, v192, v193
    v_cvt_pk_bf16_f32 v107, v194, v195
    v_accvgpr_read_b32 v208, a184
    v_accvgpr_read_b32 v209, a185
    v_accvgpr_read_b32 v210, a186
    v_accvgpr_read_b32 v211, a187
    v_pk_fma_f32 v[120:121], v[48:49], v[34:35], v[120:121] op_sel:[0,1,0] op_sel_hi:[1,1,1]
    v_pk_fma_f32 v[122:123], v[50:51], v[34:35], v[122:123] op_sel:[0,1,0] op_sel_hi:[1,1,1]
    v_pk_fma_f32 v[208:209], v[52:53], v[34:35], v[208:209] op_sel:[0,1,0] op_sel_hi:[1,1,1]
    v_pk_fma_f32 v[210:211], v[54:55], v[34:35], v[210:211] op_sel:[0,1,0] op_sel_hi:[1,1,1]
    v_pk_mul_f32 v[120:121], v[120:121], v[38:39] op_sel:[0,1] op_sel_hi:[1,1]
    v_pk_mul_f32 v[122:123], v[122:123], v[38:39] op_sel:[0,1] op_sel_hi:[1,1]
    v_pk_mul_f32 v[208:209], v[208:209], v[38:39] op_sel:[0,1] op_sel_hi:[1,1]
    v_pk_mul_f32 v[210:211], v[210:211], v[38:39] op_sel:[0,1] op_sel_hi:[1,1]
    v_cvt_pk_bf16_f32 v120, v120, v121
    v_cvt_pk_bf16_f32 v121, v122, v123
    v_cvt_pk_bf16_f32 v122, v208, v209
    v_cvt_pk_bf16_f32 v123, v210, v211
    s_waitcnt lgkmcnt(0)
    v_accvgpr_read_b32 v192, a140
    v_accvgpr_read_b32 v193, a141
    v_accvgpr_read_b32 v194, a142
    v_accvgpr_read_b32 v195, a143
    v_pk_fma_f32 v[76:77], v[56:57], v[32:33], v[76:77] op_sel:[0,0,0] op_sel_hi:[1,0,1]
    v_pk_fma_f32 v[78:79], v[58:59], v[32:33], v[78:79] op_sel:[0,0,0] op_sel_hi:[1,0,1]
    v_pk_fma_f32 v[192:193], v[60:61], v[32:33], v[192:193] op_sel:[0,0,0] op_sel_hi:[1,0,1]
    v_pk_fma_f32 v[194:195], v[62:63], v[32:33], v[194:195] op_sel:[0,0,0] op_sel_hi:[1,0,1]
    v_pk_mul_f32 v[76:77], v[76:77], v[36:37] op_sel:[0,0] op_sel_hi:[1,0]
    v_pk_mul_f32 v[78:79], v[78:79], v[36:37] op_sel:[0,0] op_sel_hi:[1,0]
    v_pk_mul_f32 v[192:193], v[192:193], v[36:37] op_sel:[0,0] op_sel_hi:[1,0]
    v_pk_mul_f32 v[194:195], v[194:195], v[36:37] op_sel:[0,0] op_sel_hi:[1,0]
    v_cvt_pk_bf16_f32 v76, v76, v77
    v_cvt_pk_bf16_f32 v77, v78, v79
    v_cvt_pk_bf16_f32 v78, v192, v193
    v_cvt_pk_bf16_f32 v79, v194, v195
    v_accvgpr_read_b32 v208, a156
    v_accvgpr_read_b32 v209, a157
    v_accvgpr_read_b32 v210, a158
    v_accvgpr_read_b32 v211, a159
    v_pk_fma_f32 v[92:93], v[56:57], v[32:33], v[92:93] op_sel:[0,1,0] op_sel_hi:[1,1,1]
    v_pk_fma_f32 v[94:95], v[58:59], v[32:33], v[94:95] op_sel:[0,1,0] op_sel_hi:[1,1,1]
    v_pk_fma_f32 v[208:209], v[60:61], v[32:33], v[208:209] op_sel:[0,1,0] op_sel_hi:[1,1,1]
    v_pk_fma_f32 v[210:211], v[62:63], v[32:33], v[210:211] op_sel:[0,1,0] op_sel_hi:[1,1,1]
    v_pk_mul_f32 v[92:93], v[92:93], v[36:37] op_sel:[0,1] op_sel_hi:[1,1]
    v_pk_mul_f32 v[94:95], v[94:95], v[36:37] op_sel:[0,1] op_sel_hi:[1,1]
    v_pk_mul_f32 v[208:209], v[208:209], v[36:37] op_sel:[0,1] op_sel_hi:[1,1]
    v_pk_mul_f32 v[210:211], v[210:211], v[36:37] op_sel:[0,1] op_sel_hi:[1,1]
    v_cvt_pk_bf16_f32 v92, v92, v93
    v_cvt_pk_bf16_f32 v93, v94, v95
    v_cvt_pk_bf16_f32 v94, v208, v209
    v_cvt_pk_bf16_f32 v95, v210, v211
    v_accvgpr_read_b32 v192, a172
    v_accvgpr_read_b32 v193, a173
    v_accvgpr_read_b32 v194, a174
    v_accvgpr_read_b32 v195, a175
    v_pk_fma_f32 v[108:109], v[56:57], v[34:35], v[108:109] op_sel:[0,0,0] op_sel_hi:[1,0,1]
    v_pk_fma_f32 v[110:111], v[58:59], v[34:35], v[110:111] op_sel:[0,0,0] op_sel_hi:[1,0,1]
    v_pk_fma_f32 v[192:193], v[60:61], v[34:35], v[192:193] op_sel:[0,0,0] op_sel_hi:[1,0,1]
    v_pk_fma_f32 v[194:195], v[62:63], v[34:35], v[194:195] op_sel:[0,0,0] op_sel_hi:[1,0,1]
    v_pk_mul_f32 v[108:109], v[108:109], v[38:39] op_sel:[0,0] op_sel_hi:[1,0]
    v_pk_mul_f32 v[110:111], v[110:111], v[38:39] op_sel:[0,0] op_sel_hi:[1,0]
    v_pk_mul_f32 v[192:193], v[192:193], v[38:39] op_sel:[0,0] op_sel_hi:[1,0]
    v_pk_mul_f32 v[194:195], v[194:195], v[38:39] op_sel:[0,0] op_sel_hi:[1,0]
    v_cvt_pk_bf16_f32 v108, v108, v109
    v_cvt_pk_bf16_f32 v109, v110, v111
    v_cvt_pk_bf16_f32 v110, v192, v193
    v_cvt_pk_bf16_f32 v111, v194, v195
    v_accvgpr_read_b32 v208, a188
    v_accvgpr_read_b32 v209, a189
    v_accvgpr_read_b32 v210, a190
    v_accvgpr_read_b32 v211, a191
    v_pk_fma_f32 v[124:125], v[56:57], v[34:35], v[124:125] op_sel:[0,1,0] op_sel_hi:[1,1,1]
    v_pk_fma_f32 v[126:127], v[58:59], v[34:35], v[126:127] op_sel:[0,1,0] op_sel_hi:[1,1,1]
    v_pk_fma_f32 v[208:209], v[60:61], v[34:35], v[208:209] op_sel:[0,1,0] op_sel_hi:[1,1,1]
    v_pk_fma_f32 v[210:211], v[62:63], v[34:35], v[210:211] op_sel:[0,1,0] op_sel_hi:[1,1,1]
    v_pk_mul_f32 v[124:125], v[124:125], v[38:39] op_sel:[0,1] op_sel_hi:[1,1]
    v_pk_mul_f32 v[126:127], v[126:127], v[38:39] op_sel:[0,1] op_sel_hi:[1,1]
    v_pk_mul_f32 v[208:209], v[208:209], v[38:39] op_sel:[0,1] op_sel_hi:[1,1]
    v_pk_mul_f32 v[210:211], v[210:211], v[38:39] op_sel:[0,1] op_sel_hi:[1,1]
    v_cvt_pk_bf16_f32 v124, v124, v125
    v_cvt_pk_bf16_f32 v125, v126, v127
    v_cvt_pk_bf16_f32 v126, v208, v209
    v_cvt_pk_bf16_f32 v127, v210, v211
    v_pk_mul_f32 v[228:229], v[228:229], v[164:165]
    v_pk_mul_f32 v[164:165], v[164:165], v[40:41] op_sel:[0,1] op_sel_hi:[1,1]
    v_pk_mul_f32 v[230:231], v[230:231], v[166:167]
    v_pk_mul_f32 v[166:167], v[166:167], v[40:41] op_sel:[0,1] op_sel_hi:[1,1]
    v_pk_mul_f32 v[244:245], v[244:245], v[180:181]
    v_pk_mul_f32 v[180:181], v[180:181], v[40:41] op_sel:[0,1] op_sel_hi:[1,1]
    v_pk_mul_f32 v[246:247], v[246:247], v[182:183]
    v_pk_mul_f32 v[182:183], v[182:183], v[40:41] op_sel:[0,1] op_sel_hi:[1,1]
    v_exp_f32 v164, v164
    v_exp_f32 v165, v165
    v_mfma_f32_16x16x32_bf16 v[48:51], a[212:215], v[64:67], 0
    v_exp_f32 v166, v166
    v_mfma_f32_16x16x32_bf16 v[48:51], a[216:219], v[68:71], v[48:51]
    v_exp_f32 v167, v167
    v_mfma_f32_16x16x32_bf16 v[48:51], a[220:223], v[72:75], v[48:51]
    v_exp_f32 v180, v180
    v_exp_f32 v181, v181
    v_exp_f32 v182, v182
    v_exp_f32 v183, v183
    v_pk_fma_f32 v[164:165], v[164:165], v[44:45], v[44:45] op_sel:[0,1,1] op_sel_hi:[1,1,1]
    v_pk_fma_f32 v[166:167], v[166:167], v[44:45], v[44:45] op_sel:[0,1,1] op_sel_hi:[1,1,1]
    v_pk_fma_f32 v[180:181], v[180:181], v[44:45], v[44:45] op_sel:[0,1,1] op_sel_hi:[1,1,1]
    v_pk_fma_f32 v[182:183], v[182:183], v[44:45], v[44:45] op_sel:[0,1,1] op_sel_hi:[1,1,1]
    v_rcp_f32 v164, v164
    v_rcp_f32 v165, v165
    v_mfma_f32_16x16x32_bf16 v[48:51], a[224:227], v[76:79], v[48:51]
    v_rcp_f32 v166, v166
    v_mfma_f32_16x16x32_bf16 v[52:55], a[224:227], v[92:95], 0
    v_rcp_f32 v167, v167
    v_mfma_f32_16x16x32_bf16 v[52:55], a[220:223], v[88:91], v[52:55]
    v_rcp_f32 v180, v180
    v_rcp_f32 v181, v181
    v_rcp_f32 v182, v182
    v_rcp_f32 v183, v183
    v_pk_mul_f32 v[164:165], v[164:165], v[228:229]
    v_pk_mul_f32 v[166:167], v[166:167], v[230:231]
    v_pk_mul_f32 v[180:181], v[180:181], v[244:245]
    v_pk_mul_f32 v[182:183], v[182:183], v[246:247]
    v_cvt_pk_bf16_f32 v164, v164, v165
    v_cvt_pk_bf16_f32 v165, v166, v167
    v_cvt_pk_bf16_f32 v166, v180, v181
    v_cvt_pk_bf16_f32 v167, v182, v183
    buffer_store_dwordx4 v[164:167], v29, s[28:31], s64 offen sc1
    s_add_u32 s64, s64, 188416
    v_pk_mul_f32 v[200:201], v[200:201], v[136:137]
    v_pk_mul_f32 v[136:137], v[136:137], v[42:43] op_sel:[0,0] op_sel_hi:[1,0]
    v_pk_mul_f32 v[202:203], v[202:203], v[138:139]
    v_pk_mul_f32 v[138:139], v[138:139], v[42:43] op_sel:[0,0] op_sel_hi:[1,0]
    v_pk_mul_f32 v[216:217], v[216:217], v[152:153]
    v_pk_mul_f32 v[152:153], v[152:153], v[42:43] op_sel:[0,0] op_sel_hi:[1,0]
    v_pk_mul_f32 v[218:219], v[218:219], v[154:155]
    v_pk_mul_f32 v[154:155], v[154:155], v[42:43] op_sel:[0,0] op_sel_hi:[1,0]
    v_exp_f32 v136, v136
    v_exp_f32 v137, v137
    v_mfma_f32_16x16x32_bf16 v[52:55], a[216:219], v[84:87], v[52:55]
    v_exp_f32 v138, v138
    v_mfma_f32_16x16x32_bf16 v[52:55], a[212:215], v[80:83], v[52:55]
    v_exp_f32 v139, v139
    v_mfma_f32_16x16x32_bf16 v[56:59], a[212:215], v[96:99], 0
    v_exp_f32 v152, v152
    v_exp_f32 v153, v153
    v_exp_f32 v154, v154
    v_exp_f32 v155, v155
    v_pk_fma_f32 v[136:137], v[136:137], v[46:47], v[46:47] op_sel:[0,0,0] op_sel_hi:[1,0,0]
    v_pk_fma_f32 v[138:139], v[138:139], v[46:47], v[46:47] op_sel:[0,0,0] op_sel_hi:[1,0,0]
    v_pk_fma_f32 v[152:153], v[152:153], v[46:47], v[46:47] op_sel:[0,0,0] op_sel_hi:[1,0,0]
    v_pk_fma_f32 v[154:155], v[154:155], v[46:47], v[46:47] op_sel:[0,0,0] op_sel_hi:[1,0,0]
    v_rcp_f32 v136, v136
    v_rcp_f32 v137, v137
    v_mfma_f32_16x16x32_bf16 v[56:59], a[216:219], v[100:103], v[56:59]
    v_rcp_f32 v138, v138
    v_mfma_f32_16x16x32_bf16 v[56:59], a[220:223], v[104:107], v[56:59]
    v_rcp_f32 v139, v139
    v_mfma_f32_16x16x32_bf16 v[56:59], a[224:227], v[108:111], v[56:59]
    v_rcp_f32 v152, v152
    v_rcp_f32 v153, v153
    v_rcp_f32 v154, v154
    v_rcp_f32 v155, v155
    v_pk_mul_f32 v[136:137], v[136:137], v[200:201]
    v_pk_mul_f32 v[138:139], v[138:139], v[202:203]
    v_pk_mul_f32 v[152:153], v[152:153], v[216:217]
    v_pk_mul_f32 v[154:155], v[154:155], v[218:219]
    v_cvt_pk_bf16_f32 v136, v136, v137
    v_cvt_pk_bf16_f32 v137, v138, v139
    v_cvt_pk_bf16_f32 v138, v152, v153
    v_cvt_pk_bf16_f32 v139, v154, v155
    buffer_store_dwordx4 v[136:139], v28, s[28:31], s64 offen sc1
    v_pk_mul_f32 v[232:233], v[232:233], v[168:169]
    v_pk_mul_f32 v[168:169], v[168:169], v[42:43] op_sel:[0,0] op_sel_hi:[1,0]
    v_pk_mul_f32 v[234:235], v[234:235], v[170:171]
    v_pk_mul_f32 v[170:171], v[170:171], v[42:43] op_sel:[0,0] op_sel_hi:[1,0]
    v_pk_mul_f32 v[248:249], v[248:249], v[184:185]
    v_pk_mul_f32 v[184:185], v[184:185], v[42:43] op_sel:[0,0] op_sel_hi:[1,0]
    v_pk_mul_f32 v[250:251], v[250:251], v[186:187]
    v_pk_mul_f32 v[186:187], v[186:187], v[42:43] op_sel:[0,0] op_sel_hi:[1,0]
    v_exp_f32 v168, v168
    v_exp_f32 v169, v169
    v_mfma_f32_16x16x32_bf16 v[60:63], a[224:227], v[124:127], 0
    v_exp_f32 v170, v170
    v_mfma_f32_16x16x32_bf16 v[60:63], a[220:223], v[120:123], v[60:63]
    v_exp_f32 v171, v171
    v_mfma_f32_16x16x32_bf16 v[60:63], a[216:219], v[116:119], v[60:63]
    v_exp_f32 v184, v184
    v_exp_f32 v185, v185
    v_exp_f32 v186, v186
    v_exp_f32 v187, v187
    v_pk_fma_f32 v[168:169], v[168:169], v[46:47], v[46:47] op_sel:[0,0,0] op_sel_hi:[1,0,0]
    v_pk_fma_f32 v[170:171], v[170:171], v[46:47], v[46:47] op_sel:[0,0,0] op_sel_hi:[1,0,0]
    v_pk_fma_f32 v[184:185], v[184:185], v[46:47], v[46:47] op_sel:[0,0,0] op_sel_hi:[1,0,0]
    v_pk_fma_f32 v[186:187], v[186:187], v[46:47], v[46:47] op_sel:[0,0,0] op_sel_hi:[1,0,0]
    v_rcp_f32 v168, v168
    v_rcp_f32 v169, v169
    v_mfma_f32_16x16x32_bf16 v[60:63], a[212:215], v[112:115], v[60:63]
    v_rcp_f32 v170, v170
    v_rcp_f32 v171, v171
    v_rcp_f32 v184, v184
    v_rcp_f32 v185, v185
    v_rcp_f32 v186, v186
    v_rcp_f32 v187, v187
    v_pk_mul_f32 v[168:169], v[168:169], v[232:233]
    v_pk_mul_f32 v[170:171], v[170:171], v[234:235]
    v_pk_mul_f32 v[184:185], v[184:185], v[248:249]
    v_pk_mul_f32 v[186:187], v[186:187], v[250:251]
    v_cvt_pk_bf16_f32 v168, v168, v169
    v_cvt_pk_bf16_f32 v169, v170, v171
    v_cvt_pk_bf16_f32 v170, v184, v185
    v_cvt_pk_bf16_f32 v171, v186, v187
    buffer_store_dwordx4 v[168:171], v29, s[28:31], s64 offen sc1
    s_add_u32 s64, s64, 188416
    v_pk_mul_f32 v[204:205], v[204:205], v[140:141]
    v_pk_mul_f32 v[140:141], v[140:141], v[42:43] op_sel:[0,1] op_sel_hi:[1,1]
    v_pk_mul_f32 v[206:207], v[206:207], v[142:143]
    v_pk_mul_f32 v[142:143], v[142:143], v[42:43] op_sel:[0,1] op_sel_hi:[1,1]
    v_pk_mul_f32 v[220:221], v[220:221], v[156:157]
    v_pk_mul_f32 v[156:157], v[156:157], v[42:43] op_sel:[0,1] op_sel_hi:[1,1]
    v_pk_mul_f32 v[222:223], v[222:223], v[158:159]
    v_pk_mul_f32 v[158:159], v[158:159], v[42:43] op_sel:[0,1] op_sel_hi:[1,1]
    v_exp_f32 v140, v140
    v_exp_f32 v141, v141
    v_exp_f32 v142, v142
    v_exp_f32 v143, v143
    v_exp_f32 v156, v156
    v_exp_f32 v157, v157
    v_exp_f32 v158, v158
    v_exp_f32 v159, v159
    v_pk_fma_f32 v[140:141], v[140:141], v[46:47], v[46:47] op_sel:[0,1,1] op_sel_hi:[1,1,1]
    v_pk_fma_f32 v[142:143], v[142:143], v[46:47], v[46:47] op_sel:[0,1,1] op_sel_hi:[1,1,1]
    v_pk_fma_f32 v[156:157], v[156:157], v[46:47], v[46:47] op_sel:[0,1,1] op_sel_hi:[1,1,1]
    v_pk_fma_f32 v[158:159], v[158:159], v[46:47], v[46:47] op_sel:[0,1,1] op_sel_hi:[1,1,1]
    v_rcp_f32 v140, v140
    v_rcp_f32 v141, v141
    v_rcp_f32 v142, v142
    v_rcp_f32 v143, v143
    v_rcp_f32 v156, v156
    v_rcp_f32 v157, v157
    v_rcp_f32 v158, v158
    v_rcp_f32 v159, v159
    v_pk_mul_f32 v[140:141], v[140:141], v[204:205]
    v_pk_mul_f32 v[142:143], v[142:143], v[206:207]
    v_pk_mul_f32 v[156:157], v[156:157], v[220:221]
    v_pk_mul_f32 v[158:159], v[158:159], v[222:223]
    v_cvt_pk_bf16_f32 v140, v140, v141
    v_cvt_pk_bf16_f32 v141, v142, v143
    v_cvt_pk_bf16_f32 v142, v156, v157
    v_cvt_pk_bf16_f32 v143, v158, v159
    buffer_store_dwordx4 v[140:143], v28, s[28:31], s64 offen sc1
    v_pk_mul_f32 v[236:237], v[236:237], v[172:173]
    v_pk_mul_f32 v[172:173], v[172:173], v[42:43] op_sel:[0,1] op_sel_hi:[1,1]
    v_pk_mul_f32 v[238:239], v[238:239], v[174:175]
    v_pk_mul_f32 v[174:175], v[174:175], v[42:43] op_sel:[0,1] op_sel_hi:[1,1]
    v_pk_mul_f32 v[252:253], v[252:253], v[188:189]
    v_pk_mul_f32 v[188:189], v[188:189], v[42:43] op_sel:[0,1] op_sel_hi:[1,1]
    v_pk_mul_f32 v[254:255], v[254:255], v[190:191]
    v_pk_mul_f32 v[190:191], v[190:191], v[42:43] op_sel:[0,1] op_sel_hi:[1,1]
    v_exp_f32 v172, v172
    v_exp_f32 v173, v173
    v_exp_f32 v174, v174
    v_exp_f32 v175, v175
    v_exp_f32 v188, v188
    v_exp_f32 v189, v189
    v_exp_f32 v190, v190
    v_exp_f32 v191, v191
    v_pk_fma_f32 v[172:173], v[172:173], v[46:47], v[46:47] op_sel:[0,1,1] op_sel_hi:[1,1,1]
    v_pk_fma_f32 v[174:175], v[174:175], v[46:47], v[46:47] op_sel:[0,1,1] op_sel_hi:[1,1,1]
    v_pk_fma_f32 v[188:189], v[188:189], v[46:47], v[46:47] op_sel:[0,1,1] op_sel_hi:[1,1,1]
    v_pk_fma_f32 v[190:191], v[190:191], v[46:47], v[46:47] op_sel:[0,1,1] op_sel_hi:[1,1,1]
    v_rcp_f32 v172, v172
    v_rcp_f32 v173, v173
    v_rcp_f32 v174, v174
    v_rcp_f32 v175, v175
    v_rcp_f32 v188, v188
    v_rcp_f32 v189, v189
    v_rcp_f32 v190, v190
    v_rcp_f32 v191, v191
    v_pk_mul_f32 v[172:173], v[172:173], v[236:237]
    v_pk_mul_f32 v[174:175], v[174:175], v[238:239]
    v_pk_mul_f32 v[188:189], v[188:189], v[252:253]
    v_pk_mul_f32 v[190:191], v[190:191], v[254:255]
    v_cvt_pk_bf16_f32 v172, v172, v173
    v_cvt_pk_bf16_f32 v173, v174, v175
    v_cvt_pk_bf16_f32 v174, v188, v189
    v_cvt_pk_bf16_f32 v175, v190, v191
    buffer_store_dwordx4 v[172:175], v29, s[28:31], s64 offen sc1
    s_cmp_eq_u32 0, 0
    s_branch L_proj_join
L_code_end:
L_fallback:
    s_mov_b32 s70, 1
    s_waitcnt vmcnt(0) lgkmcnt(0)
    s_barrier
    s_branch L_restart
L_truemax:
    s_mov_b32 s62, s59
    s_mov_b32 s64, 16
    v_mov_b32 v48, 0xff800000
    v_mov_b32 v52, 0xff800000
    v_mov_b32 v56, 0xff800000
    v_mov_b32 v60, 0xff800000
    s_waitcnt vmcnt(0) lgkmcnt(0)
L_tm_loop:
    s_barrier
    s_add_u32 m0, s59, 0
    s_nop 0
    buffer_load_dwordx4 v14, s[20:23], s62 offen offset:0 lds
    buffer_load_dwordx4 v15, s[20:23], s62 offen offset:1024 lds
    buffer_load_dwordx4 v16, s[20:23], s62 offen offset:2048 lds
    buffer_load_dwordx4 v17, s[20:23], s62 offen offset:3072 lds
    s_add_u32 s62, s62, 4096
    s_add_u32 m0, s59, 4096
    s_nop 0
    buffer_load_dwordx4 v14, s[20:23], s62 offen offset:0 lds
    buffer_load_dwordx4 v15, s[20:23], s62 offen offset:1024 lds
    buffer_load_dwordx4 v16, s[20:23], s62 offen offset:2048 lds
    buffer_load_dwordx4 v17, s[20:23], s62 offen offset:3072 lds
    s_add_u32 s62, s62, 28672
    s_waitcnt vmcnt(0)
    s_barrier
    ds_read_b128 a[212:215], v2 offset:0
    ds_read_b128 a[216:219], v3 offset:0
    ds_read_b128 a[220:223], v4 offset:0
    ds_read_b128 a[224:227], v5 offset:0
    s_waitcnt lgkmcnt(0)
    v_mfma_f32_16x16x32_bf16 v[32:35], a[212:215], v[64:67], 0
    v_mfma_f32_16x16x32_bf16 v[32:35], a[216:219], v[68:71], v[32:35]
    v_mfma_f32_16x16x32_bf16 v[32:35], a[220:223], v[72:75], v[32:35]
    v_mfma_f32_16x16x32_bf16 v[32:35], a[224:227], v[76:79], v[32:35]
    v_mfma_f32_16x16x32_bf16 v[36:39], a[224:227], v[92:95], 0
    v_mfma_f32_16x16x32_bf16 v[36:39], a[220:223], v[88:91], v[36:39]
    v_mfma_f32_16x16x32_bf16 v[36:39], a[216:219], v[84:87], v[36:39]
    v_mfma_f32_16x16x32_bf16 v[36:39], a[212:215], v[80:83], v[36:39]
    v_mfma_f32_16x16x32_bf16 v[40:43], a[212:215], v[96:99], 0
    v_mfma_f32_16x16x32_bf16 v[40:43], a[216:219], v[100:103], v[40:43]
    v_mfma_f32_16x16x32_bf16 v[40:43], a[220:223], v[104:107], v[40:43]
    v_mfma_f32_16x16x32_bf16 v[40:43], a[224:227], v[108:111], v[40:43]
    v_mfma_f32_16x16x32_bf16 v[44:47], a[224:227], v[124:127], 0
    v_mfma_f32_16x16x32_bf16 v[44:47], a[220:223], v[120:123], v[44:47]
    v_mfma_f32_16x16x32_bf16 v[44:47], a[216:219], v[116:119], v[44:47]
    v_mfma_f32_16x16x32_bf16 v[44:47], a[212:215], v[112:115], v[44:47]
    v_max3_f32 v48, v48, v32, v33
    v_max3_f32 v48, v48, v34, v35
    v_max3_f32 v52, v52, v36, v37
    v_max3_f32 v52, v52, v38, v39
    v_max3_f32 v56, v56, v40, v41
    v_max3_f32 v56, v56, v42, v43
    s_nop 1
    v_max3_f32 v60, v60, v44, v45
    s_nop 0
    v_max3_f32 v60, v60, v46, v47
    ds_read_b128 a[212:215], v2 offset:4096
    ds_read_b128 a[216:219], v3 offset:4096
    ds_read_b128 a[220:223], v4 offset:4096
    ds_read_b128 a[224:227], v5 offset:4096
    s_waitcnt lgkmcnt(0)
    v_mfma_f32_16x16x32_bf16 v[32:35], a[212:215], v[64:67], 0
    v_mfma_f32_16x16x32_bf16 v[32:35], a[216:219], v[68:71], v[32:35]
    v_mfma_f32_16x16x32_bf16 v[32:35], a[220:223], v[72:75], v[32:35]
    v_mfma_f32_16x16x32_bf16 v[32:35], a[224:227], v[76:79], v[32:35]
    v_mfma_f32_16x16x32_bf16 v[36:39], a[224:227], v[92:95], 0
    v_mfma_f32_16x16x32_bf16 v[36:39], a[220:223], v[88:91], v[36:39]
    v_mfma_f32_16x16x32_bf16 v[36:39], a[216:219], v[84:87], v[36:39]
    v_mfma_f32_16x16x32_bf16 v[36:39], a[212:215], v[80:83], v[36:39]
    v_mfma_f32_16x16x32_bf16 v[40:43], a[212:215], v[96:99], 0
    v_mfma_f32_16x16x32_bf16 v[40:43], a[216:219], v[100:103], v[40:43]
    v_mfma_f32_16x16x32_bf16 v[40:43], a[220:223], v[104:107], v[40:43]
    v_mfma_f32_16x16x32_bf16 v[40:43], a[224:227], v[108:111], v[40:43]
    v_mfma_f32_16x16x32_bf16 v[44:47], a[224:227], v[124:127], 0
    v_mfma_f32_16x16x32_bf16 v[44:47], a[220:223], v[120:123], v[44:47]
    v_mfma_f32_16x16x32_bf16 v[44:47], a[216:219], v[116:119], v[44:47]
    v_mfma_f32_16x16x32_bf16 v[44:47], a[212:215], v[112:115], v[44:47]
    v_max3_f32 v48, v48, v32, v33
    v_max3_f32 v48, v48, v34, v35
    v_max3_f32 v52, v52, v36, v37
    v_max3_f32 v52, v52, v38, v39
    v_max3_f32 v56, v56, v40, v41
    v_max3_f32 v56, v56, v42, v43
    s_nop 1
    v_max3_f32 v60, v60, v44, v45
    s_nop 0
    v_max3_f32 v60, v60, v46, v47
    ds_read_b128 a[212:215], v2 offset:8192
    ds_read_b128 a[216:219], v3 offset:8192
    ds_read_b128 a[220:223], v4 offset:8192
    ds_read_b128 a[224:227], v5 offset:8192
    s_waitcnt lgkmcnt(0)
    v_mfma_f32_16x16x32_bf16 v[32:35], a[212:215], v[64:67], 0
    v_mfma_f32_16x16x32_bf16 v[32:35], a[216:219], v[68:71], v[32:35]
    v_mfma_f32_16x16x32_bf16 v[32:35], a[220:223], v[72:75], v[32:35]
    v_mfma_f32_16x16x32_bf16 v[32:35], a[224:227], v[76:79], v[32:35]
    v_mfma_f32_16x16x32_bf16 v[36:39], a[224:227], v[92:95], 0
    v_mfma_f32_16x16x32_bf16 v[36:39], a[220:223], v[88:91], v[36:39]
    v_mfma_f32_16x16x32_bf16 v[36:39], a[216:219], v[84:87], v[36:39]
    v_mfma_f32_16x16x32_bf16 v[36:39], a[212:215], v[80:83], v[36:39]
    v_mfma_f32_16x16x32_bf16 v[40:43], a[212:215], v[96:99], 0
    v_mfma_f32_16x16x32_bf16 v[40:43], a[216:219], v[100:103], v[40:43]
    v_mfma_f32_16x16x32_bf16 v[40:43], a[220:223], v[104:107], v[40:43]
    v_mfma_f32_16x16x32_bf16 v[40:43], a[224:227], v[108:111], v[40:43]
    v_mfma_f32_16x16x32_bf16 v[44:47], a[224:227], v[124:127], 0
    v_mfma_f32_16x16x32_bf16 v[44:47], a[220:223], v[120:123], v[44:47]
    v_mfma_f32_16x16x32_bf16 v[44:47], a[216:219], v[116:119], v[44:47]
    v_mfma_f32_16x16x32_bf16 v[44:47], a[212:215], v[112:115], v[44:47]
    v_max3_f32 v48, v48, v32, v33
    v_max3_f32 v48, v48, v34, v35
    v_max3_f32 v52, v52, v36, v37
    v_max3_f32 v52, v52, v38, v39
    v_max3_f32 v56, v56, v40, v41
    v_max3_f32 v56, v56, v42, v43
    s_nop 1
    v_max3_f32 v60, v60, v44, v45
    s_nop 0
    v_max3_f32 v60, v60, v46, v47
    ds_read_b128 a[212:215], v2 offset:12288
    ds_read_b128 a[216:219], v3 offset:12288
    ds_read_b128 a[220:223], v4 offset:12288
    ds_read_b128 a[224:227], v5 offset:12288
    s_waitcnt lgkmcnt(0)
    v_mfma_f32_16x16x32_bf16 v[32:35], a[212:215], v[64:67], 0
    v_mfma_f32_16x16x32_bf16 v[32:35], a[216:219], v[68:71], v[32:35]
    v_mfma_f32_16x16x32_bf16 v[32:35], a[220:223], v[72:75], v[32:35]
    v_mfma_f32_16x16x32_bf16 v[32:35], a[224:227], v[76:79], v[32:35]
    v_mfma_f32_16x16x32_bf16 v[36:39], a[224:227], v[92:95], 0
    v_mfma_f32_16x16x32_bf16 v[36:39], a[220:223], v[88:91], v[36:39]
    v_mfma_f32_16x16x32_bf16 v[36:39], a[216:219], v[84:87], v[36:39]
    v_mfma_f32_16x16x32_bf16 v[36:39], a[212:215], v[80:83], v[36:39]
    v_mfma_f32_16x16x32_bf16 v[40:43], a[212:215], v[96:99], 0
    v_mfma_f32_16x16x32_bf16 v[40:43], a[216:219], v[100:103], v[40:43]
    v_mfma_f32_16x16x32_bf16 v[40:43], a[220:223], v[104:107], v[40:43]
    v_mfma_f32_16x16x32_bf16 v[40:43], a[224:227], v[108:111], v[40:43]
    v_mfma_f32_16x16x32_bf16 v[44:47], a[224:227], v[124:127], 0
    v_mfma_f32_16x16x32_bf16 v[44:47], a[220:223], v[120:123], v[44:47]
    v_mfma_f32_16x16x32_bf16 v[44:47], a[216:219], v[116:119], v[44:47]
    v_mfma_f32_16x16x32_bf16 v[44:47], a[212:215], v[112:115], v[44:47]
    v_max3_f32 v48, v48, v32, v33
    v_max3_f32 v48, v48, v34, v35
    v_max3_f32 v52, v52, v36, v37
    v_max3_f32 v52, v52, v38, v39
    v_max3_f32 v56, v56, v40, v41
    v_max3_f32 v56, v56, v42, v43
    s_nop 1
    v_max3_f32 v60, v60, v44, v45
    s_nop 0
    v_max3_f32 v60, v60, v46, v47
    ds_read_b128 a[212:215], v2 offset:16384
    ds_read_b128 a[216:219], v3 offset:16384
    ds_read_b128 a[220:223], v4 offset:16384
    ds_read_b128 a[224:227], v5 offset:16384
    s_waitcnt lgkmcnt(0)
    v_mfma_f32_16x16x32_bf16 v[32:35], a[212:215], v[64:67], 0
    v_mfma_f32_16x16x32_bf16 v[32:35], a[216:219], v[68:71], v[32:35]
    v_mfma_f32_16x16x32_bf16 v[32:35], a[220:223], v[72:75], v[32:35]
    v_mfma_f32_16x16x32_bf16 v[32:35], a[224:227], v[76:79], v[32:35]
    v_mfma_f32_16x16x32_bf16 v[36:39], a[224:227], v[92:95], 0
    v_mfma_f32_16x16x32_bf16 v[36:39], a[220:223], v[88:91], v[36:39]
    v_mfma_f32_16x16x32_bf16 v[36:39], a[216:219], v[84:87], v[36:39]
    v_mfma_f32_16x16x32_bf16 v[36:39], a[212:215], v[80:83], v[36:39]
    v_mfma_f32_16x16x32_bf16 v[40:43], a[212:215], v[96:99], 0
    v_mfma_f32_16x16x32_bf16 v[40:43], a[216:219], v[100:103], v[40:43]
    v_mfma_f32_16x16x32_bf16 v[40:43], a[220:223], v[104:107], v[40:43]
    v_mfma_f32_16x16x32_bf16 v[40:43], a[224:227], v[108:111], v[40:43]
    v_mfma_f32_16x16x32_bf16 v[44:47], a[224:227], v[124:127], 0
    v_mfma_f32_16x16x32_bf16 v[44:47], a[220:223], v[120:123], v[44:47]
    v_mfma_f32_16x16x32_bf16 v[44:47], a[216:219], v[116:119], v[44:47]
    v_mfma_f32_16x16x32_bf16 v[44:47], a[212:215], v[112:115], v[44:47]
    v_max3_f32 v48, v48, v32, v33
    v_max3_f32 v48, v48, v34, v35
    v_max3_f32 v52, v52, v36, v37
    v_max3_f32 v52, v52, v38, v39
    v_max3_f32 v56, v56, v40, v41
    v_max3_f32 v56, v56, v42, v43
    s_nop 1
    v_max3_f32 v60, v60, v44, v45
    s_nop 0
    v_max3_f32 v60, v60, v46, v47
    ds_read_b128 a[212:215], v2 offset:20480
    ds_read_b128 a[216:219], v3 offset:20480
    ds_read_b128 a[220:223], v4 offset:20480
    ds_read_b128 a[224:227], v5 offset:20480
    s_waitcnt lgkmcnt(0)
    v_mfma_f32_16x16x32_bf16 v[32:35], a[212:215], v[64:67], 0
    v_mfma_f32_16x16x32_bf16 v[32:35], a[216:219], v[68:71], v[32:35]
    v_mfma_f32_16x16x32_bf16 v[32:35], a[220:223], v[72:75], v[32:35]
    v_mfma_f32_16x16x32_bf16 v[32:35], a[224:227], v[76:79], v[32:35]
    v_mfma_f32_16x16x32_bf16 v[36:39], a[224:227], v[92:95], 0
    v_mfma_f32_16x16x32_bf16 v[36:39], a[220:223], v[88:91], v[36:39]
    v_mfma_f32_16x16x32_bf16 v[36:39], a[216:219], v[84:87], v[36:39]
    v_mfma_f32_16x16x32_bf16 v[36:39], a[212:215], v[80:83], v[36:39]
    v_mfma_f32_16x16x32_bf16 v[40:43], a[212:215], v[96:99], 0
    v_mfma_f32_16x16x32_bf16 v[40:43], a[216:219], v[100:103], v[40:43]
    v_mfma_f32_16x16x32_bf16 v[40:43], a[220:223], v[104:107], v[40:43]
    v_mfma_f32_16x16x32_bf16 v[40:43], a[224:227], v[108:111], v[40:43]
    v_mfma_f32_16x16x32_bf16 v[44:47], a[224:227], v[124:127], 0
    v_mfma_f32_16x16x32_bf16 v[44:47], a[220:223], v[120:123], v[44:47]
    v_mfma_f32_16x16x32_bf16 v[44:47], a[216:219], v[116:119], v[44:47]
    v_mfma_f32_16x16x32_bf16 v[44:47], a[212:215], v[112:115], v[44:47]
    v_max3_f32 v48, v48, v32, v33
    v_max3_f32 v48, v48, v34, v35
    v_max3_f32 v52, v52, v36, v37
    v_max3_f32 v52, v52, v38, v39
    v_max3_f32 v56, v56, v40, v41
    v_max3_f32 v56, v56, v42, v43
    s_nop 1
    v_max3_f32 v60, v60, v44, v45
    s_nop 0
    v_max3_f32 v60, v60, v46, v47
    ds_read_b128 a[212:215], v2 offset:24576
    ds_read_b128 a[216:219], v3 offset:24576
    ds_read_b128 a[220:223], v4 offset:24576
    ds_read_b128 a[224:227], v5 offset:24576
    s_waitcnt lgkmcnt(0)
    v_mfma_f32_16x16x32_bf16 v[32:35], a[212:215], v[64:67], 0
    v_mfma_f32_16x16x32_bf16 v[32:35], a[216:219], v[68:71], v[32:35]
    v_mfma_f32_16x16x32_bf16 v[32:35], a[220:223], v[72:75], v[32:35]
    v_mfma_f32_16x16x32_bf16 v[32:35], a[224:227], v[76:79], v[32:35]
    v_mfma_f32_16x16x32_bf16 v[36:39], a[224:227], v[92:95], 0
    v_mfma_f32_16x16x32_bf16 v[36:39], a[220:223], v[88:91], v[36:39]
    v_mfma_f32_16x16x32_bf16 v[36:39], a[216:219], v[84:87], v[36:39]
    v_mfma_f32_16x16x32_bf16 v[36:39], a[212:215], v[80:83], v[36:39]
    v_mfma_f32_16x16x32_bf16 v[40:43], a[212:215], v[96:99], 0
    v_mfma_f32_16x16x32_bf16 v[40:43], a[216:219], v[100:103], v[40:43]
    v_mfma_f32_16x16x32_bf16 v[40:43], a[220:223], v[104:107], v[40:43]
    v_mfma_f32_16x16x32_bf16 v[40:43], a[224:227], v[108:111], v[40:43]
    v_mfma_f32_16x16x32_bf16 v[44:47], a[224:227], v[124:127], 0
    v_mfma_f32_16x16x32_bf16 v[44:47], a[220:223], v[120:123], v[44:47]
    v_mfma_f32_16x16x32_bf16 v[44:47], a[216:219], v[116:119], v[44:47]
    v_mfma_f32_16x16x32_bf16 v[44:47], a[212:215], v[112:115], v[44:47]
    v_max3_f32 v48, v48, v32, v33
    v_max3_f32 v48, v48, v34, v35
    v_max3_f32 v52, v52, v36, v37
    v_max3_f32 v52, v52, v38, v39
    v_max3_f32 v56, v56, v40, v41
    v_max3_f32 v56, v56, v42, v43
    s_nop 1
    v_max3_f32 v60, v60, v44, v45
    s_nop 0
    v_max3_f32 v60, v60, v46, v47
    ds_read_b128 a[212:215], v2 offset:28672
    ds_read_b128 a[216:219], v3 offset:28672
    ds_read_b128 a[220:223], v4 offset:28672
    ds_read_b128 a[224:227], v5 offset:28672
    s_waitcnt lgkmcnt(0)
    v_mfma_f32_16x16x32_bf16 v[32:35], a[212:215], v[64:67], 0
    v_mfma_f32_16x16x32_bf16 v[32:35], a[216:219], v[68:71], v[32:35]
    v_mfma_f32_16x16x32_bf16 v[32:35], a[220:223], v[72:75], v[32:35]
    v_mfma_f32_16x16x32_bf16 v[32:35], a[224:227], v[76:79], v[32:35]
    v_mfma_f32_16x16x32_bf16 v[36:39], a[224:227], v[92:95], 0
    v_mfma_f32_16x16x32_bf16 v[36:39], a[220:223], v[88:91], v[36:39]
    v_mfma_f32_16x16x32_bf16 v[36:39], a[216:219], v[84:87], v[36:39]
    v_mfma_f32_16x16x32_bf16 v[36:39], a[212:215], v[80:83], v[36:39]
    v_mfma_f32_16x16x32_bf16 v[40:43], a[212:215], v[96:99], 0
    v_mfma_f32_16x16x32_bf16 v[40:43], a[216:219], v[100:103], v[40:43]
    v_mfma_f32_16x16x32_bf16 v[40:43], a[220:223], v[104:107], v[40:43]
    v_mfma_f32_16x16x32_bf16 v[40:43], a[224:227], v[108:111], v[40:43]
    v_mfma_f32_16x16x32_bf16 v[44:47], a[224:227], v[124:127], 0
    v_mfma_f32_16x16x32_bf16 v[44:47], a[220:223], v[120:123], v[44:47]
    v_mfma_f32_16x16x32_bf16 v[44:47], a[216:219], v[116:119], v[44:47]
    v_mfma_f32_16x16x32_bf16 v[44:47], a[212:215], v[112:115], v[44:47]
    v_max3_f32 v48, v48, v32, v33
    v_max3_f32 v48, v48, v34, v35
    v_max3_f32 v52, v52, v36, v37
    v_max3_f32 v52, v52, v38, v39
    v_max3_f32 v56, v56, v40, v41
    v_max3_f32 v56, v56, v42, v43
    s_nop 1
    v_max3_f32 v60, v60, v44, v45
    s_nop 0
    v_max3_f32 v60, v60, v46, v47
    s_sub_u32 s64, s64, 1
    s_cmp_lg_u32 s64, 0
    s_cbranch_scc1 L_tm_loop
    v_mov_b32 v24, v48
    v_mov_b32 v25, v52
    v_mov_b32 v26, v56
    v_mov_b32 v27, v60
    v_permlane32_swap_b32 v24, v48
    v_permlane32_swap_b32 v25, v52
    v_permlane32_swap_b32 v26, v56
    v_permlane32_swap_b32 v27, v60
    v_max_f32 v48, v48, v24
    v_max_f32 v52, v52, v25
    v_max_f32 v56, v56, v26
    v_max_f32 v60, v60, v27
    v_mov_b32 v24, v48
    v_mov_b32 v25, v52
    v_mov_b32 v26, v56
    v_mov_b32 v27, v60
    v_permlane16_swap_b32 v24, v48
    v_permlane16_swap_b32 v25, v52
    v_permlane16_swap_b32 v26, v56
    v_permlane16_swap_b32 v27, v60
    v_max_f32 v24, v48, v24
    v_max_f32 v25, v52, v25
    v_max_f32 v26, v56, v26
    v_max_f32 v27, v60, v27
    v_sub_f32 v48, 0, v24
    v_sub_f32 v49, 0, v24
    v_sub_f32 v50, 0, v24
    v_sub_f32 v51, 0, v24
    v_sub_f32 v52, 0, v25
    v_sub_f32 v53, 0, v25
    v_sub_f32 v54, 0, v25
    v_sub_f32 v55, 0, v25
    v_sub_f32 v56, 0, v26
    v_sub_f32 v57, 0, v26
    v_sub_f32 v58, 0, v26
    v_sub_f32 v59, 0, v26
    v_sub_f32 v60, 0, v27
    v_sub_f32 v61, 0, v27
    v_sub_f32 v62, 0, v27
    v_sub_f32 v63, 0, v27
    s_mov_b32 s62, s59
    s_barrier
    s_add_u32 m0, s59, 0
    s_nop 0
    buffer_load_dwordx4 v14, s[20:23], s62 offen offset:0 lds
    buffer_load_dwordx4 v15, s[20:23], s62 offen offset:1024 lds
    buffer_load_dwordx4 v16, s[20:23], s62 offen offset:2048 lds
    buffer_load_dwordx4 v17, s[20:23], s62 offen offset:3072 lds
    s_add_u32 s62, s62, 4096
    s_add_u32 m0, s59, 4096
    s_nop 0
    buffer_load_dwordx4 v14, s[20:23], s62 offen offset:0 lds
    buffer_load_dwordx4 v15, s[20:23], s62 offen offset:1024 lds
    buffer_load_dwordx4 v16, s[20:23], s62 offen offset:2048 lds
    buffer_load_dwordx4 v17, s[20:23], s62 offen offset:3072 lds
    s_add_u32 s62, s62, 28672
    s_add_u32 s62, s62, 32768
    s_waitcnt vmcnt(0)
    s_barrier
    ds_read_b128 a[212:215], v2 offset:0
    ds_read_b128 a[216:219], v3 offset:0
    ds_read_b128 a[220:223], v4 offset:0
    ds_read_b128 a[224:227], v5 offset:0
    s_waitcnt lgkmcnt(0)
    s_branch L_att_start
.section .rodata,"a"
.p2align 6
.amdhsa_kernel recurrent_scan__mha_block_cached__glu_gated_swiglu__prompt_kernel
  .amdhsa_next_free_vgpr 512
  .amdhsa_next_free_sgpr 102
  .amdhsa_accum_offset 256
  .amdhsa_group_segment_fixed_size 0
  .amdhsa_kernarg_size 96
  .amdhsa_user_sgpr_count 2
  .amdhsa_user_sgpr_kernarg_segment_ptr 1
  .amdhsa_system_sgpr_workgroup_id_x 1
  .amdhsa_float_denorm_mode_32 3
.end_amdhsa_kernel
```
